```python
import torch

def _softmax(x, axis=-1):
    return torch.softmax(x, dim=axis)

def _gelu(x):
    return torch.nn.functional.gelu(x, approximate='tanh')

def _silu(x):
    return torch.nn.functional.silu(x)

def _sigmoid(x):
    return torch.sigmoid(x)

def _layernorm(x, axis=-1, eps=1e-05):
    m = x.mean(dim=axis, keepdim=True)
    v = x.var(dim=axis, keepdim=True, unbiased=False)
    return (x - m) / torch.sqrt(v + eps)

def _scatter_add(tgt, idx, src, axis=0):
    return tgt.clone().index_add_(axis, idx, src)

def _segment_sum(src, seg, n):
    out = torch.zeros((n,) + src.shape[1:], dtype=src.dtype)
    return out.index_add_(0, seg, src)

def _pad(x, pw):
    flat = tuple((v for pair in reversed(pw) for v in pair))
    return torch.nn.functional.pad(x, flat)
kernel_name = 'concat_heads__softmax_full_mha__memory_aug_recurrent_mem_tr__prompt'

def setup_inputs():

    _w = lambda a: (lambda t: t.to(torch.bfloat16) if t.is_floating_point() else t)(torch.as_tensor(a))

    def _A_setup():
        B, S, D = (1, 2048, 1024)
        return {'x': _w((lambda *s: torch.randn(*s, dtype=torch.bfloat16) * 0.2)(B, S, D)), 'wqkv': _w((lambda *s: torch.randn(*s, dtype=torch.bfloat16) * 0.2)(D, 3 * D)), 'wo': _w((lambda *s: torch.randn(*s, dtype=torch.bfloat16) * 0.05)(D, D))}
    _A_in = _A_setup()

    def _B_setup():
        B, S, Dm = (1, 2048, 1024)
        H, Dh = (32, 128)
        M, seg = (8, 32)
        seg = min(seg, S)
        S = S // seg * seg
        return {'x': _w((lambda *s: torch.randn(*s, dtype=torch.bfloat16) * 0.05)(B, S, Dm)), 'mem0': _w((lambda *s: torch.randn(*s, dtype=torch.bfloat16) * 1.6)(B, M, Dm)), 'Wq': _w((lambda *s: torch.randn(*s, dtype=torch.bfloat16) * 0.8)(Dm, H, Dh) * Dm ** (-0.5)), 'Wk': _w((lambda *s: torch.randn(*s, dtype=torch.bfloat16) * 0.8)(Dm, H, Dh) * Dm ** (-0.5)), 'Wv': _w((lambda *s: torch.randn(*s, dtype=torch.bfloat16) * 1.6)(Dm, H, Dh) * Dm ** (-0.5)), 'Wo': _w((lambda *s: torch.randn(*s, dtype=torch.bfloat16) * 1.6)(H, Dh, Dm) * (H * Dh) ** (-0.5)), 'seg_len': seg}
    _B_in = _B_setup()
    return {'A_x': _A_in['x'], 'A_wqkv': _A_in['wqkv'], 'A_wo': _A_in['wo'], 'B_x': _B_in['x'], 'B_mem0': _B_in['mem0'], 'B_Wq': _B_in['Wq'], 'B_Wk': _B_in['Wk'], 'B_Wv': _B_in['Wv'], 'B_Wo': _B_in['Wo'], 'B_seg_len': _B_in['seg_len']}

def reference(A_x, A_wqkv, A_wo, B_x, B_mem0, B_Wq, B_Wk, B_Wv, B_Wo, B_seg_len):

    def _A_ref(x, wqkv, wo):
        B, S, D = x.shape
        H = 32
        Dh = D // H
        qkv = (lambda x, *d: x.permute(*d))((x @ wqkv).reshape(B, S, 3, H, Dh), 2, 0, 3, 1, 4)
        q, k, v = (qkv[0], qkv[1], qkv[2])
        scale = Dh ** (-0.5)
        scores = torch.einsum('bhqd,bhkd->bhqk', q, k) * scale
        p = _softmax(scores, axis=-1)
        o = torch.einsum('bhqk,bhkd->bhqd', p, v)
        return (lambda x, *d: x.permute(*d))(o, 0, 2, 1, 3).reshape(B, S, D) @ wo

    def _B_ref(x, mem0, Wq, Wk, Wv, Wo, seg_len):
        B, S, Dm = x.shape
        H, Dh = (Wq.shape[1], Wq.shape[2])
        M = mem0.shape[1]
        scale = Dh ** (-0.5)
        n_seg = S // seg_len
        L = M + seg_len
        idx = torch.arange(L)
        mask = (idx[:, None] < M) | (idx[:, None] >= idx[None, :])
        mem = mem0
        outs = []
        for s in range(n_seg):
            xs = x[:, s * seg_len:(s + 1) * seg_len, :].clone()
            h = torch.concatenate([mem, xs], axis=1)
            q = torch.einsum('btd,dhe->bhte', h, Wq)
            k = torch.einsum('btd,dhe->bhte', h, Wk)
            v = torch.einsum('btd,dhe->bhte', h, Wv)
            scores = torch.einsum('bhqe,bhke->bhqk', q, k) * scale
            scores = torch.where(mask[None, None], scores, -1000000000.0)
            p = _softmax(scores, axis=-1)
            o = torch.einsum('bhqk,bhke->bhqe', p, v)
            o = torch.einsum('bhte,hed->btd', o, Wo)
            mem = o[:, :M, :].clone()
            outs.append(o[:, M:, :])
        return torch.concatenate(outs, axis=1)
    a = _A_ref(A_x, A_wqkv, A_wo)
    b = _B_ref(B_x, B_mem0, B_Wq, B_Wk, B_Wv, B_Wo, B_seg_len)
    return torch.concatenate([a, b], axis=-1)
```

```asm
; @launch grid=(256,1,1) block=(256,1,1) lds=163840
.amdgcn_target "amdgcn-amd-amdhsa--gfx950"
.macro za p0,p1,p2,p3
v_mfma_f32_16x16x32_bf16 a[\p0:\p0+3], v[\p1:\p1+3], v[\p2:\p2+3], a[\p3:\p3+3]
.endm
.macro zb p0,p1
v_accvgpr_read_b32 v[\p0], a[\p1]
.endm
.macro zc p0,p1,p2
ds_read_b64_tr_b16 v[\p0:\p0+1], v[\p1] offset:\p2
.endm
.macro zd p0,p1,p2
v_cvt_pk_bf16_f32 v[\p0], v[\p1], v[\p2]
.endm
.macro ze p0,p1,p2,p3
v_mfma_f32_32x32x16_bf16 a[\p0:\p0+15], v[\p1:\p1+3], v[\p2:\p2+3], a[\p3:\p3+15]
.endm
.macro zf p0,p1
s_add_u32 m0, s[\p0], \p1
.endm
.macro zg p0,p1,p2
ds_read_b128 v[\p0:\p0+3], v[\p1] offset:\p2
.endm
.macro zh p0
v_mov_b32 v[\p0], 0
.endm
.macro zi p0,p1,p2
s_add_u32 s[\p0], s[\p1], s[\p2]
.endm
.macro zj p0,p1
v_exp_f32 v[\p0], v[\p1]
.endm
.macro zk p0,p1
buffer_load_dwordx4 v[\p0], s[24:27], s[\p1] offen lds
.endm
.macro zl p0,p1
buffer_load_dwordx4 v[\p0], s[20:23], s[\p1] offen lds
.endm
.macro zm p0,p1,p2
v_add_f32 v[\p0], v[\p1], v[\p2]
.endm
.macro zn p0,p1
v_pk_mul_f32 v[\p0:\p0+1], v[\p1:\p1+1], s[40:41] op_sel:[0,1] op_sel_hi:[1,1]
.endm
.macro zo p0,p1,p2,p3
v_smfmac_f32_16x16x64_bf16 v[\p0:\p0+3], v[\p1:\p1+3], a[\p2:\p2+7], v[\p3]
.endm
.macro zp p0,p1,p2,p3
buffer_load_dwordx4 v[\p0:\p0+3], v[\p1], s[4:7], s[\p2] offen offset:\p3
.endm
.macro zq p0,p1
v_mov_b32 v[\p0], v[\p1]
.endm
.macro zr p0,p1,p2,p3
buffer_load_dwordx4 v[\p0:\p0+3], v[\p1], s[4:7], s[\p2] offen offset:\p3 sc1
.endm
.macro zs p0,p1,p2
s_add_u32 s[\p0], s[\p1], \p2
.endm
.macro zt p0
v_accvgpr_write_b32 a[\p0], 0
.endm
.macro zu p0,p1
v_permlane16_swap_b32 v[\p0], v[\p1]
.endm
.macro zv p0,p1,p2,p3
v_mfma_f32_16x16x32_bf16 v[\p0:\p0+3], v[\p1:\p1+3], v[\p2:\p2+3], v[\p3:\p3+3]
.endm
.macro zw p0,p1,p2,p3
v_max3_f32 v[\p0], v[\p1], v[\p2], v[\p3]
.endm
.macro zx p0,p1,p2
ds_read_b64_tr_b16 a[\p0:\p0+1], v[\p1] offset:\p2
.endm
.macro zy p0,p1,p2
v_mfma_f32_16x16x32_bf16 a[\p0:\p0+3], v[\p1:\p1+3], v[\p2:\p2+3], 0
.endm
.macro zz p0,p1,p2,p3
buffer_store_dwordx4 v[\p0:\p0+3], v[\p1], s[56:59], s[\p2] offen offset:\p3 sc1
.endm
.macro zaa p0,p1,p2
v_pk_mul_f32 v[\p0:\p0+1], v[\p1:\p1+1], v[\p2:\p2+1] op_sel_hi:[1,0]
.endm
.macro zab p0,p1,p2
v_mfma_f32_16x16x32_bf16 v[\p0:\p0+3], v[\p1:\p1+3], v[\p2:\p2+3], 0
.endm
.macro zac p0,p1
s_add_u32 s[\p0], s[\p1], 1
.endm
.macro zad p0,p1,p2
v_pk_add_f32 v[\p0:\p0+1], v[\p1:\p1+1], v[\p2:\p2+1] op_sel_hi:[1,0] neg_lo:[0,1] neg_hi:[0,1]
.endm
.macro zae p0,p1,p2,p3
v_mfma_f32_16x16x16_bf16 v[\p0:\p0+3], v[\p1:\p1+1], v[\p2:\p2+1], v[\p3:\p3+3]
.endm
.macro zaf p0,p1,p2,p3
buffer_load_dwordx2 v[\p0:\p0+1], v[\p1], s[4:7], s[\p2] offen offset:\p3 sc1
.endm
.macro zag p0,p1,p2,p3
v_max3_u32 v[\p0], v[\p1], v[\p2], v[\p3]
.endm
.macro zah p0,p1,p2
v_pk_add_f32 v[\p0:\p0+1], v[\p1:\p1+1], v[\p2:\p2+1]
.endm
.macro zai p0,p1
v_permlane32_swap_b32 v[\p0], v[\p1]
.endm
.macro zaj p0,p1,p2,p3
buffer_load_dwordx4 a[\p0:\p0+3], v[\p1], s[4:7], s[\p2] offen offset:\p3
.endm
.macro zak p0,p1
v_mov_b32 v[\p0], s[\p1]
.endm
.macro zal p0,p1,p2,p3
v_mfma_f32_32x32x16_bf16 v[\p0:\p0+15], a[\p1:\p1+3], a[\p2:\p2+3], v[\p3:\p3+15]
.endm
.macro zam p0,p1,p2,p3
buffer_store_dwordx4 v[\p0:\p0+3], v[\p1], s[4:7], s[\p2] offen offset:\p3 sc1
.endm
.macro zan p0,p1,p2,p3
v_mfma_f32_16x16x32_bf16 v[\p0:\p0+3], a[\p1:\p1+3], a[\p2:\p2+3], v[\p3:\p3+3]
.endm
.macro zao p0,p1,p2,p3
v_mfma_f32_32x32x16_bf16 a[\p0:\p0+15], a[\p1:\p1+3], v[\p2:\p2+3], a[\p3:\p3+15]
.endm
.macro zap p0,p1,p2,p3
buffer_store_dwordx2 v[\p0:\p0+1], v[\p1], s[4:7], s[\p2] offen offset:\p3 sc1
.endm
.macro zaq p0,p1
buffer_load_dwordx4 v[\p0], s[44:47], s[\p1] offen nt lds
.endm
.macro zar p0,p1
buffer_load_dwordx4 v[\p0], s[44:47], s[\p1] offen lds
.endm
.macro zas p0,p1,p2,p3
buffer_store_dwordx4 v[\p0:\p0+3], v[\p1], s[28:31], s[\p2] offen offset:\p3
.endm
.macro zat p0,p1,p2
v_mfma_f32_16x16x32_bf16 v[\p0:\p0+3], a[\p1:\p1+3], v[\p2:\p2+3], 0
.endm
.macro zau p0,p1,p2,p3
v_mfma_f32_16x16x16_bf16 v[\p0:\p0+3], a[\p1:\p1+1], v[\p2:\p2+1], v[\p3:\p3+3]
.endm
.macro zav p0,p1
s_add_u32 s[\p0], s[\p1], 2
.endm
.macro zaw p0,p1,p2
v_mfma_f32_32x32x16_bf16 a[\p0:\p0+15], v[\p1:\p1+3], v[\p2:\p2+3], 0
.endm
.macro zax p0,p1
v_mov_b32 v[\p0], \p1
.endm
.macro zay p0
s_add_u32 m0, s[\p0], 0
.endm
.macro zaz p0,p1
s_add_u32 s[\p0], s[\p1], 0
.endm
.macro zba p0,p1
v_mov_b32_dpp v[\p0], v[\p1] row_ror:8 row_mask:0xf bank_mask:0xc
.endm
.macro zbb p0,p1,p2,p3
buffer_load_dwordx4 a[\p0:\p0+3], v[\p1], s[24:27], s[\p2] offen offset:\p3
.endm
.macro zbc p0,p1,p2,p3
buffer_load_dwordx4 a[\p0:\p0+3], v[\p1], s[28:31], s[\p2] offen offset:\p3
.endm
.macro zbd p0,p1,p2,p3
v_smfmac_f32_16x16x64_bf16 a[\p0:\p0+3], a[\p1:\p1+3], v[\p2:\p2+7], v[\p3]
.endm
.macro zbe p0,p1,p2
buffer_load_dword v[\p0], v[\p1], s[44:47], 0 offen offset:\p2
.endm
.macro zbf p0,p1,p2
ds_write2_b32 v[\p0], v[\p1], v[\p2] offset0:0 offset1:40
.endm
.macro zbg p0,p1,p2
ds_write2_b32 v[\p0], v[\p1], v[\p2] offset0:16 offset1:56
.endm
.macro zbh p0,p1,p2
ds_write_b64 v[\p0], v[\p1:\p1+1] offset:\p2
.endm
.macro zbi p0,p1,p2,p3
buffer_store_dwordx4 v[\p0:\p0+3], v[\p1], s[28:31], s[\p2] offen offset:\p3 sc1
.endm
.macro zbj p0,p1,p2,p3
buffer_load_dword v[\p0], v[\p1], s[52:55], s[\p2] offen offset:\p3
.endm
.macro zbk p0,p1,p2,p3
buffer_store_dwordx4 a[\p0:\p0+3], v[\p1], s[4:7], s[\p2] offen offset:\p3 sc1
.endm
.macro zbl p0,p1,p2
buffer_store_dword v[\p0], v[\p1], s[4:7], 0 offen offset:\p2 sc1
.endm
.macro zbm p0,p1,p2,p3
buffer_load_dword v[\p0], v[\p1], s[4:7], s[\p2] offen offset:\p3 sc1
.endm
.macro zbn p0,p1,p2,p3
buffer_load_dwordx2 v[\p0:\p0+1], v[\p1], s[4:7], s[\p2] offen offset:\p3
.endm
.text
.globl concat_heads__softmax_full_mha__memory_aug_recurrent_mem_tr__prompt_kernel
.p2align 8
.type concat_heads__softmax_full_mha__memory_aug_recurrent_mem_tr__prompt_kernel,@function
concat_heads__softmax_full_mha__memory_aug_recurrent_mem_tr__prompt_kernel:
s_cmp_ge_u32 s2, 256
s_cbranch_scc1 early_exit
s_load_dwordx2 s[4:5], s[0:1], 96
s_load_dwordx2 s[8:9], s[0:1], 88
s_mov_b32 s6, 268435456
s_mov_b32 s7, 0x20000
s_mov_b32 s10, 256
s_mov_b32 s11, 0x20000
v_lshrrev_b32 v1, 6, v0
s_nop 0
v_readfirstlane_b32 s3, v1
s_waitcnt lgkmcnt(0)
s_branch entry_go
early_exit:
s_endpgm
entry_go:
s_getreg_b32 s16, hwreg(HW_REG_XCC_ID, 0, 3)
s_mov_b32 s12, 0
s_mov_b32 s13, 0
zax 8,163808
s_cmp_eq_u32 s3, 0
s_cbranch_scc0 en_1_n0
s_mov_b64 exec, 1
s_lshl_b32 s20, s16, 4
zak 2,20
v_mov_b32 v4, 1
buffer_atomic_add v4, v2, s[8:11], 0 offen sc0
v_mov_b32 v3, 1
zh 2
s_waitcnt vmcnt(0)
v_readfirstlane_b32 s21, v4
ds_write_b32 v8, v4
s_cmp_eq_u32 s21, 31
s_cbranch_scc0 en_1_a
buffer_atomic_add v3, v2, s[8:11], 0 offen offset:128
en_1_a:
s_cmp_ge_u32 s21, 32
s_cbranch_scc0 en_1_b
buffer_atomic_or v3, v2, s[8:11], 0 offen offset:132
en_1_b:
s_waitcnt lgkmcnt(0)
s_mov_b64 exec, -1
s_branch en_1_j
en_1_n0:
s_cmp_eq_u32 s3, 1
s_cbranch_scc0 en_1_n1
s_cmp_ge_u32 s2, 8
s_cbranch_scc1 en_1_pf
s_mul_i32 s20, s2, 9216
zs 20,20,85983232
v_and_b32 v2, 63, v0
v_lshl_add_u32 v2, v2, 4, s20
zh 4
zh 5
zh 6
zh 7
buffer_store_dwordx4 v[4:7], v2, s[4:7], 0 offen offset:0 sc1
buffer_store_dwordx4 v[4:7], v2, s[4:7], 0 offen offset:1024 sc1
buffer_store_dwordx4 v[4:7], v2, s[4:7], 0 offen offset:2048 sc1
buffer_store_dwordx4 v[4:7], v2, s[4:7], 0 offen offset:3072 sc1
v_add_u32 v2, 4096, v2
buffer_store_dwordx4 v[4:7], v2, s[4:7], 0 offen offset:0 sc1
buffer_store_dwordx4 v[4:7], v2, s[4:7], 0 offen offset:1024 sc1
buffer_store_dwordx4 v[4:7], v2, s[4:7], 0 offen offset:2048 sc1
buffer_store_dwordx4 v[4:7], v2, s[4:7], 0 offen offset:3072 sc1
v_add_u32 v2, 4096, v2
buffer_store_dwordx4 v[4:7], v2, s[4:7], 0 offen offset:0 sc1
s_waitcnt vmcnt(0)
zh 2
v_mov_b32 v3, 1
s_mov_b64 exec, 1
buffer_atomic_add v3, v2, s[8:11], 0 offen offset:148
s_mov_b64 exec, -1
s_branch en_1_j
en_1_n1:
s_cmp_ge_u32 s16, 4
s_cbranch_scc1 en_1_pf
s_cmp_eq_u32 s3, 2
s_cbranch_scc0 en_1_j
s_lshl_b32 s20, s2, 14
zs 20,20,87048191
zi 20,20,4
s_and_b32 s20, s20, 0xffffc000
s_lshr_b32 s22, s20, 21
s_sub_u32 s20, s20, s4
s_lshr_b32 s23, s2, 3
s_and_b32 s23, s23, 1
s_xor_b32 s22, s22, s23
s_and_b32 s22, s22, 1
s_lshl_b32 s22, s22, 13
zi 20,20,22
s_mov_b64 exec, 1
zak 2,20
v_xor_b32 v3, 0x2000, v2
zbl 2,2,3584
zbl 2,3,3584
s_waitcnt vmcnt(0)
s_memtime s[24:25]
s_waitcnt lgkmcnt(0)
zbl 2,2,0
s_waitcnt vmcnt(0)
zbl 2,2,512
s_waitcnt vmcnt(0)
s_memtime s[26:27]
s_waitcnt lgkmcnt(0)
zbl 2,3,0
s_waitcnt vmcnt(0)
zbl 2,3,512
s_waitcnt vmcnt(0)
s_memtime s[28:29]
s_waitcnt lgkmcnt(0)
s_sub_u32 s28, s28, s26
s_sub_u32 s26, s26, s24
s_cmp_lt_u32 s28, s26
s_cselect_b32 s22, 1, 0
s_xor_b32 s22, s22, s23
s_xor_b32 s22, s22, 1
zak 4,22
ds_write_b32 v8, v4 offset:4
s_waitcnt lgkmcnt(0)
s_mov_b64 exec, -1
s_branch en_1_j
en_1_pf:
en_1_j:
s_barrier
zax 8,163808
ds_read_b64 v[4:5], v8
s_waitcnt lgkmcnt(0)
v_readfirstlane_b32 s17, v4
v_readfirstlane_b32 s15, v5
s_and_b32 s15, s15, 1
s_xor_b32 s15, s15, 1
s_mov_b32 s19, 0
s_cmp_ge_u32 s17, 32
s_cbranch_scc1 slow_entry
role_dispatch:
s_cmp_ge_u32 s16, 4
s_cbranch_scc1 worker
v_and_b32 v1, 63, v0
v_lshlrev_b32 v204, 4, v1
v_lshlrev_b32 v168, 3, v1
v_and_b32 v171, 15, v1
v_lshrrev_b32 v173, 4, v1
s_lshr_b32 s20, s17, 4
s_lshl_b32 s38, s16, 1
zi 38,38,20
s_lshr_b32 s20, s17, 3
s_lshl_b32 s41, s16, 2
zi 41,41,20
s_mov_b32 s42, 0
s_mov_b32 s43, -1
v_mov_b32 v196, -1
v_mov_b32 v197, -1
zax 169,0xff800000
v_cndmask_b32 v192, v169, 0, s[42:43]
zax 188,0x3f803f80
zax 189,0x3f803f80
zax 190,0x3f803f80
zax 191,0x3f803f80
zq 193,192
zq 194,192
zq 195,192
v_and_b32 v169, 1, v1
v_mul_u32_u24 v170, 0xaaaa, v169
v_add_u32 v202, 0x4444, v170
v_lshlrev_b32 v169, 4, v169
zax 170,0x3f80
v_lshlrev_b32 v170, v169, v170
v_lshrrev_b32 v169, 1, v171
v_cmp_eq_u32 vcc, 0, v169
s_nop 1
v_cndmask_b32 v184, 0, v170, vcc
v_cmp_eq_u32 vcc, 1, v169
s_nop 1
v_cndmask_b32 v185, 0, v170, vcc
v_cmp_eq_u32 vcc, 2, v169
s_nop 1
v_cndmask_b32 v186, 0, v170, vcc
v_cmp_eq_u32 vcc, 3, v169
s_nop 1
v_cndmask_b32 v187, 0, v170, vcc
v_bfe_u32 v169, v1, 4, 1
v_cmp_eq_u32 vcc, 0, v169
zax 170,0x3e0293ee
s_nop 0
v_cndmask_b32 v198, 1.0, v170, vcc
s_cmp_ge_u32 s3, 2
s_cselect_b64 vcc, -1, 0
v_cndmask_b32 v198, v198, 1.0, vcc
s_lshl_b32 s20, s3, 12
v_add_u32 v205, s20, v204
s_lshr_b32 s20, s17, 3
s_lshl_b32 s20, s20, 1
s_lshr_b32 s21, s3, 1
zi 20,20,21
s_mul_i32 s20, s20, 6144
v_add_u32 v206, s20, v204
v_add_u32 v207, 3072, v206
s_and_b32 s21, s3, 1
s_mul_i32 s21, s21, 3072
zi 20,20,21
zs 20,20,1024
v_add_u32 v208, s20, v168
v_lshrrev_b32 v169, 5, v1
v_bfe_u32 v170, v1, 4, 1
v_lshlrev_b32 v169, 10, v169
v_lshl_add_u32 v169, v170, 9, v169
v_lshl_add_u32 v209, v171, 4, v169
v_add_u32 v210, 4096, v209
s_and_b32 s21, s3, 1
s_lshl_b32 s21, s21, 12
v_add_u32 v211, s21, v209
v_mul_u32_u24 v170, 320, v173
v_lshl_add_u32 v170, v171, 2, v170
s_mul_i32 s20, s3, 3584
v_add_u32 v212, s20, v170
v_add_u32 v213, 1280, v212
v_lshrrev_b32 v170, 1, v173
v_lshlrev_b32 v170, 8, v170
v_lshl_add_u32 v170, v171, 4, v170
v_and_b32 v169, 1, v173
v_lshl_add_u32 v170, v169, 3, v170
zs 21,20,2560
v_add_u32 v214, s21, v170
v_bfe_u32 v169, v1, 1, 4
v_mul_u32_u24 v169, 160, v169
v_lshrrev_b32 v170, 5, v1
v_lshlrev_b32 v170, 5, v170
v_and_b32 v172, 1, v1
v_lshl_add_u32 v170, v172, 4, v170
v_add_u32 v169, v169, v170
s_lshl_b32 s20, s3, 6
v_add_u32 v169, s20, v169
v_add_u32 v170, 2560, v204
s_cmp_ge_u32 s3, 2
s_cselect_b64 vcc, -1, 0
v_cndmask_b32 v215, v169, v170, vcc
s_mul_i32 s20, s17, 1536
s_min_u32 s21, s3, 2
s_lshl_b32 s21, s21, 9
zi 20,20,21
s_cmp_eq_u32 s3, 3
s_cselect_b32 s21, 1073741824, 0
zi 20,20,21
v_add_u32 v216, s20, v168
v_and_b32 v169, 7, v1
v_lshlrev_b32 v169, 1, v169
v_bfe_u32 v170, v1, 3, 1
v_add_u32 v169, v169, v170
v_lshl_add_u32 v169, v173, 4, v169
s_lshl_b32 s20, s3, 10
zs 20,20,14336
v_lshl_add_u32 v217, v169, 4, s20
s_and_b32 s20, s17, 7
s_lshl_b32 s20, s20, 2
zi 20,20,3
s_lshl_b32 s20, s20, 14
s_lshl_b32 s21, s41, 9
zi 20,20,21
v_lshlrev_b32 v169, 4, v171
v_lshrrev_b32 v170, 1, v173
v_lshl_add_u32 v169, v170, 8, v169
v_and_b32 v170, 1, v173
v_lshl_add_u32 v169, v170, 3, v169
v_add_u32 v218, s20, v169
v_and_b32 v169, 3, v1
v_lshl_add_u32 v226, v169, 7, s20
v_and_b32 v169, 1, v1
v_lshl_add_u32 v169, v173, 1, v169
v_lshlrev_b32 v169, 9, v169
v_bfe_u32 v170, v1, 1, 3
v_lshl_add_u32 v169, v170, 4, v169
s_lshl_b32 s20, s17, 14
s_and_b32 s21, s3, 1
s_lshl_b32 s21, s21, 8
zi 20,20,21
s_lshr_b32 s22, s3, 1
s_lshl_b32 s22, s22, 7
zi 20,20,22
v_add_u32 v219, s20, v169
s_lshl_b32 s20, s17, 9
s_lshl_b32 s22, s22, 1
zi 20,20,22
s_lshr_b32 s21, s21, 1
zi 20,20,21
v_bfe_u32 v169, v1, 2, 1
v_lshlrev_b32 v169, 6, v169
v_and_b32 v170, 1, v1
v_lshl_add_u32 v169, v170, 5, v169
v_and_b32 v170, 1, v173
v_lshl_add_u32 v169, v170, 4, v169
v_lshrrev_b32 v170, 1, v173
v_lshl_add_u32 v169, v170, 3, v169
v_bfe_u32 v170, v1, 1, 1
v_lshl_add_u32 v169, v170, 2, v169
v_add_u32 v220, s20, v169
v_bfe_u32 v170, v1, 3, 1
v_lshl_add_u32 v228, v170, 30, v220
s_and_b32 s20, s17, 7
s_lshl_b32 s20, s20, 2
zi 20,20,3
s_lshr_b32 s21, s20, 4
s_lshl_b32 s22, s41, 1
zi 21,21,22
s_lshl_b32 s21, s21, 19
s_bfe_u32 s22, s20, 0x10003
s_lshl_b32 s22, s22, 24
zi 21,21,22
s_and_b32 s20, s20, 7
s_lshl_b32 s20, s20, 10
zi 21,21,20
zs 21,21,33570816
v_and_b32 v169, 7, v1
v_lshl_add_u32 v224, v169, 7, s21
s_lshl_b32 s20, s16, 14
zs 35,20,83886080
s_mov_b32 s24, s35
s_mul_i32 s20, s16, 49152
zs 34,20,92274688
zs 36,20,84934656
s_mov_b32 s25, s36
zs 37,4,109576191
s_and_b32 s37, s37, 4294443008
s_sub_u32 s37, s37, s4
s_lshl_b32 s20, s41, 1
s_lshr_b32 s21, s3, 1
zi 20,20,21
s_lshl_b32 s20, s20, 19
zs 29,20,33554432
zs 30,20,50331648
s_mov_b32 s14, 0
s_mov_b32 s39, 0
s_mov_b32 s81, 0
s_lshl_b32 s20, s38, 8
zs 20,20,85983232
zak 222,20
s_lshl_b32 s20, s16, 8
zs 20,20,86024192
zak 223,20
s_xor_b32 s20, s3, 3
s_or_b32 s40, s20, s17
s_lshl_b32 s20, s17, 2
zi 20,20,3
s_lshr_b32 s21, s20, 5
s_and_b32 s20, s20, 31
s_mul_i32 s22, s21, 65536
s_lshl_b32 s23, s20, 9
zi 22,22,23
v_lshl_add_u32 v168, v1, 3, s22
zaf 88,168,35,0
s_mul_i32 s22, s21, 196608
s_mul_i32 s23, s20, 1536
zi 22,22,23
v_lshl_add_u32 v169, v1, 3, s22
zaf 90,169,36,0
zaf 92,169,36,512
zaf 94,169,36,1024
v_add_u32 v168, 196608, v216
v_add_u32 v169, 65536, v220
s_cmp_lg_u32 s12, 0
s_cbranch_scc1 ini_2_s
buffer_store_dwordx2 v[196:197], v216, s[4:7], s36 offen offset:0
buffer_store_dwordx2 v[196:197], v168, s[4:7], s36 offen offset:0
s_mov_b32 exec_lo, 0x00ff00ff
s_mov_b32 exec_hi, 0x00ff00ff
buffer_store_dword v196, v169, s[4:7], s35 offen offset:0
s_mov_b64 exec, -1
s_branch ini_2_j
ini_2_s:
zap 196,216,36,0
zap 196,168,36,0
s_mov_b32 exec_lo, 0x00ff00ff
s_mov_b32 exec_hi, 0x00ff00ff
buffer_store_dword v196, v169, s[4:7], s35 offen offset:0 sc1
s_mov_b64 exec, -1
ini_2_j:
v_add_u32 v168, 0, v218
zap 196,168,37,0
v_add_u32 v168, 8192, v218
zap 196,168,37,0
v_add_u32 v168, 524288, v218
zap 196,168,37,0
v_add_u32 v168, 532480, v218
zap 196,168,37,0
s_lshl_b32 s23, s3, 15
v_lshrrev_b32 v170, 2, v1
v_and_b32 v169, 3, v1
v_lshlrev_b32 v168, 13, v170
v_lshl_add_u32 v168, v169, 4, v168
v_lshlrev_b32 v173, 11, v170
v_lshl_add_u32 v173, v169, 4, v173
v_lshrrev_b32 v170, 4, v1
v_bfe_u32 v171, v1, 2, 2
v_lshl_add_u32 v172, v170, 3, v171
v_lshlrev_b32 v172, 6, v172
v_lshl_add_u32 v172, v169, 3, v172
v_add_u32 v172, s23, v172
v_and_b32 v174, 1, v170
v_lshlrev_b32 v174, 5, v174
v_lshrrev_b32 v170, 1, v170
v_lshl_add_u32 v174, v170, 2, v174
v_add_u32 v174, v174, v171
v_lshlrev_b32 v174, 6, v174
v_lshl_add_u32 v174, v169, 4, v174
v_add_u32 v174, s23, v174
s_load_dwordx2 s[60:61], s[0:1], 40
s_load_dwordx2 s[62:63], s[0:1], 48
s_load_dwordx2 s[64:65], s[0:1], 56
s_load_dwordx2 s[66:67], s[0:1], 64
s_lshl_b32 s20, s16, 5
zi 20,20,17
s_lshl_b32 s20, s20, 6
s_lshl_b32 s21, s3, 21
zi 20,20,21
s_min_u32 s20, s20, 8388608
s_lshl_b32 s21, s41, 19
s_and_b32 s22, s17, 7
s_lshl_b32 s22, s22, 8
zi 21,21,22
s_lshl_b32 s22, s3, 6
zi 21,21,22
s_min_u32 s21, s21, 8388608
s_waitcnt lgkmcnt(0)
zi 44,60,20
s_addc_u32 s45, s61, 0
s_sub_u32 s46, 8388608, s20
s_mov_b32 s47, 0x20000
zay 23
s_mov_b32 s22, 0
zaq 168,22
zf 23,1024
s_mov_b32 s22, 131072
zaq 168,22
zf 23,2048
s_mov_b32 s22, 262144
zaq 168,22
zf 23,3072
s_mov_b32 s22, 393216
zaq 168,22
zf 23,4096
s_mov_b32 s22, 524288
zaq 168,22
zf 23,5120
s_mov_b32 s22, 655360
zaq 168,22
zf 23,6144
s_mov_b32 s22, 786432
zaq 168,22
zf 23,7168
s_mov_b32 s22, 917504
zaq 168,22
zf 23,8192
s_mov_b32 s22, 1048576
zaq 168,22
zf 23,9216
s_mov_b32 s22, 1179648
zaq 168,22
zf 23,10240
s_mov_b32 s22, 1310720
zaq 168,22
zf 23,11264
s_mov_b32 s22, 1441792
zaq 168,22
zf 23,12288
s_mov_b32 s22, 1572864
zaq 168,22
zf 23,13312
s_mov_b32 s22, 1703936
zaq 168,22
zf 23,14336
s_mov_b32 s22, 1835008
zaq 168,22
zf 23,15360
s_mov_b32 s22, 1966080
zaq 168,22
zi 44,66,21
s_addc_u32 s45, s67, 0
s_sub_u32 s46, 8388608, s21
s_mov_b32 s47, 0x20000
zf 23,16384
s_mov_b32 s22, 0
zaq 173,22
zf 23,17408
s_mov_b32 s22, 32768
zaq 173,22
zf 23,18432
s_mov_b32 s22, 65536
zaq 173,22
zf 23,19456
s_mov_b32 s22, 98304
zaq 173,22
zf 23,20480
s_mov_b32 s22, 131072
zaq 173,22
zf 23,21504
s_mov_b32 s22, 163840
zaq 173,22
zf 23,22528
s_mov_b32 s22, 196608
zaq 173,22
zf 23,23552
s_mov_b32 s22, 229376
zaq 173,22
zf 23,24576
s_mov_b32 s22, 262144
zaq 173,22
zf 23,25600
s_mov_b32 s22, 294912
zaq 173,22
zf 23,26624
s_mov_b32 s22, 327680
zaq 173,22
zf 23,27648
s_mov_b32 s22, 360448
zaq 173,22
zf 23,28672
s_mov_b32 s22, 393216
zaq 173,22
zf 23,29696
s_mov_b32 s22, 425984
zaq 173,22
zf 23,30720
s_mov_b32 s22, 458752
zaq 173,22
zf 23,31744
s_mov_b32 s22, 491520
zaq 173,22
s_waitcnt vmcnt(32)
s_barrier
s_cmp_lg_u32 s3, 0
s_cbranch_scc1 ar_3
s_lshl_b32 s68, s15, 16
zac 68,68
s_mul_i32 s69, s12, 16
zs 69,69,136
zak 176,69
zak 177,68
s_mov_b64 exec, 1
buffer_atomic_add v177, v176, s[8:11], 0 offen
s_mov_b64 exec, -1
ar_3:
s_waitcnt vmcnt(16)
zx 0,172,0
zx 2,172,256
zx 4,172,2048
zx 6,172,2304
zx 32,172,32
zx 34,172,288
zx 36,172,2080
zx 38,172,2336
zx 8,172,4096
zx 10,172,4352
zx 12,172,6144
zx 14,172,6400
zx 40,172,4128
zx 42,172,4384
zx 44,172,6176
zx 46,172,6432
zx 16,172,8192
zx 18,172,8448
zx 20,172,10240
zx 22,172,10496
zx 48,172,8224
zx 50,172,8480
zx 52,172,10272
zx 54,172,10528
zx 24,172,12288
zx 26,172,12544
zx 28,172,14336
zx 30,172,14592
zx 56,172,12320
zx 58,172,12576
zx 60,172,14368
zx 62,172,14624
s_waitcnt lgkmcnt(0)
zi 44,62,20
s_addc_u32 s45, s63, 0
s_sub_u32 s46, 8388608, s20
s_mov_b32 s47, 0x20000
zay 23
s_mov_b32 s22, 0
zar 168,22
zf 23,1024
s_mov_b32 s22, 131072
zar 168,22
zf 23,2048
s_mov_b32 s22, 262144
zar 168,22
zf 23,3072
s_mov_b32 s22, 393216
zar 168,22
zf 23,4096
s_mov_b32 s22, 524288
zar 168,22
zf 23,5120
s_mov_b32 s22, 655360
zar 168,22
zf 23,6144
s_mov_b32 s22, 786432
zar 168,22
zf 23,7168
s_mov_b32 s22, 917504
zar 168,22
zf 23,8192
s_mov_b32 s22, 1048576
zar 168,22
zf 23,9216
s_mov_b32 s22, 1179648
zar 168,22
zf 23,10240
s_mov_b32 s22, 1310720
zar 168,22
zf 23,11264
s_mov_b32 s22, 1441792
zar 168,22
zf 23,12288
s_mov_b32 s22, 1572864
zar 168,22
zf 23,13312
s_mov_b32 s22, 1703936
zar 168,22
zf 23,14336
s_mov_b32 s22, 1835008
zar 168,22
zf 23,15360
s_mov_b32 s22, 1966080
zar 168,22
s_waitcnt vmcnt(16)
zx 192,174,16384
zx 194,174,17408
zx 196,174,16896
zx 198,174,17920
zx 200,174,20480
zx 202,174,21504
zx 204,174,20992
zx 206,174,22016
zx 208,174,24576
zx 210,174,25600
zx 212,174,25088
zx 214,174,26112
zx 216,174,28672
zx 218,174,29696
zx 220,174,29184
zx 222,174,30208
zx 224,174,16392
zx 226,174,17416
zx 228,174,16904
zx 230,174,17928
zx 232,174,20488
zx 234,174,21512
zx 236,174,21000
zx 238,174,22024
zx 240,174,24584
zx 242,174,25608
zx 244,174,25096
zx 246,174,26120
zx 248,174,28680
zx 250,174,29704
zx 252,174,29192
zx 254,174,30216
s_waitcnt lgkmcnt(0)
zi 44,64,20
s_addc_u32 s45, s65, 0
s_sub_u32 s46, 8388608, s20
s_mov_b32 s47, 0x20000
zf 23,16384
s_mov_b32 s22, 0
zar 168,22
zf 23,17408
s_mov_b32 s22, 131072
zar 168,22
zf 23,18432
s_mov_b32 s22, 262144
zar 168,22
zf 23,19456
s_mov_b32 s22, 393216
zar 168,22
zf 23,20480
s_mov_b32 s22, 524288
zar 168,22
zf 23,21504
s_mov_b32 s22, 655360
zar 168,22
zf 23,22528
s_mov_b32 s22, 786432
zar 168,22
zf 23,23552
s_mov_b32 s22, 917504
zar 168,22
zf 23,24576
s_mov_b32 s22, 1048576
zar 168,22
zf 23,25600
s_mov_b32 s22, 1179648
zar 168,22
zf 23,26624
s_mov_b32 s22, 1310720
zar 168,22
zf 23,27648
s_mov_b32 s22, 1441792
zar 168,22
zf 23,28672
s_mov_b32 s22, 1572864
zar 168,22
zf 23,29696
s_mov_b32 s22, 1703936
zar 168,22
zf 23,30720
s_mov_b32 s22, 1835008
zar 168,22
zf 23,31744
s_mov_b32 s22, 1966080
zar 168,22
s_waitcnt vmcnt(16)
zx 64,172,0
zx 66,172,256
zx 68,172,2048
zx 70,172,2304
zx 96,172,32
zx 98,172,288
zx 100,172,2080
zx 102,172,2336
zx 72,172,4096
zx 74,172,4352
zx 76,172,6144
zx 78,172,6400
zx 104,172,4128
zx 106,172,4384
zx 108,172,6176
zx 110,172,6432
zx 80,172,8192
zx 82,172,8448
zx 84,172,10240
zx 86,172,10496
zx 112,172,8224
zx 114,172,8480
zx 116,172,10272
zx 118,172,10528
zx 88,172,12288
zx 90,172,12544
zx 92,172,14336
zx 94,172,14592
zx 120,172,12320
zx 122,172,12576
zx 124,172,14368
zx 126,172,14624
s_waitcnt lgkmcnt(0)
s_waitcnt vmcnt(0)
zx 128,172,16384
zx 130,172,16640
zx 132,172,18432
zx 134,172,18688
zx 160,172,16416
zx 162,172,16672
zx 164,172,18464
zx 166,172,18720
zx 136,172,20480
zx 138,172,20736
zx 140,172,22528
zx 142,172,22784
zx 168,172,20512
zx 170,172,20768
zx 172,172,22560
zx 174,172,22816
zx 144,172,24576
zx 146,172,24832
zx 148,172,26624
zx 150,172,26880
zx 176,172,24608
zx 178,172,24864
zx 180,172,26656
zx 182,172,26912
zx 152,172,28672
zx 154,172,28928
zx 156,172,30720
zx 158,172,30976
zx 184,172,28704
zx 186,172,28960
zx 188,172,30752
zx 190,172,31008
s_waitcnt lgkmcnt(0)
s_load_dwordx2 s[44:45], s[0:1], 32
s_mov_b32 s46, 16384
s_mov_b32 s47, 0x20000
v_bfe_u32 v168, v1, 1, 3
v_lshlrev_b32 v168, 11, v168
v_lshrrev_b32 v169, 4, v1
v_lshl_add_u32 v168, v169, 5, v168
v_and_b32 v169, 1, v1
v_lshl_add_u32 v168, v169, 2, v168
s_lshl_b32 s20, s3, 9
v_add_u32 v168, s20, v168
s_waitcnt lgkmcnt(0)
zbe 68,168,0
zbe 69,168,8
zbe 70,168,16
zbe 71,168,24
zbe 72,168,128
zbe 73,168,136
zbe 74,168,144
zbe 75,168,152
zbe 76,168,256
zbe 77,168,264
zbe 78,168,272
zbe 79,168,280
zbe 80,168,384
zbe 81,168,392
zbe 82,168,400
zbe 83,168,408
s_cmp_lg_u32 s3, 0
s_cbranch_scc1 cf_4_w
s_mov_b64 exec, 1
zh 168
zax 169,163808
s_mov_b32 s56, 0
cf_4_p:
buffer_load_dwordx4 v[172:175], v168, s[8:11], 0 offen offset:128 sc1
buffer_load_dwordx2 v[170:171], v168, s[8:11], 0 offen offset:148 sc1
zac 56,56
s_waitcnt vmcnt(0)
v_readfirstlane_b32 s57, v172
v_readfirstlane_b32 s59, v173
v_readfirstlane_b32 s60, v174
v_readfirstlane_b32 s58, v170
v_readfirstlane_b32 s61, v171
s_cmp_ge_u32 s56, 2097152
s_cbranch_scc1 cf_4_t
s_cmp_lg_u32 s12, 0
s_cbranch_scc1 cf_4_s
s_cmp_lg_u32 s59, 0
s_cbranch_scc1 cf_4_q
s_cmp_lt_u32 s57, 8
s_cbranch_scc1 cf_4_p
s_cmp_lt_u32 s58, 8
s_cbranch_scc1 cf_4_p
s_branch cf_4_r
cf_4_s:
s_mov_b32 s59, 0
s_mov_b32 s60, s61
cf_4_r:
s_and_b32 s58, s60, 0xffff
s_cmp_lt_u32 s58, 128
s_cbranch_scc1 cf_4_p
s_branch cf_4_q
cf_4_t:
s_mov_b32 s13, 1
s_mov_b32 s59, 0
cf_4_q:
zak 172,59
zak 173,60
zak 174,13
ds_write_b96 v169, v[172:174] offset:16
s_mov_b64 exec, -1
s_waitcnt lgkmcnt(0)
cf_4_w:
s_barrier
zax 169,163808
ds_read_b96 v[172:174], v169 offset:16
s_waitcnt lgkmcnt(0)
v_readfirstlane_b32 s59, v172
v_readfirstlane_b32 s60, v173
v_readfirstlane_b32 s13, v174
s_barrier
s_cmp_lg_u32 s59, 0
s_cbranch_scc1 far_slow_entry
s_lshr_b32 s60, s60, 16
s_cmp_gt_u32 s60, 64
s_cselect_b32 s15, 1, 0
s_waitcnt vmcnt(0) lgkmcnt(0)
s_cmp_lg_u32 s12, 0
s_cbranch_scc1 cslow_6
zh 88
zh 89
zh 90
zh 91
zh 92
zh 93
zh 94
zh 95
zh 96
zh 97
zh 98
zh 99
zh 100
zh 101
zh 102
zh 103
zh 104
zh 105
zh 106
zh 107
zh 108
zh 109
zh 110
zh 111
s_nop 1
zo 88,68,0,202
zo 92,68,32,202
zo 96,68,64,202
zo 100,68,96,202
zo 104,68,128,202
zo 108,68,160,202
zo 88,72,8,202
zo 92,72,40,202
zo 96,72,72,202
zo 100,72,104,202
zo 104,72,136,202
zo 108,72,168,202
zo 88,76,16,202
zo 92,76,48,202
zo 96,76,80,202
zo 100,76,112,202
zo 104,76,144,202
zo 108,76,176,202
zo 88,80,24,202
zo 92,80,56,202
zo 96,80,88,202
zo 100,80,120,202
zo 104,80,152,202
zo 108,80,184,202
s_nop 2
zm 88,88,89
zm 89,90,91
zbf 212,88,89
zm 92,92,93
zm 93,94,95
zbg 212,92,93
zm 96,96,97
zm 97,98,99
zbf 213,96,97
zm 100,100,101
zm 101,102,103
zbg 213,100,101
zm 104,104,105
zm 105,106,107
zbh 214,104,0
zm 108,108,109
zm 109,110,111
zbh 214,108,512
s_waitcnt lgkmcnt(0)
s_barrier
zg 168,215,0
zg 172,215,3584
zg 176,215,7168
zg 180,215,10752
s_waitcnt lgkmcnt(2)
zm 168,168,172
zm 169,169,173
zm 170,170,174
zm 171,171,175
s_waitcnt lgkmcnt(0)
zm 176,176,180
zm 177,177,181
zm 178,178,182
zm 179,179,183
zm 168,168,176
zm 169,169,177
zm 170,170,178
zm 171,171,179
zaa 168,168,198
zaa 170,170,198
zd 168,168,169
zd 169,170,171
v_min_u32 v200, -2, v168
v_min_u32 v201, -2, v169
buffer_store_dwordx2 v[200:201], v216, s[4:7], s25 offen offset:0
zs 62,38,2097152
s_and_b32 s56, s62, 0xffff
s_cmp_eq_u32 s56, 0xffff
s_cbranch_scc1 wc_7_n
s_cmp_lg_u32 s3, 0
s_cbranch_scc1 wc_7_b
s_lshl_b32 s56, s56, 8
zs 56,56,85983232
s_lshr_b32 s57, s62, 16
zak 168,56
s_mov_b32 s58, 0
s_mov_b64 exec, 1
wc_7_p:
s_cmp_lg_u32 s13, 0
s_cbranch_scc1 wc_7_x
buffer_load_dword v169, v168, s[4:7], 0 offen offset:0 sc1
zac 58,58
s_cmp_ge_u32 s58, 2097152
s_cselect_b32 s13, 1, 0
s_waitcnt vmcnt(0)
v_readfirstlane_b32 s59, v169
s_cmp_lt_u32 s59, s57
s_cbranch_scc1 wc_7_p
wc_7_x:
s_mov_b64 exec, -1
wc_7_b:
s_barrier
wc_7_n:
zp 4,209,29,0
zp 20,209,29,256
zp 8,209,29,2048
zp 24,209,29,2304
zp 12,210,29,0
zp 28,210,29,256
zp 16,210,29,2048
zp 32,210,29,2304
zp 36,211,30,0
zp 40,211,30,256
zp 44,211,30,2048
zp 48,211,30,2304
zs 29,29,8192
zs 30,30,8192
zaz 20,14
s_lshl_b32 s20, s20, 19
zi 26,37,20
zi 20,26,4
s_lshr_b32 s20, s20, 21
s_xor_b32 s20, s20, s15
s_and_b32 s20, s20, 1
s_lshl_b32 s20, s20, 13
zi 26,26,20
zs 27,26,4096
zav 20,14
s_lshl_b32 s20, s20, 19
zi 28,37,20
zi 20,28,4
s_lshr_b32 s20, s20, 21
s_xor_b32 s20, s20, s15
s_and_b32 s20, s20, 1
s_lshl_b32 s20, s20, 13
zi 28,28,20
zh 124
zh 125
zh 126
zh 127
zh 128
zh 129
zh 130
zh 131
zr 68,206,25,0
zr 72,206,25,1536
zr 76,207,25,0
zr 80,207,25,1536
zaf 84,208,25,0
zaf 86,208,25,1536
gw_8:
s_waitcnt vmcnt(5)
zab 116,4,68
zab 120,20,68
zag 203,68,69,70
v_max_u32 v203, v203, v71
v_cmp_eq_u32 vcc, -1, v203
s_cbranch_vccnz gr_12
zv 112,68,68,192
gw_9:
s_waitcnt vmcnt(4)
zag 203,72,73,74
v_max_u32 v203, v203, v75
v_cmp_eq_u32 vcc, -1, v203
s_cbranch_vccnz gr_13
zv 116,8,72,116
zv 120,24,72,120
zv 112,72,72,112
gw_10:
s_waitcnt vmcnt(3)
zag 203,76,77,78
v_max_u32 v203, v203, v79
v_cmp_eq_u32 vcc, -1, v203
s_cbranch_vccnz gr_14
zv 116,12,76,116
zv 120,28,76,120
zv 112,76,76,112
gw_11:
s_waitcnt vmcnt(2)
zv 116,16,80,116
zv 120,32,80,120
zag 203,80,81,82
v_max_u32 v203, v203, v83
v_cmp_eq_u32 vcc, -1, v203
s_cbranch_vccnz gr_15
zv 112,80,80,112
s_mov_b64 exec, 0xff
zbm 225,224,81,0
s_mov_b64 exec, -1
zs 81,81,8192
zp 4,209,29,0
s_nop 3
zw 168,116,117,118
zw 169,120,121,122
zw 168,119,123,168
zw 169,112,113,169
zw 168,114,115,168
v_max_f32 v170, v168, v169
v_max_f32 v168, v168, v169
zp 20,209,29,256
s_nop 0
zu 168,170
v_max_f32 v169, v168, v170
v_max_f32 v168, v168, v170
zp 8,209,29,2048
s_nop 0
zai 168,169
v_max_f32 v168, v168, v169
zad 116,116,168
zad 118,118,168
zad 120,120,168
zad 122,122,168
zad 112,112,168
zad 114,114,168
zp 24,209,29,2304
zj 116,116
zj 117,117
zj 118,118
zj 119,119
zp 12,210,29,0
zj 120,120
zj 121,121
zj 122,122
zj 123,123
zp 28,210,29,256
zh 142
zd 136,116,117
zd 137,118,119
zd 138,120,121
zd 139,122,123
zh 143
zj 112,112
zab 132,188,136
zj 113,113
zab 88,36,136
zj 114,114
zab 92,40,136
zj 115,115
zp 16,210,29,2048
zab 96,44,136
zd 140,112,113
zd 141,114,115
zab 100,48,136
zq 170,140
zq 171,141
zae 132,188,140,132
zp 32,210,29,2304
zai 170,142
zai 171,143
gw_17:
s_waitcnt vmcnt(9)
zag 203,84,85,86
v_max_u32 v203, v203, v87
v_cmp_eq_u32 vcc, -1, v203
s_cbranch_vccnz gr_18
zae 92,84,140,92
zae 100,86,140,100
v_rcp_f32 v172, v132
zap 196,218,28,0
zae 88,84,142,88
zae 96,86,142,96
s_nop 3
zap 200,216,34,0
zaa 92,92,172
zaa 94,94,172
zd 145,92,93
zd 149,94,95
zaa 100,100,172
zaa 102,102,172
zd 147,100,101
zd 151,102,103
zaa 88,88,172
zaa 90,90,172
zd 144,88,89
zd 148,90,91
zaa 96,96,172
zaa 98,98,172
zd 146,96,97
zd 150,98,99
s_nop 0
zba 145,149
zba 147,151
zba 144,148
zba 146,150
ds_write_b128 v217, v[144:147]
s_waitcnt lgkmcnt(0)
s_barrier
zg 152,204,14336
zg 156,204,15360
zg 160,204,16384
zg 164,204,17408
s_waitcnt lgkmcnt(3)
zo 124,152,192,202
zo 128,152,224,202
s_waitcnt lgkmcnt(2)
zo 124,156,200,202
zo 128,156,232,202
s_waitcnt lgkmcnt(1)
zo 124,160,208,202
zo 128,160,240,202
s_waitcnt lgkmcnt(0)
zo 124,164,216,202
zo 128,164,248,202
s_nop 6
zm 124,124,125
zm 125,126,127
zm 128,128,129
zm 129,130,131
zd 124,124,125
zd 125,128,129
v_min_u32 v124, -2, v124
v_min_u32 v125, -2, v125
zap 124,218,26,0
zav 20,14
s_and_b32 s20, s20, 3
s_mul_i32 s20, s20, 65536
zi 32,35,20
zav 20,14
s_and_b32 s20, s20, 3
s_mul_i32 s20, s20, 196608
zi 33,36,20
zac 20,14
s_and_b32 s20, s20, 3
s_mul_i32 s20, s20, 65536
zi 31,35,20
zp 52,211,30,0
zp 56,211,30,256
zp 60,211,30,2048
zp 64,211,30,2304
buffer_store_dwordx2 v[196:197], v216, s[4:7], s33 offen offset:0
buffer_store_dword v196, v228, s[4:7], s32 offen offset:0
zav 20,14
s_cmp_eq_u32 s20, 4
s_cselect_b32 s20, 64, s20
s_lshr_b32 s20, s20, 3
s_lshl_b32 s20, s20, 11
zbm 221,222,20,0
s_cmp_lg_u32 s40, 0
s_cbranch_scc1 pf_16
zak 175,14
s_mov_b64 exec, 1
zbl 175,223,0
s_mov_b64 exec, -1
pf_16:
zs 29,29,8192
zs 30,30,8192
zs 34,34,196608
zac 20,14
s_and_b32 s20, s20, 3
s_mul_i32 s20, s20, 196608
zi 25,36,20
zh 88
zh 89
zh 90
zh 91
zh 92
zh 93
zh 94
zh 95
zh 96
zh 97
zh 98
zh 99
zh 100
zh 101
zh 102
zh 103
zh 104
zh 105
zh 106
zh 107
zh 108
zh 109
zh 110
zh 111
zr 68,219,26,0
zr 72,219,27,0
h3_19:
s_waitcnt vmcnt(1)
zab 168,68,184
zag 203,68,69,70
v_max_u32 v203, v203, v71
s_waitcnt vmcnt(0)
zv 168,72,184,168
zag 203,72,73,203
zag 203,74,75,203
v_cmp_eq_u32 vcc, -1, v203
s_cbranch_vccnz h3r_20
s_mov_b32 s24, s31
zac 14,14
s_nop 1
zm 168,168,169
zm 169,170,171
zd 168,168,169
v_min_u32 v168, -2, v168
buffer_store_dword v168, v228, s[4:7], s31 offen offset:0
.p2align 6
chain_loop_21:
s_waitcnt vmcnt(0)
zr 68,205,24,0
zr 72,205,24,1024
zr 76,205,24,2048
zr 80,205,24,3072
gw_22:
s_waitcnt vmcnt(3)
zo 88,68,0,202
zo 92,68,32,202
zag 203,68,69,70
v_max_u32 v203, v203, v71
v_cmp_eq_u32 vcc, -1, v203
s_cbranch_vccnz gr_26
zo 96,68,64,202
zo 100,68,96,202
gw_23:
s_waitcnt vmcnt(2)
zag 203,72,73,74
v_max_u32 v203, v203, v75
v_cmp_eq_u32 vcc, -1, v203
s_cbranch_vccnz gr_27
zo 104,68,128,202
zo 108,68,160,202
zo 88,72,8,202
zo 92,72,40,202
zo 96,72,72,202
gw_24:
s_waitcnt vmcnt(1)
zag 203,76,77,78
v_max_u32 v203, v203, v79
v_cmp_eq_u32 vcc, -1, v203
s_cbranch_vccnz gr_28
zo 100,72,104,202
zo 104,72,136,202
zo 108,72,168,202
zo 88,76,16,202
zo 92,76,48,202
zo 96,76,80,202
zo 100,76,112,202
zo 104,76,144,202
zo 108,76,176,202
gw_25:
s_waitcnt vmcnt(0)
zo 88,80,24,202
zo 92,80,56,202
zag 203,80,81,82
v_max_u32 v203, v203, v83
v_cmp_eq_u32 vcc, -1, v203
s_cbranch_vccnz gr_29
zo 96,80,88,202
zo 100,80,120,202
zo 104,80,152,202
zo 108,80,184,202
s_nop 2
zm 88,88,89
zm 89,90,91
zbf 212,88,89
zm 92,92,93
zm 93,94,95
zbg 212,92,93
zm 96,96,97
zm 97,98,99
zbf 213,96,97
zm 100,100,101
zm 101,102,103
zbg 213,100,101
zm 104,104,105
zm 105,106,107
zbh 214,104,0
zm 108,108,109
zm 109,110,111
zbh 214,108,512
s_waitcnt lgkmcnt(0)
s_barrier
zg 168,215,0
zg 172,215,3584
zg 176,215,7168
zg 180,215,10752
s_waitcnt lgkmcnt(2)
zm 168,168,172
zm 169,169,173
zm 170,170,174
zm 171,171,175
s_waitcnt lgkmcnt(0)
zm 176,176,180
zm 177,177,181
zm 178,178,182
zm 179,179,183
zm 168,168,176
zm 169,169,177
zm 170,170,178
zm 171,171,179
zaa 168,168,198
zaa 170,170,198
zd 168,168,169
zd 169,170,171
v_min_u32 v200, -2, v168
v_min_u32 v201, -2, v169
buffer_store_dwordx2 v[200:201], v216, s[4:7], s25 offen offset:0
zaz 20,14
s_lshl_b32 s20, s20, 19
zi 26,37,20
zi 20,26,4
s_lshr_b32 s20, s20, 21
s_xor_b32 s20, s20, s15
s_and_b32 s20, s20, 1
s_lshl_b32 s20, s20, 13
zi 26,26,20
zs 27,26,4096
zav 20,14
s_lshl_b32 s20, s20, 19
zi 28,37,20
zi 20,28,4
s_lshr_b32 s20, s20, 21
s_xor_b32 s20, s20, s15
s_and_b32 s20, s20, 1
s_lshl_b32 s20, s20, 13
zi 28,28,20
zh 124
zh 125
zh 126
zh 127
zh 128
zh 129
zh 130
zh 131
zr 68,206,25,0
zr 72,206,25,1536
zr 76,207,25,0
zr 80,207,25,1536
zaf 84,208,25,0
zaf 86,208,25,1536
gw_30:
s_waitcnt vmcnt(5)
zab 116,4,68
zab 120,20,68
zag 203,68,69,70
v_max_u32 v203, v203, v71
v_cmp_eq_u32 vcc, -1, v203
s_cbranch_vccnz gr_34
zv 112,68,68,192
gw_31:
s_waitcnt vmcnt(4)
zag 203,72,73,74
v_max_u32 v203, v203, v75
v_cmp_eq_u32 vcc, -1, v203
s_cbranch_vccnz gr_35
zv 116,8,72,116
zv 120,24,72,120
zv 112,72,72,112
gw_32:
s_waitcnt vmcnt(3)
zag 203,76,77,78
v_max_u32 v203, v203, v79
v_cmp_eq_u32 vcc, -1, v203
s_cbranch_vccnz gr_36
zv 116,12,76,116
zv 120,28,76,120
zv 112,76,76,112
gw_33:
s_waitcnt vmcnt(2)
zv 116,16,80,116
zv 120,32,80,120
zag 203,80,81,82
v_max_u32 v203, v203, v83
v_cmp_eq_u32 vcc, -1, v203
s_cbranch_vccnz gr_37
zv 112,80,80,112
v_cmp_gt_u32 vcc, 32, v221
s_cbranch_vccnz kw_38
kb_39:
s_mov_b64 exec, 0xff
zbm 225,224,81,0
s_mov_b64 exec, -1
zs 81,81,8192
zp 4,209,29,0
s_nop 3
zw 168,116,117,118
zw 169,120,121,122
zw 168,119,123,168
zw 169,112,113,169
zw 168,114,115,168
v_max_f32 v170, v168, v169
v_max_f32 v168, v168, v169
zp 20,209,29,256
s_nop 0
zu 168,170
v_max_f32 v169, v168, v170
v_max_f32 v168, v168, v170
zp 8,209,29,2048
s_nop 0
zai 168,169
v_max_f32 v168, v168, v169
zad 116,116,168
zad 118,118,168
zad 120,120,168
zad 122,122,168
zad 112,112,168
zad 114,114,168
zp 24,209,29,2304
zj 116,116
zj 117,117
zj 118,118
zj 119,119
zp 12,210,29,0
zj 120,120
zj 121,121
zj 122,122
zj 123,123
zp 28,210,29,256
zh 142
zd 136,116,117
zd 137,118,119
zd 138,120,121
zd 139,122,123
zh 143
zj 112,112
zab 132,188,136
zj 113,113
zab 88,52,136
zj 114,114
zab 92,56,136
zj 115,115
zp 16,210,29,2048
zab 96,60,136
zd 140,112,113
zd 141,114,115
zab 100,64,136
zq 170,140
zq 171,141
zae 132,188,140,132
zp 32,210,29,2304
zai 170,142
zai 171,143
gw_41:
s_waitcnt vmcnt(9)
zag 203,84,85,86
v_max_u32 v203, v203, v87
v_cmp_eq_u32 vcc, -1, v203
s_cbranch_vccnz gr_42
zae 92,84,140,92
zae 100,86,140,100
v_rcp_f32 v172, v132
zap 196,218,28,0
zae 88,84,142,88
zae 96,86,142,96
s_nop 3
zap 200,216,34,0
zaa 92,92,172
zaa 94,94,172
zd 145,92,93
zd 149,94,95
zaa 100,100,172
zaa 102,102,172
zd 147,100,101
zd 151,102,103
zaa 88,88,172
zaa 90,90,172
zd 144,88,89
zd 148,90,91
zaa 96,96,172
zaa 98,98,172
zd 146,96,97
zd 150,98,99
s_nop 0
zba 145,149
zba 147,151
zba 144,148
zba 146,150
ds_write_b128 v217, v[144:147]
s_waitcnt lgkmcnt(0)
s_barrier
zg 152,204,14336
zg 156,204,15360
zg 160,204,16384
zg 164,204,17408
s_waitcnt lgkmcnt(3)
zo 124,152,192,202
zo 128,152,224,202
s_waitcnt lgkmcnt(2)
zo 124,156,200,202
zo 128,156,232,202
s_waitcnt lgkmcnt(1)
zo 124,160,208,202
zo 128,160,240,202
s_waitcnt lgkmcnt(0)
zo 124,164,216,202
zo 128,164,248,202
s_nop 6
zm 124,124,125
zm 125,126,127
zm 128,128,129
zm 129,130,131
zd 124,124,125
zd 125,128,129
v_min_u32 v124, -2, v124
v_min_u32 v125, -2, v125
zap 124,218,26,0
zav 20,14
s_and_b32 s20, s20, 3
s_mul_i32 s20, s20, 65536
zi 32,35,20
zav 20,14
s_and_b32 s20, s20, 3
s_mul_i32 s20, s20, 196608
zi 33,36,20
zac 20,14
s_and_b32 s20, s20, 3
s_mul_i32 s20, s20, 65536
zi 31,35,20
zp 36,211,30,0
zp 40,211,30,256
zp 44,211,30,2048
zp 48,211,30,2304
buffer_store_dwordx2 v[196:197], v216, s[4:7], s33 offen offset:0
buffer_store_dword v196, v228, s[4:7], s32 offen offset:0
s_cmp_lg_u32 s40, 0
s_cbranch_scc1 pf_40
zak 175,14
s_mov_b64 exec, 1
zbl 175,223,0
s_mov_b64 exec, -1
pf_40:
zs 29,29,8192
zs 30,30,8192
zs 34,34,196608
zac 20,14
s_and_b32 s20, s20, 3
s_mul_i32 s20, s20, 196608
zi 25,36,20
zh 88
zh 89
zh 90
zh 91
zh 92
zh 93
zh 94
zh 95
zh 96
zh 97
zh 98
zh 99
zh 100
zh 101
zh 102
zh 103
zh 104
zh 105
zh 106
zh 107
zh 108
zh 109
zh 110
zh 111
zr 68,219,26,0
zr 72,219,27,0
h3_43:
s_waitcnt vmcnt(1)
zab 168,68,184
zag 203,68,69,70
v_max_u32 v203, v203, v71
s_waitcnt vmcnt(0)
zv 168,72,184,168
zag 203,72,73,203
zag 203,74,75,203
v_cmp_eq_u32 vcc, -1, v203
s_cbranch_vccnz h3r_44
s_mov_b32 s24, s31
zac 14,14
s_nop 1
zm 168,168,169
zm 169,170,171
zd 168,168,169
v_min_u32 v168, -2, v168
buffer_store_dword v168, v228, s[4:7], s31 offen offset:0
s_waitcnt vmcnt(0)
zr 68,205,24,0
zr 72,205,24,1024
zr 76,205,24,2048
zr 80,205,24,3072
gw_45:
s_waitcnt vmcnt(3)
zo 88,68,0,202
zo 92,68,32,202
zag 203,68,69,70
v_max_u32 v203, v203, v71
v_cmp_eq_u32 vcc, -1, v203
s_cbranch_vccnz gr_49
zo 96,68,64,202
zo 100,68,96,202
gw_46:
s_waitcnt vmcnt(2)
zag 203,72,73,74
v_max_u32 v203, v203, v75
v_cmp_eq_u32 vcc, -1, v203
s_cbranch_vccnz gr_50
zo 104,68,128,202
zo 108,68,160,202
zo 88,72,8,202
zo 92,72,40,202
zo 96,72,72,202
gw_47:
s_waitcnt vmcnt(1)
zag 203,76,77,78
v_max_u32 v203, v203, v79
v_cmp_eq_u32 vcc, -1, v203
s_cbranch_vccnz gr_51
zo 100,72,104,202
zo 104,72,136,202
zo 108,72,168,202
zo 88,76,16,202
zo 92,76,48,202
zo 96,76,80,202
zo 100,76,112,202
zo 104,76,144,202
zo 108,76,176,202
gw_48:
s_waitcnt vmcnt(0)
zo 88,80,24,202
zo 92,80,56,202
zag 203,80,81,82
v_max_u32 v203, v203, v83
v_cmp_eq_u32 vcc, -1, v203
s_cbranch_vccnz gr_52
zo 96,80,88,202
zo 100,80,120,202
zo 104,80,152,202
zo 108,80,184,202
s_nop 2
zm 88,88,89
zm 89,90,91
zbf 212,88,89
zm 92,92,93
zm 93,94,95
zbg 212,92,93
zm 96,96,97
zm 97,98,99
zbf 213,96,97
zm 100,100,101
zm 101,102,103
zbg 213,100,101
zm 104,104,105
zm 105,106,107
zbh 214,104,0
zm 108,108,109
zm 109,110,111
zbh 214,108,512
s_waitcnt lgkmcnt(0)
s_barrier
zg 168,215,0
zg 172,215,3584
zg 176,215,7168
zg 180,215,10752
s_waitcnt lgkmcnt(2)
zm 168,168,172
zm 169,169,173
zm 170,170,174
zm 171,171,175
s_waitcnt lgkmcnt(0)
zm 176,176,180
zm 177,177,181
zm 178,178,182
zm 179,179,183
zm 168,168,176
zm 169,169,177
zm 170,170,178
zm 171,171,179
zaa 168,168,198
zaa 170,170,198
zd 168,168,169
zd 169,170,171
v_min_u32 v200, -2, v168
v_min_u32 v201, -2, v169
buffer_store_dwordx2 v[200:201], v216, s[4:7], s25 offen offset:0
zaz 20,14
s_lshl_b32 s20, s20, 19
zi 26,37,20
zi 20,26,4
s_lshr_b32 s20, s20, 21
s_xor_b32 s20, s20, s15
s_and_b32 s20, s20, 1
s_lshl_b32 s20, s20, 13
zi 26,26,20
zs 27,26,4096
zav 20,14
s_lshl_b32 s20, s20, 19
zi 28,37,20
zi 20,28,4
s_lshr_b32 s20, s20, 21
s_xor_b32 s20, s20, s15
s_and_b32 s20, s20, 1
s_lshl_b32 s20, s20, 13
zi 28,28,20
zh 124
zh 125
zh 126
zh 127
zh 128
zh 129
zh 130
zh 131
zr 68,206,25,0
zr 72,206,25,1536
zr 76,207,25,0
zr 80,207,25,1536
zaf 84,208,25,0
zaf 86,208,25,1536
gw_53:
s_waitcnt vmcnt(5)
zab 116,4,68
zab 120,20,68
zag 203,68,69,70
v_max_u32 v203, v203, v71
v_cmp_eq_u32 vcc, -1, v203
s_cbranch_vccnz gr_57
zv 112,68,68,192
gw_54:
s_waitcnt vmcnt(4)
zag 203,72,73,74
v_max_u32 v203, v203, v75
v_cmp_eq_u32 vcc, -1, v203
s_cbranch_vccnz gr_58
zv 116,8,72,116
zv 120,24,72,120
zv 112,72,72,112
gw_55:
s_waitcnt vmcnt(3)
zag 203,76,77,78
v_max_u32 v203, v203, v79
v_cmp_eq_u32 vcc, -1, v203
s_cbranch_vccnz gr_59
zv 116,12,76,116
zv 120,28,76,120
zv 112,76,76,112
gw_56:
s_waitcnt vmcnt(2)
zv 116,16,80,116
zv 120,32,80,120
zag 203,80,81,82
v_max_u32 v203, v203, v83
v_cmp_eq_u32 vcc, -1, v203
s_cbranch_vccnz gr_60
zv 112,80,80,112
s_mov_b64 exec, 0xff
zbm 225,224,81,0
s_mov_b64 exec, -1
zs 81,81,8192
zp 4,209,29,0
s_nop 3
zw 168,116,117,118
zw 169,120,121,122
zw 168,119,123,168
zw 169,112,113,169
zw 168,114,115,168
v_max_f32 v170, v168, v169
v_max_f32 v168, v168, v169
zp 20,209,29,256
s_nop 0
zu 168,170
v_max_f32 v169, v168, v170
v_max_f32 v168, v168, v170
zp 8,209,29,2048
s_nop 0
zai 168,169
v_max_f32 v168, v168, v169
zad 116,116,168
zad 118,118,168
zad 120,120,168
zad 122,122,168
zad 112,112,168
zad 114,114,168
zp 24,209,29,2304
zj 116,116
zj 117,117
zj 118,118
zj 119,119
zp 12,210,29,0
zj 120,120
zj 121,121
zj 122,122
zj 123,123
zp 28,210,29,256
zh 142
zd 136,116,117
zd 137,118,119
zd 138,120,121
zd 139,122,123
zh 143
zj 112,112
zab 132,188,136
zj 113,113
zab 88,36,136
zj 114,114
zab 92,40,136
zj 115,115
zp 16,210,29,2048
zab 96,44,136
zd 140,112,113
zd 141,114,115
zab 100,48,136
zq 170,140
zq 171,141
zae 132,188,140,132
zp 32,210,29,2304
zai 170,142
zai 171,143
gw_62:
s_waitcnt vmcnt(9)
zag 203,84,85,86
v_max_u32 v203, v203, v87
v_cmp_eq_u32 vcc, -1, v203
s_cbranch_vccnz gr_63
zae 92,84,140,92
zae 100,86,140,100
v_rcp_f32 v172, v132
zap 196,218,28,0
zae 88,84,142,88
zae 96,86,142,96
s_nop 3
zap 200,216,34,0
zaa 92,92,172
zaa 94,94,172
zd 145,92,93
zd 149,94,95
zaa 100,100,172
zaa 102,102,172
zd 147,100,101
zd 151,102,103
zaa 88,88,172
zaa 90,90,172
zd 144,88,89
zd 148,90,91
zaa 96,96,172
zaa 98,98,172
zd 146,96,97
zd 150,98,99
s_nop 0
zba 145,149
zba 147,151
zba 144,148
zba 146,150
ds_write_b128 v217, v[144:147]
s_waitcnt lgkmcnt(0)
s_barrier
zg 152,204,14336
zg 156,204,15360
zg 160,204,16384
zg 164,204,17408
s_waitcnt lgkmcnt(3)
zo 124,152,192,202
zo 128,152,224,202
s_waitcnt lgkmcnt(2)
zo 124,156,200,202
zo 128,156,232,202
s_waitcnt lgkmcnt(1)
zo 124,160,208,202
zo 128,160,240,202
s_waitcnt lgkmcnt(0)
zo 124,164,216,202
zo 128,164,248,202
s_nop 6
zm 124,124,125
zm 125,126,127
zm 128,128,129
zm 129,130,131
zd 124,124,125
zd 125,128,129
v_min_u32 v124, -2, v124
v_min_u32 v125, -2, v125
zap 124,218,26,0
zav 20,14
s_and_b32 s20, s20, 3
s_mul_i32 s20, s20, 65536
zi 32,35,20
zav 20,14
s_and_b32 s20, s20, 3
s_mul_i32 s20, s20, 196608
zi 33,36,20
zac 20,14
s_and_b32 s20, s20, 3
s_mul_i32 s20, s20, 65536
zi 31,35,20
zp 52,211,30,0
zp 56,211,30,256
zp 60,211,30,2048
zp 64,211,30,2304
buffer_store_dwordx2 v[196:197], v216, s[4:7], s33 offen offset:0
buffer_store_dword v196, v228, s[4:7], s32 offen offset:0
zav 20,14
s_cmp_eq_u32 s20, 4
s_cselect_b32 s20, 64, s20
s_lshr_b32 s20, s20, 3
s_lshl_b32 s20, s20, 11
zbm 221,222,20,0
s_cmp_lg_u32 s40, 0
s_cbranch_scc1 pf_61
zak 175,14
s_mov_b64 exec, 1
zbl 175,223,0
s_mov_b64 exec, -1
pf_61:
zs 29,29,8192
zs 30,30,8192
zs 34,34,196608
zac 20,14
s_and_b32 s20, s20, 3
s_mul_i32 s20, s20, 196608
zi 25,36,20
zh 88
zh 89
zh 90
zh 91
zh 92
zh 93
zh 94
zh 95
zh 96
zh 97
zh 98
zh 99
zh 100
zh 101
zh 102
zh 103
zh 104
zh 105
zh 106
zh 107
zh 108
zh 109
zh 110
zh 111
zr 68,219,26,0
zr 72,219,27,0
h3_64:
s_waitcnt vmcnt(1)
zab 168,68,184
zag 203,68,69,70
v_max_u32 v203, v203, v71
s_waitcnt vmcnt(0)
zv 168,72,184,168
zag 203,72,73,203
zag 203,74,75,203
v_cmp_eq_u32 vcc, -1, v203
s_cbranch_vccnz h3r_65
s_mov_b32 s24, s31
zac 14,14
s_nop 1
zm 168,168,169
zm 169,170,171
zd 168,168,169
v_min_u32 v168, -2, v168
buffer_store_dword v168, v228, s[4:7], s31 offen offset:0
s_cmp_lt_u32 s14, 63
s_cbranch_scc1 chain_loop_21
s_waitcnt vmcnt(0)
zr 68,205,24,0
zr 72,205,24,1024
zr 76,205,24,2048
zr 80,205,24,3072
gw_66:
s_waitcnt vmcnt(3)
zo 88,68,0,202
zo 92,68,32,202
zag 203,68,69,70
v_max_u32 v203, v203, v71
v_cmp_eq_u32 vcc, -1, v203
s_cbranch_vccnz gr_70
zo 96,68,64,202
zo 100,68,96,202
gw_67:
s_waitcnt vmcnt(2)
zag 203,72,73,74
v_max_u32 v203, v203, v75
v_cmp_eq_u32 vcc, -1, v203
s_cbranch_vccnz gr_71
zo 104,68,128,202
zo 108,68,160,202
zo 88,72,8,202
zo 92,72,40,202
zo 96,72,72,202
gw_68:
s_waitcnt vmcnt(1)
zag 203,76,77,78
v_max_u32 v203, v203, v79
v_cmp_eq_u32 vcc, -1, v203
s_cbranch_vccnz gr_72
zo 100,72,104,202
zo 104,72,136,202
zo 108,72,168,202
zo 88,76,16,202
zo 92,76,48,202
zo 96,76,80,202
zo 100,76,112,202
zo 104,76,144,202
zo 108,76,176,202
gw_69:
s_waitcnt vmcnt(0)
zo 88,80,24,202
zo 92,80,56,202
zag 203,80,81,82
v_max_u32 v203, v203, v83
v_cmp_eq_u32 vcc, -1, v203
s_cbranch_vccnz gr_73
zo 96,80,88,202
zo 100,80,120,202
zo 104,80,152,202
zo 108,80,184,202
s_nop 2
zm 88,88,89
zm 89,90,91
zbf 212,88,89
zm 92,92,93
zm 93,94,95
zbg 212,92,93
zm 96,96,97
zm 97,98,99
zbf 213,96,97
zm 100,100,101
zm 101,102,103
zbg 213,100,101
zm 104,104,105
zm 105,106,107
zbh 214,104,0
zm 108,108,109
zm 109,110,111
zbh 214,108,512
s_waitcnt lgkmcnt(0)
s_barrier
zg 168,215,0
zg 172,215,3584
zg 176,215,7168
zg 180,215,10752
s_waitcnt lgkmcnt(2)
zm 168,168,172
zm 169,169,173
zm 170,170,174
zm 171,171,175
s_waitcnt lgkmcnt(0)
zm 176,176,180
zm 177,177,181
zm 178,178,182
zm 179,179,183
zm 168,168,176
zm 169,169,177
zm 170,170,178
zm 171,171,179
zaa 168,168,198
zaa 170,170,198
zd 168,168,169
zd 169,170,171
v_min_u32 v200, -2, v168
v_min_u32 v201, -2, v169
zap 200,216,34,0
s_branch cdone_5
gr_12:
s_cmp_lg_u32 s13, 0
s_cbranch_scc1 gr_12_x
zr 68,206,25,0
zr 72,206,25,1536
zr 76,207,25,0
zr 80,207,25,1536
zaf 84,208,25,0
zaf 86,208,25,1536
zac 39,39
s_cmp_ge_u32 s39, 1048576
s_cselect_b32 s13, 1, 0
s_waitcnt vmcnt(5)
s_branch gw_8
gr_12_x:
s_waitcnt vmcnt(0)
zh 68
zh 69
zh 70
zh 71
s_nop 1
s_branch gw_8
gr_13:
s_cmp_lg_u32 s13, 0
s_cbranch_scc1 gr_13_x
zr 72,206,25,1536
zr 76,207,25,0
zr 80,207,25,1536
zaf 84,208,25,0
zaf 86,208,25,1536
zac 39,39
s_cmp_ge_u32 s39, 1048576
s_cselect_b32 s13, 1, 0
s_waitcnt vmcnt(4)
s_branch gw_9
gr_13_x:
s_waitcnt vmcnt(0)
zh 72
zh 73
zh 74
zh 75
s_nop 1
s_branch gw_9
gr_14:
s_cmp_lg_u32 s13, 0
s_cbranch_scc1 gr_14_x
zr 76,207,25,0
zr 80,207,25,1536
zaf 84,208,25,0
zaf 86,208,25,1536
zac 39,39
s_cmp_ge_u32 s39, 1048576
s_cselect_b32 s13, 1, 0
s_waitcnt vmcnt(3)
s_branch gw_10
gr_14_x:
s_waitcnt vmcnt(0)
zh 76
zh 77
zh 78
zh 79
s_nop 1
s_branch gw_10
gr_15:
s_cmp_lg_u32 s13, 0
s_cbranch_scc1 gr_15_x
zr 80,207,25,1536
zaf 84,208,25,0
zaf 86,208,25,1536
s_nop 7
zab 116,4,68
zab 120,20,68
zv 116,8,72,116
zv 120,24,72,120
zv 116,12,76,116
zv 120,28,76,120
zac 39,39
s_cmp_ge_u32 s39, 1048576
s_cselect_b32 s13, 1, 0
s_waitcnt vmcnt(2)
s_branch gw_11
gr_15_x:
s_waitcnt vmcnt(0)
zh 80
zh 81
zh 82
zh 83
s_nop 1
s_branch gw_11
gr_18:
s_cmp_lg_u32 s13, 0
s_cbranch_scc1 gr_18_x
zaf 84,208,25,0
zaf 86,208,25,1536
zac 39,39
s_cmp_ge_u32 s39, 1048576
s_cselect_b32 s13, 1, 0
s_waitcnt vmcnt(0)
s_branch gw_17
gr_18_x:
s_waitcnt vmcnt(0)
zh 84
zh 85
zh 86
zh 87
s_nop 1
s_branch gw_17
h3r_20:
s_cmp_lg_u32 s13, 0
s_cbranch_scc1 h3r_20_x
zr 68,219,26,0
zr 72,219,27,0
zac 39,39
s_cmp_ge_u32 s39, 1048576
s_cselect_b32 s13, 1, 0
s_branch h3_19
h3r_20_x:
zh 68
zh 69
zh 70
zh 71
zh 72
zh 73
zh 74
zh 75
s_nop 1
s_branch h3_19
gr_26:
s_cmp_lg_u32 s13, 0
s_cbranch_scc1 gr_26_x
zr 68,205,24,0
zr 72,205,24,1024
zr 76,205,24,2048
zr 80,205,24,3072
s_nop 7
zh 88
zh 89
zh 90
zh 91
zh 92
zh 93
zh 94
zh 95
zac 39,39
s_cmp_ge_u32 s39, 1048576
s_cselect_b32 s13, 1, 0
s_waitcnt vmcnt(3)
s_branch gw_22
gr_26_x:
s_waitcnt vmcnt(0)
zh 68
zh 69
zh 70
zh 71
s_nop 1
s_branch gw_22
gr_27:
s_cmp_lg_u32 s13, 0
s_cbranch_scc1 gr_27_x
zr 72,205,24,1024
zr 76,205,24,2048
zr 80,205,24,3072
zac 39,39
s_cmp_ge_u32 s39, 1048576
s_cselect_b32 s13, 1, 0
s_waitcnt vmcnt(2)
s_branch gw_23
gr_27_x:
s_waitcnt vmcnt(0)
zh 72
zh 73
zh 74
zh 75
s_nop 1
s_branch gw_23
gr_28:
s_cmp_lg_u32 s13, 0
s_cbranch_scc1 gr_28_x
zr 76,205,24,2048
zr 80,205,24,3072
zac 39,39
s_cmp_ge_u32 s39, 1048576
s_cselect_b32 s13, 1, 0
s_waitcnt vmcnt(1)
s_branch gw_24
gr_28_x:
s_waitcnt vmcnt(0)
zh 76
zh 77
zh 78
zh 79
s_nop 1
s_branch gw_24
gr_29:
s_cmp_lg_u32 s13, 0
s_cbranch_scc1 gr_29_x
zr 80,205,24,3072
s_nop 7
zh 88
zh 89
zh 90
zh 91
zh 92
zh 93
zh 94
zh 95
s_nop 1
zo 88,68,0,202
zo 92,68,32,202
zo 88,72,8,202
zo 92,72,40,202
zo 88,76,16,202
zo 92,76,48,202
zac 39,39
s_cmp_ge_u32 s39, 1048576
s_cselect_b32 s13, 1, 0
s_waitcnt vmcnt(0)
s_branch gw_25
gr_29_x:
s_waitcnt vmcnt(0)
zh 80
zh 81
zh 82
zh 83
s_nop 1
s_branch gw_25
gr_34:
s_cmp_lg_u32 s13, 0
s_cbranch_scc1 gr_34_x
zr 68,206,25,0
zr 72,206,25,1536
zr 76,207,25,0
zr 80,207,25,1536
zaf 84,208,25,0
zaf 86,208,25,1536
zac 39,39
s_cmp_ge_u32 s39, 1048576
s_cselect_b32 s13, 1, 0
s_waitcnt vmcnt(5)
s_branch gw_30
gr_34_x:
s_waitcnt vmcnt(0)
zh 68
zh 69
zh 70
zh 71
s_nop 1
s_branch gw_30
gr_35:
s_cmp_lg_u32 s13, 0
s_cbranch_scc1 gr_35_x
zr 72,206,25,1536
zr 76,207,25,0
zr 80,207,25,1536
zaf 84,208,25,0
zaf 86,208,25,1536
zac 39,39
s_cmp_ge_u32 s39, 1048576
s_cselect_b32 s13, 1, 0
s_waitcnt vmcnt(4)
s_branch gw_31
gr_35_x:
s_waitcnt vmcnt(0)
zh 72
zh 73
zh 74
zh 75
s_nop 1
s_branch gw_31
gr_36:
s_cmp_lg_u32 s13, 0
s_cbranch_scc1 gr_36_x
zr 76,207,25,0
zr 80,207,25,1536
zaf 84,208,25,0
zaf 86,208,25,1536
zac 39,39
s_cmp_ge_u32 s39, 1048576
s_cselect_b32 s13, 1, 0
s_waitcnt vmcnt(3)
s_branch gw_32
gr_36_x:
s_waitcnt vmcnt(0)
zh 76
zh 77
zh 78
zh 79
s_nop 1
s_branch gw_32
gr_37:
s_cmp_lg_u32 s13, 0
s_cbranch_scc1 gr_37_x
zr 80,207,25,1536
zaf 84,208,25,0
zaf 86,208,25,1536
s_nop 7
zab 116,4,68
zab 120,20,68
zv 116,8,72,116
zv 120,24,72,120
zv 116,12,76,116
zv 120,28,76,120
zac 39,39
s_cmp_ge_u32 s39, 1048576
s_cselect_b32 s13, 1, 0
s_waitcnt vmcnt(2)
s_branch gw_33
gr_37_x:
s_waitcnt vmcnt(0)
zh 80
zh 81
zh 82
zh 83
s_nop 1
s_branch gw_33
kw_38:
s_cmp_lg_u32 s13, 0
s_cbranch_scc1 kb_39
zac 20,14
s_cmp_eq_u32 s20, 4
s_cselect_b32 s20, 64, s20
s_lshr_b32 s20, s20, 3
s_lshl_b32 s20, s20, 11
zbm 221,222,20,0
zac 39,39
s_cmp_ge_u32 s39, 1048576
s_cselect_b32 s13, 1, 0
s_waitcnt vmcnt(0)
v_cmp_gt_u32 vcc, 32, v221
s_cbranch_vccnz kw_38
s_branch kb_39
gr_42:
s_cmp_lg_u32 s13, 0
s_cbranch_scc1 gr_42_x
zaf 84,208,25,0
zaf 86,208,25,1536
zac 39,39
s_cmp_ge_u32 s39, 1048576
s_cselect_b32 s13, 1, 0
s_waitcnt vmcnt(0)
s_branch gw_41
gr_42_x:
s_waitcnt vmcnt(0)
zh 84
zh 85
zh 86
zh 87
s_nop 1
s_branch gw_41
h3r_44:
s_cmp_lg_u32 s13, 0
s_cbranch_scc1 h3r_44_x
zr 68,219,26,0
zr 72,219,27,0
zac 39,39
s_cmp_ge_u32 s39, 1048576
s_cselect_b32 s13, 1, 0
s_branch h3_43
h3r_44_x:
zh 68
zh 69
zh 70
zh 71
zh 72
zh 73
zh 74
zh 75
s_nop 1
s_branch h3_43
gr_49:
s_cmp_lg_u32 s13, 0
s_cbranch_scc1 gr_49_x
zr 68,205,24,0
zr 72,205,24,1024
zr 76,205,24,2048
zr 80,205,24,3072
s_nop 7
zh 88
zh 89
zh 90
zh 91
zh 92
zh 93
zh 94
zh 95
zac 39,39
s_cmp_ge_u32 s39, 1048576
s_cselect_b32 s13, 1, 0
s_waitcnt vmcnt(3)
s_branch gw_45
gr_49_x:
s_waitcnt vmcnt(0)
zh 68
zh 69
zh 70
zh 71
s_nop 1
s_branch gw_45
gr_50:
s_cmp_lg_u32 s13, 0
s_cbranch_scc1 gr_50_x
zr 72,205,24,1024
zr 76,205,24,2048
zr 80,205,24,3072
zac 39,39
s_cmp_ge_u32 s39, 1048576
s_cselect_b32 s13, 1, 0
s_waitcnt vmcnt(2)
s_branch gw_46
gr_50_x:
s_waitcnt vmcnt(0)
zh 72
zh 73
zh 74
zh 75
s_nop 1
s_branch gw_46
gr_51:
s_cmp_lg_u32 s13, 0
s_cbranch_scc1 gr_51_x
zr 76,205,24,2048
zr 80,205,24,3072
zac 39,39
s_cmp_ge_u32 s39, 1048576
s_cselect_b32 s13, 1, 0
s_waitcnt vmcnt(1)
s_branch gw_47
gr_51_x:
s_waitcnt vmcnt(0)
zh 76
zh 77
zh 78
zh 79
s_nop 1
s_branch gw_47
gr_52:
s_cmp_lg_u32 s13, 0
s_cbranch_scc1 gr_52_x
zr 80,205,24,3072
s_nop 7
zh 88
zh 89
zh 90
zh 91
zh 92
zh 93
zh 94
zh 95
s_nop 1
zo 88,68,0,202
zo 92,68,32,202
zo 88,72,8,202
zo 92,72,40,202
zo 88,76,16,202
zo 92,76,48,202
zac 39,39
s_cmp_ge_u32 s39, 1048576
s_cselect_b32 s13, 1, 0
s_waitcnt vmcnt(0)
s_branch gw_48
gr_52_x:
s_waitcnt vmcnt(0)
zh 80
zh 81
zh 82
zh 83
s_nop 1
s_branch gw_48
gr_57:
s_cmp_lg_u32 s13, 0
s_cbranch_scc1 gr_57_x
zr 68,206,25,0
zr 72,206,25,1536
zr 76,207,25,0
zr 80,207,25,1536
zaf 84,208,25,0
zaf 86,208,25,1536
zac 39,39
s_cmp_ge_u32 s39, 1048576
s_cselect_b32 s13, 1, 0
s_waitcnt vmcnt(5)
s_branch gw_53
gr_57_x:
s_waitcnt vmcnt(0)
zh 68
zh 69
zh 70
zh 71
s_nop 1
s_branch gw_53
gr_58:
s_cmp_lg_u32 s13, 0
s_cbranch_scc1 gr_58_x
zr 72,206,25,1536
zr 76,207,25,0
zr 80,207,25,1536
zaf 84,208,25,0
zaf 86,208,25,1536
zac 39,39
s_cmp_ge_u32 s39, 1048576
s_cselect_b32 s13, 1, 0
s_waitcnt vmcnt(4)
s_branch gw_54
gr_58_x:
s_waitcnt vmcnt(0)
zh 72
zh 73
zh 74
zh 75
s_nop 1
s_branch gw_54
gr_59:
s_cmp_lg_u32 s13, 0
s_cbranch_scc1 gr_59_x
zr 76,207,25,0
zr 80,207,25,1536
zaf 84,208,25,0
zaf 86,208,25,1536
zac 39,39
s_cmp_ge_u32 s39, 1048576
s_cselect_b32 s13, 1, 0
s_waitcnt vmcnt(3)
s_branch gw_55
gr_59_x:
s_waitcnt vmcnt(0)
zh 76
zh 77
zh 78
zh 79
s_nop 1
s_branch gw_55
gr_60:
s_cmp_lg_u32 s13, 0
s_cbranch_scc1 gr_60_x
zr 80,207,25,1536
zaf 84,208,25,0
zaf 86,208,25,1536
s_nop 7
zab 116,4,68
zab 120,20,68
zv 116,8,72,116
zv 120,24,72,120
zv 116,12,76,116
zv 120,28,76,120
zac 39,39
s_cmp_ge_u32 s39, 1048576
s_cselect_b32 s13, 1, 0
s_waitcnt vmcnt(2)
s_branch gw_56
gr_60_x:
s_waitcnt vmcnt(0)
zh 80
zh 81
zh 82
zh 83
s_nop 1
s_branch gw_56
gr_63:
s_cmp_lg_u32 s13, 0
s_cbranch_scc1 gr_63_x
zaf 84,208,25,0
zaf 86,208,25,1536
zac 39,39
s_cmp_ge_u32 s39, 1048576
s_cselect_b32 s13, 1, 0
s_waitcnt vmcnt(0)
s_branch gw_62
gr_63_x:
s_waitcnt vmcnt(0)
zh 84
zh 85
zh 86
zh 87
s_nop 1
s_branch gw_62
h3r_65:
s_cmp_lg_u32 s13, 0
s_cbranch_scc1 h3r_65_x
zr 68,219,26,0
zr 72,219,27,0
zac 39,39
s_cmp_ge_u32 s39, 1048576
s_cselect_b32 s13, 1, 0
s_branch h3_64
h3r_65_x:
zh 68
zh 69
zh 70
zh 71
zh 72
zh 73
zh 74
zh 75
s_nop 1
s_branch h3_64
gr_70:
s_cmp_lg_u32 s13, 0
s_cbranch_scc1 gr_70_x
zr 68,205,24,0
zr 72,205,24,1024
zr 76,205,24,2048
zr 80,205,24,3072
s_nop 7
zh 88
zh 89
zh 90
zh 91
zh 92
zh 93
zh 94
zh 95
zac 39,39
s_cmp_ge_u32 s39, 1048576
s_cselect_b32 s13, 1, 0
s_waitcnt vmcnt(3)
s_branch gw_66
gr_70_x:
s_waitcnt vmcnt(0)
zh 68
zh 69
zh 70
zh 71
s_nop 1
s_branch gw_66
gr_71:
s_cmp_lg_u32 s13, 0
s_cbranch_scc1 gr_71_x
zr 72,205,24,1024
zr 76,205,24,2048
zr 80,205,24,3072
zac 39,39
s_cmp_ge_u32 s39, 1048576
s_cselect_b32 s13, 1, 0
s_waitcnt vmcnt(2)
s_branch gw_67
gr_71_x:
s_waitcnt vmcnt(0)
zh 72
zh 73
zh 74
zh 75
s_nop 1
s_branch gw_67
gr_72:
s_cmp_lg_u32 s13, 0
s_cbranch_scc1 gr_72_x
zr 76,205,24,2048
zr 80,205,24,3072
zac 39,39
s_cmp_ge_u32 s39, 1048576
s_cselect_b32 s13, 1, 0
s_waitcnt vmcnt(1)
s_branch gw_68
gr_72_x:
s_waitcnt vmcnt(0)
zh 76
zh 77
zh 78
zh 79
s_nop 1
s_branch gw_68
gr_73:
s_cmp_lg_u32 s13, 0
s_cbranch_scc1 gr_73_x
zr 80,205,24,3072
s_nop 7
zh 88
zh 89
zh 90
zh 91
zh 92
zh 93
zh 94
zh 95
s_nop 1
zo 88,68,0,202
zo 92,68,32,202
zo 88,72,8,202
zo 92,72,40,202
zo 88,76,16,202
zo 92,76,48,202
zac 39,39
s_cmp_ge_u32 s39, 1048576
s_cselect_b32 s13, 1, 0
s_waitcnt vmcnt(0)
s_branch gw_69
gr_73_x:
s_waitcnt vmcnt(0)
zh 80
zh 81
zh 82
zh 83
s_nop 1
s_branch gw_69
cslow_6:
zh 88
zh 89
zh 90
zh 91
zh 92
zh 93
zh 94
zh 95
zh 96
zh 97
zh 98
zh 99
zh 100
zh 101
zh 102
zh 103
zh 104
zh 105
zh 106
zh 107
zh 108
zh 109
zh 110
zh 111
s_nop 1
zo 88,68,0,202
zo 92,68,32,202
zo 96,68,64,202
zo 100,68,96,202
zo 104,68,128,202
zo 108,68,160,202
zo 88,72,8,202
zo 92,72,40,202
zo 96,72,72,202
zo 100,72,104,202
zo 104,72,136,202
zo 108,72,168,202
zo 88,76,16,202
zo 92,76,48,202
zo 96,76,80,202
zo 100,76,112,202
zo 104,76,144,202
zo 108,76,176,202
zo 88,80,24,202
zo 92,80,56,202
zo 96,80,88,202
zo 100,80,120,202
zo 104,80,152,202
zo 108,80,184,202
s_nop 2
zm 88,88,89
zm 89,90,91
zbf 212,88,89
zm 92,92,93
zm 93,94,95
zbg 212,92,93
zm 96,96,97
zm 97,98,99
zbf 213,96,97
zm 100,100,101
zm 101,102,103
zbg 213,100,101
zm 104,104,105
zm 105,106,107
zbh 214,104,0
zm 108,108,109
zm 109,110,111
zbh 214,108,512
s_waitcnt lgkmcnt(0)
s_barrier
zg 168,215,0
zg 172,215,3584
zg 176,215,7168
zg 180,215,10752
s_waitcnt lgkmcnt(2)
zm 168,168,172
zm 169,169,173
zm 170,170,174
zm 171,171,175
s_waitcnt lgkmcnt(0)
zm 176,176,180
zm 177,177,181
zm 178,178,182
zm 179,179,183
zm 168,168,176
zm 169,169,177
zm 170,170,178
zm 171,171,179
zaa 168,168,198
zaa 170,170,198
zd 168,168,169
zd 169,170,171
v_min_u32 v200, -2, v168
v_min_u32 v201, -2, v169
zap 200,216,25,0
zs 62,38,2097152
s_and_b32 s56, s62, 0xffff
s_cmp_eq_u32 s56, 0xffff
s_cbranch_scc1 wc_74_n
s_cmp_lg_u32 s3, 0
s_cbranch_scc1 wc_74_b
s_lshl_b32 s56, s56, 8
zs 56,56,85983232
s_lshr_b32 s57, s62, 16
zak 168,56
s_mov_b32 s58, 0
s_mov_b64 exec, 1
wc_74_p:
s_cmp_lg_u32 s13, 0
s_cbranch_scc1 wc_74_x
buffer_load_dword v169, v168, s[4:7], 0 offen offset:0 sc1
zac 58,58
s_cmp_ge_u32 s58, 2097152
s_cselect_b32 s13, 1, 0
s_waitcnt vmcnt(0)
v_readfirstlane_b32 s59, v169
s_cmp_lt_u32 s59, s57
s_cbranch_scc1 wc_74_p
wc_74_x:
s_mov_b64 exec, -1
wc_74_b:
s_barrier
wc_74_n:
zp 4,209,29,0
zp 20,209,29,256
zp 8,209,29,2048
zp 24,209,29,2304
zp 12,210,29,0
zp 28,210,29,256
zp 16,210,29,2048
zp 32,210,29,2304
zp 36,211,30,0
zp 40,211,30,256
zp 44,211,30,2048
zp 48,211,30,2304
zs 29,29,8192
zs 30,30,8192
zaz 20,14
s_lshl_b32 s20, s20, 19
zi 26,37,20
zi 20,26,4
s_lshr_b32 s20, s20, 21
s_xor_b32 s20, s20, s15
s_and_b32 s20, s20, 1
s_lshl_b32 s20, s20, 13
zi 26,26,20
zs 27,26,4096
zav 20,14
s_lshl_b32 s20, s20, 19
zi 28,37,20
zi 20,28,4
s_lshr_b32 s20, s20, 21
s_xor_b32 s20, s20, s15
s_and_b32 s20, s20, 1
s_lshl_b32 s20, s20, 13
zi 28,28,20
zh 124
zh 125
zh 126
zh 127
zh 128
zh 129
zh 130
zh 131
zr 68,206,25,0
zr 72,206,25,1536
zr 76,207,25,0
zr 80,207,25,1536
zaf 84,208,25,0
zaf 86,208,25,1536
gw_75:
s_waitcnt vmcnt(5)
zab 116,4,68
zab 120,20,68
zag 203,68,69,70
v_max_u32 v203, v203, v71
v_cmp_eq_u32 vcc, -1, v203
s_cbranch_vccnz gr_79
zv 112,68,68,192
gw_76:
s_waitcnt vmcnt(4)
zag 203,72,73,74
v_max_u32 v203, v203, v75
v_cmp_eq_u32 vcc, -1, v203
s_cbranch_vccnz gr_80
zv 116,8,72,116
zv 120,24,72,120
zv 112,72,72,112
gw_77:
s_waitcnt vmcnt(3)
zag 203,76,77,78
v_max_u32 v203, v203, v79
v_cmp_eq_u32 vcc, -1, v203
s_cbranch_vccnz gr_81
zv 116,12,76,116
zv 120,28,76,120
zv 112,76,76,112
gw_78:
s_waitcnt vmcnt(2)
zv 116,16,80,116
zv 120,32,80,120
zag 203,80,81,82
v_max_u32 v203, v203, v83
v_cmp_eq_u32 vcc, -1, v203
s_cbranch_vccnz gr_82
zv 112,80,80,112
s_mov_b64 exec, 0xff
zbm 225,224,81,0
s_mov_b64 exec, -1
zs 81,81,8192
zp 4,209,29,0
s_nop 3
zw 168,116,117,118
zw 169,120,121,122
zw 168,119,123,168
zw 169,112,113,169
zw 168,114,115,168
v_max_f32 v170, v168, v169
v_max_f32 v168, v168, v169
zp 20,209,29,256
s_nop 0
zu 168,170
v_max_f32 v169, v168, v170
v_max_f32 v168, v168, v170
zp 8,209,29,2048
s_nop 0
zai 168,169
v_max_f32 v168, v168, v169
zad 116,116,168
zad 118,118,168
zad 120,120,168
zad 122,122,168
zad 112,112,168
zad 114,114,168
zp 24,209,29,2304
zj 116,116
zj 117,117
zj 118,118
zj 119,119
zp 12,210,29,0
zj 120,120
zj 121,121
zj 122,122
zj 123,123
zp 28,210,29,256
zh 142
zd 136,116,117
zd 137,118,119
zd 138,120,121
zd 139,122,123
zh 143
zj 112,112
zab 132,188,136
zj 113,113
zab 88,36,136
zj 114,114
zab 92,40,136
zj 115,115
zp 16,210,29,2048
zab 96,44,136
zd 140,112,113
zd 141,114,115
zab 100,48,136
zq 170,140
zq 171,141
zae 132,188,140,132
zp 32,210,29,2304
zai 170,142
zai 171,143
gw_84:
s_waitcnt vmcnt(9)
zag 203,84,85,86
v_max_u32 v203, v203, v87
v_cmp_eq_u32 vcc, -1, v203
s_cbranch_vccnz gr_85
zae 92,84,140,92
zae 100,86,140,100
v_rcp_f32 v172, v132
zap 196,218,28,0
zae 88,84,142,88
zae 96,86,142,96
s_nop 3
zap 200,216,34,0
zaa 92,92,172
zaa 94,94,172
zd 145,92,93
zd 149,94,95
zaa 100,100,172
zaa 102,102,172
zd 147,100,101
zd 151,102,103
zaa 88,88,172
zaa 90,90,172
zd 144,88,89
zd 148,90,91
zaa 96,96,172
zaa 98,98,172
zd 146,96,97
zd 150,98,99
s_nop 0
zba 145,149
zba 147,151
zba 144,148
zba 146,150
ds_write_b128 v217, v[144:147]
s_waitcnt lgkmcnt(0)
s_barrier
zg 152,204,14336
zg 156,204,15360
zg 160,204,16384
zg 164,204,17408
s_waitcnt lgkmcnt(3)
zo 124,152,192,202
zo 128,152,224,202
s_waitcnt lgkmcnt(2)
zo 124,156,200,202
zo 128,156,232,202
s_waitcnt lgkmcnt(1)
zo 124,160,208,202
zo 128,160,240,202
s_waitcnt lgkmcnt(0)
zo 124,164,216,202
zo 128,164,248,202
s_nop 6
zm 124,124,125
zm 125,126,127
zm 128,128,129
zm 129,130,131
zd 124,124,125
zd 125,128,129
v_min_u32 v124, -2, v124
v_min_u32 v125, -2, v125
zap 124,218,26,0
zav 20,14
s_and_b32 s20, s20, 3
s_mul_i32 s20, s20, 65536
zi 32,35,20
zav 20,14
s_and_b32 s20, s20, 3
s_mul_i32 s20, s20, 196608
zi 33,36,20
zac 20,14
s_and_b32 s20, s20, 3
s_mul_i32 s20, s20, 65536
zi 31,35,20
zp 52,211,30,0
zp 56,211,30,256
zp 60,211,30,2048
zp 64,211,30,2304
zap 196,216,33,0
buffer_store_dword v196, v228, s[4:7], s32 offen offset:0 sc1
zav 20,14
s_cmp_eq_u32 s20, 4
s_cselect_b32 s20, 64, s20
s_lshr_b32 s20, s20, 3
s_lshl_b32 s20, s20, 11
zbm 221,222,20,0
s_cmp_lg_u32 s40, 0
s_cbranch_scc1 pf_83
zak 175,14
s_mov_b64 exec, 1
zbl 175,223,0
s_mov_b64 exec, -1
pf_83:
zs 29,29,8192
zs 30,30,8192
zs 34,34,196608
zac 20,14
s_and_b32 s20, s20, 3
s_mul_i32 s20, s20, 196608
zi 25,36,20
zh 88
zh 89
zh 90
zh 91
zh 92
zh 93
zh 94
zh 95
zh 96
zh 97
zh 98
zh 99
zh 100
zh 101
zh 102
zh 103
zh 104
zh 105
zh 106
zh 107
zh 108
zh 109
zh 110
zh 111
zr 68,219,26,0
zr 72,219,27,0
h3_86:
s_waitcnt vmcnt(1)
zab 168,68,184
zag 203,68,69,70
v_max_u32 v203, v203, v71
s_waitcnt vmcnt(0)
zv 168,72,184,168
zag 203,72,73,203
zag 203,74,75,203
v_cmp_eq_u32 vcc, -1, v203
s_cbranch_vccnz h3r_87
s_mov_b32 s24, s31
zac 14,14
s_nop 1
zm 168,168,169
zm 169,170,171
zd 168,168,169
v_min_u32 v168, -2, v168
buffer_store_dword v168, v228, s[4:7], s31 offen offset:0 sc1
.p2align 6
chain_loop_88:
s_waitcnt vmcnt(0)
zr 68,205,24,0
zr 72,205,24,1024
zr 76,205,24,2048
zr 80,205,24,3072
gw_89:
s_waitcnt vmcnt(3)
zo 88,68,0,202
zo 92,68,32,202
zag 203,68,69,70
v_max_u32 v203, v203, v71
v_cmp_eq_u32 vcc, -1, v203
s_cbranch_vccnz gr_93
zo 96,68,64,202
zo 100,68,96,202
gw_90:
s_waitcnt vmcnt(2)
zag 203,72,73,74
v_max_u32 v203, v203, v75
v_cmp_eq_u32 vcc, -1, v203
s_cbranch_vccnz gr_94
zo 104,68,128,202
zo 108,68,160,202
zo 88,72,8,202
zo 92,72,40,202
zo 96,72,72,202
gw_91:
s_waitcnt vmcnt(1)
zag 203,76,77,78
v_max_u32 v203, v203, v79
v_cmp_eq_u32 vcc, -1, v203
s_cbranch_vccnz gr_95
zo 100,72,104,202
zo 104,72,136,202
zo 108,72,168,202
zo 88,76,16,202
zo 92,76,48,202
zo 96,76,80,202
zo 100,76,112,202
zo 104,76,144,202
zo 108,76,176,202
gw_92:
s_waitcnt vmcnt(0)
zo 88,80,24,202
zo 92,80,56,202
zag 203,80,81,82
v_max_u32 v203, v203, v83
v_cmp_eq_u32 vcc, -1, v203
s_cbranch_vccnz gr_96
zo 96,80,88,202
zo 100,80,120,202
zo 104,80,152,202
zo 108,80,184,202
s_nop 2
zm 88,88,89
zm 89,90,91
zbf 212,88,89
zm 92,92,93
zm 93,94,95
zbg 212,92,93
zm 96,96,97
zm 97,98,99
zbf 213,96,97
zm 100,100,101
zm 101,102,103
zbg 213,100,101
zm 104,104,105
zm 105,106,107
zbh 214,104,0
zm 108,108,109
zm 109,110,111
zbh 214,108,512
s_waitcnt lgkmcnt(0)
s_barrier
zg 168,215,0
zg 172,215,3584
zg 176,215,7168
zg 180,215,10752
s_waitcnt lgkmcnt(2)
zm 168,168,172
zm 169,169,173
zm 170,170,174
zm 171,171,175
s_waitcnt lgkmcnt(0)
zm 176,176,180
zm 177,177,181
zm 178,178,182
zm 179,179,183
zm 168,168,176
zm 169,169,177
zm 170,170,178
zm 171,171,179
zaa 168,168,198
zaa 170,170,198
zd 168,168,169
zd 169,170,171
v_min_u32 v200, -2, v168
v_min_u32 v201, -2, v169
zap 200,216,25,0
zaz 20,14
s_lshl_b32 s20, s20, 19
zi 26,37,20
zi 20,26,4
s_lshr_b32 s20, s20, 21
s_xor_b32 s20, s20, s15
s_and_b32 s20, s20, 1
s_lshl_b32 s20, s20, 13
zi 26,26,20
zs 27,26,4096
zav 20,14
s_lshl_b32 s20, s20, 19
zi 28,37,20
zi 20,28,4
s_lshr_b32 s20, s20, 21
s_xor_b32 s20, s20, s15
s_and_b32 s20, s20, 1
s_lshl_b32 s20, s20, 13
zi 28,28,20
zh 124
zh 125
zh 126
zh 127
zh 128
zh 129
zh 130
zh 131
zr 68,206,25,0
zr 72,206,25,1536
zr 76,207,25,0
zr 80,207,25,1536
zaf 84,208,25,0
zaf 86,208,25,1536
gw_97:
s_waitcnt vmcnt(5)
zab 116,4,68
zab 120,20,68
zag 203,68,69,70
v_max_u32 v203, v203, v71
v_cmp_eq_u32 vcc, -1, v203
s_cbranch_vccnz gr_101
zv 112,68,68,192
gw_98:
s_waitcnt vmcnt(4)
zag 203,72,73,74
v_max_u32 v203, v203, v75
v_cmp_eq_u32 vcc, -1, v203
s_cbranch_vccnz gr_102
zv 116,8,72,116
zv 120,24,72,120
zv 112,72,72,112
gw_99:
s_waitcnt vmcnt(3)
zag 203,76,77,78
v_max_u32 v203, v203, v79
v_cmp_eq_u32 vcc, -1, v203
s_cbranch_vccnz gr_103
zv 116,12,76,116
zv 120,28,76,120
zv 112,76,76,112
gw_100:
s_waitcnt vmcnt(2)
zv 116,16,80,116
zv 120,32,80,120
zag 203,80,81,82
v_max_u32 v203, v203, v83
v_cmp_eq_u32 vcc, -1, v203
s_cbranch_vccnz gr_104
zv 112,80,80,112
v_cmp_gt_u32 vcc, 32, v221
s_cbranch_vccnz kw_105
kb_106:
s_mov_b64 exec, 0xff
zbm 225,224,81,0
s_mov_b64 exec, -1
zs 81,81,8192
zp 4,209,29,0
s_nop 3
zw 168,116,117,118
zw 169,120,121,122
zw 168,119,123,168
zw 169,112,113,169
zw 168,114,115,168
v_max_f32 v170, v168, v169
v_max_f32 v168, v168, v169
zp 20,209,29,256
s_nop 0
zu 168,170
v_max_f32 v169, v168, v170
v_max_f32 v168, v168, v170
zp 8,209,29,2048
s_nop 0
zai 168,169
v_max_f32 v168, v168, v169
zad 116,116,168
zad 118,118,168
zad 120,120,168
zad 122,122,168
zad 112,112,168
zad 114,114,168
zp 24,209,29,2304
zj 116,116
zj 117,117
zj 118,118
zj 119,119
zp 12,210,29,0
zj 120,120
zj 121,121
zj 122,122
zj 123,123
zp 28,210,29,256
zh 142
zd 136,116,117
zd 137,118,119
zd 138,120,121
zd 139,122,123
zh 143
zj 112,112
zab 132,188,136
zj 113,113
zab 88,52,136
zj 114,114
zab 92,56,136
zj 115,115
zp 16,210,29,2048
zab 96,60,136
zd 140,112,113
zd 141,114,115
zab 100,64,136
zq 170,140
zq 171,141
zae 132,188,140,132
zp 32,210,29,2304
zai 170,142
zai 171,143
gw_108:
s_waitcnt vmcnt(9)
zag 203,84,85,86
v_max_u32 v203, v203, v87
v_cmp_eq_u32 vcc, -1, v203
s_cbranch_vccnz gr_109
zae 92,84,140,92
zae 100,86,140,100
v_rcp_f32 v172, v132
zap 196,218,28,0
zae 88,84,142,88
zae 96,86,142,96
s_nop 3
zap 200,216,34,0
zaa 92,92,172
zaa 94,94,172
zd 145,92,93
zd 149,94,95
zaa 100,100,172
zaa 102,102,172
zd 147,100,101
zd 151,102,103
zaa 88,88,172
zaa 90,90,172
zd 144,88,89
zd 148,90,91
zaa 96,96,172
zaa 98,98,172
zd 146,96,97
zd 150,98,99
s_nop 0
zba 145,149
zba 147,151
zba 144,148
zba 146,150
ds_write_b128 v217, v[144:147]
s_waitcnt lgkmcnt(0)
s_barrier
zg 152,204,14336
zg 156,204,15360
zg 160,204,16384
zg 164,204,17408
s_waitcnt lgkmcnt(3)
zo 124,152,192,202
zo 128,152,224,202
s_waitcnt lgkmcnt(2)
zo 124,156,200,202
zo 128,156,232,202
s_waitcnt lgkmcnt(1)
zo 124,160,208,202
zo 128,160,240,202
s_waitcnt lgkmcnt(0)
zo 124,164,216,202
zo 128,164,248,202
s_nop 6
zm 124,124,125
zm 125,126,127
zm 128,128,129
zm 129,130,131
zd 124,124,125
zd 125,128,129
v_min_u32 v124, -2, v124
v_min_u32 v125, -2, v125
zap 124,218,26,0
zav 20,14
s_and_b32 s20, s20, 3
s_mul_i32 s20, s20, 65536
zi 32,35,20
zav 20,14
s_and_b32 s20, s20, 3
s_mul_i32 s20, s20, 196608
zi 33,36,20
zac 20,14
s_and_b32 s20, s20, 3
s_mul_i32 s20, s20, 65536
zi 31,35,20
zp 36,211,30,0
zp 40,211,30,256
zp 44,211,30,2048
zp 48,211,30,2304
zap 196,216,33,0
buffer_store_dword v196, v228, s[4:7], s32 offen offset:0 sc1
s_cmp_lg_u32 s40, 0
s_cbranch_scc1 pf_107
zak 175,14
s_mov_b64 exec, 1
zbl 175,223,0
s_mov_b64 exec, -1
pf_107:
zs 29,29,8192
zs 30,30,8192
zs 34,34,196608
zac 20,14
s_and_b32 s20, s20, 3
s_mul_i32 s20, s20, 196608
zi 25,36,20
zh 88
zh 89
zh 90
zh 91
zh 92
zh 93
zh 94
zh 95
zh 96
zh 97
zh 98
zh 99
zh 100
zh 101
zh 102
zh 103
zh 104
zh 105
zh 106
zh 107
zh 108
zh 109
zh 110
zh 111
zr 68,219,26,0
zr 72,219,27,0
h3_110:
s_waitcnt vmcnt(1)
zab 168,68,184
zag 203,68,69,70
v_max_u32 v203, v203, v71
s_waitcnt vmcnt(0)
zv 168,72,184,168
zag 203,72,73,203
zag 203,74,75,203
v_cmp_eq_u32 vcc, -1, v203
s_cbranch_vccnz h3r_111
s_mov_b32 s24, s31
zac 14,14
s_nop 1
zm 168,168,169
zm 169,170,171
zd 168,168,169
v_min_u32 v168, -2, v168
buffer_store_dword v168, v228, s[4:7], s31 offen offset:0 sc1
s_waitcnt vmcnt(0)
zr 68,205,24,0
zr 72,205,24,1024
zr 76,205,24,2048
zr 80,205,24,3072
gw_112:
s_waitcnt vmcnt(3)
zo 88,68,0,202
zo 92,68,32,202
zag 203,68,69,70
v_max_u32 v203, v203, v71
v_cmp_eq_u32 vcc, -1, v203
s_cbranch_vccnz gr_116
zo 96,68,64,202
zo 100,68,96,202
gw_113:
s_waitcnt vmcnt(2)
zag 203,72,73,74
v_max_u32 v203, v203, v75
v_cmp_eq_u32 vcc, -1, v203
s_cbranch_vccnz gr_117
zo 104,68,128,202
zo 108,68,160,202
zo 88,72,8,202
zo 92,72,40,202
zo 96,72,72,202
gw_114:
s_waitcnt vmcnt(1)
zag 203,76,77,78
v_max_u32 v203, v203, v79
v_cmp_eq_u32 vcc, -1, v203
s_cbranch_vccnz gr_118
zo 100,72,104,202
zo 104,72,136,202
zo 108,72,168,202
zo 88,76,16,202
zo 92,76,48,202
zo 96,76,80,202
zo 100,76,112,202
zo 104,76,144,202
zo 108,76,176,202
gw_115:
s_waitcnt vmcnt(0)
zo 88,80,24,202
zo 92,80,56,202
zag 203,80,81,82
v_max_u32 v203, v203, v83
v_cmp_eq_u32 vcc, -1, v203
s_cbranch_vccnz gr_119
zo 96,80,88,202
zo 100,80,120,202
zo 104,80,152,202
zo 108,80,184,202
s_nop 2
zm 88,88,89
zm 89,90,91
zbf 212,88,89
zm 92,92,93
zm 93,94,95
zbg 212,92,93
zm 96,96,97
zm 97,98,99
zbf 213,96,97
zm 100,100,101
zm 101,102,103
zbg 213,100,101
zm 104,104,105
zm 105,106,107
zbh 214,104,0
zm 108,108,109
zm 109,110,111
zbh 214,108,512
s_waitcnt lgkmcnt(0)
s_barrier
zg 168,215,0
zg 172,215,3584
zg 176,215,7168
zg 180,215,10752
s_waitcnt lgkmcnt(2)
zm 168,168,172
zm 169,169,173
zm 170,170,174
zm 171,171,175
s_waitcnt lgkmcnt(0)
zm 176,176,180
zm 177,177,181
zm 178,178,182
zm 179,179,183
zm 168,168,176
zm 169,169,177
zm 170,170,178
zm 171,171,179
zaa 168,168,198
zaa 170,170,198
zd 168,168,169
zd 169,170,171
v_min_u32 v200, -2, v168
v_min_u32 v201, -2, v169
zap 200,216,25,0
zaz 20,14
s_lshl_b32 s20, s20, 19
zi 26,37,20
zi 20,26,4
s_lshr_b32 s20, s20, 21
s_xor_b32 s20, s20, s15
s_and_b32 s20, s20, 1
s_lshl_b32 s20, s20, 13
zi 26,26,20
zs 27,26,4096
zav 20,14
s_lshl_b32 s20, s20, 19
zi 28,37,20
zi 20,28,4
s_lshr_b32 s20, s20, 21
s_xor_b32 s20, s20, s15
s_and_b32 s20, s20, 1
s_lshl_b32 s20, s20, 13
zi 28,28,20
zh 124
zh 125
zh 126
zh 127
zh 128
zh 129
zh 130
zh 131
zr 68,206,25,0
zr 72,206,25,1536
zr 76,207,25,0
zr 80,207,25,1536
zaf 84,208,25,0
zaf 86,208,25,1536
gw_120:
s_waitcnt vmcnt(5)
zab 116,4,68
zab 120,20,68
zag 203,68,69,70
v_max_u32 v203, v203, v71
v_cmp_eq_u32 vcc, -1, v203
s_cbranch_vccnz gr_124
zv 112,68,68,192
gw_121:
s_waitcnt vmcnt(4)
zag 203,72,73,74
v_max_u32 v203, v203, v75
v_cmp_eq_u32 vcc, -1, v203
s_cbranch_vccnz gr_125
zv 116,8,72,116
zv 120,24,72,120
zv 112,72,72,112
gw_122:
s_waitcnt vmcnt(3)
zag 203,76,77,78
v_max_u32 v203, v203, v79
v_cmp_eq_u32 vcc, -1, v203
s_cbranch_vccnz gr_126
zv 116,12,76,116
zv 120,28,76,120
zv 112,76,76,112
gw_123:
s_waitcnt vmcnt(2)
zv 116,16,80,116
zv 120,32,80,120
zag 203,80,81,82
v_max_u32 v203, v203, v83
v_cmp_eq_u32 vcc, -1, v203
s_cbranch_vccnz gr_127
zv 112,80,80,112
s_mov_b64 exec, 0xff
zbm 225,224,81,0
s_mov_b64 exec, -1
zs 81,81,8192
zp 4,209,29,0
s_nop 3
zw 168,116,117,118
zw 169,120,121,122
zw 168,119,123,168
zw 169,112,113,169
zw 168,114,115,168
v_max_f32 v170, v168, v169
v_max_f32 v168, v168, v169
zp 20,209,29,256
s_nop 0
zu 168,170
v_max_f32 v169, v168, v170
v_max_f32 v168, v168, v170
zp 8,209,29,2048
s_nop 0
zai 168,169
v_max_f32 v168, v168, v169
zad 116,116,168
zad 118,118,168
zad 120,120,168
zad 122,122,168
zad 112,112,168
zad 114,114,168
zp 24,209,29,2304
zj 116,116
zj 117,117
zj 118,118
zj 119,119
zp 12,210,29,0
zj 120,120
zj 121,121
zj 122,122
zj 123,123
zp 28,210,29,256
zh 142
zd 136,116,117
zd 137,118,119
zd 138,120,121
zd 139,122,123
zh 143
zj 112,112
zab 132,188,136
zj 113,113
zab 88,36,136
zj 114,114
zab 92,40,136
zj 115,115
zp 16,210,29,2048
zab 96,44,136
zd 140,112,113
zd 141,114,115
zab 100,48,136
zq 170,140
zq 171,141
zae 132,188,140,132
zp 32,210,29,2304
zai 170,142
zai 171,143
gw_129:
s_waitcnt vmcnt(9)
zag 203,84,85,86
v_max_u32 v203, v203, v87
v_cmp_eq_u32 vcc, -1, v203
s_cbranch_vccnz gr_130
zae 92,84,140,92
zae 100,86,140,100
v_rcp_f32 v172, v132
zap 196,218,28,0
zae 88,84,142,88
zae 96,86,142,96
s_nop 3
zap 200,216,34,0
zaa 92,92,172
zaa 94,94,172
zd 145,92,93
zd 149,94,95
zaa 100,100,172
zaa 102,102,172
zd 147,100,101
zd 151,102,103
zaa 88,88,172
zaa 90,90,172
zd 144,88,89
zd 148,90,91
zaa 96,96,172
zaa 98,98,172
zd 146,96,97
zd 150,98,99
s_nop 0
zba 145,149
zba 147,151
zba 144,148
zba 146,150
ds_write_b128 v217, v[144:147]
s_waitcnt lgkmcnt(0)
s_barrier
zg 152,204,14336
zg 156,204,15360
zg 160,204,16384
zg 164,204,17408
s_waitcnt lgkmcnt(3)
zo 124,152,192,202
zo 128,152,224,202
s_waitcnt lgkmcnt(2)
zo 124,156,200,202
zo 128,156,232,202
s_waitcnt lgkmcnt(1)
zo 124,160,208,202
zo 128,160,240,202
s_waitcnt lgkmcnt(0)
zo 124,164,216,202
zo 128,164,248,202
s_nop 6
zm 124,124,125
zm 125,126,127
zm 128,128,129
zm 129,130,131
zd 124,124,125
zd 125,128,129
v_min_u32 v124, -2, v124
v_min_u32 v125, -2, v125
zap 124,218,26,0
zav 20,14
s_and_b32 s20, s20, 3
s_mul_i32 s20, s20, 65536
zi 32,35,20
zav 20,14
s_and_b32 s20, s20, 3
s_mul_i32 s20, s20, 196608
zi 33,36,20
zac 20,14
s_and_b32 s20, s20, 3
s_mul_i32 s20, s20, 65536
zi 31,35,20
zp 52,211,30,0
zp 56,211,30,256
zp 60,211,30,2048
zp 64,211,30,2304
zap 196,216,33,0
buffer_store_dword v196, v228, s[4:7], s32 offen offset:0 sc1
zav 20,14
s_cmp_eq_u32 s20, 4
s_cselect_b32 s20, 64, s20
s_lshr_b32 s20, s20, 3
s_lshl_b32 s20, s20, 11
zbm 221,222,20,0
s_cmp_lg_u32 s40, 0
s_cbranch_scc1 pf_128
zak 175,14
s_mov_b64 exec, 1
zbl 175,223,0
s_mov_b64 exec, -1
pf_128:
zs 29,29,8192
zs 30,30,8192
zs 34,34,196608
zac 20,14
s_and_b32 s20, s20, 3
s_mul_i32 s20, s20, 196608
zi 25,36,20
zh 88
zh 89
zh 90
zh 91
zh 92
zh 93
zh 94
zh 95
zh 96
zh 97
zh 98
zh 99
zh 100
zh 101
zh 102
zh 103
zh 104
zh 105
zh 106
zh 107
zh 108
zh 109
zh 110
zh 111
zr 68,219,26,0
zr 72,219,27,0
h3_131:
s_waitcnt vmcnt(1)
zab 168,68,184
zag 203,68,69,70
v_max_u32 v203, v203, v71
s_waitcnt vmcnt(0)
zv 168,72,184,168
zag 203,72,73,203
zag 203,74,75,203
v_cmp_eq_u32 vcc, -1, v203
s_cbranch_vccnz h3r_132
s_mov_b32 s24, s31
zac 14,14
s_nop 1
zm 168,168,169
zm 169,170,171
zd 168,168,169
v_min_u32 v168, -2, v168
buffer_store_dword v168, v228, s[4:7], s31 offen offset:0 sc1
s_cmp_lt_u32 s14, 63
s_cbranch_scc1 chain_loop_88
s_waitcnt vmcnt(0)
zr 68,205,24,0
zr 72,205,24,1024
zr 76,205,24,2048
zr 80,205,24,3072
gw_133:
s_waitcnt vmcnt(3)
zo 88,68,0,202
zo 92,68,32,202
zag 203,68,69,70
v_max_u32 v203, v203, v71
v_cmp_eq_u32 vcc, -1, v203
s_cbranch_vccnz gr_137
zo 96,68,64,202
zo 100,68,96,202
gw_134:
s_waitcnt vmcnt(2)
zag 203,72,73,74
v_max_u32 v203, v203, v75
v_cmp_eq_u32 vcc, -1, v203
s_cbranch_vccnz gr_138
zo 104,68,128,202
zo 108,68,160,202
zo 88,72,8,202
zo 92,72,40,202
zo 96,72,72,202
gw_135:
s_waitcnt vmcnt(1)
zag 203,76,77,78
v_max_u32 v203, v203, v79
v_cmp_eq_u32 vcc, -1, v203
s_cbranch_vccnz gr_139
zo 100,72,104,202
zo 104,72,136,202
zo 108,72,168,202
zo 88,76,16,202
zo 92,76,48,202
zo 96,76,80,202
zo 100,76,112,202
zo 104,76,144,202
zo 108,76,176,202
gw_136:
s_waitcnt vmcnt(0)
zo 88,80,24,202
zo 92,80,56,202
zag 203,80,81,82
v_max_u32 v203, v203, v83
v_cmp_eq_u32 vcc, -1, v203
s_cbranch_vccnz gr_140
zo 96,80,88,202
zo 100,80,120,202
zo 104,80,152,202
zo 108,80,184,202
s_nop 2
zm 88,88,89
zm 89,90,91
zbf 212,88,89
zm 92,92,93
zm 93,94,95
zbg 212,92,93
zm 96,96,97
zm 97,98,99
zbf 213,96,97
zm 100,100,101
zm 101,102,103
zbg 213,100,101
zm 104,104,105
zm 105,106,107
zbh 214,104,0
zm 108,108,109
zm 109,110,111
zbh 214,108,512
s_waitcnt lgkmcnt(0)
s_barrier
zg 168,215,0
zg 172,215,3584
zg 176,215,7168
zg 180,215,10752
s_waitcnt lgkmcnt(2)
zm 168,168,172
zm 169,169,173
zm 170,170,174
zm 171,171,175
s_waitcnt lgkmcnt(0)
zm 176,176,180
zm 177,177,181
zm 178,178,182
zm 179,179,183
zm 168,168,176
zm 169,169,177
zm 170,170,178
zm 171,171,179
zaa 168,168,198
zaa 170,170,198
zd 168,168,169
zd 169,170,171
v_min_u32 v200, -2, v168
v_min_u32 v201, -2, v169
zap 200,216,34,0
s_branch cdone_5
gr_79:
s_cmp_lg_u32 s13, 0
s_cbranch_scc1 gr_79_x
zr 68,206,25,0
zr 72,206,25,1536
zr 76,207,25,0
zr 80,207,25,1536
zaf 84,208,25,0
zaf 86,208,25,1536
zac 39,39
s_cmp_ge_u32 s39, 1048576
s_cselect_b32 s13, 1, 0
s_waitcnt vmcnt(5)
s_branch gw_75
gr_79_x:
s_waitcnt vmcnt(0)
zh 68
zh 69
zh 70
zh 71
s_nop 1
s_branch gw_75
gr_80:
s_cmp_lg_u32 s13, 0
s_cbranch_scc1 gr_80_x
zr 72,206,25,1536
zr 76,207,25,0
zr 80,207,25,1536
zaf 84,208,25,0
zaf 86,208,25,1536
zac 39,39
s_cmp_ge_u32 s39, 1048576
s_cselect_b32 s13, 1, 0
s_waitcnt vmcnt(4)
s_branch gw_76
gr_80_x:
s_waitcnt vmcnt(0)
zh 72
zh 73
zh 74
zh 75
s_nop 1
s_branch gw_76
gr_81:
s_cmp_lg_u32 s13, 0
s_cbranch_scc1 gr_81_x
zr 76,207,25,0
zr 80,207,25,1536
zaf 84,208,25,0
zaf 86,208,25,1536
zac 39,39
s_cmp_ge_u32 s39, 1048576
s_cselect_b32 s13, 1, 0
s_waitcnt vmcnt(3)
s_branch gw_77
gr_81_x:
s_waitcnt vmcnt(0)
zh 76
zh 77
zh 78
zh 79
s_nop 1
s_branch gw_77
gr_82:
s_cmp_lg_u32 s13, 0
s_cbranch_scc1 gr_82_x
zr 80,207,25,1536
zaf 84,208,25,0
zaf 86,208,25,1536
s_nop 7
zab 116,4,68
zab 120,20,68
zv 116,8,72,116
zv 120,24,72,120
zv 116,12,76,116
zv 120,28,76,120
zac 39,39
s_cmp_ge_u32 s39, 1048576
s_cselect_b32 s13, 1, 0
s_waitcnt vmcnt(2)
s_branch gw_78
gr_82_x:
s_waitcnt vmcnt(0)
zh 80
zh 81
zh 82
zh 83
s_nop 1
s_branch gw_78
gr_85:
s_cmp_lg_u32 s13, 0
s_cbranch_scc1 gr_85_x
zaf 84,208,25,0
zaf 86,208,25,1536
zac 39,39
s_cmp_ge_u32 s39, 1048576
s_cselect_b32 s13, 1, 0
s_waitcnt vmcnt(0)
s_branch gw_84
gr_85_x:
s_waitcnt vmcnt(0)
zh 84
zh 85
zh 86
zh 87
s_nop 1
s_branch gw_84
h3r_87:
s_cmp_lg_u32 s13, 0
s_cbranch_scc1 h3r_87_x
zr 68,219,26,0
zr 72,219,27,0
zac 39,39
s_cmp_ge_u32 s39, 1048576
s_cselect_b32 s13, 1, 0
s_branch h3_86
h3r_87_x:
zh 68
zh 69
zh 70
zh 71
zh 72
zh 73
zh 74
zh 75
s_nop 1
s_branch h3_86
gr_93:
s_cmp_lg_u32 s13, 0
s_cbranch_scc1 gr_93_x
zr 68,205,24,0
zr 72,205,24,1024
zr 76,205,24,2048
zr 80,205,24,3072
s_nop 7
zh 88
zh 89
zh 90
zh 91
zh 92
zh 93
zh 94
zh 95
zac 39,39
s_cmp_ge_u32 s39, 1048576
s_cselect_b32 s13, 1, 0
s_waitcnt vmcnt(3)
s_branch gw_89
gr_93_x:
s_waitcnt vmcnt(0)
zh 68
zh 69
zh 70
zh 71
s_nop 1
s_branch gw_89
gr_94:
s_cmp_lg_u32 s13, 0
s_cbranch_scc1 gr_94_x
zr 72,205,24,1024
zr 76,205,24,2048
zr 80,205,24,3072
zac 39,39
s_cmp_ge_u32 s39, 1048576
s_cselect_b32 s13, 1, 0
s_waitcnt vmcnt(2)
s_branch gw_90
gr_94_x:
s_waitcnt vmcnt(0)
zh 72
zh 73
zh 74
zh 75
s_nop 1
s_branch gw_90
gr_95:
s_cmp_lg_u32 s13, 0
s_cbranch_scc1 gr_95_x
zr 76,205,24,2048
zr 80,205,24,3072
zac 39,39
s_cmp_ge_u32 s39, 1048576
s_cselect_b32 s13, 1, 0
s_waitcnt vmcnt(1)
s_branch gw_91
gr_95_x:
s_waitcnt vmcnt(0)
zh 76
zh 77
zh 78
zh 79
s_nop 1
s_branch gw_91
gr_96:
s_cmp_lg_u32 s13, 0
s_cbranch_scc1 gr_96_x
zr 80,205,24,3072
s_nop 7
zh 88
zh 89
zh 90
zh 91
zh 92
zh 93
zh 94
zh 95
s_nop 1
zo 88,68,0,202
zo 92,68,32,202
zo 88,72,8,202
zo 92,72,40,202
zo 88,76,16,202
zo 92,76,48,202
zac 39,39
s_cmp_ge_u32 s39, 1048576
s_cselect_b32 s13, 1, 0
s_waitcnt vmcnt(0)
s_branch gw_92
gr_96_x:
s_waitcnt vmcnt(0)
zh 80
zh 81
zh 82
zh 83
s_nop 1
s_branch gw_92
gr_101:
s_cmp_lg_u32 s13, 0
s_cbranch_scc1 gr_101_x
zr 68,206,25,0
zr 72,206,25,1536
zr 76,207,25,0
zr 80,207,25,1536
zaf 84,208,25,0
zaf 86,208,25,1536
zac 39,39
s_cmp_ge_u32 s39, 1048576
s_cselect_b32 s13, 1, 0
s_waitcnt vmcnt(5)
s_branch gw_97
gr_101_x:
s_waitcnt vmcnt(0)
zh 68
zh 69
zh 70
zh 71
s_nop 1
s_branch gw_97
gr_102:
s_cmp_lg_u32 s13, 0
s_cbranch_scc1 gr_102_x
zr 72,206,25,1536
zr 76,207,25,0
zr 80,207,25,1536
zaf 84,208,25,0
zaf 86,208,25,1536
zac 39,39
s_cmp_ge_u32 s39, 1048576
s_cselect_b32 s13, 1, 0
s_waitcnt vmcnt(4)
s_branch gw_98
gr_102_x:
s_waitcnt vmcnt(0)
zh 72
zh 73
zh 74
zh 75
s_nop 1
s_branch gw_98
gr_103:
s_cmp_lg_u32 s13, 0
s_cbranch_scc1 gr_103_x
zr 76,207,25,0
zr 80,207,25,1536
zaf 84,208,25,0
zaf 86,208,25,1536
zac 39,39
s_cmp_ge_u32 s39, 1048576
s_cselect_b32 s13, 1, 0
s_waitcnt vmcnt(3)
s_branch gw_99
gr_103_x:
s_waitcnt vmcnt(0)
zh 76
zh 77
zh 78
zh 79
s_nop 1
s_branch gw_99
gr_104:
s_cmp_lg_u32 s13, 0
s_cbranch_scc1 gr_104_x
zr 80,207,25,1536
zaf 84,208,25,0
zaf 86,208,25,1536
s_nop 7
zab 116,4,68
zab 120,20,68
zv 116,8,72,116
zv 120,24,72,120
zv 116,12,76,116
zv 120,28,76,120
zac 39,39
s_cmp_ge_u32 s39, 1048576
s_cselect_b32 s13, 1, 0
s_waitcnt vmcnt(2)
s_branch gw_100
gr_104_x:
s_waitcnt vmcnt(0)
zh 80
zh 81
zh 82
zh 83
s_nop 1
s_branch gw_100
kw_105:
s_cmp_lg_u32 s13, 0
s_cbranch_scc1 kb_106
zac 20,14
s_cmp_eq_u32 s20, 4
s_cselect_b32 s20, 64, s20
s_lshr_b32 s20, s20, 3
s_lshl_b32 s20, s20, 11
zbm 221,222,20,0
zac 39,39
s_cmp_ge_u32 s39, 1048576
s_cselect_b32 s13, 1, 0
s_waitcnt vmcnt(0)
v_cmp_gt_u32 vcc, 32, v221
s_cbranch_vccnz kw_105
s_branch kb_106
gr_109:
s_cmp_lg_u32 s13, 0
s_cbranch_scc1 gr_109_x
zaf 84,208,25,0
zaf 86,208,25,1536
zac 39,39
s_cmp_ge_u32 s39, 1048576
s_cselect_b32 s13, 1, 0
s_waitcnt vmcnt(0)
s_branch gw_108
gr_109_x:
s_waitcnt vmcnt(0)
zh 84
zh 85
zh 86
zh 87
s_nop 1
s_branch gw_108
h3r_111:
s_cmp_lg_u32 s13, 0
s_cbranch_scc1 h3r_111_x
zr 68,219,26,0
zr 72,219,27,0
zac 39,39
s_cmp_ge_u32 s39, 1048576
s_cselect_b32 s13, 1, 0
s_branch h3_110
h3r_111_x:
zh 68
zh 69
zh 70
zh 71
zh 72
zh 73
zh 74
zh 75
s_nop 1
s_branch h3_110
gr_116:
s_cmp_lg_u32 s13, 0
s_cbranch_scc1 gr_116_x
zr 68,205,24,0
zr 72,205,24,1024
zr 76,205,24,2048
zr 80,205,24,3072
s_nop 7
zh 88
zh 89
zh 90
zh 91
zh 92
zh 93
zh 94
zh 95
zac 39,39
s_cmp_ge_u32 s39, 1048576
s_cselect_b32 s13, 1, 0
s_waitcnt vmcnt(3)
s_branch gw_112
gr_116_x:
s_waitcnt vmcnt(0)
zh 68
zh 69
zh 70
zh 71
s_nop 1
s_branch gw_112
gr_117:
s_cmp_lg_u32 s13, 0
s_cbranch_scc1 gr_117_x
zr 72,205,24,1024
zr 76,205,24,2048
zr 80,205,24,3072
zac 39,39
s_cmp_ge_u32 s39, 1048576
s_cselect_b32 s13, 1, 0
s_waitcnt vmcnt(2)
s_branch gw_113
gr_117_x:
s_waitcnt vmcnt(0)
zh 72
zh 73
zh 74
zh 75
s_nop 1
s_branch gw_113
gr_118:
s_cmp_lg_u32 s13, 0
s_cbranch_scc1 gr_118_x
zr 76,205,24,2048
zr 80,205,24,3072
zac 39,39
s_cmp_ge_u32 s39, 1048576
s_cselect_b32 s13, 1, 0
s_waitcnt vmcnt(1)
s_branch gw_114
gr_118_x:
s_waitcnt vmcnt(0)
zh 76
zh 77
zh 78
zh 79
s_nop 1
s_branch gw_114
gr_119:
s_cmp_lg_u32 s13, 0
s_cbranch_scc1 gr_119_x
zr 80,205,24,3072
s_nop 7
zh 88
zh 89
zh 90
zh 91
zh 92
zh 93
zh 94
zh 95
s_nop 1
zo 88,68,0,202
zo 92,68,32,202
zo 88,72,8,202
zo 92,72,40,202
zo 88,76,16,202
zo 92,76,48,202
zac 39,39
s_cmp_ge_u32 s39, 1048576
s_cselect_b32 s13, 1, 0
s_waitcnt vmcnt(0)
s_branch gw_115
gr_119_x:
s_waitcnt vmcnt(0)
zh 80
zh 81
zh 82
zh 83
s_nop 1
s_branch gw_115
gr_124:
s_cmp_lg_u32 s13, 0
s_cbranch_scc1 gr_124_x
zr 68,206,25,0
zr 72,206,25,1536
zr 76,207,25,0
zr 80,207,25,1536
zaf 84,208,25,0
zaf 86,208,25,1536
zac 39,39
s_cmp_ge_u32 s39, 1048576
s_cselect_b32 s13, 1, 0
s_waitcnt vmcnt(5)
s_branch gw_120
gr_124_x:
s_waitcnt vmcnt(0)
zh 68
zh 69
zh 70
zh 71
s_nop 1
s_branch gw_120
gr_125:
s_cmp_lg_u32 s13, 0
s_cbranch_scc1 gr_125_x
zr 72,206,25,1536
zr 76,207,25,0
zr 80,207,25,1536
zaf 84,208,25,0
zaf 86,208,25,1536
zac 39,39
s_cmp_ge_u32 s39, 1048576
s_cselect_b32 s13, 1, 0
s_waitcnt vmcnt(4)
s_branch gw_121
gr_125_x:
s_waitcnt vmcnt(0)
zh 72
zh 73
zh 74
zh 75
s_nop 1
s_branch gw_121
gr_126:
s_cmp_lg_u32 s13, 0
s_cbranch_scc1 gr_126_x
zr 76,207,25,0
zr 80,207,25,1536
zaf 84,208,25,0
zaf 86,208,25,1536
zac 39,39
s_cmp_ge_u32 s39, 1048576
s_cselect_b32 s13, 1, 0
s_waitcnt vmcnt(3)
s_branch gw_122
gr_126_x:
s_waitcnt vmcnt(0)
zh 76
zh 77
zh 78
zh 79
s_nop 1
s_branch gw_122
gr_127:
s_cmp_lg_u32 s13, 0
s_cbranch_scc1 gr_127_x
zr 80,207,25,1536
zaf 84,208,25,0
zaf 86,208,25,1536
s_nop 7
zab 116,4,68
zab 120,20,68
zv 116,8,72,116
zv 120,24,72,120
zv 116,12,76,116
zv 120,28,76,120
zac 39,39
s_cmp_ge_u32 s39, 1048576
s_cselect_b32 s13, 1, 0
s_waitcnt vmcnt(2)
s_branch gw_123
gr_127_x:
s_waitcnt vmcnt(0)
zh 80
zh 81
zh 82
zh 83
s_nop 1
s_branch gw_123
gr_130:
s_cmp_lg_u32 s13, 0
s_cbranch_scc1 gr_130_x
zaf 84,208,25,0
zaf 86,208,25,1536
zac 39,39
s_cmp_ge_u32 s39, 1048576
s_cselect_b32 s13, 1, 0
s_waitcnt vmcnt(0)
s_branch gw_129
gr_130_x:
s_waitcnt vmcnt(0)
zh 84
zh 85
zh 86
zh 87
s_nop 1
s_branch gw_129
h3r_132:
s_cmp_lg_u32 s13, 0
s_cbranch_scc1 h3r_132_x
zr 68,219,26,0
zr 72,219,27,0
zac 39,39
s_cmp_ge_u32 s39, 1048576
s_cselect_b32 s13, 1, 0
s_branch h3_131
h3r_132_x:
zh 68
zh 69
zh 70
zh 71
zh 72
zh 73
zh 74
zh 75
s_nop 1
s_branch h3_131
gr_137:
s_cmp_lg_u32 s13, 0
s_cbranch_scc1 gr_137_x
zr 68,205,24,0
zr 72,205,24,1024
zr 76,205,24,2048
zr 80,205,24,3072
s_nop 7
zh 88
zh 89
zh 90
zh 91
zh 92
zh 93
zh 94
zh 95
zac 39,39
s_cmp_ge_u32 s39, 1048576
s_cselect_b32 s13, 1, 0
s_waitcnt vmcnt(3)
s_branch gw_133
gr_137_x:
s_waitcnt vmcnt(0)
zh 68
zh 69
zh 70
zh 71
s_nop 1
s_branch gw_133
gr_138:
s_cmp_lg_u32 s13, 0
s_cbranch_scc1 gr_138_x
zr 72,205,24,1024
zr 76,205,24,2048
zr 80,205,24,3072
zac 39,39
s_cmp_ge_u32 s39, 1048576
s_cselect_b32 s13, 1, 0
s_waitcnt vmcnt(2)
s_branch gw_134
gr_138_x:
s_waitcnt vmcnt(0)
zh 72
zh 73
zh 74
zh 75
s_nop 1
s_branch gw_134
gr_139:
s_cmp_lg_u32 s13, 0
s_cbranch_scc1 gr_139_x
zr 76,205,24,2048
zr 80,205,24,3072
zac 39,39
s_cmp_ge_u32 s39, 1048576
s_cselect_b32 s13, 1, 0
s_waitcnt vmcnt(1)
s_branch gw_135
gr_139_x:
s_waitcnt vmcnt(0)
zh 76
zh 77
zh 78
zh 79
s_nop 1
s_branch gw_135
gr_140:
s_cmp_lg_u32 s13, 0
s_cbranch_scc1 gr_140_x
zr 80,205,24,3072
s_nop 7
zh 88
zh 89
zh 90
zh 91
zh 92
zh 93
zh 94
zh 95
s_nop 1
zo 88,68,0,202
zo 92,68,32,202
zo 88,72,8,202
zo 92,72,40,202
zo 88,76,16,202
zo 92,76,48,202
zac 39,39
s_cmp_ge_u32 s39, 1048576
s_cselect_b32 s13, 1, 0
s_waitcnt vmcnt(0)
s_branch gw_136
gr_140_x:
s_waitcnt vmcnt(0)
zh 80
zh 81
zh 82
zh 83
s_nop 1
s_branch gw_136
cdone_5:
s_lshl_b32 s62, s16, 3
s_lshr_b32 s63, s17, 2
zi 62,62,63
zs 62,62,65772
s_and_b32 s20, s62, 0xffff
s_cmp_eq_u32 s20, 0xffff
s_cbranch_scc1 sg_141_n
s_waitcnt vmcnt(0)
s_barrier
s_cmp_lg_u32 s3, 0
s_cbranch_scc1 sg_141_n
s_lshl_b32 s20, s20, 8
zs 20,20,85983232
s_lshr_b32 s21, s62, 16
zak 168,20
zak 169,21
s_mov_b64 exec, 1
buffer_atomic_add v169, v168, s[4:7], 0 offen
s_mov_b64 exec, -1
sg_141_n:
s_add_u32 s16, s16, 8
s_mov_b32 s19, 99
s_branch worker
slow_entry:
s_waitcnt vmcnt(0) lgkmcnt(0)
s_barrier
s_cmp_lg_u32 s3, 0
s_cbranch_scc1 sl_142_w
s_mov_b64 exec, 1
zh 2
v_mov_b32 v3, 1
buffer_atomic_add v3, v2, s[8:11], 0 offen offset:140
s_mov_b32 s21, 0
sl_142_p:
buffer_load_dword v4, v2, s[8:11], 0 offen offset:140 sc1
buffer_load_dword v5, v2, s[8:11], 0 offen offset:148 sc1
zac 21,21
s_waitcnt vmcnt(0)
v_readfirstlane_b32 s22, v4
v_readfirstlane_b32 s23, v5
s_cmp_ge_u32 s21, 2097152
s_cbranch_scc1 sl_142_t
s_cmp_lt_u32 s22, 256
s_cbranch_scc1 sl_142_p
s_cmp_lt_u32 s23, 8
s_cbranch_scc1 sl_142_p
s_branch sl_142_q
sl_142_t:
s_mov_b32 s13, 1
sl_142_q:
s_mov_b64 exec, -1
sl_142_w:
s_barrier
s_mov_b32 s12, 1
s_mov_b32 s19, 99
s_lshr_b32 s16, s2, 5
s_and_b32 s17, s2, 31
s_branch role_dispatch
far_slow_entry:
s_branch slow_entry
worker:
s_load_dwordx2 s[70:71], s[0:1], 0
s_load_dwordx2 s[72:73], s[0:1], 8
s_load_dwordx2 s[74:75], s[0:1], 16
s_load_dwordx2 s[76:77], s[0:1], 24
s_load_dwordx2 s[78:79], s[0:1], 40
s_load_dwordx2 s[80:81], s[0:1], 48
s_load_dwordx2 s[82:83], s[0:1], 56
s_load_dwordx2 s[84:85], s[0:1], 64
s_load_dwordx2 s[86:87], s[0:1], 80
s_waitcnt lgkmcnt(0)
s_sub_u32 s16, s16, 4
s_lshl_b32 s14, s16, 5
zi 14,14,17
s_and_b32 s14, s14, 255
s_mul_i32 s20, s14, 256
s_getpc_b64 s[88:89]
pc_anchor:
s_add_u32 s88, s88, task_table-pc_anchor
s_addc_u32 s89, s89, 0
zi 88,88,20
s_addc_u32 s89, s89, 0
s_mov_b32 s18, 0
task_loop:
s_load_dwordx4 s[64:67], s[88:89], 0
zs 88,88,16
s_addc_u32 s89, s89, 0
s_waitcnt lgkmcnt(0)
s_and_b32 s68, s64, 0xff
s_cmp_eq_u32 s68, 0
s_cbranch_scc1 worker_done
s_and_b32 s20, s65, 0xffff
s_cmp_eq_u32 s20, 0xffff
s_cbranch_scc1 wc_143_n
s_cmp_lg_u32 s3, 0
s_cbranch_scc1 wc_143_b
s_lshl_b32 s20, s20, 8
zs 20,20,85983232
s_lshr_b32 s21, s65, 16
zak 2,20
s_mov_b32 s22, 0
s_mov_b64 exec, 1
wc_143_p:
s_cmp_lg_u32 s13, 0
s_cbranch_scc1 wc_143_x
buffer_load_dword v3, v2, s[4:7], 0 offen offset:0 sc1
zac 22,22
s_cmp_ge_u32 s22, 2097152
s_cselect_b32 s13, 1, 0
s_waitcnt vmcnt(0)
v_readfirstlane_b32 s23, v3
s_cmp_lt_u32 s23, s21
s_cbranch_scc1 wc_143_p
wc_143_x:
s_mov_b64 exec, -1
wc_143_b:
s_barrier
wc_143_n:
s_cmp_eq_u32 s68, 7
s_cbranch_scc1 no_wait2
s_and_b32 s20, s64, 0xff0000ff
s_cmp_eq_u32 s20, 16777221
s_cbranch_scc1 no_wait2
s_and_b32 s20, s66, 0xffff
s_cmp_eq_u32 s20, 0xffff
s_cbranch_scc1 wc_144_n
s_cmp_lg_u32 s3, 0
s_cbranch_scc1 wc_144_b
s_lshl_b32 s20, s20, 8
zs 20,20,85983232
s_lshr_b32 s21, s66, 16
zak 2,20
s_mov_b32 s22, 0
s_mov_b64 exec, 1
wc_144_p:
s_cmp_lg_u32 s13, 0
s_cbranch_scc1 wc_144_x
buffer_load_dword v3, v2, s[4:7], 0 offen offset:0 sc1
zac 22,22
s_cmp_ge_u32 s22, 2097152
s_cselect_b32 s13, 1, 0
s_waitcnt vmcnt(0)
v_readfirstlane_b32 s23, v3
s_cmp_lt_u32 s23, s21
s_cbranch_scc1 wc_144_p
wc_144_x:
s_mov_b64 exec, -1
wc_144_b:
s_barrier
wc_144_n:
no_wait2:
s_bfe_u32 s46, s64, 0x80008
s_bfe_u32 s47, s64, 0x80010
s_bfe_u32 s48, s64, 0x80018
s_cmp_eq_u32 s68, 1
s_cbranch_scc1 j_t_p128
s_cmp_eq_u32 s68, 2
s_cbranch_scc1 j_t_p256
s_cmp_eq_u32 s68, 3
s_cbranch_scc1 j_t_att
s_cmp_eq_u32 s68, 4
s_cbranch_scc1 j_t_outa
s_cmp_eq_u32 s68, 5
s_cbranch_scc1 j_t_xat
s_cmp_eq_u32 s68, 7
s_cbranch_scc1 j_t_outs
s_cmp_eq_u32 s68, 8
s_cbranch_scc1 j_t_outb1
s_branch j_t_outb
j_t_p128:
s_getpc_b64 s[20:21]
ja_t_p128:
s_add_u32 s20, s20, t_p128-ja_t_p128
s_addc_u32 s21, s21, 0
s_setpc_b64 s[20:21]
j_t_p256:
s_getpc_b64 s[20:21]
ja_t_p256:
s_add_u32 s20, s20, t_p256-ja_t_p256
s_addc_u32 s21, s21, 0
s_setpc_b64 s[20:21]
j_t_att:
s_getpc_b64 s[20:21]
ja_t_att:
s_add_u32 s20, s20, t_att-ja_t_att
s_addc_u32 s21, s21, 0
s_setpc_b64 s[20:21]
j_t_outa:
s_getpc_b64 s[20:21]
ja_t_outa:
s_add_u32 s20, s20, t_outa-ja_t_outa
s_addc_u32 s21, s21, 0
s_setpc_b64 s[20:21]
j_t_xat:
s_getpc_b64 s[20:21]
ja_t_xat:
s_add_u32 s20, s20, t_xat-ja_t_xat
s_addc_u32 s21, s21, 0
s_setpc_b64 s[20:21]
j_t_outb:
s_getpc_b64 s[20:21]
ja_t_outb:
s_add_u32 s20, s20, t_outb-ja_t_outb
s_addc_u32 s21, s21, 0
s_setpc_b64 s[20:21]
j_t_outs:
s_getpc_b64 s[20:21]
ja_t_outs:
s_add_u32 s20, s20, t_outs-ja_t_outs
s_addc_u32 s21, s21, 0
s_setpc_b64 s[20:21]
j_t_outb1:
s_getpc_b64 s[20:21]
ja_t_outb1:
s_add_u32 s20, s20, t_outb1-ja_t_outb1
s_addc_u32 s21, s21, 0
s_setpc_b64 s[20:21]
task_next:
s_cmp_lg_u32 s19, 0
s_cbranch_scc1 task_sig
s_cmp_lg_u32 s3, 0
s_cbranch_scc1 cf_145_w
s_mov_b64 exec, 1
zh 8
zax 9,163808
s_mov_b32 s56, 0
cf_145_p:
buffer_load_dwordx4 v[12:15], v8, s[8:11], 0 offen offset:128 sc1
buffer_load_dwordx2 v[10:11], v8, s[8:11], 0 offen offset:148 sc1
zac 56,56
s_waitcnt vmcnt(0)
v_readfirstlane_b32 s57, v12
v_readfirstlane_b32 s59, v13
v_readfirstlane_b32 s60, v14
v_readfirstlane_b32 s58, v10
v_readfirstlane_b32 s61, v11
s_cmp_ge_u32 s56, 2097152
s_cbranch_scc1 cf_145_t
s_cmp_lg_u32 s12, 0
s_cbranch_scc1 cf_145_s
s_cmp_lg_u32 s59, 0
s_cbranch_scc1 cf_145_q
s_cmp_lt_u32 s57, 8
s_cbranch_scc1 cf_145_p
s_cmp_lt_u32 s58, 8
s_cbranch_scc1 cf_145_p
s_branch cf_145_r
cf_145_s:
s_mov_b32 s59, 0
s_mov_b32 s60, s61
cf_145_r:
s_branch cf_145_q
cf_145_t:
s_mov_b32 s13, 1
s_mov_b32 s59, 0
cf_145_q:
zak 12,59
zak 13,60
zak 14,13
ds_write_b96 v9, v[12:14] offset:16
s_mov_b64 exec, -1
s_waitcnt lgkmcnt(0)
cf_145_w:
s_barrier
zax 9,163808
ds_read_b96 v[12:14], v9 offset:16
s_waitcnt lgkmcnt(0)
v_readfirstlane_b32 s59, v12
v_readfirstlane_b32 s60, v13
v_readfirstlane_b32 s13, v14
s_barrier
s_cmp_lg_u32 s59, 0
s_cbranch_scc1 far_slow_entry
s_mov_b32 s19, 2
task_sig:
s_and_b32 s20, s67, 0xffff
s_cmp_eq_u32 s20, 0xffff
s_cbranch_scc1 sg_146_n
s_waitcnt vmcnt(0)
s_barrier
s_cmp_lg_u32 s3, 0
s_cbranch_scc1 sg_146_n
s_lshl_b32 s20, s20, 8
zs 20,20,85983232
s_lshr_b32 s21, s67, 16
zak 2,20
zak 3,21
s_mov_b64 exec, 1
buffer_atomic_add v3, v2, s[4:7], 0 offen
s_mov_b64 exec, -1
sg_146_n:
s_cmp_eq_u32 s19, 2
s_cbranch_scc0 task_nt
s_mov_b32 s19, 1
s_and_b32 s20, s14, 127
s_lshl_b32 s20, s20, 2
zi 20,20,3
s_mul_i32 s20, s20, 8192
v_and_b32 v2, 63, v0
v_lshl_add_u32 v2, v2, 7, s20
s_mov_b64 s[24:25], s[76:77]
s_mov_b32 s26, 4194304
s_mov_b32 s27, 0x20000
s_mov_b32 s21, 0
buffer_load_dword v250, v2, s[24:27], s21 offen offset:0
s_mov_b32 s19, 10
task_nt:
s_branch task_loop
worker_done:
s_endpgm
t_p128:
s_lshl_b32 s47, s47, 7
s_and_b32 s57, s3, 1
s_cmp_eq_u32 s46, 0
s_cbranch_scc0 ps_147_b
s_mov_b64 s[50:51], s[70:71]
s_mov_b64 s[52:53], s[72:73]
s_mov_b32 s43, 6144
s_mov_b32 s54, 6291456
s_lshr_b32 s55, s48, 2
s_and_b32 s56, s48, 3
s_lshl_b32 s56, s56, 3
s_lshl_b32 s57, s57, 2
zi 56,56,57
s_lshl_b32 s56, s56, 17
s_lshl_b32 s57, s55, 22
zi 56,56,57
s_mov_b32 s37, 2048
s_mov_b32 s38, 131072
s_cmp_eq_u32 s55, 0
s_cselect_b32 s41, 0x3e8293ee, 1.0
s_cmp_eq_u32 s55, 2
s_cselect_b32 s49, 1, 0
s_branch ps_147_c
ps_147_b:
s_mov_b64 s[50:51], s[76:77]
s_cmp_eq_u32 s46, 1
s_cselect_b64 s[52:53], s[78:79], s[80:81]
s_cselect_b32 s41, 0x3e0293ee, 1.0
s_cmp_eq_u32 s46, 3
s_cselect_b64 s[52:53], s[82:83], s[52:53]
s_cselect_b32 s49, 2, 0
s_mov_b32 s43, 8192
s_mov_b32 s54, 8388608
s_lshl_b32 s56, s48, 19
s_lshl_b32 s57, s57, 12
zi 56,56,57
s_lshl_b32 s57, s46, 24
zi 56,56,57
s_mov_b32 s37, 8192
s_mov_b32 s38, 2048
ps_147_c:
s_lshr_b32 s57, s3, 1
s_mul_i32 s57, s57, 2
s_lshr_b32 s55, s47, 5
zi 57,57,55
s_mul_i32 s57, s57, s37
zi 56,56,57
s_mov_b32 s42, 2048
s_mov_b32 s35, 128
s_lshl_b32 s36, s43, 6
s_mov_b32 s34, 16
s_lshl_b32 s55, s47, 11
s_mul_i32 s57, s48, 256
s_min_u32 s55, s55, 4194304
zi 20,50,55
s_addc_u32 s21, s51, 0
s_sub_u32 s22, 4194304, s55
s_mov_b32 s23, 0x20000
s_min_u32 s57, s57, s54
zi 24,52,57
s_addc_u32 s25, s53, 0
s_sub_u32 s26, s54, s57
s_mov_b32 s27, 0x20000
s_min_u32 s56, s56, 67108864
zi 28,4,56
s_addc_u32 s29, s5, 0
s_sub_u32 s30, 67108864, s56
s_mov_b32 s31, 0x20000
s_cmp_eq_u32 s49, 0
s_cbranch_scc0 t_p128_tr
v_and_b32 v1, 63, v0
v_lshlrev_b32 v100, 4, v1
s_mul_i32 s39, s3, 32
v_lshrrev_b32 v52, 3, v1
v_add_u32 v52, s39, v52
v_mul_lo_u32 v52, v52, s42
v_and_b32 v53, 7, v1
v_lshrrev_b32 v54, 4, v1
v_xor_b32 v53, v53, v54
v_xor_b32 v54, 4, v53
v_lshl_add_u32 v53, v53, 4, v52
v_lshl_add_u32 v54, v54, 4, v52
s_lshl_b32 s39, s42, 3
s_mov_b32 s40, 0
v_add_u32 v4, s40, v53
zi 40,40,39
v_add_u32 v5, s40, v54
zi 40,40,39
v_add_u32 v6, s40, v53
zi 40,40,39
v_add_u32 v7, s40, v54
v_lshrrev_b32 v52, 4, v1
v_and_b32 v53, 15, v1
s_lshl_b32 s39, s3, 4
v_add_u32 v54, 0, v52
v_and_b32 v55, 3, v54
v_lshlrev_b32 v55, 2, v55
v_xor_b32 v55, v55, v53
v_add_u32 v54, s39, v54
v_mul_lo_u32 v54, v54, s43
v_lshl_add_u32 v8, v55, 4, v54
v_add_u32 v54, 4, v52
v_and_b32 v55, 3, v54
v_lshlrev_b32 v55, 2, v55
v_xor_b32 v55, v55, v53
v_add_u32 v54, s39, v54
v_mul_lo_u32 v54, v54, s43
v_lshl_add_u32 v9, v55, 4, v54
v_add_u32 v54, 8, v52
v_and_b32 v55, 3, v54
v_lshlrev_b32 v55, 2, v55
v_xor_b32 v55, v55, v53
v_add_u32 v54, s39, v54
v_mul_lo_u32 v54, v54, s43
v_lshl_add_u32 v10, v55, 4, v54
v_add_u32 v54, 12, v52
v_and_b32 v55, 3, v54
v_lshlrev_b32 v55, 2, v55
v_xor_b32 v55, v55, v53
v_add_u32 v54, s39, v54
v_mul_lo_u32 v54, v54, s43
v_lshl_add_u32 v11, v55, 4, v54
s_lshr_b32 s39, s3, 1
s_mul_i32 s39, s39, 8192
zs 39,39,65536
v_and_b32 v52, 31, v1
v_lshl_add_u32 v53, v52, 7, s39
v_bfe_u32 v52, v1, 1, 3
v_lshrrev_b32 v54, 5, v1
v_xor_b32 v52, v52, v54
v_xor_b32 v54, 0, v52
v_lshl_add_u32 v12, v54, 4, v53
v_xor_b32 v54, 2, v52
v_lshl_add_u32 v13, v54, 4, v53
v_xor_b32 v54, 4, v52
v_lshl_add_u32 v14, v54, 4, v53
v_xor_b32 v54, 6, v52
v_lshl_add_u32 v15, v54, 4, v53
v_bfe_u32 v52, v1, 2, 2
v_lshrrev_b32 v53, 5, v1
v_mul_u32_u24 v53, 8, v53
v_add_u32 v53, v53, v52
v_mul_u32_u24 v53, 256, v53
v_and_b32 v54, 3, v1
v_and_b32 v55, 1, v54
v_lshrrev_b32 v54, 1, v54
v_lshl_add_u32 v54, v55, 1, v54
v_bfe_u32 v55, v1, 4, 1
v_lshl_add_u32 v54, v55, 2, v54
v_lshl_add_u32 v53, v54, 3, v53
s_and_b32 s39, s3, 1
s_mul_i32 s39, s39, 2
zaz 40,39
v_xor_b32 v54, s40, v52
v_lshl_add_u32 v16, v54, 6, v53
zac 40,39
v_xor_b32 v54, s40, v52
v_lshl_add_u32 v17, v54, 6, v53
s_lshl_b32 s44, s3, 12
s_lshl_b32 s45, s3, 12
s_mov_b32 s32, 0
s_mov_b32 s33, 0
s_barrier
zay 44
s_nop 0
zk 8,33
zf 45,65536
s_nop 0
zl 4,32
zf 44,1024
s_nop 0
zk 9,33
zf 45,66560
s_nop 0
zl 5,32
zf 44,2048
s_nop 0
zk 10,33
zf 45,67584
s_nop 0
zl 6,32
zf 44,3072
s_nop 0
zk 11,33
zf 45,68608
s_nop 0
zl 7,32
zi 32,32,35
zi 33,33,36
zf 44,16384
s_nop 0
zk 8,33
zf 45,81920
s_nop 0
zl 4,32
zf 44,17408
s_nop 0
zk 9,33
zf 45,82944
s_nop 0
zl 5,32
zf 44,18432
s_nop 0
zk 10,33
zf 45,83968
s_nop 0
zl 6,32
zf 44,19456
s_nop 0
zk 11,33
zf 45,84992
s_nop 0
zl 7,32
zi 32,32,35
zi 33,33,36
zf 44,32768
s_nop 0
zk 8,33
zf 45,98304
s_nop 0
zl 4,32
zf 44,33792
s_nop 0
zk 9,33
zf 45,99328
s_nop 0
zl 5,32
zf 44,34816
s_nop 0
zk 10,33
zf 45,100352
s_nop 0
zl 6,32
zf 44,35840
s_nop 0
zk 11,33
zf 45,101376
s_nop 0
zl 7,32
zi 32,32,35
zi 33,33,36
zf 44,49152
s_nop 0
zk 8,33
zf 45,114688
s_nop 0
zl 4,32
zf 44,50176
s_nop 0
zk 9,33
zf 45,115712
s_nop 0
zl 5,32
zf 44,51200
s_nop 0
zk 10,33
zf 45,116736
s_nop 0
zl 6,32
zf 44,52224
s_nop 0
zk 11,33
zf 45,117760
s_nop 0
zl 7,32
zi 32,32,35
zi 33,33,36
s_cmp_lg_u32 s19, 0
s_cbranch_scc1 ec_148
s_cmp_lg_u32 s3, 0
s_cbranch_scc1 cf_149_w
s_mov_b64 exec, 1
zh 240
zax 241,163808
s_mov_b32 s56, 0
cf_149_p:
buffer_load_dwordx4 v[244:247], v240, s[8:11], 0 offen offset:128 sc1
buffer_load_dwordx2 v[242:243], v240, s[8:11], 0 offen offset:148 sc1
zac 56,56
s_waitcnt vmcnt(0)
v_readfirstlane_b32 s57, v244
v_readfirstlane_b32 s59, v245
v_readfirstlane_b32 s60, v246
v_readfirstlane_b32 s58, v242
v_readfirstlane_b32 s61, v243
s_cmp_ge_u32 s56, 2097152
s_cbranch_scc1 cf_149_t
s_cmp_lg_u32 s12, 0
s_cbranch_scc1 cf_149_s
s_cmp_lg_u32 s59, 0
s_cbranch_scc1 cf_149_q
s_cmp_lt_u32 s57, 8
s_cbranch_scc1 cf_149_p
s_cmp_lt_u32 s58, 8
s_cbranch_scc1 cf_149_p
s_branch cf_149_r
cf_149_s:
s_mov_b32 s59, 0
s_mov_b32 s60, s61
cf_149_r:
s_branch cf_149_q
cf_149_t:
s_mov_b32 s13, 1
s_mov_b32 s59, 0
cf_149_q:
zak 244,59
zak 245,60
zak 246,13
ds_write_b96 v241, v[244:246] offset:16
s_mov_b64 exec, -1
s_waitcnt lgkmcnt(0)
cf_149_w:
s_barrier
zax 241,163808
ds_read_b96 v[244:246], v241 offset:16
s_waitcnt lgkmcnt(0)
v_readfirstlane_b32 s59, v244
v_readfirstlane_b32 s60, v245
v_readfirstlane_b32 s13, v246
s_barrier
s_cmp_lg_u32 s59, 0
s_cbranch_scc1 far_slow_entry
s_mov_b32 s19, 2
ec_148:
s_waitcnt vmcnt(24)
s_barrier
zg 20,12,0
zc 36,16,0
zc 38,16,1024
zc 40,17,0
zc 42,17,1024
zg 24,12,4096
s_waitcnt lgkmcnt(3)
zaw 0,36,20
zg 28,13,0
zc 44,16,4096
s_waitcnt lgkmcnt(3)
zaw 16,40,20
zc 46,16,5120
zc 48,17,4096
s_waitcnt lgkmcnt(4)
zaw 32,36,24
zc 50,17,5120
zg 32,13,4096
zaw 48,40,24
s_waitcnt lgkmcnt(3)
ze 0,44,28,0
zg 20,14,0
zc 36,16,8192
s_waitcnt lgkmcnt(3)
ze 16,48,28,16
zc 38,16,9216
zc 40,17,8192
s_waitcnt lgkmcnt(4)
ze 32,44,32,32
zc 42,17,9216
zg 24,14,4096
ze 48,48,32,48
s_waitcnt lgkmcnt(3)
ze 0,36,20,0
zg 28,15,0
zc 44,16,12288
s_waitcnt lgkmcnt(3)
ze 16,40,20,16
zc 46,16,13312
zc 48,17,12288
s_waitcnt lgkmcnt(4)
ze 32,36,24,32
zc 50,17,13312
zg 32,15,4096
ze 48,40,24,48
s_sub_u32 s34, s34, 4
t_p128nr_loop_150:
s_waitcnt vmcnt(16) lgkmcnt(0)
s_barrier
zay 44
ze 0,44,28,0
zk 8,33
zg 20,12,16384
zc 36,16,16384
zf 45,65536
ze 16,48,28,16
zl 4,32
zc 38,16,17408
zc 40,17,16384
ze 32,44,32,32
zc 42,17,17408
zg 24,12,20480
ze 48,48,32,48
s_waitcnt lgkmcnt(3)
zf 44,1024
ze 0,36,20,0
zk 9,33
zg 28,13,16384
zc 44,16,20480
s_waitcnt lgkmcnt(3)
zf 45,66560
ze 16,40,20,16
zl 5,32
zc 46,16,21504
zc 48,17,20480
s_waitcnt lgkmcnt(4)
ze 32,36,24,32
zc 50,17,21504
zg 32,13,20480
ze 48,40,24,48
s_waitcnt lgkmcnt(3)
zf 44,2048
ze 0,44,28,0
zk 10,33
zg 20,14,16384
zc 36,16,24576
s_waitcnt lgkmcnt(3)
zf 45,67584
ze 16,48,28,16
zl 6,32
zc 38,16,25600
zc 40,17,24576
s_waitcnt lgkmcnt(4)
ze 32,44,32,32
zc 42,17,25600
zg 24,14,20480
ze 48,48,32,48
s_waitcnt lgkmcnt(3)
zf 44,3072
ze 0,36,20,0
zk 11,33
zg 28,15,16384
zc 44,16,28672
s_waitcnt lgkmcnt(3)
zf 45,68608
ze 16,40,20,16
zl 7,32
zc 46,16,29696
zc 48,17,28672
s_waitcnt lgkmcnt(4)
ze 32,36,24,32
zc 50,17,29696
zg 32,15,20480
ze 48,40,24,48
zi 32,32,35
zi 33,33,36
s_waitcnt vmcnt(16) lgkmcnt(0)
s_barrier
zf 44,16384
ze 0,44,28,0
zk 8,33
zg 20,12,32768
zc 36,16,32768
zf 45,81920
ze 16,48,28,16
zl 4,32
zc 38,16,33792
zc 40,17,32768
ze 32,44,32,32
zc 42,17,33792
zg 24,12,36864
ze 48,48,32,48
s_waitcnt lgkmcnt(3)
zf 44,17408
ze 0,36,20,0
zk 9,33
zg 28,13,32768
zc 44,16,36864
s_waitcnt lgkmcnt(3)
zf 45,82944
ze 16,40,20,16
zl 5,32
zc 46,16,37888
zc 48,17,36864
s_waitcnt lgkmcnt(4)
ze 32,36,24,32
zc 50,17,37888
zg 32,13,36864
ze 48,40,24,48
s_waitcnt lgkmcnt(3)
zf 44,18432
ze 0,44,28,0
zk 10,33
zg 20,14,32768
zc 36,16,40960
s_waitcnt lgkmcnt(3)
zf 45,83968
ze 16,48,28,16
zl 6,32
zc 38,16,41984
zc 40,17,40960
s_waitcnt lgkmcnt(4)
ze 32,44,32,32
zc 42,17,41984
zg 24,14,36864
ze 48,48,32,48
s_waitcnt lgkmcnt(3)
zf 44,19456
ze 0,36,20,0
zk 11,33
zg 28,15,32768
zc 44,16,45056
s_waitcnt lgkmcnt(3)
zf 45,84992
ze 16,40,20,16
zl 7,32
zc 46,16,46080
zc 48,17,45056
s_waitcnt lgkmcnt(4)
ze 32,36,24,32
zc 50,17,46080
zg 32,15,36864
ze 48,40,24,48
zi 32,32,35
zi 33,33,36
s_waitcnt vmcnt(16) lgkmcnt(0)
s_barrier
zf 44,32768
ze 0,44,28,0
zk 8,33
zg 20,12,49152
zc 36,16,49152
zf 45,98304
ze 16,48,28,16
zl 4,32
zc 38,16,50176
zc 40,17,49152
ze 32,44,32,32
zc 42,17,50176
zg 24,12,53248
ze 48,48,32,48
s_waitcnt lgkmcnt(3)
zf 44,33792
ze 0,36,20,0
zk 9,33
zg 28,13,49152
zc 44,16,53248
s_waitcnt lgkmcnt(3)
zf 45,99328
ze 16,40,20,16
zl 5,32
zc 46,16,54272
zc 48,17,53248
s_waitcnt lgkmcnt(4)
ze 32,36,24,32
zc 50,17,54272
zg 32,13,53248
ze 48,40,24,48
s_waitcnt lgkmcnt(3)
zf 44,34816
ze 0,44,28,0
zk 10,33
zg 20,14,49152
zc 36,16,57344
s_waitcnt lgkmcnt(3)
zf 45,100352
ze 16,48,28,16
zl 6,32
zc 38,16,58368
zc 40,17,57344
s_waitcnt lgkmcnt(4)
ze 32,44,32,32
zc 42,17,58368
zg 24,14,53248
ze 48,48,32,48
s_waitcnt lgkmcnt(3)
zf 44,35840
ze 0,36,20,0
zk 11,33
zg 28,15,49152
zc 44,16,61440
s_waitcnt lgkmcnt(3)
zf 45,101376
ze 16,40,20,16
zl 7,32
zc 46,16,62464
zc 48,17,61440
s_waitcnt lgkmcnt(4)
ze 32,36,24,32
zc 50,17,62464
zg 32,15,53248
ze 48,40,24,48
zi 32,32,35
zi 33,33,36
s_waitcnt vmcnt(16) lgkmcnt(0)
s_barrier
zf 44,49152
ze 0,44,28,0
zk 8,33
zg 20,12,0
zc 36,16,0
zf 45,114688
ze 16,48,28,16
zl 4,32
zc 38,16,1024
zc 40,17,0
ze 32,44,32,32
zc 42,17,1024
zg 24,12,4096
ze 48,48,32,48
s_waitcnt lgkmcnt(3)
zf 44,50176
ze 0,36,20,0
zk 9,33
zg 28,13,0
zc 44,16,4096
s_waitcnt lgkmcnt(3)
zf 45,115712
ze 16,40,20,16
zl 5,32
zc 46,16,5120
zc 48,17,4096
s_waitcnt lgkmcnt(4)
ze 32,36,24,32
zc 50,17,5120
zg 32,13,4096
ze 48,40,24,48
s_waitcnt lgkmcnt(3)
zf 44,51200
ze 0,44,28,0
zk 10,33
zg 20,14,0
zc 36,16,8192
s_waitcnt lgkmcnt(3)
zf 45,116736
ze 16,48,28,16
zl 6,32
zc 38,16,9216
zc 40,17,8192
s_waitcnt lgkmcnt(4)
ze 32,44,32,32
zc 42,17,9216
zg 24,14,4096
ze 48,48,32,48
s_waitcnt lgkmcnt(3)
zf 44,52224
ze 0,36,20,0
zk 11,33
zg 28,15,0
zc 44,16,12288
s_waitcnt lgkmcnt(3)
zf 45,117760
ze 16,40,20,16
zl 7,32
zc 46,16,13312
zc 48,17,12288
s_waitcnt lgkmcnt(4)
ze 32,36,24,32
zc 50,17,13312
zg 32,15,4096
ze 48,40,24,48
zi 32,32,35
zi 33,33,36
s_sub_u32 s34, s34, 4
s_cmp_lg_u32 s34, 0
s_cbranch_scc1 t_p128nr_loop_150
s_waitcnt vmcnt(16) lgkmcnt(0)
s_barrier
ze 0,44,28,0
zg 20,12,16384
zc 36,16,16384
ze 16,48,28,16
zc 38,16,17408
zc 40,17,16384
ze 32,44,32,32
zc 42,17,17408
zg 24,12,20480
ze 48,48,32,48
s_waitcnt lgkmcnt(3)
ze 0,36,20,0
zg 28,13,16384
zc 44,16,20480
s_waitcnt lgkmcnt(3)
ze 16,40,20,16
zc 46,16,21504
zc 48,17,20480
s_waitcnt lgkmcnt(4)
ze 32,36,24,32
zc 50,17,21504
zg 32,13,20480
ze 48,40,24,48
s_waitcnt lgkmcnt(3)
ze 0,44,28,0
zg 20,14,16384
zc 36,16,24576
s_waitcnt lgkmcnt(3)
ze 16,48,28,16
zc 38,16,25600
zc 40,17,24576
s_waitcnt lgkmcnt(4)
ze 32,44,32,32
zc 42,17,25600
zg 24,14,20480
ze 48,48,32,48
s_waitcnt lgkmcnt(3)
ze 0,36,20,0
zg 28,15,16384
zc 44,16,28672
s_waitcnt lgkmcnt(3)
ze 16,40,20,16
zc 46,16,29696
zc 48,17,28672
s_waitcnt lgkmcnt(4)
ze 32,36,24,32
zc 50,17,29696
zg 32,15,20480
ze 48,40,24,48
s_waitcnt vmcnt(8) lgkmcnt(0)
s_barrier
ze 0,44,28,0
zg 20,12,32768
zc 36,16,32768
ze 16,48,28,16
zc 38,16,33792
zc 40,17,32768
ze 32,44,32,32
zc 42,17,33792
zg 24,12,36864
ze 48,48,32,48
s_waitcnt lgkmcnt(3)
ze 0,36,20,0
zg 28,13,32768
zc 44,16,36864
s_waitcnt lgkmcnt(3)
ze 16,40,20,16
zc 46,16,37888
zc 48,17,36864
s_waitcnt lgkmcnt(4)
ze 32,36,24,32
zc 50,17,37888
zg 32,13,36864
ze 48,40,24,48
s_waitcnt lgkmcnt(3)
ze 0,44,28,0
zg 20,14,32768
zc 36,16,40960
s_waitcnt lgkmcnt(3)
ze 16,48,28,16
zc 38,16,41984
zc 40,17,40960
s_waitcnt lgkmcnt(4)
ze 32,44,32,32
zc 42,17,41984
zg 24,14,36864
ze 48,48,32,48
s_waitcnt lgkmcnt(3)
ze 0,36,20,0
zg 28,15,32768
zc 44,16,45056
s_waitcnt lgkmcnt(3)
ze 16,40,20,16
zc 46,16,46080
zc 48,17,45056
s_waitcnt lgkmcnt(4)
ze 32,36,24,32
zc 50,17,46080
zg 32,15,36864
ze 48,40,24,48
s_waitcnt vmcnt(0) lgkmcnt(0)
s_barrier
ze 0,44,28,0
zg 20,12,49152
zc 36,16,49152
ze 16,48,28,16
zc 38,16,50176
zc 40,17,49152
ze 32,44,32,32
zc 42,17,50176
zg 24,12,53248
ze 48,48,32,48
s_waitcnt lgkmcnt(3)
ze 0,36,20,0
zg 28,13,49152
zc 44,16,53248
s_waitcnt lgkmcnt(3)
ze 16,40,20,16
zc 46,16,54272
zc 48,17,53248
s_waitcnt lgkmcnt(4)
ze 32,36,24,32
zc 50,17,54272
zg 32,13,53248
ze 48,40,24,48
s_waitcnt lgkmcnt(3)
ze 0,44,28,0
zg 20,14,49152
zc 36,16,57344
s_waitcnt lgkmcnt(3)
ze 16,48,28,16
zc 38,16,58368
zc 40,17,57344
s_waitcnt lgkmcnt(4)
ze 32,44,32,32
zc 42,17,58368
zg 24,14,53248
ze 48,48,32,48
s_waitcnt lgkmcnt(3)
ze 0,36,20,0
zg 28,15,49152
zc 44,16,61440
s_waitcnt lgkmcnt(3)
ze 16,40,20,16
zc 46,16,62464
zc 48,17,61440
s_waitcnt lgkmcnt(4)
ze 32,36,24,32
zc 50,17,62464
zg 32,15,53248
ze 48,40,24,48
s_waitcnt lgkmcnt(3)
ze 0,44,28,0
s_waitcnt lgkmcnt(1)
ze 16,48,28,16
s_waitcnt lgkmcnt(0)
ze 32,44,32,32
ze 48,48,32,48
s_mov_b32 s39, 0
s_mov_b32 s40, s39
zb 52,0
zb 53,1
zb 54,2
zb 55,3
zb 56,4
zb 57,5
zb 58,6
zb 59,7
zn 52,52
zn 54,54
zn 56,56
zn 58,58
zd 92,52,53
zd 93,54,55
zd 94,56,57
zd 95,58,59
zbi 92,100,40,0
zb 60,8
zb 61,9
zb 62,10
zb 63,11
zb 64,12
zb 65,13
zb 66,14
zb 67,15
zn 60,60
zn 62,62
zn 64,64
zn 66,66
zd 84,60,61
zd 85,62,63
zd 86,64,65
zd 87,66,67
zbi 84,100,40,1024
zi 40,40,38
zb 68,16
zb 69,17
zb 70,18
zb 71,19
zb 72,20
zb 73,21
zb 74,22
zb 75,23
zn 68,68
zn 70,70
zn 72,72
zn 74,74
zd 88,68,69
zd 89,70,71
zd 90,72,73
zd 91,74,75
zbi 88,100,40,0
zb 76,24
zb 77,25
zb 78,26
zb 79,27
zb 80,28
zb 81,29
zb 82,30
zb 83,31
zn 76,76
zn 78,78
zn 80,80
zn 82,82
zd 92,76,77
zd 93,78,79
zd 94,80,81
zd 95,82,83
zbi 92,100,40,1024
zi 39,39,37
s_mov_b32 s40, s39
zb 52,32
zb 53,33
zb 54,34
zb 55,35
zb 56,36
zb 57,37
zb 58,38
zb 59,39
zn 52,52
zn 54,54
zn 56,56
zn 58,58
zd 84,52,53
zd 85,54,55
zd 86,56,57
zd 87,58,59
zbi 84,100,40,0
zb 60,40
zb 61,41
zb 62,42
zb 63,43
zb 64,44
zb 65,45
zb 66,46
zb 67,47
zn 60,60
zn 62,62
zn 64,64
zn 66,66
zd 88,60,61
zd 89,62,63
zd 90,64,65
zd 91,66,67
zbi 88,100,40,1024
zi 40,40,38
zb 68,48
zb 69,49
zb 70,50
zb 71,51
zb 72,52
zb 73,53
zb 74,54
zb 75,55
zn 68,68
zn 70,70
zn 72,72
zn 74,74
zd 92,68,69
zd 93,70,71
zd 94,72,73
zd 95,74,75
zbi 92,100,40,0
zb 76,56
zb 77,57
zb 78,58
zb 79,59
zb 80,60
zb 81,61
zb 82,62
zb 83,63
zn 76,76
zn 78,78
zn 80,80
zn 82,82
zd 84,76,77
zd 85,78,79
zd 86,80,81
zd 87,82,83
zbi 84,100,40,1024
s_getpc_b64 s[20:21]
bk_151:
s_sub_u32 s20, s20, bk_151-task_next
s_subb_u32 s21, s21, 0
s_setpc_b64 s[20:21]
t_p128_tr:
v_and_b32 v1, 63, v0
v_lshlrev_b32 v100, 4, v1
s_mul_i32 s39, s3, 32
v_lshrrev_b32 v52, 3, v1
v_add_u32 v52, s39, v52
v_mul_lo_u32 v52, v52, s42
v_and_b32 v53, 7, v1
v_lshrrev_b32 v54, 4, v1
v_xor_b32 v53, v53, v54
v_xor_b32 v54, 4, v53
v_lshl_add_u32 v53, v53, 4, v52
v_lshl_add_u32 v54, v54, 4, v52
s_lshl_b32 s39, s42, 3
s_mov_b32 s40, 0
v_add_u32 v4, s40, v53
zi 40,40,39
v_add_u32 v5, s40, v54
zi 40,40,39
v_add_u32 v6, s40, v53
zi 40,40,39
v_add_u32 v7, s40, v54
v_lshrrev_b32 v52, 4, v1
v_and_b32 v53, 15, v1
s_lshl_b32 s39, s3, 4
v_add_u32 v54, 0, v52
v_and_b32 v55, 3, v54
v_lshlrev_b32 v55, 2, v55
v_xor_b32 v55, v55, v53
v_add_u32 v54, s39, v54
v_mul_lo_u32 v54, v54, s43
v_lshl_add_u32 v8, v55, 4, v54
v_add_u32 v54, 4, v52
v_and_b32 v55, 3, v54
v_lshlrev_b32 v55, 2, v55
v_xor_b32 v55, v55, v53
v_add_u32 v54, s39, v54
v_mul_lo_u32 v54, v54, s43
v_lshl_add_u32 v9, v55, 4, v54
v_add_u32 v54, 8, v52
v_and_b32 v55, 3, v54
v_lshlrev_b32 v55, 2, v55
v_xor_b32 v55, v55, v53
v_add_u32 v54, s39, v54
v_mul_lo_u32 v54, v54, s43
v_lshl_add_u32 v10, v55, 4, v54
v_add_u32 v54, 12, v52
v_and_b32 v55, 3, v54
v_lshlrev_b32 v55, 2, v55
v_xor_b32 v55, v55, v53
v_add_u32 v54, s39, v54
v_mul_lo_u32 v54, v54, s43
v_lshl_add_u32 v11, v55, 4, v54
s_lshr_b32 s39, s3, 1
s_mul_i32 s39, s39, 8192
zs 39,39,65536
v_and_b32 v52, 31, v1
v_lshl_add_u32 v53, v52, 7, s39
v_bfe_u32 v52, v1, 1, 3
v_lshrrev_b32 v54, 5, v1
v_xor_b32 v52, v52, v54
v_xor_b32 v54, 0, v52
v_lshl_add_u32 v12, v54, 4, v53
v_xor_b32 v54, 2, v52
v_lshl_add_u32 v13, v54, 4, v53
v_xor_b32 v54, 4, v52
v_lshl_add_u32 v14, v54, 4, v53
v_xor_b32 v54, 6, v52
v_lshl_add_u32 v15, v54, 4, v53
v_bfe_u32 v52, v1, 2, 2
v_lshrrev_b32 v53, 5, v1
v_mul_u32_u24 v53, 8, v53
v_add_u32 v53, v53, v52
v_mul_u32_u24 v53, 256, v53
v_and_b32 v54, 3, v1
v_bfe_u32 v55, v1, 4, 1
v_lshl_add_u32 v54, v55, 2, v54
v_lshl_add_u32 v53, v54, 3, v53
s_and_b32 s39, s3, 1
s_mul_i32 s39, s39, 2
zaz 40,39
v_xor_b32 v54, s40, v52
v_lshl_add_u32 v16, v54, 6, v53
zac 40,39
v_xor_b32 v54, s40, v52
v_lshl_add_u32 v17, v54, 6, v53
s_lshl_b32 s44, s3, 12
s_lshl_b32 s45, s3, 12
s_mov_b32 s32, 0
s_mov_b32 s33, 0
s_barrier
zay 44
s_nop 0
zk 8,33
zf 45,65536
s_nop 0
zl 4,32
zf 44,1024
s_nop 0
zk 9,33
zf 45,66560
s_nop 0
zl 5,32
zf 44,2048
s_nop 0
zk 10,33
zf 45,67584
s_nop 0
zl 6,32
zf 44,3072
s_nop 0
zk 11,33
zf 45,68608
s_nop 0
zl 7,32
zi 32,32,35
zi 33,33,36
zf 44,16384
s_nop 0
zk 8,33
zf 45,81920
s_nop 0
zl 4,32
zf 44,17408
s_nop 0
zk 9,33
zf 45,82944
s_nop 0
zl 5,32
zf 44,18432
s_nop 0
zk 10,33
zf 45,83968
s_nop 0
zl 6,32
zf 44,19456
s_nop 0
zk 11,33
zf 45,84992
s_nop 0
zl 7,32
zi 32,32,35
zi 33,33,36
zf 44,32768
s_nop 0
zk 8,33
zf 45,98304
s_nop 0
zl 4,32
zf 44,33792
s_nop 0
zk 9,33
zf 45,99328
s_nop 0
zl 5,32
zf 44,34816
s_nop 0
zk 10,33
zf 45,100352
s_nop 0
zl 6,32
zf 44,35840
s_nop 0
zk 11,33
zf 45,101376
s_nop 0
zl 7,32
zi 32,32,35
zi 33,33,36
zf 44,49152
s_nop 0
zk 8,33
zf 45,114688
s_nop 0
zl 4,32
zf 44,50176
s_nop 0
zk 9,33
zf 45,115712
s_nop 0
zl 5,32
zf 44,51200
s_nop 0
zk 10,33
zf 45,116736
s_nop 0
zl 6,32
zf 44,52224
s_nop 0
zk 11,33
zf 45,117760
s_nop 0
zl 7,32
zi 32,32,35
zi 33,33,36
s_cmp_lg_u32 s19, 0
s_cbranch_scc1 ec_152
s_cmp_lg_u32 s3, 0
s_cbranch_scc1 cf_153_w
s_mov_b64 exec, 1
zh 240
zax 241,163808
s_mov_b32 s56, 0
cf_153_p:
buffer_load_dwordx4 v[244:247], v240, s[8:11], 0 offen offset:128 sc1
buffer_load_dwordx2 v[242:243], v240, s[8:11], 0 offen offset:148 sc1
zac 56,56
s_waitcnt vmcnt(0)
v_readfirstlane_b32 s57, v244
v_readfirstlane_b32 s59, v245
v_readfirstlane_b32 s60, v246
v_readfirstlane_b32 s58, v242
v_readfirstlane_b32 s61, v243
s_cmp_ge_u32 s56, 2097152
s_cbranch_scc1 cf_153_t
s_cmp_lg_u32 s12, 0
s_cbranch_scc1 cf_153_s
s_cmp_lg_u32 s59, 0
s_cbranch_scc1 cf_153_q
s_cmp_lt_u32 s57, 8
s_cbranch_scc1 cf_153_p
s_cmp_lt_u32 s58, 8
s_cbranch_scc1 cf_153_p
s_branch cf_153_r
cf_153_s:
s_mov_b32 s59, 0
s_mov_b32 s60, s61
cf_153_r:
s_branch cf_153_q
cf_153_t:
s_mov_b32 s13, 1
s_mov_b32 s59, 0
cf_153_q:
zak 244,59
zak 245,60
zak 246,13
ds_write_b96 v241, v[244:246] offset:16
s_mov_b64 exec, -1
s_waitcnt lgkmcnt(0)
cf_153_w:
s_barrier
zax 241,163808
ds_read_b96 v[244:246], v241 offset:16
s_waitcnt lgkmcnt(0)
v_readfirstlane_b32 s59, v244
v_readfirstlane_b32 s60, v245
v_readfirstlane_b32 s13, v246
s_barrier
s_cmp_lg_u32 s59, 0
s_cbranch_scc1 far_slow_entry
s_mov_b32 s19, 2
ec_152:
s_waitcnt vmcnt(24)
s_barrier
zg 20,12,0
zc 36,16,0
zc 38,16,1024
zc 40,17,0
zc 42,17,1024
zg 24,12,4096
s_waitcnt lgkmcnt(3)
zaw 0,20,36
zg 28,13,0
zc 44,16,4096
s_waitcnt lgkmcnt(3)
zaw 16,20,40
zc 46,16,5120
zc 48,17,4096
s_waitcnt lgkmcnt(4)
zaw 32,24,36
zc 50,17,5120
zg 32,13,4096
zaw 48,24,40
s_waitcnt lgkmcnt(3)
ze 0,28,44,0
zg 20,14,0
zc 36,16,8192
s_waitcnt lgkmcnt(3)
ze 16,28,48,16
zc 38,16,9216
zc 40,17,8192
s_waitcnt lgkmcnt(4)
ze 32,32,44,32
zc 42,17,9216
zg 24,14,4096
ze 48,32,48,48
s_waitcnt lgkmcnt(3)
ze 0,20,36,0
zg 28,15,0
zc 44,16,12288
s_waitcnt lgkmcnt(3)
ze 16,20,40,16
zc 46,16,13312
zc 48,17,12288
s_waitcnt lgkmcnt(4)
ze 32,24,36,32
zc 50,17,13312
zg 32,15,4096
ze 48,24,40,48
s_sub_u32 s34, s34, 4
t_p128tr_loop_154:
s_waitcnt vmcnt(16) lgkmcnt(0)
s_barrier
zay 44
ze 0,28,44,0
zk 8,33
zg 20,12,16384
zc 36,16,16384
zf 45,65536
ze 16,28,48,16
zl 4,32
zc 38,16,17408
zc 40,17,16384
ze 32,32,44,32
zc 42,17,17408
zg 24,12,20480
ze 48,32,48,48
s_waitcnt lgkmcnt(3)
zf 44,1024
ze 0,20,36,0
zk 9,33
zg 28,13,16384
zc 44,16,20480
s_waitcnt lgkmcnt(3)
zf 45,66560
ze 16,20,40,16
zl 5,32
zc 46,16,21504
zc 48,17,20480
s_waitcnt lgkmcnt(4)
ze 32,24,36,32
zc 50,17,21504
zg 32,13,20480
ze 48,24,40,48
s_waitcnt lgkmcnt(3)
zf 44,2048
ze 0,28,44,0
zk 10,33
zg 20,14,16384
zc 36,16,24576
s_waitcnt lgkmcnt(3)
zf 45,67584
ze 16,28,48,16
zl 6,32
zc 38,16,25600
zc 40,17,24576
s_waitcnt lgkmcnt(4)
ze 32,32,44,32
zc 42,17,25600
zg 24,14,20480
ze 48,32,48,48
s_waitcnt lgkmcnt(3)
zf 44,3072
ze 0,20,36,0
zk 11,33
zg 28,15,16384
zc 44,16,28672
s_waitcnt lgkmcnt(3)
zf 45,68608
ze 16,20,40,16
zl 7,32
zc 46,16,29696
zc 48,17,28672
s_waitcnt lgkmcnt(4)
ze 32,24,36,32
zc 50,17,29696
zg 32,15,20480
ze 48,24,40,48
zi 32,32,35
zi 33,33,36
s_waitcnt vmcnt(16) lgkmcnt(0)
s_barrier
zf 44,16384
ze 0,28,44,0
zk 8,33
zg 20,12,32768
zc 36,16,32768
zf 45,81920
ze 16,28,48,16
zl 4,32
zc 38,16,33792
zc 40,17,32768
ze 32,32,44,32
zc 42,17,33792
zg 24,12,36864
ze 48,32,48,48
s_waitcnt lgkmcnt(3)
zf 44,17408
ze 0,20,36,0
zk 9,33
zg 28,13,32768
zc 44,16,36864
s_waitcnt lgkmcnt(3)
zf 45,82944
ze 16,20,40,16
zl 5,32
zc 46,16,37888
zc 48,17,36864
s_waitcnt lgkmcnt(4)
ze 32,24,36,32
zc 50,17,37888
zg 32,13,36864
ze 48,24,40,48
s_waitcnt lgkmcnt(3)
zf 44,18432
ze 0,28,44,0
zk 10,33
zg 20,14,32768
zc 36,16,40960
s_waitcnt lgkmcnt(3)
zf 45,83968
ze 16,28,48,16
zl 6,32
zc 38,16,41984
zc 40,17,40960
s_waitcnt lgkmcnt(4)
ze 32,32,44,32
zc 42,17,41984
zg 24,14,36864
ze 48,32,48,48
s_waitcnt lgkmcnt(3)
zf 44,19456
ze 0,20,36,0
zk 11,33
zg 28,15,32768
zc 44,16,45056
s_waitcnt lgkmcnt(3)
zf 45,84992
ze 16,20,40,16
zl 7,32
zc 46,16,46080
zc 48,17,45056
s_waitcnt lgkmcnt(4)
ze 32,24,36,32
zc 50,17,46080
zg 32,15,36864
ze 48,24,40,48
zi 32,32,35
zi 33,33,36
s_waitcnt vmcnt(16) lgkmcnt(0)
s_barrier
zf 44,32768
ze 0,28,44,0
zk 8,33
zg 20,12,49152
zc 36,16,49152
zf 45,98304
ze 16,28,48,16
zl 4,32
zc 38,16,50176
zc 40,17,49152
ze 32,32,44,32
zc 42,17,50176
zg 24,12,53248
ze 48,32,48,48
s_waitcnt lgkmcnt(3)
zf 44,33792
ze 0,20,36,0
zk 9,33
zg 28,13,49152
zc 44,16,53248
s_waitcnt lgkmcnt(3)
zf 45,99328
ze 16,20,40,16
zl 5,32
zc 46,16,54272
zc 48,17,53248
s_waitcnt lgkmcnt(4)
ze 32,24,36,32
zc 50,17,54272
zg 32,13,53248
ze 48,24,40,48
s_waitcnt lgkmcnt(3)
zf 44,34816
ze 0,28,44,0
zk 10,33
zg 20,14,49152
zc 36,16,57344
s_waitcnt lgkmcnt(3)
zf 45,100352
ze 16,28,48,16
zl 6,32
zc 38,16,58368
zc 40,17,57344
s_waitcnt lgkmcnt(4)
ze 32,32,44,32
zc 42,17,58368
zg 24,14,53248
ze 48,32,48,48
s_waitcnt lgkmcnt(3)
zf 44,35840
ze 0,20,36,0
zk 11,33
zg 28,15,49152
zc 44,16,61440
s_waitcnt lgkmcnt(3)
zf 45,101376
ze 16,20,40,16
zl 7,32
zc 46,16,62464
zc 48,17,61440
s_waitcnt lgkmcnt(4)
ze 32,24,36,32
zc 50,17,62464
zg 32,15,53248
ze 48,24,40,48
zi 32,32,35
zi 33,33,36
s_waitcnt vmcnt(16) lgkmcnt(0)
s_barrier
zf 44,49152
ze 0,28,44,0
zk 8,33
zg 20,12,0
zc 36,16,0
zf 45,114688
ze 16,28,48,16
zl 4,32
zc 38,16,1024
zc 40,17,0
ze 32,32,44,32
zc 42,17,1024
zg 24,12,4096
ze 48,32,48,48
s_waitcnt lgkmcnt(3)
zf 44,50176
ze 0,20,36,0
zk 9,33
zg 28,13,0
zc 44,16,4096
s_waitcnt lgkmcnt(3)
zf 45,115712
ze 16,20,40,16
zl 5,32
zc 46,16,5120
zc 48,17,4096
s_waitcnt lgkmcnt(4)
ze 32,24,36,32
zc 50,17,5120
zg 32,13,4096
ze 48,24,40,48
s_waitcnt lgkmcnt(3)
zf 44,51200
ze 0,28,44,0
zk 10,33
zg 20,14,0
zc 36,16,8192
s_waitcnt lgkmcnt(3)
zf 45,116736
ze 16,28,48,16
zl 6,32
zc 38,16,9216
zc 40,17,8192
s_waitcnt lgkmcnt(4)
ze 32,32,44,32
zc 42,17,9216
zg 24,14,4096
ze 48,32,48,48
s_waitcnt lgkmcnt(3)
zf 44,52224
ze 0,20,36,0
zk 11,33
zg 28,15,0
zc 44,16,12288
s_waitcnt lgkmcnt(3)
zf 45,117760
ze 16,20,40,16
zl 7,32
zc 46,16,13312
zc 48,17,12288
s_waitcnt lgkmcnt(4)
ze 32,24,36,32
zc 50,17,13312
zg 32,15,4096
ze 48,24,40,48
zi 32,32,35
zi 33,33,36
s_sub_u32 s34, s34, 4
s_cmp_lg_u32 s34, 0
s_cbranch_scc1 t_p128tr_loop_154
s_waitcnt vmcnt(16) lgkmcnt(0)
s_barrier
ze 0,28,44,0
zg 20,12,16384
zc 36,16,16384
ze 16,28,48,16
zc 38,16,17408
zc 40,17,16384
ze 32,32,44,32
zc 42,17,17408
zg 24,12,20480
ze 48,32,48,48
s_waitcnt lgkmcnt(3)
ze 0,20,36,0
zg 28,13,16384
zc 44,16,20480
s_waitcnt lgkmcnt(3)
ze 16,20,40,16
zc 46,16,21504
zc 48,17,20480
s_waitcnt lgkmcnt(4)
ze 32,24,36,32
zc 50,17,21504
zg 32,13,20480
ze 48,24,40,48
s_waitcnt lgkmcnt(3)
ze 0,28,44,0
zg 20,14,16384
zc 36,16,24576
s_waitcnt lgkmcnt(3)
ze 16,28,48,16
zc 38,16,25600
zc 40,17,24576
s_waitcnt lgkmcnt(4)
ze 32,32,44,32
zc 42,17,25600
zg 24,14,20480
ze 48,32,48,48
s_waitcnt lgkmcnt(3)
ze 0,20,36,0
zg 28,15,16384
zc 44,16,28672
s_waitcnt lgkmcnt(3)
ze 16,20,40,16
zc 46,16,29696
zc 48,17,28672
s_waitcnt lgkmcnt(4)
ze 32,24,36,32
zc 50,17,29696
zg 32,15,20480
ze 48,24,40,48
s_waitcnt vmcnt(8) lgkmcnt(0)
s_barrier
ze 0,28,44,0
zg 20,12,32768
zc 36,16,32768
ze 16,28,48,16
zc 38,16,33792
zc 40,17,32768
ze 32,32,44,32
zc 42,17,33792
zg 24,12,36864
ze 48,32,48,48
s_waitcnt lgkmcnt(3)
ze 0,20,36,0
zg 28,13,32768
zc 44,16,36864
s_waitcnt lgkmcnt(3)
ze 16,20,40,16
zc 46,16,37888
zc 48,17,36864
s_waitcnt lgkmcnt(4)
ze 32,24,36,32
zc 50,17,37888
zg 32,13,36864
ze 48,24,40,48
s_waitcnt lgkmcnt(3)
ze 0,28,44,0
zg 20,14,32768
zc 36,16,40960
s_waitcnt lgkmcnt(3)
ze 16,28,48,16
zc 38,16,41984
zc 40,17,40960
s_waitcnt lgkmcnt(4)
ze 32,32,44,32
zc 42,17,41984
zg 24,14,36864
ze 48,32,48,48
s_waitcnt lgkmcnt(3)
ze 0,20,36,0
zg 28,15,32768
zc 44,16,45056
s_waitcnt lgkmcnt(3)
ze 16,20,40,16
zc 46,16,46080
zc 48,17,45056
s_waitcnt lgkmcnt(4)
ze 32,24,36,32
zc 50,17,46080
zg 32,15,36864
ze 48,24,40,48
s_waitcnt vmcnt(0) lgkmcnt(0)
s_barrier
ze 0,28,44,0
zg 20,12,49152
zc 36,16,49152
ze 16,28,48,16
zc 38,16,50176
zc 40,17,49152
ze 32,32,44,32
zc 42,17,50176
zg 24,12,53248
ze 48,32,48,48
s_waitcnt lgkmcnt(3)
ze 0,20,36,0
zg 28,13,49152
zc 44,16,53248
s_waitcnt lgkmcnt(3)
ze 16,20,40,16
zc 46,16,54272
zc 48,17,53248
s_waitcnt lgkmcnt(4)
ze 32,24,36,32
zc 50,17,54272
zg 32,13,53248
ze 48,24,40,48
s_waitcnt lgkmcnt(3)
ze 0,28,44,0
zg 20,14,49152
zc 36,16,57344
s_waitcnt lgkmcnt(3)
ze 16,28,48,16
zc 38,16,58368
zc 40,17,57344
s_waitcnt lgkmcnt(4)
ze 32,32,44,32
zc 42,17,58368
zg 24,14,53248
ze 48,32,48,48
s_waitcnt lgkmcnt(3)
ze 0,20,36,0
zg 28,15,49152
zc 44,16,61440
s_waitcnt lgkmcnt(3)
ze 16,20,40,16
zc 46,16,62464
zc 48,17,61440
s_waitcnt lgkmcnt(4)
ze 32,24,36,32
zc 50,17,62464
zg 32,15,53248
ze 48,24,40,48
s_waitcnt lgkmcnt(3)
ze 0,28,44,0
s_waitcnt lgkmcnt(1)
ze 16,28,48,16
s_waitcnt lgkmcnt(0)
ze 32,32,44,32
ze 48,32,48,48
s_mov_b32 s39, 0
s_mov_b32 s40, s39
zb 52,0
zb 53,1
zb 54,2
zb 55,3
zb 56,8
zb 57,9
zb 58,10
zb 59,11
zd 92,52,53
zd 93,54,55
zd 94,56,57
zd 95,58,59
zbi 92,100,40,0
zb 60,4
zb 61,5
zb 62,6
zb 63,7
zb 64,12
zb 65,13
zb 66,14
zb 67,15
zd 84,60,61
zd 85,62,63
zd 86,64,65
zd 87,66,67
zbi 84,100,40,1024
zi 40,40,38
zb 68,16
zb 69,17
zb 70,18
zb 71,19
zb 72,24
zb 73,25
zb 74,26
zb 75,27
zd 88,68,69
zd 89,70,71
zd 90,72,73
zd 91,74,75
zbi 88,100,40,0
zb 76,20
zb 77,21
zb 78,22
zb 79,23
zb 80,28
zb 81,29
zb 82,30
zb 83,31
zd 92,76,77
zd 93,78,79
zd 94,80,81
zd 95,82,83
zbi 92,100,40,1024
zi 39,39,37
s_mov_b32 s40, s39
zb 52,32
zb 53,33
zb 54,34
zb 55,35
zb 56,40
zb 57,41
zb 58,42
zb 59,43
zd 84,52,53
zd 85,54,55
zd 86,56,57
zd 87,58,59
zbi 84,100,40,0
zb 60,36
zb 61,37
zb 62,38
zb 63,39
zb 64,44
zb 65,45
zb 66,46
zb 67,47
zd 88,60,61
zd 89,62,63
zd 90,64,65
zd 91,66,67
zbi 88,100,40,1024
zi 40,40,38
zb 68,48
zb 69,49
zb 70,50
zb 71,51
zb 72,56
zb 73,57
zb 74,58
zb 75,59
zd 92,68,69
zd 93,70,71
zd 94,72,73
zd 95,74,75
zbi 92,100,40,0
zb 76,52
zb 77,53
zb 78,54
zb 79,55
zb 80,60
zb 81,61
zb 82,62
zb 83,63
zd 84,76,77
zd 85,78,79
zd 86,80,81
zd 87,82,83
zbi 84,100,40,1024
s_getpc_b64 s[20:21]
bk_155:
s_sub_u32 s20, s20, bk_155-task_next
s_subb_u32 s21, s21, 0
s_setpc_b64 s[20:21]
t_p256:
s_cmp_lg_u32 s19, 0
s_cbranch_scc1 t_p256c
s_cmp_lg_u32 s3, 0
s_cbranch_scc1 cf_156_w
s_mov_b64 exec, 1
zh 8
zax 9,163808
s_mov_b32 s56, 0
cf_156_p:
buffer_load_dwordx4 v[12:15], v8, s[8:11], 0 offen offset:128 sc1
buffer_load_dwordx2 v[10:11], v8, s[8:11], 0 offen offset:148 sc1
zac 56,56
s_waitcnt vmcnt(0)
v_readfirstlane_b32 s57, v12
v_readfirstlane_b32 s59, v13
v_readfirstlane_b32 s60, v14
v_readfirstlane_b32 s58, v10
v_readfirstlane_b32 s61, v11
s_cmp_ge_u32 s56, 2097152
s_cbranch_scc1 cf_156_t
s_cmp_lg_u32 s12, 0
s_cbranch_scc1 cf_156_s
s_cmp_lg_u32 s59, 0
s_cbranch_scc1 cf_156_q
s_cmp_lt_u32 s57, 8
s_cbranch_scc1 cf_156_p
s_cmp_lt_u32 s58, 8
s_cbranch_scc1 cf_156_p
s_branch cf_156_r
cf_156_s:
s_mov_b32 s59, 0
s_mov_b32 s60, s61
cf_156_r:
s_branch cf_156_q
cf_156_t:
s_mov_b32 s13, 1
s_mov_b32 s59, 0
cf_156_q:
zak 12,59
zak 13,60
zak 14,13
ds_write_b96 v9, v[12:14] offset:16
s_mov_b64 exec, -1
s_waitcnt lgkmcnt(0)
cf_156_w:
s_barrier
zax 9,163808
ds_read_b96 v[12:14], v9 offset:16
s_waitcnt lgkmcnt(0)
v_readfirstlane_b32 s59, v12
v_readfirstlane_b32 s60, v13
v_readfirstlane_b32 s13, v14
s_barrier
s_cmp_lg_u32 s59, 0
s_cbranch_scc1 far2_slow_entry
s_and_b32 s20, s14, 127
s_lshl_b32 s20, s20, 2
zi 20,20,3
s_mul_i32 s20, s20, 8192
v_and_b32 v2, 63, v0
v_lshl_add_u32 v2, v2, 7, s20
s_mov_b64 s[24:25], s[76:77]
s_mov_b32 s26, 4194304
s_mov_b32 s27, 0x20000
s_mov_b32 s21, 0
buffer_load_dword v31, v2, s[24:27], s21 offen offset:0
s_mov_b32 s19, 10
s_branch t_p256c
far2_slow_entry:
s_getpc_b64 s[20:21]
far2a:
s_sub_u32 s20, s20, far2a-slow_entry
s_subb_u32 s21, s21, 0
s_setpc_b64 s[20:21]
t_p256c:
s_lshl_b32 s47, s47, 8
s_and_b32 s57, s3, 1
s_cmp_eq_u32 s46, 0
s_cbranch_scc0 ps_157_b
s_mov_b64 s[50:51], s[70:71]
s_mov_b64 s[52:53], s[72:73]
s_mov_b32 s43, 6144
s_mov_b32 s54, 6291456
s_lshr_b32 s55, s48, 2
s_and_b32 s56, s48, 3
s_lshl_b32 s56, s56, 3
s_lshl_b32 s57, s57, 2
zi 56,56,57
s_lshl_b32 s56, s56, 17
s_lshl_b32 s57, s55, 22
zi 56,56,57
s_mov_b32 s37, 2048
s_mov_b32 s38, 131072
s_cmp_eq_u32 s55, 0
s_cselect_b32 s41, 0x3e8293ee, 1.0
s_cmp_eq_u32 s55, 2
s_cselect_b32 s49, 1, 0
s_branch ps_157_c
ps_157_b:
s_mov_b64 s[50:51], s[76:77]
s_cmp_eq_u32 s46, 1
s_cselect_b64 s[52:53], s[78:79], s[80:81]
s_cselect_b32 s41, 0x3e0293ee, 1.0
s_cmp_eq_u32 s46, 3
s_cselect_b64 s[52:53], s[82:83], s[52:53]
s_cselect_b32 s49, 2, 0
s_mov_b32 s43, 8192
s_mov_b32 s54, 8388608
s_lshl_b32 s56, s48, 1
zi 56,56,57
s_lshl_b32 s56, s56, 19
s_lshl_b32 s57, s46, 24
zi 56,56,57
s_mov_b32 s37, 8192
s_mov_b32 s38, 2048
ps_157_c:
s_lshr_b32 s57, s3, 1
s_mul_i32 s57, s57, 4
s_lshr_b32 s55, s47, 5
zi 57,57,55
s_mul_i32 s57, s57, s37
zi 56,56,57
s_mov_b32 s42, 2048
s_mov_b32 s35, 128
s_lshl_b32 s36, s43, 6
s_mov_b32 s34, 16
s_lshl_b32 s55, s47, 11
s_mul_i32 s57, s48, 512
s_min_u32 s55, s55, 4194304
zi 20,50,55
s_addc_u32 s21, s51, 0
s_sub_u32 s22, 4194304, s55
s_mov_b32 s23, 0x20000
s_min_u32 s57, s57, s54
zi 24,52,57
s_addc_u32 s25, s53, 0
s_sub_u32 s26, s54, s57
s_mov_b32 s27, 0x20000
s_min_u32 s56, s56, 67108864
zi 28,4,56
s_addc_u32 s29, s5, 0
s_sub_u32 s30, 67108864, s56
s_mov_b32 s31, 0x20000
v_and_b32 v1, 63, v0
s_lshl_b32 s39, s3, 6
v_lshrrev_b32 v128, 3, v1
v_add_u32 v128, s39, v128
v_lshlrev_b32 v128, 11, v128
v_and_b32 v129, 7, v1
v_lshrrev_b32 v130, 4, v1
v_xor_b32 v129, v129, v130
v_xor_b32 v131, 4, v129
v_lshl_add_u32 v129, v129, 4, v128
v_lshl_add_u32 v131, v131, 4, v128
v_add_u32 v4, 0, v129
v_add_u32 v5, 16384, v131
v_add_u32 v6, 32768, v129
v_add_u32 v7, 49152, v131
v_add_u32 v8, 65536, v129
v_add_u32 v9, 81920, v131
v_add_u32 v10, 98304, v129
v_add_u32 v11, 114688, v131
v_lshrrev_b32 v132, 5, v1
v_and_b32 v133, 31, v1
v_lshlrev_b32 v134, 1, v132
v_xor_b32 v133, v133, v134
v_lshlrev_b32 v133, 4, v133
s_lshl_b32 s39, s3, 4
v_add_u32 v132, s39, v132
v_mul_lo_u32 v132, v132, s43
s_lshl_b32 s39, s43, 1
s_mov_b32 s40, 0
v_xor_b32 v134, 0, v133
v_add3_u32 v12, v132, v134, s40
zi 40,40,39
v_xor_b32 v134, 64, v133
v_add3_u32 v13, v132, v134, s40
zi 40,40,39
v_xor_b32 v134, 0, v133
v_add3_u32 v14, v132, v134, s40
zi 40,40,39
v_xor_b32 v134, 64, v133
v_add3_u32 v15, v132, v134, s40
zi 40,40,39
v_xor_b32 v134, 128, v133
v_add3_u32 v16, v132, v134, s40
zi 40,40,39
v_xor_b32 v134, 192, v133
v_add3_u32 v17, v132, v134, s40
zi 40,40,39
v_xor_b32 v134, 128, v133
v_add3_u32 v18, v132, v134, s40
zi 40,40,39
v_xor_b32 v134, 192, v133
v_add3_u32 v19, v132, v134, s40
s_lshr_b32 s39, s3, 1
s_lshl_b32 s39, s39, 14
zs 39,39,65536
v_and_b32 v128, 15, v1
v_lshl_add_u32 v129, v128, 7, s39
v_lshrrev_b32 v128, 1, v128
v_xor_b32 v128, v128, v130
v_lshl_add_u32 v20, v128, 4, v129
v_xor_b32 v128, 4, v128
v_lshl_add_u32 v21, v128, 4, v129
v_bfe_u32 v128, v1, 2, 2
v_lshl_add_u32 v129, v130, 3, v128
v_lshlrev_b32 v129, 9, v129
v_and_b32 v131, 1, v130
v_lshl_add_u32 v128, v131, 2, v128
v_lshl_add_u32 v129, v128, 5, v129
v_and_b32 v128, 3, v1
v_lshl_add_u32 v129, v128, 3, v129
s_and_b32 s39, s3, 1
s_lshl_b32 s39, s39, 8
v_add_u32 v129, s39, v129
s_lshl_b32 s44, s3, 13
s_lshl_b32 s45, s3, 13
zh 30
v_xor_b32 v22, 0, v129
v_xor_b32 v23, 32, v129
v_xor_b32 v24, 64, v129
v_xor_b32 v25, 96, v129
v_xor_b32 v26, 128, v129
v_xor_b32 v27, 160, v129
v_xor_b32 v28, 192, v129
v_xor_b32 v29, 224, v129
s_min_u32 s94, s49, 1
s_mov_b32 s101, s67
s_mov_b32 s100, 0xffff
s_mov_b64 s[56:57], s[28:29]
s_mov_b32 s58, 0
s_mov_b32 s59, 0x20000
s_mov_b32 s60, 0
s_mov_b32 s61, 0
s_mov_b32 s62, 0
s_mov_b32 s63, 0
s_mov_b32 s32, 0
s_mov_b32 s33, 0
s_load_dwordx4 s[96:99], s[88:89], 0
s_barrier
zay 44
s_nop 0
zk 12,33
zf 45,65536
s_nop 0
zl 4,32
zf 44,1024
s_nop 0
zk 13,33
zf 45,66560
s_nop 0
zl 5,32
zf 44,2048
s_nop 0
zk 14,33
zf 45,67584
s_nop 0
zl 6,32
zf 44,3072
s_nop 0
zk 15,33
zf 45,68608
s_nop 0
zl 7,32
zf 44,4096
s_nop 0
zk 16,33
zf 45,69632
s_nop 0
zl 8,32
zf 44,5120
s_nop 0
zk 17,33
zf 45,70656
s_nop 0
zl 9,32
zf 44,6144
s_nop 0
zk 18,33
zf 45,71680
s_nop 0
zl 10,32
zf 44,7168
s_nop 0
zk 19,33
zf 45,72704
s_nop 0
zl 11,32
zs 32,32,128
zi 33,33,36
zf 44,32768
s_nop 0
zk 12,33
zf 45,98304
s_nop 0
zl 4,32
zf 44,33792
s_nop 0
zk 13,33
zf 45,99328
s_nop 0
zl 5,32
zf 44,34816
s_nop 0
zk 14,33
zf 45,100352
s_nop 0
zl 6,32
zf 44,35840
s_nop 0
zk 15,33
zf 45,101376
s_nop 0
zl 7,32
zf 44,36864
s_nop 0
zk 16,33
zf 45,102400
s_nop 0
zl 8,32
zf 44,37888
s_nop 0
zk 17,33
s_waitcnt vmcnt(11) lgkmcnt(0)
s_barrier
zg 32,20,0
zc 64,22,0
zc 66,22,2048
zc 68,23,0
zc 70,23,2048
zc 72,24,0
zc 74,24,2048
zc 76,25,0
zc 78,25,2048
zc 80,26,0
zc 82,26,2048
zc 84,27,0
zc 86,27,2048
zc 88,28,0
zc 90,28,2048
zc 92,29,0
zc 94,29,2048
zg 36,20,2048
zg 40,20,4096
zg 44,20,6144
zg 48,20,8192
zg 52,20,10240
zg 56,20,12288
zg 60,20,14336
s_waitcnt lgkmcnt(0)
s_cmp_eq_u32 s94, 0
s_cbranch_scc0 t_p256c_head_TR
t_p256c_head_NR:
zy 0,64,32
zc 96,22,16384
zf 45,103424
zy 4,68,32
zl 9,32
zy 8,72,32
zc 98,22,18432
zy 12,76,32
zc 100,23,16384
zy 16,80,32
zy 20,84,32
zy 24,88,32
zy 28,92,32
zy 32,64,36
zg 32,21,0
zf 44,38912
zy 36,68,36
zk 18,33
zy 40,72,36
zc 102,23,18432
zy 44,76,36
zc 104,24,16384
zf 45,104448
zy 48,80,36
zl 10,32
zy 52,84,36
zc 106,24,18432
zy 56,88,36
zy 60,92,36
zy 64,64,40
zg 36,21,2048
zf 44,39936
zy 68,68,40
zk 19,33
zy 72,72,40
zc 108,25,16384
zy 76,76,40
zc 110,25,18432
zy 80,80,40
zy 84,84,40
zy 88,88,40
zy 92,92,40
zy 96,64,44
zg 40,21,4096
zf 45,105472
zy 100,68,44
zl 11,32
zy 104,72,44
zc 112,26,16384
zy 108,76,44
zc 114,26,18432
zy 112,80,44
zy 116,84,44
zy 120,88,44
zy 124,92,44
zy 128,64,48
zg 44,21,6144
s_nop 0
zy 132,68,48
zz 128,30,63,0
zy 136,72,48
zc 116,27,16384
zy 140,76,48
zc 118,27,18432
s_nop 0
zy 144,80,48
zz 132,30,63,256
zy 148,84,48
zy 152,88,48
zy 156,92,48
zy 160,64,52
zg 48,21,8192
zi 63,63,61
zy 164,68,52
zz 136,30,63,0
zy 168,72,52
zc 120,28,16384
zy 172,76,52
zc 122,28,18432
s_nop 0
zy 176,80,52
zz 140,30,63,256
zy 180,84,52
zy 184,88,52
zy 188,92,52
zy 192,64,56
zg 52,21,10240
zi 63,63,61
zy 196,68,56
zz 144,30,63,0
zy 200,72,56
zc 124,29,16384
zy 204,76,56
zc 126,29,18432
s_nop 0
zy 208,80,56
zz 148,30,63,256
zy 212,84,56
zy 216,88,56
zy 220,92,56
zy 224,64,60
zg 56,21,12288
zi 63,63,61
zy 228,68,60
zz 152,30,63,0
zy 232,72,60
zy 236,76,60
s_nop 0
zy 240,80,60
zz 156,30,63,256
zy 244,84,60
zy 248,88,60
zy 252,92,60
s_waitcnt lgkmcnt(15)
za 0,96,32,0
zg 60,21,14336
zi 62,62,60
s_mov_b32 s63, s62
za 4,100,32,4
zz 160,30,63,0
za 8,104,32,8
s_waitcnt lgkmcnt(14)
za 12,108,32,12
s_waitcnt lgkmcnt(11)
s_nop 0
za 16,112,32,16
zz 164,30,63,256
s_waitcnt lgkmcnt(8)
za 20,116,32,20
s_waitcnt lgkmcnt(5)
za 24,120,32,24
s_waitcnt lgkmcnt(2)
za 28,124,32,28
zs 32,32,128
zi 33,33,36
s_waitcnt vmcnt(10) lgkmcnt(0)
s_barrier
za 32,96,36,32
zg 32,20,32768
zay 44
za 36,100,36,36
zk 12,33
za 40,104,36,40
zc 64,22,32768
za 44,108,36,44
zc 66,22,34816
zf 45,65536
za 48,112,36,48
zl 4,32
za 52,116,36,52
zc 68,23,32768
za 56,120,36,56
za 60,124,36,60
za 64,96,40,64
zg 36,20,34816
zf 44,1024
za 68,100,40,68
zk 13,33
za 72,104,40,72
zc 70,23,34816
za 76,108,40,76
zc 72,24,32768
za 80,112,40,80
zc 74,24,34816
za 84,116,40,84
za 88,120,40,88
za 92,124,40,92
za 96,96,44,96
zg 40,20,36864
zf 45,66560
za 100,100,44,100
zl 5,32
za 104,104,44,104
zc 76,25,32768
za 108,108,44,108
zc 78,25,34816
zf 44,2048
za 112,112,44,112
zk 14,33
za 116,116,44,116
za 120,120,44,120
za 124,124,44,124
za 128,96,48,128
zg 44,20,38912
zf 45,67584
za 132,100,48,132
zl 6,32
za 136,104,48,136
zc 80,26,32768
za 140,108,48,140
zc 82,26,34816
za 144,112,48,144
za 148,116,48,148
za 152,120,48,152
za 156,124,48,156
za 160,96,52,160
zg 48,20,40960
zf 44,3072
za 164,100,52,164
zk 15,33
za 168,104,52,168
zc 84,27,32768
za 172,108,52,172
zc 86,27,34816
zf 45,68608
za 176,112,52,176
zl 7,32
za 180,116,52,180
za 184,120,52,184
za 188,124,52,188
za 192,96,56,192
zg 52,20,43008
zf 44,4096
za 196,100,56,196
zk 16,33
za 200,104,56,200
zc 88,28,32768
za 204,108,56,204
zc 90,28,34816
za 208,112,56,208
za 212,116,56,212
za 216,120,56,216
za 220,124,56,220
za 224,96,60,224
zg 56,20,45056
zf 45,69632
za 228,100,60,228
zl 8,32
za 232,104,60,232
zc 92,29,32768
za 236,108,60,236
zc 94,29,34816
zf 44,5120
za 240,112,60,240
zk 17,33
za 244,116,60,244
za 248,120,60,248
za 252,124,60,252
zg 60,20,47104
s_waitcnt lgkmcnt(15)
za 0,64,32,0
zc 96,22,49152
zf 45,70656
za 4,68,32,4
zl 9,32
za 8,72,32,8
zc 98,22,51200
s_waitcnt lgkmcnt(15)
za 12,76,32,12
zc 100,23,49152
s_waitcnt lgkmcnt(13)
za 16,80,32,16
s_waitcnt lgkmcnt(10)
za 20,84,32,20
s_waitcnt lgkmcnt(7)
za 24,88,32,24
s_waitcnt lgkmcnt(4)
za 28,92,32,28
za 32,64,36,32
zg 32,21,32768
zf 44,6144
za 36,68,36,36
zk 18,33
za 40,72,36,40
zc 102,23,51200
za 44,76,36,44
zc 104,24,49152
zf 45,71680
za 48,80,36,48
zl 10,32
za 52,84,36,52
zc 106,24,51200
za 56,88,36,56
za 60,92,36,60
za 64,64,40,64
zg 36,21,34816
zf 44,7168
za 68,68,40,68
zk 19,33
za 72,72,40,72
zc 108,25,49152
za 76,76,40,76
zc 110,25,51200
za 80,80,40,80
za 84,84,40,84
za 88,88,40,88
za 92,92,40,92
za 96,64,44,96
zg 40,21,36864
zf 45,72704
za 100,68,44,100
zl 11,32
za 104,72,44,104
zc 112,26,49152
za 108,76,44,108
zc 114,26,51200
za 112,80,44,112
za 116,84,44,116
za 120,88,44,120
za 124,92,44,124
za 128,64,48,128
zg 44,21,38912
zi 63,63,61
za 132,68,48,132
zz 168,30,63,0
za 136,72,48,136
zc 116,27,49152
za 140,76,48,140
zc 118,27,51200
s_nop 0
za 144,80,48,144
zz 172,30,63,256
za 148,84,48,148
za 152,88,48,152
za 156,92,48,156
za 160,64,52,160
zg 48,21,40960
zi 63,63,61
za 164,68,52,164
zz 176,30,63,0
za 168,72,52,168
zc 120,28,49152
za 172,76,52,172
zc 122,28,51200
s_nop 0
za 176,80,52,176
zz 180,30,63,256
za 180,84,52,180
za 184,88,52,184
za 188,92,52,188
za 192,64,56,192
zg 52,21,43008
zi 63,63,61
za 196,68,56,196
zz 184,30,63,0
za 200,72,56,200
zc 124,29,49152
za 204,76,56,204
zc 126,29,51200
s_nop 0
za 208,80,56,208
zz 188,30,63,256
za 212,84,56,212
za 216,88,56,216
za 220,92,56,220
s_waitcnt lgkmcnt(15)
zi 62,62,60
s_mov_b32 s63, s62
za 224,64,60,224
zz 192,30,63,0
za 228,68,60,228
zg 56,21,45056
s_nop 0
za 232,72,60,232
zz 196,30,63,256
za 236,76,60,236
za 240,80,60,240
zi 63,63,61
za 244,84,60,244
zz 200,30,63,0
za 248,88,60,248
za 252,92,60,252
za 0,96,32,0
zg 60,21,47104
s_nop 0
za 4,100,32,4
zz 204,30,63,256
za 8,104,32,8
s_waitcnt lgkmcnt(14)
za 12,108,32,12
s_waitcnt lgkmcnt(11)
zi 63,63,61
za 16,112,32,16
zz 208,30,63,0
s_waitcnt lgkmcnt(8)
za 20,116,32,20
s_waitcnt lgkmcnt(5)
za 24,120,32,24
s_waitcnt lgkmcnt(2)
za 28,124,32,28
zs 32,32,128
zi 33,33,36
s_waitcnt vmcnt(11) lgkmcnt(0)
s_barrier
za 32,96,36,32
zg 32,20,0
zf 44,32768
za 36,100,36,36
zk 12,33
za 40,104,36,40
zc 64,22,0
za 44,108,36,44
zc 66,22,2048
zf 45,98304
za 48,112,36,48
zl 4,32
za 52,116,36,52
zc 68,23,0
za 56,120,36,56
za 60,124,36,60
za 64,96,40,64
zg 36,20,2048
zf 44,33792
za 68,100,40,68
zk 13,33
za 72,104,40,72
zc 70,23,2048
za 76,108,40,76
zc 72,24,0
za 80,112,40,80
zc 74,24,2048
za 84,116,40,84
za 88,120,40,88
za 92,124,40,92
za 96,96,44,96
zg 40,20,4096
zf 45,99328
za 100,100,44,100
zl 5,32
za 104,104,44,104
zc 76,25,0
za 108,108,44,108
zc 78,25,2048
zf 44,34816
za 112,112,44,112
zk 14,33
za 116,116,44,116
za 120,120,44,120
za 124,124,44,124
za 128,96,48,128
zg 44,20,6144
zf 45,100352
za 132,100,48,132
zl 6,32
za 136,104,48,136
zc 80,26,0
za 140,108,48,140
zc 82,26,2048
za 144,112,48,144
za 148,116,48,148
za 152,120,48,152
za 156,124,48,156
za 160,96,52,160
zg 48,20,8192
zf 44,35840
za 164,100,52,164
zk 15,33
za 168,104,52,168
zc 84,27,0
za 172,108,52,172
zc 86,27,2048
zf 45,101376
za 176,112,52,176
zl 7,32
za 180,116,52,180
za 184,120,52,184
za 188,124,52,188
za 192,96,56,192
zg 52,20,10240
zf 44,36864
za 196,100,56,196
zk 16,33
za 200,104,56,200
zc 88,28,0
za 204,108,56,204
zc 90,28,2048
za 208,112,56,208
za 212,116,56,212
za 216,120,56,216
za 220,124,56,220
za 224,96,60,224
zg 56,20,12288
zf 45,102400
za 228,100,60,228
zl 8,32
za 232,104,60,232
zc 92,29,0
za 236,108,60,236
zc 94,29,2048
zf 44,37888
za 240,112,60,240
zk 17,33
za 244,116,60,244
za 248,120,60,248
za 252,124,60,252
zg 60,20,14336
s_waitcnt lgkmcnt(15)
za 0,64,32,0
zc 96,22,16384
zf 45,103424
za 4,68,32,4
zl 9,32
za 8,72,32,8
zc 98,22,18432
s_waitcnt lgkmcnt(15)
za 12,76,32,12
zc 100,23,16384
s_waitcnt lgkmcnt(13)
za 16,80,32,16
s_waitcnt lgkmcnt(10)
za 20,84,32,20
s_waitcnt lgkmcnt(7)
za 24,88,32,24
s_waitcnt lgkmcnt(4)
za 28,92,32,28
za 32,64,36,32
zg 32,21,0
zf 44,38912
za 36,68,36,36
zk 18,33
za 40,72,36,40
zc 102,23,18432
za 44,76,36,44
zc 104,24,16384
zf 45,104448
za 48,80,36,48
zl 10,32
za 52,84,36,52
zc 106,24,18432
za 56,88,36,56
za 60,92,36,60
za 64,64,40,64
zg 36,21,2048
zf 44,39936
za 68,68,40,68
zk 19,33
za 72,72,40,72
zc 108,25,16384
za 76,76,40,76
zc 110,25,18432
za 80,80,40,80
za 84,84,40,84
za 88,88,40,88
za 92,92,40,92
za 96,64,44,96
zg 40,21,4096
zf 45,105472
za 100,68,44,100
zl 11,32
za 104,72,44,104
zc 112,26,16384
za 108,76,44,108
zc 114,26,18432
za 112,80,44,112
za 116,84,44,116
za 120,88,44,120
za 124,92,44,124
za 128,64,48,128
zg 44,21,6144
s_nop 0
za 132,68,48,132
zz 212,30,63,256
za 136,72,48,136
zc 116,27,16384
za 140,76,48,140
zc 118,27,18432
zi 63,63,61
za 144,80,48,144
zz 216,30,63,0
za 148,84,48,148
za 152,88,48,152
za 156,92,48,156
za 160,64,52,160
zg 48,21,8192
s_nop 0
za 164,68,52,164
zz 220,30,63,256
za 168,72,52,168
zc 120,28,16384
za 172,76,52,172
zc 122,28,18432
zi 62,62,60
s_mov_b32 s63, s62
za 176,80,52,176
zz 224,30,63,0
za 180,84,52,180
za 184,88,52,184
za 188,92,52,188
za 192,64,56,192
zg 52,21,10240
s_nop 0
za 196,68,56,196
zz 228,30,63,256
za 200,72,56,200
zc 124,29,16384
za 204,76,56,204
zc 126,29,18432
zi 63,63,61
za 208,80,56,208
zz 232,30,63,0
za 212,84,56,212
za 216,88,56,216
za 220,92,56,220
s_waitcnt lgkmcnt(15)
s_nop 0
za 224,64,60,224
zz 236,30,63,256
za 228,68,60,228
zg 56,21,12288
zi 63,63,61
za 232,72,60,232
zz 240,30,63,0
za 236,76,60,236
za 240,80,60,240
s_nop 0
za 244,84,60,244
zz 244,30,63,256
za 248,88,60,248
za 252,92,60,252
za 0,96,32,0
zg 60,21,14336
zi 63,63,61
za 4,100,32,4
zz 248,30,63,0
za 8,104,32,8
s_waitcnt lgkmcnt(14)
za 12,108,32,12
s_waitcnt lgkmcnt(11)
s_nop 0
za 16,112,32,16
zz 252,30,63,256
s_waitcnt lgkmcnt(8)
za 20,116,32,20
s_waitcnt lgkmcnt(5)
za 24,120,32,24
s_waitcnt lgkmcnt(2)
za 28,124,32,28
zs 32,32,128
zi 33,33,36
s_waitcnt vmcnt(11) lgkmcnt(0)
s_barrier
za 32,96,36,32
zg 32,20,32768
zay 44
za 36,100,36,36
zk 12,33
za 40,104,36,40
zc 64,22,32768
za 44,108,36,44
zc 66,22,34816
zf 45,65536
za 48,112,36,48
zl 4,32
za 52,116,36,52
zc 68,23,32768
za 56,120,36,56
za 60,124,36,60
za 64,96,40,64
zg 36,20,34816
zf 44,1024
za 68,100,40,68
zk 13,33
za 72,104,40,72
zc 70,23,34816
za 76,108,40,76
zc 72,24,32768
za 80,112,40,80
zc 74,24,34816
za 84,116,40,84
za 88,120,40,88
za 92,124,40,92
za 96,96,44,96
zg 40,20,36864
zf 45,66560
za 100,100,44,100
zl 5,32
za 104,104,44,104
zc 76,25,32768
za 108,108,44,108
zc 78,25,34816
zf 44,2048
za 112,112,44,112
zk 14,33
za 116,116,44,116
za 120,120,44,120
za 124,124,44,124
za 128,96,48,128
zg 44,20,38912
zf 45,67584
za 132,100,48,132
zl 6,32
za 136,104,48,136
zc 80,26,32768
za 140,108,48,140
zc 82,26,34816
za 144,112,48,144
za 148,116,48,148
za 152,120,48,152
za 156,124,48,156
za 160,96,52,160
zg 48,20,40960
zf 44,3072
za 164,100,52,164
zk 15,33
za 168,104,52,168
zc 84,27,32768
za 172,108,52,172
zc 86,27,34816
zf 45,68608
za 176,112,52,176
zl 7,32
za 180,116,52,180
za 184,120,52,184
za 188,124,52,188
za 192,96,56,192
zg 52,20,43008
zf 44,4096
za 196,100,56,196
zk 16,33
za 200,104,56,200
zc 88,28,32768
za 204,108,56,204
zc 90,28,34816
za 208,112,56,208
za 212,116,56,212
za 216,120,56,216
za 220,124,56,220
za 224,96,60,224
zg 56,20,45056
zf 45,69632
za 228,100,60,228
zl 8,32
za 232,104,60,232
zc 92,29,32768
za 236,108,60,236
zc 94,29,34816
zf 44,5120
za 240,112,60,240
zk 17,33
za 244,116,60,244
za 248,120,60,248
za 252,124,60,252
zg 60,20,47104
s_waitcnt lgkmcnt(15)
za 0,64,32,0
zc 96,22,49152
zf 45,70656
za 4,68,32,4
zl 9,32
za 8,72,32,8
zc 98,22,51200
s_waitcnt lgkmcnt(15)
za 12,76,32,12
zc 100,23,49152
s_waitcnt lgkmcnt(13)
za 16,80,32,16
s_waitcnt lgkmcnt(10)
za 20,84,32,20
s_waitcnt lgkmcnt(7)
za 24,88,32,24
s_waitcnt lgkmcnt(4)
za 28,92,32,28
za 32,64,36,32
zg 32,21,32768
zf 44,6144
za 36,68,36,36
zk 18,33
za 40,72,36,40
zc 102,23,51200
za 44,76,36,44
zc 104,24,49152
zf 45,71680
za 48,80,36,48
zl 10,32
za 52,84,36,52
zc 106,24,51200
za 56,88,36,56
za 60,92,36,60
za 64,64,40,64
zg 36,21,34816
zf 44,7168
za 68,68,40,68
zk 19,33
za 72,72,40,72
zc 108,25,49152
za 76,76,40,76
zc 110,25,51200
za 80,80,40,80
za 84,84,40,84
za 88,88,40,88
za 92,92,40,92
za 96,64,44,96
zg 40,21,36864
zf 45,72704
za 100,68,44,100
zl 11,32
za 104,72,44,104
zc 112,26,49152
za 108,76,44,108
zc 114,26,51200
za 112,80,44,112
za 116,84,44,116
za 120,88,44,120
za 124,92,44,124
za 128,64,48,128
zg 44,21,38912
za 132,68,48,132
zc 116,27,49152
za 136,72,48,136
zc 118,27,51200
za 140,76,48,140
za 144,80,48,144
za 148,84,48,148
za 152,88,48,152
za 156,92,48,156
za 160,64,52,160
zg 48,21,40960
za 164,68,52,164
zc 120,28,49152
za 168,72,52,168
zc 122,28,51200
za 172,76,52,172
za 176,80,52,176
za 180,84,52,180
za 184,88,52,184
za 188,92,52,188
za 192,64,56,192
zg 52,21,43008
za 196,68,56,196
zc 124,29,49152
za 200,72,56,200
zc 126,29,51200
za 204,76,56,204
za 208,80,56,208
za 212,84,56,212
za 216,88,56,216
za 220,92,56,220
s_waitcnt lgkmcnt(15)
za 224,64,60,224
zg 56,21,45056
za 228,68,60,228
za 232,72,60,232
za 236,76,60,236
za 240,80,60,240
za 244,84,60,244
za 248,88,60,248
za 252,92,60,252
za 0,96,32,0
zg 60,21,47104
za 4,100,32,4
za 8,104,32,8
s_waitcnt lgkmcnt(14)
za 12,108,32,12
s_waitcnt lgkmcnt(11)
za 16,112,32,16
s_waitcnt lgkmcnt(8)
za 20,116,32,20
s_waitcnt lgkmcnt(5)
za 24,120,32,24
s_waitcnt lgkmcnt(2)
za 28,124,32,28
zs 32,32,128
zi 33,33,36
s_waitcnt vmcnt(0) lgkmcnt(0)
s_barrier
s_and_b32 s46, s100, 0xffff
s_cmp_eq_u32 s46, 0xffff
s_cbranch_scc1 sg_158_n
s_cmp_lg_u32 s3, 0
s_cbranch_scc1 sg_158_n
s_lshl_b32 s46, s46, 8
zs 46,46,85983232
s_lshr_b32 s47, s100, 16
zak 2,46
zak 3,47
s_mov_b64 exec, 1
buffer_atomic_add v3, v2, s[4:7], 0 offen
s_mov_b64 exec, -1
sg_158_n:
za 32,96,36,32
zg 32,20,0
zf 44,32768
za 36,100,36,36
zk 12,33
za 40,104,36,40
zc 64,22,0
za 44,108,36,44
zc 66,22,2048
zf 45,98304
za 48,112,36,48
zl 4,32
za 52,116,36,52
zc 68,23,0
za 56,120,36,56
za 60,124,36,60
za 64,96,40,64
zg 36,20,2048
zf 44,33792
za 68,100,40,68
zk 13,33
za 72,104,40,72
zc 70,23,2048
za 76,108,40,76
zc 72,24,0
za 80,112,40,80
zc 74,24,2048
za 84,116,40,84
za 88,120,40,88
za 92,124,40,92
za 96,96,44,96
zg 40,20,4096
zf 45,99328
za 100,100,44,100
zl 5,32
za 104,104,44,104
zc 76,25,0
za 108,108,44,108
zc 78,25,2048
zf 44,34816
za 112,112,44,112
zk 14,33
za 116,116,44,116
za 120,120,44,120
za 124,124,44,124
za 128,96,48,128
zg 44,20,6144
zf 45,100352
za 132,100,48,132
zl 6,32
za 136,104,48,136
zc 80,26,0
za 140,108,48,140
zc 82,26,2048
za 144,112,48,144
za 148,116,48,148
za 152,120,48,152
za 156,124,48,156
za 160,96,52,160
zg 48,20,8192
zf 44,35840
za 164,100,52,164
zk 15,33
za 168,104,52,168
zc 84,27,0
za 172,108,52,172
zc 86,27,2048
zf 45,101376
za 176,112,52,176
zl 7,32
za 180,116,52,180
za 184,120,52,184
za 188,124,52,188
za 192,96,56,192
zg 52,20,10240
zf 44,36864
za 196,100,56,196
zk 16,33
za 200,104,56,200
zc 88,28,0
za 204,108,56,204
zc 90,28,2048
za 208,112,56,208
za 212,116,56,212
za 216,120,56,216
za 220,124,56,220
za 224,96,60,224
zg 56,20,12288
zf 45,102400
za 228,100,60,228
zl 8,32
za 232,104,60,232
zc 92,29,0
za 236,108,60,236
zc 94,29,2048
zf 44,37888
za 240,112,60,240
zk 17,33
za 244,116,60,244
za 248,120,60,248
za 252,124,60,252
zg 60,20,14336
s_waitcnt lgkmcnt(15)
za 0,64,32,0
zc 96,22,16384
zf 45,103424
za 4,68,32,4
zl 9,32
za 8,72,32,8
zc 98,22,18432
s_waitcnt lgkmcnt(15)
za 12,76,32,12
zc 100,23,16384
s_waitcnt lgkmcnt(13)
za 16,80,32,16
s_waitcnt lgkmcnt(10)
za 20,84,32,20
s_waitcnt lgkmcnt(7)
za 24,88,32,24
s_waitcnt lgkmcnt(4)
za 28,92,32,28
za 32,64,36,32
zg 32,21,0
zf 44,38912
za 36,68,36,36
zk 18,33
za 40,72,36,40
zc 102,23,18432
za 44,76,36,44
zc 104,24,16384
zf 45,104448
za 48,80,36,48
zl 10,32
za 52,84,36,52
zc 106,24,18432
za 56,88,36,56
za 60,92,36,60
za 64,64,40,64
zg 36,21,2048
zf 44,39936
za 68,68,40,68
zk 19,33
za 72,72,40,72
zc 108,25,16384
za 76,76,40,76
zc 110,25,18432
za 80,80,40,80
za 84,84,40,84
za 88,88,40,88
za 92,92,40,92
za 96,64,44,96
zg 40,21,4096
zf 45,105472
za 100,68,44,100
zl 11,32
za 104,72,44,104
zc 112,26,16384
za 108,76,44,108
zc 114,26,18432
za 112,80,44,112
za 116,84,44,116
za 120,88,44,120
za 124,92,44,124
za 128,64,48,128
zg 44,21,6144
za 132,68,48,132
zc 116,27,16384
za 136,72,48,136
zc 118,27,18432
za 140,76,48,140
za 144,80,48,144
za 148,84,48,148
za 152,88,48,152
za 156,92,48,156
za 160,64,52,160
zg 48,21,8192
za 164,68,52,164
zc 120,28,16384
za 168,72,52,168
zc 122,28,18432
za 172,76,52,172
za 176,80,52,176
za 180,84,52,180
za 184,88,52,184
za 188,92,52,188
za 192,64,56,192
zg 52,21,10240
za 196,68,56,196
zc 124,29,16384
za 200,72,56,200
zc 126,29,18432
za 204,76,56,204
za 208,80,56,208
za 212,84,56,212
za 216,88,56,216
za 220,92,56,220
s_waitcnt lgkmcnt(15)
za 224,64,60,224
zg 56,21,12288
za 228,68,60,228
za 232,72,60,232
za 236,76,60,236
za 240,80,60,240
za 244,84,60,244
za 248,88,60,248
za 252,92,60,252
za 0,96,32,0
zg 60,21,14336
za 4,100,32,4
za 8,104,32,8
s_waitcnt lgkmcnt(14)
za 12,108,32,12
s_waitcnt lgkmcnt(11)
za 16,112,32,16
s_waitcnt lgkmcnt(8)
za 20,116,32,20
s_waitcnt lgkmcnt(5)
za 24,120,32,24
s_waitcnt lgkmcnt(2)
za 28,124,32,28
zs 32,32,128
zi 33,33,36
s_mov_b32 s34, 5
t_p256c_loop_159:
s_waitcnt vmcnt(0) lgkmcnt(0)
s_barrier
za 32,96,36,32
zg 32,20,32768
zay 44
za 36,100,36,36
zk 12,33
za 40,104,36,40
zc 64,22,32768
za 44,108,36,44
zc 66,22,34816
zf 45,65536
za 48,112,36,48
zl 4,32
za 52,116,36,52
zc 68,23,32768
za 56,120,36,56
za 60,124,36,60
za 64,96,40,64
zg 36,20,34816
zf 44,1024
za 68,100,40,68
zk 13,33
za 72,104,40,72
zc 70,23,34816
za 76,108,40,76
zc 72,24,32768
za 80,112,40,80
zc 74,24,34816
za 84,116,40,84
za 88,120,40,88
za 92,124,40,92
za 96,96,44,96
zg 40,20,36864
zf 45,66560
za 100,100,44,100
zl 5,32
za 104,104,44,104
zc 76,25,32768
za 108,108,44,108
zc 78,25,34816
zf 44,2048
za 112,112,44,112
zk 14,33
za 116,116,44,116
za 120,120,44,120
za 124,124,44,124
za 128,96,48,128
zg 44,20,38912
zf 45,67584
za 132,100,48,132
zl 6,32
za 136,104,48,136
zc 80,26,32768
za 140,108,48,140
zc 82,26,34816
za 144,112,48,144
za 148,116,48,148
za 152,120,48,152
za 156,124,48,156
za 160,96,52,160
zg 48,20,40960
zf 44,3072
za 164,100,52,164
zk 15,33
za 168,104,52,168
zc 84,27,32768
za 172,108,52,172
zc 86,27,34816
zf 45,68608
za 176,112,52,176
zl 7,32
za 180,116,52,180
za 184,120,52,184
za 188,124,52,188
za 192,96,56,192
zg 52,20,43008
zf 44,4096
za 196,100,56,196
zk 16,33
za 200,104,56,200
zc 88,28,32768
za 204,108,56,204
zc 90,28,34816
za 208,112,56,208
za 212,116,56,212
za 216,120,56,216
za 220,124,56,220
za 224,96,60,224
zg 56,20,45056
zf 45,69632
za 228,100,60,228
zl 8,32
za 232,104,60,232
zc 92,29,32768
za 236,108,60,236
zc 94,29,34816
zf 44,5120
za 240,112,60,240
zk 17,33
za 244,116,60,244
za 248,120,60,248
za 252,124,60,252
zg 60,20,47104
s_waitcnt lgkmcnt(15)
za 0,64,32,0
zc 96,22,49152
zf 45,70656
za 4,68,32,4
zl 9,32
za 8,72,32,8
zc 98,22,51200
s_waitcnt lgkmcnt(15)
za 12,76,32,12
zc 100,23,49152
s_waitcnt lgkmcnt(13)
za 16,80,32,16
s_waitcnt lgkmcnt(10)
za 20,84,32,20
s_waitcnt lgkmcnt(7)
za 24,88,32,24
s_waitcnt lgkmcnt(4)
za 28,92,32,28
za 32,64,36,32
zg 32,21,32768
zf 44,6144
za 36,68,36,36
zk 18,33
za 40,72,36,40
zc 102,23,51200
za 44,76,36,44
zc 104,24,49152
zf 45,71680
za 48,80,36,48
zl 10,32
za 52,84,36,52
zc 106,24,51200
za 56,88,36,56
za 60,92,36,60
za 64,64,40,64
zg 36,21,34816
zf 44,7168
za 68,68,40,68
zk 19,33
za 72,72,40,72
zc 108,25,49152
za 76,76,40,76
zc 110,25,51200
za 80,80,40,80
za 84,84,40,84
za 88,88,40,88
za 92,92,40,92
za 96,64,44,96
zg 40,21,36864
zf 45,72704
za 100,68,44,100
zl 11,32
za 104,72,44,104
zc 112,26,49152
za 108,76,44,108
zc 114,26,51200
za 112,80,44,112
za 116,84,44,116
za 120,88,44,120
za 124,92,44,124
za 128,64,48,128
zg 44,21,38912
za 132,68,48,132
zc 116,27,49152
za 136,72,48,136
zc 118,27,51200
za 140,76,48,140
za 144,80,48,144
za 148,84,48,148
za 152,88,48,152
za 156,92,48,156
za 160,64,52,160
zg 48,21,40960
za 164,68,52,164
zc 120,28,49152
za 168,72,52,168
zc 122,28,51200
za 172,76,52,172
za 176,80,52,176
za 180,84,52,180
za 184,88,52,184
za 188,92,52,188
za 192,64,56,192
zg 52,21,43008
za 196,68,56,196
zc 124,29,49152
za 200,72,56,200
zc 126,29,51200
za 204,76,56,204
za 208,80,56,208
za 212,84,56,212
za 216,88,56,216
za 220,92,56,220
s_waitcnt lgkmcnt(15)
za 224,64,60,224
zg 56,21,45056
za 228,68,60,228
za 232,72,60,232
za 236,76,60,236
za 240,80,60,240
za 244,84,60,244
za 248,88,60,248
za 252,92,60,252
za 0,96,32,0
zg 60,21,47104
za 4,100,32,4
za 8,104,32,8
s_waitcnt lgkmcnt(14)
za 12,108,32,12
s_waitcnt lgkmcnt(11)
za 16,112,32,16
s_waitcnt lgkmcnt(8)
za 20,116,32,20
s_waitcnt lgkmcnt(5)
za 24,120,32,24
s_waitcnt lgkmcnt(2)
za 28,124,32,28
zs 32,32,128
zi 33,33,36
s_waitcnt vmcnt(0) lgkmcnt(0)
s_barrier
za 32,96,36,32
zg 32,20,0
zf 44,32768
za 36,100,36,36
zk 12,33
za 40,104,36,40
zc 64,22,0
za 44,108,36,44
zc 66,22,2048
zf 45,98304
za 48,112,36,48
zl 4,32
za 52,116,36,52
zc 68,23,0
za 56,120,36,56
za 60,124,36,60
za 64,96,40,64
zg 36,20,2048
zf 44,33792
za 68,100,40,68
zk 13,33
za 72,104,40,72
zc 70,23,2048
za 76,108,40,76
zc 72,24,0
za 80,112,40,80
zc 74,24,2048
za 84,116,40,84
za 88,120,40,88
za 92,124,40,92
za 96,96,44,96
zg 40,20,4096
zf 45,99328
za 100,100,44,100
zl 5,32
za 104,104,44,104
zc 76,25,0
za 108,108,44,108
zc 78,25,2048
zf 44,34816
za 112,112,44,112
zk 14,33
za 116,116,44,116
za 120,120,44,120
za 124,124,44,124
za 128,96,48,128
zg 44,20,6144
zf 45,100352
za 132,100,48,132
zl 6,32
za 136,104,48,136
zc 80,26,0
za 140,108,48,140
zc 82,26,2048
za 144,112,48,144
za 148,116,48,148
za 152,120,48,152
za 156,124,48,156
za 160,96,52,160
zg 48,20,8192
zf 44,35840
za 164,100,52,164
zk 15,33
za 168,104,52,168
zc 84,27,0
za 172,108,52,172
zc 86,27,2048
zf 45,101376
za 176,112,52,176
zl 7,32
za 180,116,52,180
za 184,120,52,184
za 188,124,52,188
za 192,96,56,192
zg 52,20,10240
zf 44,36864
za 196,100,56,196
zk 16,33
za 200,104,56,200
zc 88,28,0
za 204,108,56,204
zc 90,28,2048
za 208,112,56,208
za 212,116,56,212
za 216,120,56,216
za 220,124,56,220
za 224,96,60,224
zg 56,20,12288
zf 45,102400
za 228,100,60,228
zl 8,32
za 232,104,60,232
zc 92,29,0
za 236,108,60,236
zc 94,29,2048
zf 44,37888
za 240,112,60,240
zk 17,33
za 244,116,60,244
za 248,120,60,248
za 252,124,60,252
zg 60,20,14336
s_waitcnt lgkmcnt(15)
za 0,64,32,0
zc 96,22,16384
zf 45,103424
za 4,68,32,4
zl 9,32
za 8,72,32,8
zc 98,22,18432
s_waitcnt lgkmcnt(15)
za 12,76,32,12
zc 100,23,16384
s_waitcnt lgkmcnt(13)
za 16,80,32,16
s_waitcnt lgkmcnt(10)
za 20,84,32,20
s_waitcnt lgkmcnt(7)
za 24,88,32,24
s_waitcnt lgkmcnt(4)
za 28,92,32,28
za 32,64,36,32
zg 32,21,0
zf 44,38912
za 36,68,36,36
zk 18,33
za 40,72,36,40
zc 102,23,18432
za 44,76,36,44
zc 104,24,16384
zf 45,104448
za 48,80,36,48
zl 10,32
za 52,84,36,52
zc 106,24,18432
za 56,88,36,56
za 60,92,36,60
za 64,64,40,64
zg 36,21,2048
zf 44,39936
za 68,68,40,68
zk 19,33
za 72,72,40,72
zc 108,25,16384
za 76,76,40,76
zc 110,25,18432
za 80,80,40,80
za 84,84,40,84
za 88,88,40,88
za 92,92,40,92
za 96,64,44,96
zg 40,21,4096
zf 45,105472
za 100,68,44,100
zl 11,32
za 104,72,44,104
zc 112,26,16384
za 108,76,44,108
zc 114,26,18432
za 112,80,44,112
za 116,84,44,116
za 120,88,44,120
za 124,92,44,124
za 128,64,48,128
zg 44,21,6144
za 132,68,48,132
zc 116,27,16384
za 136,72,48,136
zc 118,27,18432
za 140,76,48,140
za 144,80,48,144
za 148,84,48,148
za 152,88,48,152
za 156,92,48,156
za 160,64,52,160
zg 48,21,8192
za 164,68,52,164
zc 120,28,16384
za 168,72,52,168
zc 122,28,18432
za 172,76,52,172
za 176,80,52,176
za 180,84,52,180
za 184,88,52,184
za 188,92,52,188
za 192,64,56,192
zg 52,21,10240
za 196,68,56,196
zc 124,29,16384
za 200,72,56,200
zc 126,29,18432
za 204,76,56,204
za 208,80,56,208
za 212,84,56,212
za 216,88,56,216
za 220,92,56,220
s_waitcnt lgkmcnt(15)
za 224,64,60,224
zg 56,21,12288
za 228,68,60,228
za 232,72,60,232
za 236,76,60,236
za 240,80,60,240
za 244,84,60,244
za 248,88,60,248
za 252,92,60,252
za 0,96,32,0
zg 60,21,14336
za 4,100,32,4
za 8,104,32,8
s_waitcnt lgkmcnt(14)
za 12,108,32,12
s_waitcnt lgkmcnt(11)
za 16,112,32,16
s_waitcnt lgkmcnt(8)
za 20,116,32,20
s_waitcnt lgkmcnt(5)
za 24,120,32,24
s_waitcnt lgkmcnt(2)
za 28,124,32,28
zs 32,32,128
zi 33,33,36
s_sub_u32 s34, s34, 1
s_cmp_lg_u32 s34, 0
s_cbranch_scc1 t_p256c_loop_159
s_and_b32 s68, s96, 0xff
s_cmp_eq_u32 s68, 2
s_cbranch_scc0 nonext_160
s_bfe_u32 s46, s96, 0x80008
s_bfe_u32 s47, s96, 0x80010
s_bfe_u32 s48, s96, 0x80018
s_lshl_b32 s47, s47, 8
s_and_b32 s57, s3, 1
s_cmp_eq_u32 s46, 0
s_cbranch_scc0 ps_162_b
s_mov_b64 s[50:51], s[70:71]
s_mov_b64 s[52:53], s[72:73]
s_mov_b32 s43, 6144
s_mov_b32 s54, 6291456
s_lshr_b32 s55, s48, 2
s_and_b32 s56, s48, 3
s_lshl_b32 s56, s56, 3
s_lshl_b32 s57, s57, 2
zi 56,56,57
s_lshl_b32 s56, s56, 17
s_lshl_b32 s57, s55, 22
zi 56,56,57
s_mov_b32 s61, 2048
s_mov_b32 s62, 131072
s_cmp_eq_u32 s55, 0
s_cselect_b32 s63, 0x3e8293ee, 1.0
s_cmp_eq_u32 s55, 2
s_cselect_b32 s49, 1, 0
s_branch ps_162_c
ps_162_b:
s_mov_b64 s[50:51], s[76:77]
s_cmp_eq_u32 s46, 1
s_cselect_b64 s[52:53], s[78:79], s[80:81]
s_cselect_b32 s63, 0x3e0293ee, 1.0
s_cmp_eq_u32 s46, 3
s_cselect_b64 s[52:53], s[82:83], s[52:53]
s_cselect_b32 s49, 2, 0
s_mov_b32 s43, 8192
s_mov_b32 s54, 8388608
s_lshl_b32 s56, s48, 1
zi 56,56,57
s_lshl_b32 s56, s56, 19
s_lshl_b32 s57, s46, 24
zi 56,56,57
s_mov_b32 s61, 8192
s_mov_b32 s62, 2048
ps_162_c:
s_lshr_b32 s57, s3, 1
s_mul_i32 s57, s57, 4
s_lshr_b32 s55, s47, 5
zi 57,57,55
s_mul_i32 s57, s57, s61
zi 56,56,57
s_mov_b32 s42, 2048
s_mov_b32 s35, 128
s_lshl_b32 s36, s43, 6
s_mov_b32 s34, 16
s_lshl_b32 s55, s47, 11
s_mul_i32 s57, s48, 512
s_min_u32 s55, s55, 4194304
zi 20,50,55
s_addc_u32 s21, s51, 0
s_sub_u32 s22, 4194304, s55
s_mov_b32 s23, 0x20000
s_min_u32 s57, s57, s54
zi 24,52,57
s_addc_u32 s25, s53, 0
s_sub_u32 s26, s54, s57
s_mov_b32 s27, 0x20000
s_min_u32 s56, s56, 67108864
zi 58,4,56
s_addc_u32 s59, s5, 0
s_sub_u32 s60, 67108864, s56
v_lshrrev_b32 v128, 5, v1
v_and_b32 v129, 31, v1
v_lshlrev_b32 v130, 1, v128
v_xor_b32 v129, v129, v130
v_lshlrev_b32 v129, 4, v129
s_lshl_b32 s39, s3, 4
v_add_u32 v128, s39, v128
v_mul_lo_u32 v128, v128, s43
s_lshl_b32 s39, s43, 1
s_mov_b32 s40, 0
v_xor_b32 v130, 0, v129
v_add3_u32 v12, v128, v130, s40
zi 40,40,39
v_xor_b32 v130, 64, v129
v_add3_u32 v13, v128, v130, s40
zi 40,40,39
v_xor_b32 v130, 0, v129
v_add3_u32 v14, v128, v130, s40
zi 40,40,39
v_xor_b32 v130, 64, v129
v_add3_u32 v15, v128, v130, s40
zi 40,40,39
v_xor_b32 v130, 128, v129
v_add3_u32 v16, v128, v130, s40
zi 40,40,39
v_xor_b32 v130, 192, v129
v_add3_u32 v17, v128, v130, s40
zi 40,40,39
v_xor_b32 v130, 128, v129
v_add3_u32 v18, v128, v130, s40
zi 40,40,39
v_xor_b32 v130, 192, v129
v_add3_u32 v19, v128, v130, s40
s_min_u32 s95, s49, 1
s_branch sw_161
nonext_160:
s_mov_b64 s[58:59], s[28:29]
s_mov_b32 s60, 0
s_mov_b32 s22, 0
s_mov_b32 s26, 0
s_mov_b32 s95, 3
sw_161:
s_mov_b32 s32, 0
s_mov_b32 s33, 0
s_waitcnt vmcnt(0) lgkmcnt(0)
s_barrier
za 32,96,36,32
zg 32,20,32768
zay 44
za 36,100,36,36
zk 12,33
za 40,104,36,40
zc 64,22,32768
za 44,108,36,44
zc 66,22,34816
zf 45,65536
za 48,112,36,48
zl 4,32
za 52,116,36,52
zc 68,23,32768
za 56,120,36,56
za 60,124,36,60
za 64,96,40,64
zg 36,20,34816
zf 44,1024
za 68,100,40,68
zk 13,33
za 72,104,40,72
zc 70,23,34816
za 76,108,40,76
zc 72,24,32768
za 80,112,40,80
zc 74,24,34816
za 84,116,40,84
za 88,120,40,88
za 92,124,40,92
za 96,96,44,96
zg 40,20,36864
zf 45,66560
za 100,100,44,100
zl 5,32
za 104,104,44,104
zc 76,25,32768
za 108,108,44,108
zc 78,25,34816
zf 44,2048
za 112,112,44,112
zk 14,33
za 116,116,44,116
za 120,120,44,120
za 124,124,44,124
za 128,96,48,128
zg 44,20,38912
zf 45,67584
za 132,100,48,132
zl 6,32
za 136,104,48,136
zc 80,26,32768
za 140,108,48,140
zc 82,26,34816
za 144,112,48,144
za 148,116,48,148
za 152,120,48,152
za 156,124,48,156
za 160,96,52,160
zg 48,20,40960
zf 44,3072
za 164,100,52,164
zk 15,33
za 168,104,52,168
zc 84,27,32768
za 172,108,52,172
zc 86,27,34816
zf 45,68608
za 176,112,52,176
zl 7,32
za 180,116,52,180
za 184,120,52,184
za 188,124,52,188
za 192,96,56,192
zg 52,20,43008
zf 44,4096
za 196,100,56,196
zk 16,33
za 200,104,56,200
zc 88,28,32768
za 204,108,56,204
zc 90,28,34816
za 208,112,56,208
za 212,116,56,212
za 216,120,56,216
za 220,124,56,220
za 224,96,60,224
zg 56,20,45056
zf 45,69632
za 228,100,60,228
zl 8,32
za 232,104,60,232
zc 92,29,32768
za 236,108,60,236
zc 94,29,34816
zf 44,5120
za 240,112,60,240
zk 17,33
za 244,116,60,244
za 248,120,60,248
za 252,124,60,252
zg 60,20,47104
s_waitcnt lgkmcnt(15)
za 0,64,32,0
zc 96,22,49152
zf 45,70656
za 4,68,32,4
zl 9,32
za 8,72,32,8
zc 98,22,51200
s_waitcnt lgkmcnt(15)
za 12,76,32,12
zc 100,23,49152
s_waitcnt lgkmcnt(13)
za 16,80,32,16
s_waitcnt lgkmcnt(10)
za 20,84,32,20
s_waitcnt lgkmcnt(7)
za 24,88,32,24
s_waitcnt lgkmcnt(4)
za 28,92,32,28
za 32,64,36,32
zg 32,21,32768
zf 44,6144
za 36,68,36,36
zk 18,33
za 40,72,36,40
zc 102,23,51200
za 44,76,36,44
zc 104,24,49152
zf 45,71680
za 48,80,36,48
zl 10,32
za 52,84,36,52
zc 106,24,51200
za 56,88,36,56
za 60,92,36,60
za 64,64,40,64
zg 36,21,34816
zf 44,7168
za 68,68,40,68
zk 19,33
za 72,72,40,72
zc 108,25,49152
za 76,76,40,76
zc 110,25,51200
za 80,80,40,80
za 84,84,40,84
za 88,88,40,88
za 92,92,40,92
za 96,64,44,96
zg 40,21,36864
zf 45,72704
za 100,68,44,100
zl 11,32
za 104,72,44,104
zc 112,26,49152
za 108,76,44,108
zc 114,26,51200
za 112,80,44,112
za 116,84,44,116
za 120,88,44,120
za 124,92,44,124
za 128,64,48,128
zg 44,21,38912
za 132,68,48,132
zc 116,27,49152
za 136,72,48,136
zc 118,27,51200
za 140,76,48,140
za 144,80,48,144
za 148,84,48,148
za 152,88,48,152
za 156,92,48,156
za 160,64,52,160
zg 48,21,40960
za 164,68,52,164
zc 120,28,49152
za 168,72,52,168
zc 122,28,51200
za 172,76,52,172
za 176,80,52,176
za 180,84,52,180
za 184,88,52,184
za 188,92,52,188
za 192,64,56,192
zg 52,21,43008
za 196,68,56,196
zc 124,29,49152
za 200,72,56,200
zc 126,29,51200
za 204,76,56,204
za 208,80,56,208
za 212,84,56,212
za 216,88,56,216
za 220,92,56,220
s_waitcnt lgkmcnt(15)
za 224,64,60,224
zg 56,21,45056
za 228,68,60,228
za 232,72,60,232
za 236,76,60,236
za 240,80,60,240
za 244,84,60,244
za 248,88,60,248
za 252,92,60,252
za 0,96,32,0
zg 60,21,47104
za 4,100,32,4
za 8,104,32,8
s_waitcnt lgkmcnt(14)
za 12,108,32,12
s_waitcnt lgkmcnt(11)
za 16,112,32,16
s_waitcnt lgkmcnt(8)
za 20,116,32,20
s_waitcnt lgkmcnt(5)
za 24,120,32,24
s_waitcnt lgkmcnt(2)
za 28,124,32,28
zs 32,32,128
zi 33,33,36
s_cmp_eq_u32 s95, 3
s_cbranch_scc1 drain_163
s_waitcnt vmcnt(0) lgkmcnt(0)
s_barrier
za 32,96,36,32
zg 32,20,0
zf 44,32768
za 36,100,36,36
zk 12,33
za 40,104,36,40
zc 64,22,0
za 44,108,36,44
zc 66,22,2048
zf 45,98304
za 48,112,36,48
zl 4,32
za 52,116,36,52
zc 68,23,0
za 56,120,36,56
za 60,124,36,60
za 64,96,40,64
zg 36,20,2048
zf 44,33792
za 68,100,40,68
zk 13,33
za 72,104,40,72
zc 70,23,2048
za 76,108,40,76
zc 72,24,0
za 80,112,40,80
zc 74,24,2048
za 84,116,40,84
za 88,120,40,88
za 92,124,40,92
za 96,96,44,96
zg 40,20,4096
zf 45,99328
za 100,100,44,100
zl 5,32
za 104,104,44,104
zc 76,25,0
za 108,108,44,108
zc 78,25,2048
zf 44,34816
za 112,112,44,112
zk 14,33
za 116,116,44,116
za 120,120,44,120
za 124,124,44,124
za 128,96,48,128
zg 44,20,6144
zf 45,100352
za 132,100,48,132
zl 6,32
za 136,104,48,136
zc 80,26,0
za 140,108,48,140
zc 82,26,2048
za 144,112,48,144
za 148,116,48,148
za 152,120,48,152
za 156,124,48,156
za 160,96,52,160
zg 48,20,8192
zf 44,35840
za 164,100,52,164
zk 15,33
za 168,104,52,168
zc 84,27,0
za 172,108,52,172
zc 86,27,2048
zf 45,101376
za 176,112,52,176
zl 7,32
za 180,116,52,180
za 184,120,52,184
za 188,124,52,188
za 192,96,56,192
zg 52,20,10240
zf 44,36864
za 196,100,56,196
zk 16,33
za 200,104,56,200
zc 88,28,0
za 204,108,56,204
zc 90,28,2048
za 208,112,56,208
za 212,116,56,212
za 216,120,56,216
za 220,124,56,220
za 224,96,60,224
zg 56,20,12288
zf 45,102400
za 228,100,60,228
zl 8,32
za 232,104,60,232
zc 92,29,0
za 236,108,60,236
zc 94,29,2048
zf 44,37888
za 240,112,60,240
zk 17,33
za 244,116,60,244
za 248,120,60,248
za 252,124,60,252
zg 60,20,14336
s_mov_b64 s[64:65], s[96:97]
s_mov_b64 s[66:67], s[98:99]
zs 88,88,16
s_addc_u32 s89, s89, 0
s_load_dwordx4 s[96:99], s[88:89], 0
s_mov_b32 s46, s58
s_mov_b32 s47, s59
s_mov_b32 s48, s60
s_mov_b32 s49, s61
s_mov_b32 s50, s62
s_mov_b32 s51, s63
s_cmp_eq_u32 s19, 10
s_cbranch_scc0 tch_164
s_and_b32 s68, s14, 127
s_lshl_b32 s68, s68, 2
zi 68,68,3
s_mul_i32 s68, s68, 8192
v_and_b32 v2, 63, v0
v_lshl_add_u32 v2, v2, 7, s68
s_mov_b64 s[52:53], s[70:71]
s_mov_b32 s54, 4194304
s_mov_b32 s55, 0x20000
s_mov_b32 s69, 0
zbj 31,2,69,0
s_and_b32 s68, s14, 127
s_lshl_b32 s68, s68, 2
zi 68,68,3
s_mul_i32 s68, s68, 12288
v_and_b32 v2, 63, v0
v_lshl_add_u32 v2, v2, 7, s68
s_mov_b64 s[52:53], s[72:73]
s_mov_b32 s54, 6291456
s_mov_b32 s55, 0x20000
s_mov_b32 s69, 0
zbj 31,2,69,0
s_mov_b32 exec_hi, 0
s_mov_b32 s69, 8192
zbj 31,2,69,0
s_mov_b64 exec, -1
s_and_b32 s68, s14, 127
s_lshl_b32 s68, s68, 2
zi 68,68,3
s_mul_i32 s68, s68, 16384
v_and_b32 v2, 63, v0
v_lshl_add_u32 v2, v2, 7, s68
s_mov_b64 s[52:53], s[78:79]
s_mov_b32 s54, 8388608
s_mov_b32 s55, 0x20000
s_mov_b32 s69, 0
zbj 31,2,69,0
s_mov_b32 s69, 8192
zbj 31,2,69,0
tch_164:
s_cmp_eq_u32 s19, 11
s_cbranch_scc0 tch_165
s_and_b32 s68, s14, 127
s_lshl_b32 s68, s68, 2
zi 68,68,3
s_mul_i32 s68, s68, 4096
v_and_b32 v2, 63, v0
v_lshl_add_u32 v2, v2, 7, s68
s_mov_b64 s[52:53], s[74:75]
s_mov_b32 s54, 2097152
s_mov_b32 s55, 0x20000
s_mov_b32 exec_hi, 0
s_mov_b32 s69, 0
zbj 31,2,69,0
s_mov_b64 exec, -1
s_and_b32 s68, s14, 127
s_lshl_b32 s68, s68, 2
zi 68,68,3
s_mul_i32 s68, s68, 16384
v_and_b32 v2, 63, v0
v_lshl_add_u32 v2, v2, 7, s68
s_mov_b64 s[52:53], s[84:85]
s_mov_b32 s54, 8388608
s_mov_b32 s55, 0x20000
s_mov_b32 s69, 0
zbj 31,2,69,0
s_mov_b32 s69, 8192
zbj 31,2,69,0
tch_165:
zac 19,19
v_bfe_u32 v2, v1, 4, 1
v_lshrrev_b32 v3, 5, v1
v_lshlrev_b32 v2, 10, v2
v_lshl_add_u32 v2, v3, 9, v2
v_and_b32 v3, 15, v1
v_lshl_add_u32 v30, v3, 4, v2
zb 96,0
zb 97,1
zb 98,2
zb 99,3
zb 100,4
zb 101,5
zb 102,6
zb 103,7
zn 96,96
zn 98,98
zn 100,100
zn 102,102
zd 128,96,97
zd 129,98,99
zd 130,100,101
zd 131,102,103
zb 104,32
zb 105,33
zb 106,34
zb 107,35
zb 108,36
zb 109,37
zb 110,38
zb 111,39
zu 128,130
zu 129,131
zn 104,104
zn 106,106
zn 108,108
zn 110,110
zd 132,104,105
zd 133,106,107
zd 134,108,109
zd 135,110,111
zb 112,8
zb 113,9
zb 114,10
zb 115,11
zb 116,12
zb 117,13
zb 118,14
zb 119,15
zu 132,134
zu 133,135
zn 112,112
zn 114,114
zn 116,116
zn 118,118
zd 136,112,113
zd 137,114,115
zd 138,116,117
zd 139,118,119
zb 120,40
zb 121,41
zb 122,42
zb 123,43
zb 124,44
zb 125,45
zb 126,46
zb 127,47
zu 136,138
zu 137,139
zn 120,120
zn 122,122
zn 124,124
zn 126,126
zd 140,120,121
zd 141,122,123
zd 142,124,125
zd 143,126,127
zb 96,16
zb 97,17
zb 98,18
zb 99,19
zb 100,20
zb 101,21
zb 102,22
zb 103,23
zu 140,142
zu 141,143
zn 96,96
zn 98,98
zn 100,100
zn 102,102
zd 144,96,97
zd 145,98,99
zd 146,100,101
zd 147,102,103
zb 104,48
zb 105,49
zb 106,50
zb 107,51
zb 108,52
zb 109,53
zb 110,54
zb 111,55
zu 144,146
zu 145,147
zn 104,104
zn 106,106
zn 108,108
zn 110,110
zd 148,104,105
zd 149,106,107
zd 150,108,109
zd 151,110,111
zb 112,24
zb 113,25
zb 114,26
zb 115,27
zb 116,28
zb 117,29
zb 118,30
zb 119,31
zu 148,150
zu 149,151
zn 112,112
zn 114,114
zn 116,116
zn 118,118
zd 152,112,113
zd 153,114,115
zd 154,116,117
zd 155,118,119
zb 120,56
zb 121,57
zb 122,58
zb 123,59
zb 124,60
zb 125,61
zb 126,62
zb 127,63
zu 152,154
zu 153,155
zn 120,120
zn 122,122
zn 124,124
zn 126,126
zd 156,120,121
zd 157,122,123
zd 158,124,125
zd 159,126,127
zb 96,64
zb 97,65
zb 98,66
zb 99,67
zb 100,68
zb 101,69
zb 102,70
zb 103,71
zu 156,158
zu 157,159
zn 96,96
zn 98,98
zn 100,100
zn 102,102
zd 160,96,97
zd 161,98,99
zd 162,100,101
zd 163,102,103
zb 104,96
zb 105,97
zb 106,98
zb 107,99
zb 108,100
zb 109,101
zb 110,102
zb 111,103
zu 160,162
zu 161,163
zn 104,104
zn 106,106
zn 108,108
zn 110,110
zd 164,104,105
zd 165,106,107
zd 166,108,109
zd 167,110,111
zb 112,72
zb 113,73
zb 114,74
zb 115,75
zb 116,76
zb 117,77
zb 118,78
zb 119,79
zu 164,166
zu 165,167
zn 112,112
zn 114,114
zn 116,116
zn 118,118
zd 168,112,113
zd 169,114,115
zd 170,116,117
zd 171,118,119
zb 120,104
zb 121,105
zb 122,106
zb 123,107
zb 124,108
zb 125,109
zb 126,110
zb 127,111
zu 168,170
zu 169,171
zn 120,120
zn 122,122
zn 124,124
zn 126,126
zd 172,120,121
zd 173,122,123
zd 174,124,125
zd 175,126,127
zb 96,80
zb 97,81
zb 98,82
zb 99,83
zb 100,84
zb 101,85
zb 102,86
zb 103,87
zu 172,174
zu 173,175
zn 96,96
zn 98,98
zn 100,100
zn 102,102
zd 176,96,97
zd 177,98,99
zd 178,100,101
zd 179,102,103
zb 104,112
zb 105,113
zb 106,114
zb 107,115
zb 108,116
zb 109,117
zb 110,118
zb 111,119
zu 176,178
zu 177,179
zn 104,104
zn 106,106
zn 108,108
zn 110,110
zd 180,104,105
zd 181,106,107
zd 182,108,109
zd 183,110,111
zb 112,88
zb 113,89
zb 114,90
zb 115,91
zb 116,92
zb 117,93
zb 118,94
zb 119,95
zu 180,182
zu 181,183
zn 112,112
zn 114,114
zn 116,116
zn 118,118
zd 184,112,113
zd 185,114,115
zd 186,116,117
zd 187,118,119
zb 120,120
zb 121,121
zb 122,122
zb 123,123
zb 124,124
zb 125,125
zb 126,126
zb 127,127
zu 184,186
zu 185,187
zn 120,120
zn 122,122
zn 124,124
zn 126,126
zd 188,120,121
zd 189,122,123
zd 190,124,125
zd 191,126,127
zb 96,128
zb 97,129
zb 98,130
zb 99,131
zb 100,132
zb 101,133
zb 102,134
zb 103,135
zu 188,190
zu 189,191
zn 96,96
zn 98,98
zn 100,100
zn 102,102
zd 192,96,97
zd 193,98,99
zd 194,100,101
zd 195,102,103
zb 104,160
zb 105,161
zb 106,162
zb 107,163
zb 108,164
zb 109,165
zb 110,166
zb 111,167
zu 192,194
zu 193,195
zn 104,104
zn 106,106
zn 108,108
zn 110,110
zd 196,104,105
zd 197,106,107
zd 198,108,109
zd 199,110,111
zb 112,136
zb 113,137
zb 114,138
zb 115,139
zb 116,140
zb 117,141
zb 118,142
zb 119,143
zu 196,198
zu 197,199
zn 112,112
zn 114,114
zn 116,116
zn 118,118
zd 200,112,113
zd 201,114,115
zd 202,116,117
zd 203,118,119
zb 120,168
zb 121,169
zb 122,170
zb 123,171
zb 124,172
zb 125,173
zb 126,174
zb 127,175
zu 200,202
zu 201,203
zn 120,120
zn 122,122
zn 124,124
zn 126,126
zd 204,120,121
zd 205,122,123
zd 206,124,125
zd 207,126,127
zb 96,144
zb 97,145
zb 98,146
zb 99,147
zb 100,148
zb 101,149
zb 102,150
zb 103,151
zu 204,206
zu 205,207
zn 96,96
zn 98,98
zn 100,100
zn 102,102
zd 208,96,97
zd 209,98,99
zd 210,100,101
zd 211,102,103
zb 104,176
zb 105,177
zb 106,178
zb 107,179
zb 108,180
zb 109,181
zb 110,182
zb 111,183
zu 208,210
zu 209,211
zn 104,104
zn 106,106
zn 108,108
zn 110,110
zd 212,104,105
zd 213,106,107
zd 214,108,109
zd 215,110,111
zb 112,152
zb 113,153
zb 114,154
zb 115,155
zb 116,156
zb 117,157
zb 118,158
zb 119,159
zu 212,214
zu 213,215
zn 112,112
zn 114,114
zn 116,116
zn 118,118
zd 216,112,113
zd 217,114,115
zd 218,116,117
zd 219,118,119
zb 120,184
zb 121,185
zb 122,186
zb 123,187
zb 124,188
zb 125,189
zb 126,190
zb 127,191
zu 216,218
zu 217,219
zn 120,120
zn 122,122
zn 124,124
zn 126,126
zd 220,120,121
zd 221,122,123
zd 222,124,125
zd 223,126,127
zb 96,192
zb 97,193
zb 98,194
zb 99,195
zb 100,196
zb 101,197
zb 102,198
zb 103,199
zu 220,222
zu 221,223
zn 96,96
zn 98,98
zn 100,100
zn 102,102
zd 224,96,97
zd 225,98,99
zd 226,100,101
zd 227,102,103
zb 104,224
zb 105,225
zb 106,226
zb 107,227
zb 108,228
zb 109,229
zb 110,230
zb 111,231
zu 224,226
zu 225,227
zn 104,104
zn 106,106
zn 108,108
zn 110,110
zd 228,104,105
zd 229,106,107
zd 230,108,109
zd 231,110,111
zb 112,200
zb 113,201
zb 114,202
zb 115,203
zb 116,204
zb 117,205
zb 118,206
zb 119,207
zu 228,230
zu 229,231
zn 112,112
zn 114,114
zn 116,116
zn 118,118
zd 232,112,113
zd 233,114,115
zd 234,116,117
zd 235,118,119
zb 120,232
zb 121,233
zb 122,234
zb 123,235
zb 124,236
zb 125,237
zb 126,238
zb 127,239
zu 232,234
zu 233,235
zn 120,120
zn 122,122
zn 124,124
zn 126,126
zd 236,120,121
zd 237,122,123
zd 238,124,125
zd 239,126,127
zb 96,208
zb 97,209
zb 98,210
zb 99,211
zb 100,212
zb 101,213
zb 102,214
zb 103,215
zu 236,238
zu 237,239
zn 96,96
zn 98,98
zn 100,100
zn 102,102
zd 240,96,97
zd 241,98,99
zd 242,100,101
zd 243,102,103
zb 104,240
zb 105,241
zb 106,242
zb 107,243
zb 108,244
zb 109,245
zb 110,246
zb 111,247
zu 240,242
zu 241,243
zn 104,104
zn 106,106
zn 108,108
zn 110,110
zd 244,104,105
zd 245,106,107
zd 246,108,109
zd 247,110,111
zb 112,216
zb 113,217
zb 114,218
zb 115,219
zb 116,220
zb 117,221
zb 118,222
zb 119,223
zu 244,246
zu 245,247
zn 112,112
zn 114,114
zn 116,116
zn 118,118
zd 248,112,113
zd 249,114,115
zd 250,116,117
zd 251,118,119
zb 120,248
zb 121,249
zb 122,250
zb 123,251
zb 124,252
zb 125,253
zb 126,254
zb 127,255
zu 248,250
zu 249,251
zn 120,120
zn 122,122
zn 124,124
zn 126,126
zd 252,120,121
zd 253,122,123
zd 254,124,125
zd 255,126,127
s_nop 1
zu 252,254
zu 253,255
s_mov_b64 s[56:57], s[28:29]
s_mov_b32 s58, s30
s_mov_b32 s59, 0x20000
s_mov_b32 s60, s37
s_mov_b32 s61, s38
s_mov_b32 s62, 0
s_mov_b32 s63, 0
s_mov_b32 s100, s101
s_waitcnt lgkmcnt(0)
s_mov_b64 s[28:29], s[46:47]
s_mov_b32 s30, s48
s_mov_b32 s37, s49
s_mov_b32 s38, s50
s_mov_b32 s41, s51
s_mov_b32 s94, s95
s_mov_b32 s101, s67
s_cmp_eq_u32 s94, 0
s_cbranch_scc1 t_p256c_head_NR
s_branch t_p256c_head_TR
drain_163:
s_waitcnt lgkmcnt(0)
za 32,96,36,32
za 36,100,36,36
za 40,104,36,40
za 44,108,36,44
za 48,112,36,48
za 52,116,36,52
za 56,120,36,56
za 60,124,36,60
za 64,96,40,64
za 68,100,40,68
za 72,104,40,72
za 76,108,40,76
za 80,112,40,80
za 84,116,40,84
za 88,120,40,88
za 92,124,40,92
za 96,96,44,96
za 100,100,44,100
za 104,104,44,104
za 108,108,44,108
za 112,112,44,112
za 116,116,44,116
za 120,120,44,120
za 124,124,44,124
za 128,96,48,128
za 132,100,48,132
za 136,104,48,136
za 140,108,48,140
za 144,112,48,144
za 148,116,48,148
za 152,120,48,152
za 156,124,48,156
za 160,96,52,160
za 164,100,52,164
za 168,104,52,168
za 172,108,52,172
za 176,112,52,176
za 180,116,52,180
za 184,120,52,184
za 188,124,52,188
za 192,96,56,192
za 196,100,56,196
za 200,104,56,200
za 204,108,56,204
za 208,112,56,208
za 212,116,56,212
za 216,120,56,216
za 220,124,56,220
za 224,96,60,224
za 228,100,60,228
za 232,104,60,232
za 236,108,60,236
za 240,112,60,240
za 244,116,60,244
za 248,120,60,248
za 252,124,60,252
s_nop 7
v_bfe_u32 v2, v1, 4, 1
v_lshrrev_b32 v3, 5, v1
v_lshlrev_b32 v2, 10, v2
v_lshl_add_u32 v2, v3, 9, v2
v_and_b32 v3, 15, v1
v_lshl_add_u32 v30, v3, 4, v2
zb 96,0
zb 97,1
zb 98,2
zb 99,3
zb 100,4
zb 101,5
zb 102,6
zb 103,7
zn 96,96
zn 98,98
zn 100,100
zn 102,102
zd 128,96,97
zd 129,98,99
zd 130,100,101
zd 131,102,103
zb 104,32
zb 105,33
zb 106,34
zb 107,35
zb 108,36
zb 109,37
zb 110,38
zb 111,39
zu 128,130
zu 129,131
zn 104,104
zn 106,106
zn 108,108
zn 110,110
zd 132,104,105
zd 133,106,107
zd 134,108,109
zd 135,110,111
zb 112,8
zb 113,9
zb 114,10
zb 115,11
zb 116,12
zb 117,13
zb 118,14
zb 119,15
zu 132,134
zu 133,135
zn 112,112
zn 114,114
zn 116,116
zn 118,118
zd 136,112,113
zd 137,114,115
zd 138,116,117
zd 139,118,119
zb 120,40
zb 121,41
zb 122,42
zb 123,43
zb 124,44
zb 125,45
zb 126,46
zb 127,47
zu 136,138
zu 137,139
zn 120,120
zn 122,122
zn 124,124
zn 126,126
zd 140,120,121
zd 141,122,123
zd 142,124,125
zd 143,126,127
zb 96,16
zb 97,17
zb 98,18
zb 99,19
zb 100,20
zb 101,21
zb 102,22
zb 103,23
zu 140,142
zu 141,143
zn 96,96
zn 98,98
zn 100,100
zn 102,102
zd 144,96,97
zd 145,98,99
zd 146,100,101
zd 147,102,103
zb 104,48
zb 105,49
zb 106,50
zb 107,51
zb 108,52
zb 109,53
zb 110,54
zb 111,55
zu 144,146
zu 145,147
zn 104,104
zn 106,106
zn 108,108
zn 110,110
zd 148,104,105
zd 149,106,107
zd 150,108,109
zd 151,110,111
zb 112,24
zb 113,25
zb 114,26
zb 115,27
zb 116,28
zb 117,29
zb 118,30
zb 119,31
zu 148,150
zu 149,151
zn 112,112
zn 114,114
zn 116,116
zn 118,118
zd 152,112,113
zd 153,114,115
zd 154,116,117
zd 155,118,119
zb 120,56
zb 121,57
zb 122,58
zb 123,59
zb 124,60
zb 125,61
zb 126,62
zb 127,63
zu 152,154
zu 153,155
zn 120,120
zn 122,122
zn 124,124
zn 126,126
zd 156,120,121
zd 157,122,123
zd 158,124,125
zd 159,126,127
zb 96,64
zb 97,65
zb 98,66
zb 99,67
zb 100,68
zb 101,69
zb 102,70
zb 103,71
zu 156,158
zu 157,159
zn 96,96
zn 98,98
zn 100,100
zn 102,102
zd 160,96,97
zd 161,98,99
zd 162,100,101
zd 163,102,103
zb 104,96
zb 105,97
zb 106,98
zb 107,99
zb 108,100
zb 109,101
zb 110,102
zb 111,103
zu 160,162
zu 161,163
zn 104,104
zn 106,106
zn 108,108
zn 110,110
zd 164,104,105
zd 165,106,107
zd 166,108,109
zd 167,110,111
zb 112,72
zb 113,73
zb 114,74
zb 115,75
zb 116,76
zb 117,77
zb 118,78
zb 119,79
zu 164,166
zu 165,167
zn 112,112
zn 114,114
zn 116,116
zn 118,118
zd 168,112,113
zd 169,114,115
zd 170,116,117
zd 171,118,119
zb 120,104
zb 121,105
zb 122,106
zb 123,107
zb 124,108
zb 125,109
zb 126,110
zb 127,111
zu 168,170
zu 169,171
zn 120,120
zn 122,122
zn 124,124
zn 126,126
zd 172,120,121
zd 173,122,123
zd 174,124,125
zd 175,126,127
zb 96,80
zb 97,81
zb 98,82
zb 99,83
zb 100,84
zb 101,85
zb 102,86
zb 103,87
zu 172,174
zu 173,175
zn 96,96
zn 98,98
zn 100,100
zn 102,102
zd 176,96,97
zd 177,98,99
zd 178,100,101
zd 179,102,103
zb 104,112
zb 105,113
zb 106,114
zb 107,115
zb 108,116
zb 109,117
zb 110,118
zb 111,119
zu 176,178
zu 177,179
zn 104,104
zn 106,106
zn 108,108
zn 110,110
zd 180,104,105
zd 181,106,107
zd 182,108,109
zd 183,110,111
zb 112,88
zb 113,89
zb 114,90
zb 115,91
zb 116,92
zb 117,93
zb 118,94
zb 119,95
zu 180,182
zu 181,183
zn 112,112
zn 114,114
zn 116,116
zn 118,118
zd 184,112,113
zd 185,114,115
zd 186,116,117
zd 187,118,119
zb 120,120
zb 121,121
zb 122,122
zb 123,123
zb 124,124
zb 125,125
zb 126,126
zb 127,127
zu 184,186
zu 185,187
zn 120,120
zn 122,122
zn 124,124
zn 126,126
zd 188,120,121
zd 189,122,123
zd 190,124,125
zd 191,126,127
zb 96,128
zb 97,129
zb 98,130
zb 99,131
zb 100,132
zb 101,133
zb 102,134
zb 103,135
zu 188,190
zu 189,191
zn 96,96
zn 98,98
zn 100,100
zn 102,102
zd 192,96,97
zd 193,98,99
zd 194,100,101
zd 195,102,103
zb 104,160
zb 105,161
zb 106,162
zb 107,163
zb 108,164
zb 109,165
zb 110,166
zb 111,167
zu 192,194
zu 193,195
zn 104,104
zn 106,106
zn 108,108
zn 110,110
zd 196,104,105
zd 197,106,107
zd 198,108,109
zd 199,110,111
zb 112,136
zb 113,137
zb 114,138
zb 115,139
zb 116,140
zb 117,141
zb 118,142
zb 119,143
zu 196,198
zu 197,199
zn 112,112
zn 114,114
zn 116,116
zn 118,118
zd 200,112,113
zd 201,114,115
zd 202,116,117
zd 203,118,119
zb 120,168
zb 121,169
zb 122,170
zb 123,171
zb 124,172
zb 125,173
zb 126,174
zb 127,175
zu 200,202
zu 201,203
zn 120,120
zn 122,122
zn 124,124
zn 126,126
zd 204,120,121
zd 205,122,123
zd 206,124,125
zd 207,126,127
zb 96,144
zb 97,145
zb 98,146
zb 99,147
zb 100,148
zb 101,149
zb 102,150
zb 103,151
zu 204,206
zu 205,207
zn 96,96
zn 98,98
zn 100,100
zn 102,102
zd 208,96,97
zd 209,98,99
zd 210,100,101
zd 211,102,103
zb 104,176
zb 105,177
zb 106,178
zb 107,179
zb 108,180
zb 109,181
zb 110,182
zb 111,183
zu 208,210
zu 209,211
zn 104,104
zn 106,106
zn 108,108
zn 110,110
zd 212,104,105
zd 213,106,107
zd 214,108,109
zd 215,110,111
zb 112,152
zb 113,153
zb 114,154
zb 115,155
zb 116,156
zb 117,157
zb 118,158
zb 119,159
zu 212,214
zu 213,215
zn 112,112
zn 114,114
zn 116,116
zn 118,118
zd 216,112,113
zd 217,114,115
zd 218,116,117
zd 219,118,119
zb 120,184
zb 121,185
zb 122,186
zb 123,187
zb 124,188
zb 125,189
zb 126,190
zb 127,191
zu 216,218
zu 217,219
zn 120,120
zn 122,122
zn 124,124
zn 126,126
zd 220,120,121
zd 221,122,123
zd 222,124,125
zd 223,126,127
zb 96,192
zb 97,193
zb 98,194
zb 99,195
zb 100,196
zb 101,197
zb 102,198
zb 103,199
zu 220,222
zu 221,223
zn 96,96
zn 98,98
zn 100,100
zn 102,102
zd 224,96,97
zd 225,98,99
zd 226,100,101
zd 227,102,103
zb 104,224
zb 105,225
zb 106,226
zb 107,227
zb 108,228
zb 109,229
zb 110,230
zb 111,231
zu 224,226
zu 225,227
zn 104,104
zn 106,106
zn 108,108
zn 110,110
zd 228,104,105
zd 229,106,107
zd 230,108,109
zd 231,110,111
zb 112,200
zb 113,201
zb 114,202
zb 115,203
zb 116,204
zb 117,205
zb 118,206
zb 119,207
zu 228,230
zu 229,231
zn 112,112
zn 114,114
zn 116,116
zn 118,118
zd 232,112,113
zd 233,114,115
zd 234,116,117
zd 235,118,119
zb 120,232
zb 121,233
zb 122,234
zb 123,235
zb 124,236
zb 125,237
zb 126,238
zb 127,239
zu 232,234
zu 233,235
zn 120,120
zn 122,122
zn 124,124
zn 126,126
zd 236,120,121
zd 237,122,123
zd 238,124,125
zd 239,126,127
zb 96,208
zb 97,209
zb 98,210
zb 99,211
zb 100,212
zb 101,213
zb 102,214
zb 103,215
zu 236,238
zu 237,239
zn 96,96
zn 98,98
zn 100,100
zn 102,102
zd 240,96,97
zd 241,98,99
zd 242,100,101
zd 243,102,103
zb 104,240
zb 105,241
zb 106,242
zb 107,243
zb 108,244
zb 109,245
zb 110,246
zb 111,247
zu 240,242
zu 241,243
zn 104,104
zn 106,106
zn 108,108
zn 110,110
zd 244,104,105
zd 245,106,107
zd 246,108,109
zd 247,110,111
zb 112,216
zb 113,217
zb 114,218
zb 115,219
zb 116,220
zb 117,221
zb 118,222
zb 119,223
zu 244,246
zu 245,247
zn 112,112
zn 114,114
zn 116,116
zn 118,118
zd 248,112,113
zd 249,114,115
zd 250,116,117
zd 251,118,119
zb 120,248
zb 121,249
zb 122,250
zb 123,251
zb 124,252
zb 125,253
zb 126,254
zb 127,255
zu 248,250
zu 249,251
zn 120,120
zn 122,122
zn 124,124
zn 126,126
zd 252,120,121
zd 253,122,123
zd 254,124,125
zd 255,126,127
s_nop 1
zu 252,254
zu 253,255
s_mov_b64 s[56:57], s[28:29]
s_mov_b32 s58, s30
s_mov_b32 s59, 0x20000
s_mov_b32 s60, s37
s_mov_b32 s61, s38
s_mov_b32 s62, 0
s_mov_b32 s63, 0
s_mov_b32 s100, s101
s_nop 0
zz 128,30,63,0
s_nop 0
zz 132,30,63,256
zi 63,63,61
zz 136,30,63,0
s_nop 0
zz 140,30,63,256
zi 63,63,61
zz 144,30,63,0
s_nop 0
zz 148,30,63,256
zi 63,63,61
zz 152,30,63,0
s_nop 0
zz 156,30,63,256
zi 62,62,60
s_mov_b32 s63, s62
zz 160,30,63,0
s_nop 0
zz 164,30,63,256
zi 63,63,61
zz 168,30,63,0
s_nop 0
zz 172,30,63,256
zi 63,63,61
zz 176,30,63,0
s_nop 0
zz 180,30,63,256
zi 63,63,61
zz 184,30,63,0
s_nop 0
zz 188,30,63,256
zi 62,62,60
s_mov_b32 s63, s62
zz 192,30,63,0
s_nop 0
zz 196,30,63,256
zi 63,63,61
zz 200,30,63,0
s_nop 0
zz 204,30,63,256
zi 63,63,61
zz 208,30,63,0
s_nop 0
zz 212,30,63,256
zi 63,63,61
zz 216,30,63,0
s_nop 0
zz 220,30,63,256
zi 62,62,60
s_mov_b32 s63, s62
zz 224,30,63,0
s_nop 0
zz 228,30,63,256
zi 63,63,61
zz 232,30,63,0
s_nop 0
zz 236,30,63,256
zi 63,63,61
zz 240,30,63,0
s_nop 0
zz 244,30,63,256
zi 63,63,61
zz 248,30,63,0
s_nop 0
zz 252,30,63,256
s_mov_b32 s67, s101
s_getpc_b64 s[20:21]
bk_166:
s_sub_u32 s20, s20, bk_166-task_next
s_subb_u32 s21, s21, 0
s_setpc_b64 s[20:21]
t_p256c_head_TR:
zy 0,32,64
zc 96,22,16384
zf 45,103424
zy 4,32,68
zl 9,32
zy 8,32,72
zc 98,22,18432
zy 12,32,76
zc 100,23,16384
zy 16,32,80
zy 20,32,84
zy 24,32,88
zy 28,32,92
zy 32,36,64
zg 32,21,0
zf 44,38912
zy 36,36,68
zk 18,33
zy 40,36,72
zc 102,23,18432
zy 44,36,76
zc 104,24,16384
zf 45,104448
zy 48,36,80
zl 10,32
zy 52,36,84
zc 106,24,18432
zy 56,36,88
zy 60,36,92
zy 64,40,64
zg 36,21,2048
zf 44,39936
zy 68,40,68
zk 19,33
zy 72,40,72
zc 108,25,16384
zy 76,40,76
zc 110,25,18432
zy 80,40,80
zy 84,40,84
zy 88,40,88
zy 92,40,92
zy 96,44,64
zg 40,21,4096
zf 45,105472
zy 100,44,68
zl 11,32
zy 104,44,72
zc 112,26,16384
zy 108,44,76
zc 114,26,18432
zy 112,44,80
zy 116,44,84
zy 120,44,88
zy 124,44,92
zy 128,48,64
zg 44,21,6144
s_nop 0
zy 132,48,68
zz 128,30,63,0
zy 136,48,72
zc 116,27,16384
zy 140,48,76
zc 118,27,18432
s_nop 0
zy 144,48,80
zz 132,30,63,256
zy 148,48,84
zy 152,48,88
zy 156,48,92
zy 160,52,64
zg 48,21,8192
zi 63,63,61
zy 164,52,68
zz 136,30,63,0
zy 168,52,72
zc 120,28,16384
zy 172,52,76
zc 122,28,18432
s_nop 0
zy 176,52,80
zz 140,30,63,256
zy 180,52,84
zy 184,52,88
zy 188,52,92
zy 192,56,64
zg 52,21,10240
zi 63,63,61
zy 196,56,68
zz 144,30,63,0
zy 200,56,72
zc 124,29,16384
zy 204,56,76
zc 126,29,18432
s_nop 0
zy 208,56,80
zz 148,30,63,256
zy 212,56,84
zy 216,56,88
zy 220,56,92
zy 224,60,64
zg 56,21,12288
zi 63,63,61
zy 228,60,68
zz 152,30,63,0
zy 232,60,72
zy 236,60,76
s_nop 0
zy 240,60,80
zz 156,30,63,256
zy 244,60,84
zy 248,60,88
zy 252,60,92
s_waitcnt lgkmcnt(15)
za 0,32,96,0
zg 60,21,14336
zi 62,62,60
s_mov_b32 s63, s62
za 4,32,100,4
zz 160,30,63,0
za 8,32,104,8
s_waitcnt lgkmcnt(14)
za 12,32,108,12
s_waitcnt lgkmcnt(11)
s_nop 0
za 16,32,112,16
zz 164,30,63,256
s_waitcnt lgkmcnt(8)
za 20,32,116,20
s_waitcnt lgkmcnt(5)
za 24,32,120,24
s_waitcnt lgkmcnt(2)
za 28,32,124,28
zs 32,32,128
zi 33,33,36
s_waitcnt vmcnt(10) lgkmcnt(0)
s_barrier
za 32,36,96,32
zg 32,20,32768
zay 44
za 36,36,100,36
zk 12,33
za 40,36,104,40
zc 64,22,32768
za 44,36,108,44
zc 66,22,34816
zf 45,65536
za 48,36,112,48
zl 4,32
za 52,36,116,52
zc 68,23,32768
za 56,36,120,56
za 60,36,124,60
za 64,40,96,64
zg 36,20,34816
zf 44,1024
za 68,40,100,68
zk 13,33
za 72,40,104,72
zc 70,23,34816
za 76,40,108,76
zc 72,24,32768
za 80,40,112,80
zc 74,24,34816
za 84,40,116,84
za 88,40,120,88
za 92,40,124,92
za 96,44,96,96
zg 40,20,36864
zf 45,66560
za 100,44,100,100
zl 5,32
za 104,44,104,104
zc 76,25,32768
za 108,44,108,108
zc 78,25,34816
zf 44,2048
za 112,44,112,112
zk 14,33
za 116,44,116,116
za 120,44,120,120
za 124,44,124,124
za 128,48,96,128
zg 44,20,38912
zf 45,67584
za 132,48,100,132
zl 6,32
za 136,48,104,136
zc 80,26,32768
za 140,48,108,140
zc 82,26,34816
za 144,48,112,144
za 148,48,116,148
za 152,48,120,152
za 156,48,124,156
za 160,52,96,160
zg 48,20,40960
zf 44,3072
za 164,52,100,164
zk 15,33
za 168,52,104,168
zc 84,27,32768
za 172,52,108,172
zc 86,27,34816
zf 45,68608
za 176,52,112,176
zl 7,32
za 180,52,116,180
za 184,52,120,184
za 188,52,124,188
za 192,56,96,192
zg 52,20,43008
zf 44,4096
za 196,56,100,196
zk 16,33
za 200,56,104,200
zc 88,28,32768
za 204,56,108,204
zc 90,28,34816
za 208,56,112,208
za 212,56,116,212
za 216,56,120,216
za 220,56,124,220
za 224,60,96,224
zg 56,20,45056
zf 45,69632
za 228,60,100,228
zl 8,32
za 232,60,104,232
zc 92,29,32768
za 236,60,108,236
zc 94,29,34816
zf 44,5120
za 240,60,112,240
zk 17,33
za 244,60,116,244
za 248,60,120,248
za 252,60,124,252
zg 60,20,47104
s_waitcnt lgkmcnt(15)
za 0,32,64,0
zc 96,22,49152
zf 45,70656
za 4,32,68,4
zl 9,32
za 8,32,72,8
zc 98,22,51200
s_waitcnt lgkmcnt(15)
za 12,32,76,12
zc 100,23,49152
s_waitcnt lgkmcnt(13)
za 16,32,80,16
s_waitcnt lgkmcnt(10)
za 20,32,84,20
s_waitcnt lgkmcnt(7)
za 24,32,88,24
s_waitcnt lgkmcnt(4)
za 28,32,92,28
za 32,36,64,32
zg 32,21,32768
zf 44,6144
za 36,36,68,36
zk 18,33
za 40,36,72,40
zc 102,23,51200
za 44,36,76,44
zc 104,24,49152
zf 45,71680
za 48,36,80,48
zl 10,32
za 52,36,84,52
zc 106,24,51200
za 56,36,88,56
za 60,36,92,60
za 64,40,64,64
zg 36,21,34816
zf 44,7168
za 68,40,68,68
zk 19,33
za 72,40,72,72
zc 108,25,49152
za 76,40,76,76
zc 110,25,51200
za 80,40,80,80
za 84,40,84,84
za 88,40,88,88
za 92,40,92,92
za 96,44,64,96
zg 40,21,36864
zf 45,72704
za 100,44,68,100
zl 11,32
za 104,44,72,104
zc 112,26,49152
za 108,44,76,108
zc 114,26,51200
za 112,44,80,112
za 116,44,84,116
za 120,44,88,120
za 124,44,92,124
za 128,48,64,128
zg 44,21,38912
zi 63,63,61
za 132,48,68,132
zz 168,30,63,0
za 136,48,72,136
zc 116,27,49152
za 140,48,76,140
zc 118,27,51200
s_nop 0
za 144,48,80,144
zz 172,30,63,256
za 148,48,84,148
za 152,48,88,152
za 156,48,92,156
za 160,52,64,160
zg 48,21,40960
zi 63,63,61
za 164,52,68,164
zz 176,30,63,0
za 168,52,72,168
zc 120,28,49152
za 172,52,76,172
zc 122,28,51200
s_nop 0
za 176,52,80,176
zz 180,30,63,256
za 180,52,84,180
za 184,52,88,184
za 188,52,92,188
za 192,56,64,192
zg 52,21,43008
zi 63,63,61
za 196,56,68,196
zz 184,30,63,0
za 200,56,72,200
zc 124,29,49152
za 204,56,76,204
zc 126,29,51200
s_nop 0
za 208,56,80,208
zz 188,30,63,256
za 212,56,84,212
za 216,56,88,216
za 220,56,92,220
s_waitcnt lgkmcnt(15)
zi 62,62,60
s_mov_b32 s63, s62
za 224,60,64,224
zz 192,30,63,0
za 228,60,68,228
zg 56,21,45056
s_nop 0
za 232,60,72,232
zz 196,30,63,256
za 236,60,76,236
za 240,60,80,240
zi 63,63,61
za 244,60,84,244
zz 200,30,63,0
za 248,60,88,248
za 252,60,92,252
za 0,32,96,0
zg 60,21,47104
s_nop 0
za 4,32,100,4
zz 204,30,63,256
za 8,32,104,8
s_waitcnt lgkmcnt(14)
za 12,32,108,12
s_waitcnt lgkmcnt(11)
zi 63,63,61
za 16,32,112,16
zz 208,30,63,0
s_waitcnt lgkmcnt(8)
za 20,32,116,20
s_waitcnt lgkmcnt(5)
za 24,32,120,24
s_waitcnt lgkmcnt(2)
za 28,32,124,28
zs 32,32,128
zi 33,33,36
s_waitcnt vmcnt(11) lgkmcnt(0)
s_barrier
za 32,36,96,32
zg 32,20,0
zf 44,32768
za 36,36,100,36
zk 12,33
za 40,36,104,40
zc 64,22,0
za 44,36,108,44
zc 66,22,2048
zf 45,98304
za 48,36,112,48
zl 4,32
za 52,36,116,52
zc 68,23,0
za 56,36,120,56
za 60,36,124,60
za 64,40,96,64
zg 36,20,2048
zf 44,33792
za 68,40,100,68
zk 13,33
za 72,40,104,72
zc 70,23,2048
za 76,40,108,76
zc 72,24,0
za 80,40,112,80
zc 74,24,2048
za 84,40,116,84
za 88,40,120,88
za 92,40,124,92
za 96,44,96,96
zg 40,20,4096
zf 45,99328
za 100,44,100,100
zl 5,32
za 104,44,104,104
zc 76,25,0
za 108,44,108,108
zc 78,25,2048
zf 44,34816
za 112,44,112,112
zk 14,33
za 116,44,116,116
za 120,44,120,120
za 124,44,124,124
za 128,48,96,128
zg 44,20,6144
zf 45,100352
za 132,48,100,132
zl 6,32
za 136,48,104,136
zc 80,26,0
za 140,48,108,140
zc 82,26,2048
za 144,48,112,144
za 148,48,116,148
za 152,48,120,152
za 156,48,124,156
za 160,52,96,160
zg 48,20,8192
zf 44,35840
za 164,52,100,164
zk 15,33
za 168,52,104,168
zc 84,27,0
za 172,52,108,172
zc 86,27,2048
zf 45,101376
za 176,52,112,176
zl 7,32
za 180,52,116,180
za 184,52,120,184
za 188,52,124,188
za 192,56,96,192
zg 52,20,10240
zf 44,36864
za 196,56,100,196
zk 16,33
za 200,56,104,200
zc 88,28,0
za 204,56,108,204
zc 90,28,2048
za 208,56,112,208
za 212,56,116,212
za 216,56,120,216
za 220,56,124,220
za 224,60,96,224
zg 56,20,12288
zf 45,102400
za 228,60,100,228
zl 8,32
za 232,60,104,232
zc 92,29,0
za 236,60,108,236
zc 94,29,2048
zf 44,37888
za 240,60,112,240
zk 17,33
za 244,60,116,244
za 248,60,120,248
za 252,60,124,252
zg 60,20,14336
s_waitcnt lgkmcnt(15)
za 0,32,64,0
zc 96,22,16384
zf 45,103424
za 4,32,68,4
zl 9,32
za 8,32,72,8
zc 98,22,18432
s_waitcnt lgkmcnt(15)
za 12,32,76,12
zc 100,23,16384
s_waitcnt lgkmcnt(13)
za 16,32,80,16
s_waitcnt lgkmcnt(10)
za 20,32,84,20
s_waitcnt lgkmcnt(7)
za 24,32,88,24
s_waitcnt lgkmcnt(4)
za 28,32,92,28
za 32,36,64,32
zg 32,21,0
zf 44,38912
za 36,36,68,36
zk 18,33
za 40,36,72,40
zc 102,23,18432
za 44,36,76,44
zc 104,24,16384
zf 45,104448
za 48,36,80,48
zl 10,32
za 52,36,84,52
zc 106,24,18432
za 56,36,88,56
za 60,36,92,60
za 64,40,64,64
zg 36,21,2048
zf 44,39936
za 68,40,68,68
zk 19,33
za 72,40,72,72
zc 108,25,16384
za 76,40,76,76
zc 110,25,18432
za 80,40,80,80
za 84,40,84,84
za 88,40,88,88
za 92,40,92,92
za 96,44,64,96
zg 40,21,4096
zf 45,105472
za 100,44,68,100
zl 11,32
za 104,44,72,104
zc 112,26,16384
za 108,44,76,108
zc 114,26,18432
za 112,44,80,112
za 116,44,84,116
za 120,44,88,120
za 124,44,92,124
za 128,48,64,128
zg 44,21,6144
s_nop 0
za 132,48,68,132
zz 212,30,63,256
za 136,48,72,136
zc 116,27,16384
za 140,48,76,140
zc 118,27,18432
zi 63,63,61
za 144,48,80,144
zz 216,30,63,0
za 148,48,84,148
za 152,48,88,152
za 156,48,92,156
za 160,52,64,160
zg 48,21,8192
s_nop 0
za 164,52,68,164
zz 220,30,63,256
za 168,52,72,168
zc 120,28,16384
za 172,52,76,172
zc 122,28,18432
zi 62,62,60
s_mov_b32 s63, s62
za 176,52,80,176
zz 224,30,63,0
za 180,52,84,180
za 184,52,88,184
za 188,52,92,188
za 192,56,64,192
zg 52,21,10240
s_nop 0
za 196,56,68,196
zz 228,30,63,256
za 200,56,72,200
zc 124,29,16384
za 204,56,76,204
zc 126,29,18432
zi 63,63,61
za 208,56,80,208
zz 232,30,63,0
za 212,56,84,212
za 216,56,88,216
za 220,56,92,220
s_waitcnt lgkmcnt(15)
s_nop 0
za 224,60,64,224
zz 236,30,63,256
za 228,60,68,228
zg 56,21,12288
zi 63,63,61
za 232,60,72,232
zz 240,30,63,0
za 236,60,76,236
za 240,60,80,240
s_nop 0
za 244,60,84,244
zz 244,30,63,256
za 248,60,88,248
za 252,60,92,252
za 0,32,96,0
zg 60,21,14336
zi 63,63,61
za 4,32,100,4
zz 248,30,63,0
za 8,32,104,8
s_waitcnt lgkmcnt(14)
za 12,32,108,12
s_waitcnt lgkmcnt(11)
s_nop 0
za 16,32,112,16
zz 252,30,63,256
s_waitcnt lgkmcnt(8)
za 20,32,116,20
s_waitcnt lgkmcnt(5)
za 24,32,120,24
s_waitcnt lgkmcnt(2)
za 28,32,124,28
zs 32,32,128
zi 33,33,36
s_waitcnt vmcnt(11) lgkmcnt(0)
s_barrier
za 32,36,96,32
zg 32,20,32768
zay 44
za 36,36,100,36
zk 12,33
za 40,36,104,40
zc 64,22,32768
za 44,36,108,44
zc 66,22,34816
zf 45,65536
za 48,36,112,48
zl 4,32
za 52,36,116,52
zc 68,23,32768
za 56,36,120,56
za 60,36,124,60
za 64,40,96,64
zg 36,20,34816
zf 44,1024
za 68,40,100,68
zk 13,33
za 72,40,104,72
zc 70,23,34816
za 76,40,108,76
zc 72,24,32768
za 80,40,112,80
zc 74,24,34816
za 84,40,116,84
za 88,40,120,88
za 92,40,124,92
za 96,44,96,96
zg 40,20,36864
zf 45,66560
za 100,44,100,100
zl 5,32
za 104,44,104,104
zc 76,25,32768
za 108,44,108,108
zc 78,25,34816
zf 44,2048
za 112,44,112,112
zk 14,33
za 116,44,116,116
za 120,44,120,120
za 124,44,124,124
za 128,48,96,128
zg 44,20,38912
zf 45,67584
za 132,48,100,132
zl 6,32
za 136,48,104,136
zc 80,26,32768
za 140,48,108,140
zc 82,26,34816
za 144,48,112,144
za 148,48,116,148
za 152,48,120,152
za 156,48,124,156
za 160,52,96,160
zg 48,20,40960
zf 44,3072
za 164,52,100,164
zk 15,33
za 168,52,104,168
zc 84,27,32768
za 172,52,108,172
zc 86,27,34816
zf 45,68608
za 176,52,112,176
zl 7,32
za 180,52,116,180
za 184,52,120,184
za 188,52,124,188
za 192,56,96,192
zg 52,20,43008
zf 44,4096
za 196,56,100,196
zk 16,33
za 200,56,104,200
zc 88,28,32768
za 204,56,108,204
zc 90,28,34816
za 208,56,112,208
za 212,56,116,212
za 216,56,120,216
za 220,56,124,220
za 224,60,96,224
zg 56,20,45056
zf 45,69632
za 228,60,100,228
zl 8,32
za 232,60,104,232
zc 92,29,32768
za 236,60,108,236
zc 94,29,34816
zf 44,5120
za 240,60,112,240
zk 17,33
za 244,60,116,244
za 248,60,120,248
za 252,60,124,252
zg 60,20,47104
s_waitcnt lgkmcnt(15)
za 0,32,64,0
zc 96,22,49152
zf 45,70656
za 4,32,68,4
zl 9,32
za 8,32,72,8
zc 98,22,51200
s_waitcnt lgkmcnt(15)
za 12,32,76,12
zc 100,23,49152
s_waitcnt lgkmcnt(13)
za 16,32,80,16
s_waitcnt lgkmcnt(10)
za 20,32,84,20
s_waitcnt lgkmcnt(7)
za 24,32,88,24
s_waitcnt lgkmcnt(4)
za 28,32,92,28
za 32,36,64,32
zg 32,21,32768
zf 44,6144
za 36,36,68,36
zk 18,33
za 40,36,72,40
zc 102,23,51200
za 44,36,76,44
zc 104,24,49152
zf 45,71680
za 48,36,80,48
zl 10,32
za 52,36,84,52
zc 106,24,51200
za 56,36,88,56
za 60,36,92,60
za 64,40,64,64
zg 36,21,34816
zf 44,7168
za 68,40,68,68
zk 19,33
za 72,40,72,72
zc 108,25,49152
za 76,40,76,76
zc 110,25,51200
za 80,40,80,80
za 84,40,84,84
za 88,40,88,88
za 92,40,92,92
za 96,44,64,96
zg 40,21,36864
zf 45,72704
za 100,44,68,100
zl 11,32
za 104,44,72,104
zc 112,26,49152
za 108,44,76,108
zc 114,26,51200
za 112,44,80,112
za 116,44,84,116
za 120,44,88,120
za 124,44,92,124
za 128,48,64,128
zg 44,21,38912
za 132,48,68,132
zc 116,27,49152
za 136,48,72,136
zc 118,27,51200
za 140,48,76,140
za 144,48,80,144
za 148,48,84,148
za 152,48,88,152
za 156,48,92,156
za 160,52,64,160
zg 48,21,40960
za 164,52,68,164
zc 120,28,49152
za 168,52,72,168
zc 122,28,51200
za 172,52,76,172
za 176,52,80,176
za 180,52,84,180
za 184,52,88,184
za 188,52,92,188
za 192,56,64,192
zg 52,21,43008
za 196,56,68,196
zc 124,29,49152
za 200,56,72,200
zc 126,29,51200
za 204,56,76,204
za 208,56,80,208
za 212,56,84,212
za 216,56,88,216
za 220,56,92,220
s_waitcnt lgkmcnt(15)
za 224,60,64,224
zg 56,21,45056
za 228,60,68,228
za 232,60,72,232
za 236,60,76,236
za 240,60,80,240
za 244,60,84,244
za 248,60,88,248
za 252,60,92,252
za 0,32,96,0
zg 60,21,47104
za 4,32,100,4
za 8,32,104,8
s_waitcnt lgkmcnt(14)
za 12,32,108,12
s_waitcnt lgkmcnt(11)
za 16,32,112,16
s_waitcnt lgkmcnt(8)
za 20,32,116,20
s_waitcnt lgkmcnt(5)
za 24,32,120,24
s_waitcnt lgkmcnt(2)
za 28,32,124,28
zs 32,32,128
zi 33,33,36
s_waitcnt vmcnt(0) lgkmcnt(0)
s_barrier
s_and_b32 s46, s100, 0xffff
s_cmp_eq_u32 s46, 0xffff
s_cbranch_scc1 sg_167_n
s_cmp_lg_u32 s3, 0
s_cbranch_scc1 sg_167_n
s_lshl_b32 s46, s46, 8
zs 46,46,85983232
s_lshr_b32 s47, s100, 16
zak 2,46
zak 3,47
s_mov_b64 exec, 1
buffer_atomic_add v3, v2, s[4:7], 0 offen
s_mov_b64 exec, -1
sg_167_n:
za 32,36,96,32
zg 32,20,0
zf 44,32768
za 36,36,100,36
zk 12,33
za 40,36,104,40
zc 64,22,0
za 44,36,108,44
zc 66,22,2048
zf 45,98304
za 48,36,112,48
zl 4,32
za 52,36,116,52
zc 68,23,0
za 56,36,120,56
za 60,36,124,60
za 64,40,96,64
zg 36,20,2048
zf 44,33792
za 68,40,100,68
zk 13,33
za 72,40,104,72
zc 70,23,2048
za 76,40,108,76
zc 72,24,0
za 80,40,112,80
zc 74,24,2048
za 84,40,116,84
za 88,40,120,88
za 92,40,124,92
za 96,44,96,96
zg 40,20,4096
zf 45,99328
za 100,44,100,100
zl 5,32
za 104,44,104,104
zc 76,25,0
za 108,44,108,108
zc 78,25,2048
zf 44,34816
za 112,44,112,112
zk 14,33
za 116,44,116,116
za 120,44,120,120
za 124,44,124,124
za 128,48,96,128
zg 44,20,6144
zf 45,100352
za 132,48,100,132
zl 6,32
za 136,48,104,136
zc 80,26,0
za 140,48,108,140
zc 82,26,2048
za 144,48,112,144
za 148,48,116,148
za 152,48,120,152
za 156,48,124,156
za 160,52,96,160
zg 48,20,8192
zf 44,35840
za 164,52,100,164
zk 15,33
za 168,52,104,168
zc 84,27,0
za 172,52,108,172
zc 86,27,2048
zf 45,101376
za 176,52,112,176
zl 7,32
za 180,52,116,180
za 184,52,120,184
za 188,52,124,188
za 192,56,96,192
zg 52,20,10240
zf 44,36864
za 196,56,100,196
zk 16,33
za 200,56,104,200
zc 88,28,0
za 204,56,108,204
zc 90,28,2048
za 208,56,112,208
za 212,56,116,212
za 216,56,120,216
za 220,56,124,220
za 224,60,96,224
zg 56,20,12288
zf 45,102400
za 228,60,100,228
zl 8,32
za 232,60,104,232
zc 92,29,0
za 236,60,108,236
zc 94,29,2048
zf 44,37888
za 240,60,112,240
zk 17,33
za 244,60,116,244
za 248,60,120,248
za 252,60,124,252
zg 60,20,14336
s_waitcnt lgkmcnt(15)
za 0,32,64,0
zc 96,22,16384
zf 45,103424
za 4,32,68,4
zl 9,32
za 8,32,72,8
zc 98,22,18432
s_waitcnt lgkmcnt(15)
za 12,32,76,12
zc 100,23,16384
s_waitcnt lgkmcnt(13)
za 16,32,80,16
s_waitcnt lgkmcnt(10)
za 20,32,84,20
s_waitcnt lgkmcnt(7)
za 24,32,88,24
s_waitcnt lgkmcnt(4)
za 28,32,92,28
za 32,36,64,32
zg 32,21,0
zf 44,38912
za 36,36,68,36
zk 18,33
za 40,36,72,40
zc 102,23,18432
za 44,36,76,44
zc 104,24,16384
zf 45,104448
za 48,36,80,48
zl 10,32
za 52,36,84,52
zc 106,24,18432
za 56,36,88,56
za 60,36,92,60
za 64,40,64,64
zg 36,21,2048
zf 44,39936
za 68,40,68,68
zk 19,33
za 72,40,72,72
zc 108,25,16384
za 76,40,76,76
zc 110,25,18432
za 80,40,80,80
za 84,40,84,84
za 88,40,88,88
za 92,40,92,92
za 96,44,64,96
zg 40,21,4096
zf 45,105472
za 100,44,68,100
zl 11,32
za 104,44,72,104
zc 112,26,16384
za 108,44,76,108
zc 114,26,18432
za 112,44,80,112
za 116,44,84,116
za 120,44,88,120
za 124,44,92,124
za 128,48,64,128
zg 44,21,6144
za 132,48,68,132
zc 116,27,16384
za 136,48,72,136
zc 118,27,18432
za 140,48,76,140
za 144,48,80,144
za 148,48,84,148
za 152,48,88,152
za 156,48,92,156
za 160,52,64,160
zg 48,21,8192
za 164,52,68,164
zc 120,28,16384
za 168,52,72,168
zc 122,28,18432
za 172,52,76,172
za 176,52,80,176
za 180,52,84,180
za 184,52,88,184
za 188,52,92,188
za 192,56,64,192
zg 52,21,10240
za 196,56,68,196
zc 124,29,16384
za 200,56,72,200
zc 126,29,18432
za 204,56,76,204
za 208,56,80,208
za 212,56,84,212
za 216,56,88,216
za 220,56,92,220
s_waitcnt lgkmcnt(15)
za 224,60,64,224
zg 56,21,12288
za 228,60,68,228
za 232,60,72,232
za 236,60,76,236
za 240,60,80,240
za 244,60,84,244
za 248,60,88,248
za 252,60,92,252
za 0,32,96,0
zg 60,21,14336
za 4,32,100,4
za 8,32,104,8
s_waitcnt lgkmcnt(14)
za 12,32,108,12
s_waitcnt lgkmcnt(11)
za 16,32,112,16
s_waitcnt lgkmcnt(8)
za 20,32,116,20
s_waitcnt lgkmcnt(5)
za 24,32,120,24
s_waitcnt lgkmcnt(2)
za 28,32,124,28
zs 32,32,128
zi 33,33,36
s_mov_b32 s34, 5
t_p256c_loop_168:
s_waitcnt vmcnt(0) lgkmcnt(0)
s_barrier
za 32,36,96,32
zg 32,20,32768
zay 44
za 36,36,100,36
zk 12,33
za 40,36,104,40
zc 64,22,32768
za 44,36,108,44
zc 66,22,34816
zf 45,65536
za 48,36,112,48
zl 4,32
za 52,36,116,52
zc 68,23,32768
za 56,36,120,56
za 60,36,124,60
za 64,40,96,64
zg 36,20,34816
zf 44,1024
za 68,40,100,68
zk 13,33
za 72,40,104,72
zc 70,23,34816
za 76,40,108,76
zc 72,24,32768
za 80,40,112,80
zc 74,24,34816
za 84,40,116,84
za 88,40,120,88
za 92,40,124,92
za 96,44,96,96
zg 40,20,36864
zf 45,66560
za 100,44,100,100
zl 5,32
za 104,44,104,104
zc 76,25,32768
za 108,44,108,108
zc 78,25,34816
zf 44,2048
za 112,44,112,112
zk 14,33
za 116,44,116,116
za 120,44,120,120
za 124,44,124,124
za 128,48,96,128
zg 44,20,38912
zf 45,67584
za 132,48,100,132
zl 6,32
za 136,48,104,136
zc 80,26,32768
za 140,48,108,140
zc 82,26,34816
za 144,48,112,144
za 148,48,116,148
za 152,48,120,152
za 156,48,124,156
za 160,52,96,160
zg 48,20,40960
zf 44,3072
za 164,52,100,164
zk 15,33
za 168,52,104,168
zc 84,27,32768
za 172,52,108,172
zc 86,27,34816
zf 45,68608
za 176,52,112,176
zl 7,32
za 180,52,116,180
za 184,52,120,184
za 188,52,124,188
za 192,56,96,192
zg 52,20,43008
zf 44,4096
za 196,56,100,196
zk 16,33
za 200,56,104,200
zc 88,28,32768
za 204,56,108,204
zc 90,28,34816
za 208,56,112,208
za 212,56,116,212
za 216,56,120,216
za 220,56,124,220
za 224,60,96,224
zg 56,20,45056
zf 45,69632
za 228,60,100,228
zl 8,32
za 232,60,104,232
zc 92,29,32768
za 236,60,108,236
zc 94,29,34816
zf 44,5120
za 240,60,112,240
zk 17,33
za 244,60,116,244
za 248,60,120,248
za 252,60,124,252
zg 60,20,47104
s_waitcnt lgkmcnt(15)
za 0,32,64,0
zc 96,22,49152
zf 45,70656
za 4,32,68,4
zl 9,32
za 8,32,72,8
zc 98,22,51200
s_waitcnt lgkmcnt(15)
za 12,32,76,12
zc 100,23,49152
s_waitcnt lgkmcnt(13)
za 16,32,80,16
s_waitcnt lgkmcnt(10)
za 20,32,84,20
s_waitcnt lgkmcnt(7)
za 24,32,88,24
s_waitcnt lgkmcnt(4)
za 28,32,92,28
za 32,36,64,32
zg 32,21,32768
zf 44,6144
za 36,36,68,36
zk 18,33
za 40,36,72,40
zc 102,23,51200
za 44,36,76,44
zc 104,24,49152
zf 45,71680
za 48,36,80,48
zl 10,32
za 52,36,84,52
zc 106,24,51200
za 56,36,88,56
za 60,36,92,60
za 64,40,64,64
zg 36,21,34816
zf 44,7168
za 68,40,68,68
zk 19,33
za 72,40,72,72
zc 108,25,49152
za 76,40,76,76
zc 110,25,51200
za 80,40,80,80
za 84,40,84,84
za 88,40,88,88
za 92,40,92,92
za 96,44,64,96
zg 40,21,36864
zf 45,72704
za 100,44,68,100
zl 11,32
za 104,44,72,104
zc 112,26,49152
za 108,44,76,108
zc 114,26,51200
za 112,44,80,112
za 116,44,84,116
za 120,44,88,120
za 124,44,92,124
za 128,48,64,128
zg 44,21,38912
za 132,48,68,132
zc 116,27,49152
za 136,48,72,136
zc 118,27,51200
za 140,48,76,140
za 144,48,80,144
za 148,48,84,148
za 152,48,88,152
za 156,48,92,156
za 160,52,64,160
zg 48,21,40960
za 164,52,68,164
zc 120,28,49152
za 168,52,72,168
zc 122,28,51200
za 172,52,76,172
za 176,52,80,176
za 180,52,84,180
za 184,52,88,184
za 188,52,92,188
za 192,56,64,192
zg 52,21,43008
za 196,56,68,196
zc 124,29,49152
za 200,56,72,200
zc 126,29,51200
za 204,56,76,204
za 208,56,80,208
za 212,56,84,212
za 216,56,88,216
za 220,56,92,220
s_waitcnt lgkmcnt(15)
za 224,60,64,224
zg 56,21,45056
za 228,60,68,228
za 232,60,72,232
za 236,60,76,236
za 240,60,80,240
za 244,60,84,244
za 248,60,88,248
za 252,60,92,252
za 0,32,96,0
zg 60,21,47104
za 4,32,100,4
za 8,32,104,8
s_waitcnt lgkmcnt(14)
za 12,32,108,12
s_waitcnt lgkmcnt(11)
za 16,32,112,16
s_waitcnt lgkmcnt(8)
za 20,32,116,20
s_waitcnt lgkmcnt(5)
za 24,32,120,24
s_waitcnt lgkmcnt(2)
za 28,32,124,28
zs 32,32,128
zi 33,33,36
s_waitcnt vmcnt(0) lgkmcnt(0)
s_barrier
za 32,36,96,32
zg 32,20,0
zf 44,32768
za 36,36,100,36
zk 12,33
za 40,36,104,40
zc 64,22,0
za 44,36,108,44
zc 66,22,2048
zf 45,98304
za 48,36,112,48
zl 4,32
za 52,36,116,52
zc 68,23,0
za 56,36,120,56
za 60,36,124,60
za 64,40,96,64
zg 36,20,2048
zf 44,33792
za 68,40,100,68
zk 13,33
za 72,40,104,72
zc 70,23,2048
za 76,40,108,76
zc 72,24,0
za 80,40,112,80
zc 74,24,2048
za 84,40,116,84
za 88,40,120,88
za 92,40,124,92
za 96,44,96,96
zg 40,20,4096
zf 45,99328
za 100,44,100,100
zl 5,32
za 104,44,104,104
zc 76,25,0
za 108,44,108,108
zc 78,25,2048
zf 44,34816
za 112,44,112,112
zk 14,33
za 116,44,116,116
za 120,44,120,120
za 124,44,124,124
za 128,48,96,128
zg 44,20,6144
zf 45,100352
za 132,48,100,132
zl 6,32
za 136,48,104,136
zc 80,26,0
za 140,48,108,140
zc 82,26,2048
za 144,48,112,144
za 148,48,116,148
za 152,48,120,152
za 156,48,124,156
za 160,52,96,160
zg 48,20,8192
zf 44,35840
za 164,52,100,164
zk 15,33
za 168,52,104,168
zc 84,27,0
za 172,52,108,172
zc 86,27,2048
zf 45,101376
za 176,52,112,176
zl 7,32
za 180,52,116,180
za 184,52,120,184
za 188,52,124,188
za 192,56,96,192
zg 52,20,10240
zf 44,36864
za 196,56,100,196
zk 16,33
za 200,56,104,200
zc 88,28,0
za 204,56,108,204
zc 90,28,2048
za 208,56,112,208
za 212,56,116,212
za 216,56,120,216
za 220,56,124,220
za 224,60,96,224
zg 56,20,12288
zf 45,102400
za 228,60,100,228
zl 8,32
za 232,60,104,232
zc 92,29,0
za 236,60,108,236
zc 94,29,2048
zf 44,37888
za 240,60,112,240
zk 17,33
za 244,60,116,244
za 248,60,120,248
za 252,60,124,252
zg 60,20,14336
s_waitcnt lgkmcnt(15)
za 0,32,64,0
zc 96,22,16384
zf 45,103424
za 4,32,68,4
zl 9,32
za 8,32,72,8
zc 98,22,18432
s_waitcnt lgkmcnt(15)
za 12,32,76,12
zc 100,23,16384
s_waitcnt lgkmcnt(13)
za 16,32,80,16
s_waitcnt lgkmcnt(10)
za 20,32,84,20
s_waitcnt lgkmcnt(7)
za 24,32,88,24
s_waitcnt lgkmcnt(4)
za 28,32,92,28
za 32,36,64,32
zg 32,21,0
zf 44,38912
za 36,36,68,36
zk 18,33
za 40,36,72,40
zc 102,23,18432
za 44,36,76,44
zc 104,24,16384
zf 45,104448
za 48,36,80,48
zl 10,32
za 52,36,84,52
zc 106,24,18432
za 56,36,88,56
za 60,36,92,60
za 64,40,64,64
zg 36,21,2048
zf 44,39936
za 68,40,68,68
zk 19,33
za 72,40,72,72
zc 108,25,16384
za 76,40,76,76
zc 110,25,18432
za 80,40,80,80
za 84,40,84,84
za 88,40,88,88
za 92,40,92,92
za 96,44,64,96
zg 40,21,4096
zf 45,105472
za 100,44,68,100
zl 11,32
za 104,44,72,104
zc 112,26,16384
za 108,44,76,108
zc 114,26,18432
za 112,44,80,112
za 116,44,84,116
za 120,44,88,120
za 124,44,92,124
za 128,48,64,128
zg 44,21,6144
za 132,48,68,132
zc 116,27,16384
za 136,48,72,136
zc 118,27,18432
za 140,48,76,140
za 144,48,80,144
za 148,48,84,148
za 152,48,88,152
za 156,48,92,156
za 160,52,64,160
zg 48,21,8192
za 164,52,68,164
zc 120,28,16384
za 168,52,72,168
zc 122,28,18432
za 172,52,76,172
za 176,52,80,176
za 180,52,84,180
za 184,52,88,184
za 188,52,92,188
za 192,56,64,192
zg 52,21,10240
za 196,56,68,196
zc 124,29,16384
za 200,56,72,200
zc 126,29,18432
za 204,56,76,204
za 208,56,80,208
za 212,56,84,212
za 216,56,88,216
za 220,56,92,220
s_waitcnt lgkmcnt(15)
za 224,60,64,224
zg 56,21,12288
za 228,60,68,228
za 232,60,72,232
za 236,60,76,236
za 240,60,80,240
za 244,60,84,244
za 248,60,88,248
za 252,60,92,252
za 0,32,96,0
zg 60,21,14336
za 4,32,100,4
za 8,32,104,8
s_waitcnt lgkmcnt(14)
za 12,32,108,12
s_waitcnt lgkmcnt(11)
za 16,32,112,16
s_waitcnt lgkmcnt(8)
za 20,32,116,20
s_waitcnt lgkmcnt(5)
za 24,32,120,24
s_waitcnt lgkmcnt(2)
za 28,32,124,28
zs 32,32,128
zi 33,33,36
s_sub_u32 s34, s34, 1
s_cmp_lg_u32 s34, 0
s_cbranch_scc1 t_p256c_loop_168
s_and_b32 s68, s96, 0xff
s_cmp_eq_u32 s68, 2
s_cbranch_scc0 nonext_169
s_bfe_u32 s46, s96, 0x80008
s_bfe_u32 s47, s96, 0x80010
s_bfe_u32 s48, s96, 0x80018
s_lshl_b32 s47, s47, 8
s_and_b32 s57, s3, 1
s_cmp_eq_u32 s46, 0
s_cbranch_scc0 ps_171_b
s_mov_b64 s[50:51], s[70:71]
s_mov_b64 s[52:53], s[72:73]
s_mov_b32 s43, 6144
s_mov_b32 s54, 6291456
s_lshr_b32 s55, s48, 2
s_and_b32 s56, s48, 3
s_lshl_b32 s56, s56, 3
s_lshl_b32 s57, s57, 2
zi 56,56,57
s_lshl_b32 s56, s56, 17
s_lshl_b32 s57, s55, 22
zi 56,56,57
s_mov_b32 s61, 2048
s_mov_b32 s62, 131072
s_cmp_eq_u32 s55, 0
s_cselect_b32 s63, 0x3e8293ee, 1.0
s_cmp_eq_u32 s55, 2
s_cselect_b32 s49, 1, 0
s_branch ps_171_c
ps_171_b:
s_mov_b64 s[50:51], s[76:77]
s_cmp_eq_u32 s46, 1
s_cselect_b64 s[52:53], s[78:79], s[80:81]
s_cselect_b32 s63, 0x3e0293ee, 1.0
s_cmp_eq_u32 s46, 3
s_cselect_b64 s[52:53], s[82:83], s[52:53]
s_cselect_b32 s49, 2, 0
s_mov_b32 s43, 8192
s_mov_b32 s54, 8388608
s_lshl_b32 s56, s48, 1
zi 56,56,57
s_lshl_b32 s56, s56, 19
s_lshl_b32 s57, s46, 24
zi 56,56,57
s_mov_b32 s61, 8192
s_mov_b32 s62, 2048
ps_171_c:
s_lshr_b32 s57, s3, 1
s_mul_i32 s57, s57, 4
s_lshr_b32 s55, s47, 5
zi 57,57,55
s_mul_i32 s57, s57, s61
zi 56,56,57
s_mov_b32 s42, 2048
s_mov_b32 s35, 128
s_lshl_b32 s36, s43, 6
s_mov_b32 s34, 16
s_lshl_b32 s55, s47, 11
s_mul_i32 s57, s48, 512
s_min_u32 s55, s55, 4194304
zi 20,50,55
s_addc_u32 s21, s51, 0
s_sub_u32 s22, 4194304, s55
s_mov_b32 s23, 0x20000
s_min_u32 s57, s57, s54
zi 24,52,57
s_addc_u32 s25, s53, 0
s_sub_u32 s26, s54, s57
s_mov_b32 s27, 0x20000
s_min_u32 s56, s56, 67108864
zi 58,4,56
s_addc_u32 s59, s5, 0
s_sub_u32 s60, 67108864, s56
v_lshrrev_b32 v128, 5, v1
v_and_b32 v129, 31, v1
v_lshlrev_b32 v130, 1, v128
v_xor_b32 v129, v129, v130
v_lshlrev_b32 v129, 4, v129
s_lshl_b32 s39, s3, 4
v_add_u32 v128, s39, v128
v_mul_lo_u32 v128, v128, s43
s_lshl_b32 s39, s43, 1
s_mov_b32 s40, 0
v_xor_b32 v130, 0, v129
v_add3_u32 v12, v128, v130, s40
zi 40,40,39
v_xor_b32 v130, 64, v129
v_add3_u32 v13, v128, v130, s40
zi 40,40,39
v_xor_b32 v130, 0, v129
v_add3_u32 v14, v128, v130, s40
zi 40,40,39
v_xor_b32 v130, 64, v129
v_add3_u32 v15, v128, v130, s40
zi 40,40,39
v_xor_b32 v130, 128, v129
v_add3_u32 v16, v128, v130, s40
zi 40,40,39
v_xor_b32 v130, 192, v129
v_add3_u32 v17, v128, v130, s40
zi 40,40,39
v_xor_b32 v130, 128, v129
v_add3_u32 v18, v128, v130, s40
zi 40,40,39
v_xor_b32 v130, 192, v129
v_add3_u32 v19, v128, v130, s40
s_min_u32 s95, s49, 1
s_branch sw_170
nonext_169:
s_mov_b64 s[58:59], s[28:29]
s_mov_b32 s60, 0
s_mov_b32 s22, 0
s_mov_b32 s26, 0
s_mov_b32 s95, 3
sw_170:
s_mov_b32 s32, 0
s_mov_b32 s33, 0
s_waitcnt vmcnt(0) lgkmcnt(0)
s_barrier
za 32,36,96,32
zg 32,20,32768
zay 44
za 36,36,100,36
zk 12,33
za 40,36,104,40
zc 64,22,32768
za 44,36,108,44
zc 66,22,34816
zf 45,65536
za 48,36,112,48
zl 4,32
za 52,36,116,52
zc 68,23,32768
za 56,36,120,56
za 60,36,124,60
za 64,40,96,64
zg 36,20,34816
zf 44,1024
za 68,40,100,68
zk 13,33
za 72,40,104,72
zc 70,23,34816
za 76,40,108,76
zc 72,24,32768
za 80,40,112,80
zc 74,24,34816
za 84,40,116,84
za 88,40,120,88
za 92,40,124,92
za 96,44,96,96
zg 40,20,36864
zf 45,66560
za 100,44,100,100
zl 5,32
za 104,44,104,104
zc 76,25,32768
za 108,44,108,108
zc 78,25,34816
zf 44,2048
za 112,44,112,112
zk 14,33
za 116,44,116,116
za 120,44,120,120
za 124,44,124,124
za 128,48,96,128
zg 44,20,38912
zf 45,67584
za 132,48,100,132
zl 6,32
za 136,48,104,136
zc 80,26,32768
za 140,48,108,140
zc 82,26,34816
za 144,48,112,144
za 148,48,116,148
za 152,48,120,152
za 156,48,124,156
za 160,52,96,160
zg 48,20,40960
zf 44,3072
za 164,52,100,164
zk 15,33
za 168,52,104,168
zc 84,27,32768
za 172,52,108,172
zc 86,27,34816
zf 45,68608
za 176,52,112,176
zl 7,32
za 180,52,116,180
za 184,52,120,184
za 188,52,124,188
za 192,56,96,192
zg 52,20,43008
zf 44,4096
za 196,56,100,196
zk 16,33
za 200,56,104,200
zc 88,28,32768
za 204,56,108,204
zc 90,28,34816
za 208,56,112,208
za 212,56,116,212
za 216,56,120,216
za 220,56,124,220
za 224,60,96,224
zg 56,20,45056
zf 45,69632
za 228,60,100,228
zl 8,32
za 232,60,104,232
zc 92,29,32768
za 236,60,108,236
zc 94,29,34816
zf 44,5120
za 240,60,112,240
zk 17,33
za 244,60,116,244
za 248,60,120,248
za 252,60,124,252
zg 60,20,47104
s_waitcnt lgkmcnt(15)
za 0,32,64,0
zc 96,22,49152
zf 45,70656
za 4,32,68,4
zl 9,32
za 8,32,72,8
zc 98,22,51200
s_waitcnt lgkmcnt(15)
za 12,32,76,12
zc 100,23,49152
s_waitcnt lgkmcnt(13)
za 16,32,80,16
s_waitcnt lgkmcnt(10)
za 20,32,84,20
s_waitcnt lgkmcnt(7)
za 24,32,88,24
s_waitcnt lgkmcnt(4)
za 28,32,92,28
za 32,36,64,32
zg 32,21,32768
zf 44,6144
za 36,36,68,36
zk 18,33
za 40,36,72,40
zc 102,23,51200
za 44,36,76,44
zc 104,24,49152
zf 45,71680
za 48,36,80,48
zl 10,32
za 52,36,84,52
zc 106,24,51200
za 56,36,88,56
za 60,36,92,60
za 64,40,64,64
zg 36,21,34816
zf 44,7168
za 68,40,68,68
zk 19,33
za 72,40,72,72
zc 108,25,49152
za 76,40,76,76
zc 110,25,51200
za 80,40,80,80
za 84,40,84,84
za 88,40,88,88
za 92,40,92,92
za 96,44,64,96
zg 40,21,36864
zf 45,72704
za 100,44,68,100
zl 11,32
za 104,44,72,104
zc 112,26,49152
za 108,44,76,108
zc 114,26,51200
za 112,44,80,112
za 116,44,84,116
za 120,44,88,120
za 124,44,92,124
za 128,48,64,128
zg 44,21,38912
za 132,48,68,132
zc 116,27,49152
za 136,48,72,136
zc 118,27,51200
za 140,48,76,140
za 144,48,80,144
za 148,48,84,148
za 152,48,88,152
za 156,48,92,156
za 160,52,64,160
zg 48,21,40960
za 164,52,68,164
zc 120,28,49152
za 168,52,72,168
zc 122,28,51200
za 172,52,76,172
za 176,52,80,176
za 180,52,84,180
za 184,52,88,184
za 188,52,92,188
za 192,56,64,192
zg 52,21,43008
za 196,56,68,196
zc 124,29,49152
za 200,56,72,200
zc 126,29,51200
za 204,56,76,204
za 208,56,80,208
za 212,56,84,212
za 216,56,88,216
za 220,56,92,220
s_waitcnt lgkmcnt(15)
za 224,60,64,224
zg 56,21,45056
za 228,60,68,228
za 232,60,72,232
za 236,60,76,236
za 240,60,80,240
za 244,60,84,244
za 248,60,88,248
za 252,60,92,252
za 0,32,96,0
zg 60,21,47104
za 4,32,100,4
za 8,32,104,8
s_waitcnt lgkmcnt(14)
za 12,32,108,12
s_waitcnt lgkmcnt(11)
za 16,32,112,16
s_waitcnt lgkmcnt(8)
za 20,32,116,20
s_waitcnt lgkmcnt(5)
za 24,32,120,24
s_waitcnt lgkmcnt(2)
za 28,32,124,28
zs 32,32,128
zi 33,33,36
s_cmp_eq_u32 s95, 3
s_cbranch_scc1 drain_172
s_waitcnt vmcnt(0) lgkmcnt(0)
s_barrier
za 32,36,96,32
zg 32,20,0
zf 44,32768
za 36,36,100,36
zk 12,33
za 40,36,104,40
zc 64,22,0
za 44,36,108,44
zc 66,22,2048
zf 45,98304
za 48,36,112,48
zl 4,32
za 52,36,116,52
zc 68,23,0
za 56,36,120,56
za 60,36,124,60
za 64,40,96,64
zg 36,20,2048
zf 44,33792
za 68,40,100,68
zk 13,33
za 72,40,104,72
zc 70,23,2048
za 76,40,108,76
zc 72,24,0
za 80,40,112,80
zc 74,24,2048
za 84,40,116,84
za 88,40,120,88
za 92,40,124,92
za 96,44,96,96
zg 40,20,4096
zf 45,99328
za 100,44,100,100
zl 5,32
za 104,44,104,104
zc 76,25,0
za 108,44,108,108
zc 78,25,2048
zf 44,34816
za 112,44,112,112
zk 14,33
za 116,44,116,116
za 120,44,120,120
za 124,44,124,124
za 128,48,96,128
zg 44,20,6144
zf 45,100352
za 132,48,100,132
zl 6,32
za 136,48,104,136
zc 80,26,0
za 140,48,108,140
zc 82,26,2048
za 144,48,112,144
za 148,48,116,148
za 152,48,120,152
za 156,48,124,156
za 160,52,96,160
zg 48,20,8192
zf 44,35840
za 164,52,100,164
zk 15,33
za 168,52,104,168
zc 84,27,0
za 172,52,108,172
zc 86,27,2048
zf 45,101376
za 176,52,112,176
zl 7,32
za 180,52,116,180
za 184,52,120,184
za 188,52,124,188
za 192,56,96,192
zg 52,20,10240
zf 44,36864
za 196,56,100,196
zk 16,33
za 200,56,104,200
zc 88,28,0
za 204,56,108,204
zc 90,28,2048
za 208,56,112,208
za 212,56,116,212
za 216,56,120,216
za 220,56,124,220
za 224,60,96,224
zg 56,20,12288
zf 45,102400
za 228,60,100,228
zl 8,32
za 232,60,104,232
zc 92,29,0
za 236,60,108,236
zc 94,29,2048
zf 44,37888
za 240,60,112,240
zk 17,33
za 244,60,116,244
za 248,60,120,248
za 252,60,124,252
zg 60,20,14336
s_mov_b64 s[64:65], s[96:97]
s_mov_b64 s[66:67], s[98:99]
zs 88,88,16
s_addc_u32 s89, s89, 0
s_load_dwordx4 s[96:99], s[88:89], 0
s_mov_b32 s46, s58
s_mov_b32 s47, s59
s_mov_b32 s48, s60
s_mov_b32 s49, s61
s_mov_b32 s50, s62
s_mov_b32 s51, s63
s_cmp_eq_u32 s19, 10
s_cbranch_scc0 tch_173
s_and_b32 s68, s14, 127
s_lshl_b32 s68, s68, 2
zi 68,68,3
s_mul_i32 s68, s68, 8192
v_and_b32 v2, 63, v0
v_lshl_add_u32 v2, v2, 7, s68
s_mov_b64 s[52:53], s[70:71]
s_mov_b32 s54, 4194304
s_mov_b32 s55, 0x20000
s_mov_b32 s69, 0
zbj 31,2,69,0
s_and_b32 s68, s14, 127
s_lshl_b32 s68, s68, 2
zi 68,68,3
s_mul_i32 s68, s68, 12288
v_and_b32 v2, 63, v0
v_lshl_add_u32 v2, v2, 7, s68
s_mov_b64 s[52:53], s[72:73]
s_mov_b32 s54, 6291456
s_mov_b32 s55, 0x20000
s_mov_b32 s69, 0
zbj 31,2,69,0
s_mov_b32 exec_hi, 0
s_mov_b32 s69, 8192
zbj 31,2,69,0
s_mov_b64 exec, -1
s_and_b32 s68, s14, 127
s_lshl_b32 s68, s68, 2
zi 68,68,3
s_mul_i32 s68, s68, 16384
v_and_b32 v2, 63, v0
v_lshl_add_u32 v2, v2, 7, s68
s_mov_b64 s[52:53], s[78:79]
s_mov_b32 s54, 8388608
s_mov_b32 s55, 0x20000
s_mov_b32 s69, 0
zbj 31,2,69,0
s_mov_b32 s69, 8192
zbj 31,2,69,0
tch_173:
s_cmp_eq_u32 s19, 11
s_cbranch_scc0 tch_174
s_and_b32 s68, s14, 127
s_lshl_b32 s68, s68, 2
zi 68,68,3
s_mul_i32 s68, s68, 4096
v_and_b32 v2, 63, v0
v_lshl_add_u32 v2, v2, 7, s68
s_mov_b64 s[52:53], s[74:75]
s_mov_b32 s54, 2097152
s_mov_b32 s55, 0x20000
s_mov_b32 exec_hi, 0
s_mov_b32 s69, 0
zbj 31,2,69,0
s_mov_b64 exec, -1
s_and_b32 s68, s14, 127
s_lshl_b32 s68, s68, 2
zi 68,68,3
s_mul_i32 s68, s68, 16384
v_and_b32 v2, 63, v0
v_lshl_add_u32 v2, v2, 7, s68
s_mov_b64 s[52:53], s[84:85]
s_mov_b32 s54, 8388608
s_mov_b32 s55, 0x20000
s_mov_b32 s69, 0
zbj 31,2,69,0
s_mov_b32 s69, 8192
zbj 31,2,69,0
tch_174:
zac 19,19
v_bfe_u32 v2, v1, 4, 1
v_lshrrev_b32 v3, 5, v1
v_lshlrev_b32 v2, 9, v2
v_lshl_add_u32 v2, v3, 10, v2
v_and_b32 v3, 15, v1
v_lshl_add_u32 v30, v3, 4, v2
zb 96,0
zb 97,1
zb 98,2
zb 99,3
zb 100,32
zb 101,33
zb 102,34
zb 103,35
zd 128,96,97
zd 129,98,99
zd 130,100,101
zd 131,102,103
zb 104,4
zb 105,5
zb 106,6
zb 107,7
zb 108,36
zb 109,37
zb 110,38
zb 111,39
zd 132,104,105
zd 133,106,107
zd 134,108,109
zd 135,110,111
zb 112,8
zb 113,9
zb 114,10
zb 115,11
zb 116,40
zb 117,41
zb 118,42
zb 119,43
zd 136,112,113
zd 137,114,115
zd 138,116,117
zd 139,118,119
zb 120,12
zb 121,13
zb 122,14
zb 123,15
zb 124,44
zb 125,45
zb 126,46
zb 127,47
zd 140,120,121
zd 141,122,123
zd 142,124,125
zd 143,126,127
zb 96,16
zb 97,17
zb 98,18
zb 99,19
zb 100,48
zb 101,49
zb 102,50
zb 103,51
zd 144,96,97
zd 145,98,99
zd 146,100,101
zd 147,102,103
zb 104,20
zb 105,21
zb 106,22
zb 107,23
zb 108,52
zb 109,53
zb 110,54
zb 111,55
zd 148,104,105
zd 149,106,107
zd 150,108,109
zd 151,110,111
zb 112,24
zb 113,25
zb 114,26
zb 115,27
zb 116,56
zb 117,57
zb 118,58
zb 119,59
zd 152,112,113
zd 153,114,115
zd 154,116,117
zd 155,118,119
zb 120,28
zb 121,29
zb 122,30
zb 123,31
zb 124,60
zb 125,61
zb 126,62
zb 127,63
zd 156,120,121
zd 157,122,123
zd 158,124,125
zd 159,126,127
zb 96,64
zb 97,65
zb 98,66
zb 99,67
zb 100,96
zb 101,97
zb 102,98
zb 103,99
zd 160,96,97
zd 161,98,99
zd 162,100,101
zd 163,102,103
zb 104,68
zb 105,69
zb 106,70
zb 107,71
zb 108,100
zb 109,101
zb 110,102
zb 111,103
zd 164,104,105
zd 165,106,107
zd 166,108,109
zd 167,110,111
zb 112,72
zb 113,73
zb 114,74
zb 115,75
zb 116,104
zb 117,105
zb 118,106
zb 119,107
zd 168,112,113
zd 169,114,115
zd 170,116,117
zd 171,118,119
zb 120,76
zb 121,77
zb 122,78
zb 123,79
zb 124,108
zb 125,109
zb 126,110
zb 127,111
zd 172,120,121
zd 173,122,123
zd 174,124,125
zd 175,126,127
zb 96,80
zb 97,81
zb 98,82
zb 99,83
zb 100,112
zb 101,113
zb 102,114
zb 103,115
zd 176,96,97
zd 177,98,99
zd 178,100,101
zd 179,102,103
zb 104,84
zb 105,85
zb 106,86
zb 107,87
zb 108,116
zb 109,117
zb 110,118
zb 111,119
zd 180,104,105
zd 181,106,107
zd 182,108,109
zd 183,110,111
zb 112,88
zb 113,89
zb 114,90
zb 115,91
zb 116,120
zb 117,121
zb 118,122
zb 119,123
zd 184,112,113
zd 185,114,115
zd 186,116,117
zd 187,118,119
zb 120,92
zb 121,93
zb 122,94
zb 123,95
zb 124,124
zb 125,125
zb 126,126
zb 127,127
zd 188,120,121
zd 189,122,123
zd 190,124,125
zd 191,126,127
zb 96,128
zb 97,129
zb 98,130
zb 99,131
zb 100,160
zb 101,161
zb 102,162
zb 103,163
zd 192,96,97
zd 193,98,99
zd 194,100,101
zd 195,102,103
zb 104,132
zb 105,133
zb 106,134
zb 107,135
zb 108,164
zb 109,165
zb 110,166
zb 111,167
zd 196,104,105
zd 197,106,107
zd 198,108,109
zd 199,110,111
zb 112,136
zb 113,137
zb 114,138
zb 115,139
zb 116,168
zb 117,169
zb 118,170
zb 119,171
zd 200,112,113
zd 201,114,115
zd 202,116,117
zd 203,118,119
zb 120,140
zb 121,141
zb 122,142
zb 123,143
zb 124,172
zb 125,173
zb 126,174
zb 127,175
zd 204,120,121
zd 205,122,123
zd 206,124,125
zd 207,126,127
zb 96,144
zb 97,145
zb 98,146
zb 99,147
zb 100,176
zb 101,177
zb 102,178
zb 103,179
zd 208,96,97
zd 209,98,99
zd 210,100,101
zd 211,102,103
zb 104,148
zb 105,149
zb 106,150
zb 107,151
zb 108,180
zb 109,181
zb 110,182
zb 111,183
zd 212,104,105
zd 213,106,107
zd 214,108,109
zd 215,110,111
zb 112,152
zb 113,153
zb 114,154
zb 115,155
zb 116,184
zb 117,185
zb 118,186
zb 119,187
zd 216,112,113
zd 217,114,115
zd 218,116,117
zd 219,118,119
zb 120,156
zb 121,157
zb 122,158
zb 123,159
zb 124,188
zb 125,189
zb 126,190
zb 127,191
zd 220,120,121
zd 221,122,123
zd 222,124,125
zd 223,126,127
zb 96,192
zb 97,193
zb 98,194
zb 99,195
zb 100,224
zb 101,225
zb 102,226
zb 103,227
zd 224,96,97
zd 225,98,99
zd 226,100,101
zd 227,102,103
zb 104,196
zb 105,197
zb 106,198
zb 107,199
zb 108,228
zb 109,229
zb 110,230
zb 111,231
zd 228,104,105
zd 229,106,107
zd 230,108,109
zd 231,110,111
zb 112,200
zb 113,201
zb 114,202
zb 115,203
zb 116,232
zb 117,233
zb 118,234
zb 119,235
zd 232,112,113
zd 233,114,115
zd 234,116,117
zd 235,118,119
zb 120,204
zb 121,205
zb 122,206
zb 123,207
zb 124,236
zb 125,237
zb 126,238
zb 127,239
zd 236,120,121
zd 237,122,123
zd 238,124,125
zd 239,126,127
zb 96,208
zb 97,209
zb 98,210
zb 99,211
zb 100,240
zb 101,241
zb 102,242
zb 103,243
zd 240,96,97
zd 241,98,99
zd 242,100,101
zd 243,102,103
zb 104,212
zb 105,213
zb 106,214
zb 107,215
zb 108,244
zb 109,245
zb 110,246
zb 111,247
zd 244,104,105
zd 245,106,107
zd 246,108,109
zd 247,110,111
zb 112,216
zb 113,217
zb 114,218
zb 115,219
zb 116,248
zb 117,249
zb 118,250
zb 119,251
zd 248,112,113
zd 249,114,115
zd 250,116,117
zd 251,118,119
zb 120,220
zb 121,221
zb 122,222
zb 123,223
zb 124,252
zb 125,253
zb 126,254
zb 127,255
zd 252,120,121
zd 253,122,123
zd 254,124,125
zd 255,126,127
s_mov_b64 s[56:57], s[28:29]
s_mov_b32 s58, s30
s_mov_b32 s59, 0x20000
s_mov_b32 s60, s37
s_mov_b32 s61, s38
s_mov_b32 s62, 0
s_mov_b32 s63, 0
s_mov_b32 s100, s101
s_waitcnt lgkmcnt(0)
s_mov_b64 s[28:29], s[46:47]
s_mov_b32 s30, s48
s_mov_b32 s37, s49
s_mov_b32 s38, s50
s_mov_b32 s41, s51
s_mov_b32 s94, s95
s_mov_b32 s101, s67
s_cmp_eq_u32 s94, 0
s_cbranch_scc1 t_p256c_head_NR
s_branch t_p256c_head_TR
drain_172:
s_waitcnt lgkmcnt(0)
za 32,36,96,32
za 36,36,100,36
za 40,36,104,40
za 44,36,108,44
za 48,36,112,48
za 52,36,116,52
za 56,36,120,56
za 60,36,124,60
za 64,40,96,64
za 68,40,100,68
za 72,40,104,72
za 76,40,108,76
za 80,40,112,80
za 84,40,116,84
za 88,40,120,88
za 92,40,124,92
za 96,44,96,96
za 100,44,100,100
za 104,44,104,104
za 108,44,108,108
za 112,44,112,112
za 116,44,116,116
za 120,44,120,120
za 124,44,124,124
za 128,48,96,128
za 132,48,100,132
za 136,48,104,136
za 140,48,108,140
za 144,48,112,144
za 148,48,116,148
za 152,48,120,152
za 156,48,124,156
za 160,52,96,160
za 164,52,100,164
za 168,52,104,168
za 172,52,108,172
za 176,52,112,176
za 180,52,116,180
za 184,52,120,184
za 188,52,124,188
za 192,56,96,192
za 196,56,100,196
za 200,56,104,200
za 204,56,108,204
za 208,56,112,208
za 212,56,116,212
za 216,56,120,216
za 220,56,124,220
za 224,60,96,224
za 228,60,100,228
za 232,60,104,232
za 236,60,108,236
za 240,60,112,240
za 244,60,116,244
za 248,60,120,248
za 252,60,124,252
s_nop 7
v_bfe_u32 v2, v1, 4, 1
v_lshrrev_b32 v3, 5, v1
v_lshlrev_b32 v2, 9, v2
v_lshl_add_u32 v2, v3, 10, v2
v_and_b32 v3, 15, v1
v_lshl_add_u32 v30, v3, 4, v2
zb 96,0
zb 97,1
zb 98,2
zb 99,3
zb 100,32
zb 101,33
zb 102,34
zb 103,35
zd 128,96,97
zd 129,98,99
zd 130,100,101
zd 131,102,103
zb 104,4
zb 105,5
zb 106,6
zb 107,7
zb 108,36
zb 109,37
zb 110,38
zb 111,39
zd 132,104,105
zd 133,106,107
zd 134,108,109
zd 135,110,111
zb 112,8
zb 113,9
zb 114,10
zb 115,11
zb 116,40
zb 117,41
zb 118,42
zb 119,43
zd 136,112,113
zd 137,114,115
zd 138,116,117
zd 139,118,119
zb 120,12
zb 121,13
zb 122,14
zb 123,15
zb 124,44
zb 125,45
zb 126,46
zb 127,47
zd 140,120,121
zd 141,122,123
zd 142,124,125
zd 143,126,127
zb 96,16
zb 97,17
zb 98,18
zb 99,19
zb 100,48
zb 101,49
zb 102,50
zb 103,51
zd 144,96,97
zd 145,98,99
zd 146,100,101
zd 147,102,103
zb 104,20
zb 105,21
zb 106,22
zb 107,23
zb 108,52
zb 109,53
zb 110,54
zb 111,55
zd 148,104,105
zd 149,106,107
zd 150,108,109
zd 151,110,111
zb 112,24
zb 113,25
zb 114,26
zb 115,27
zb 116,56
zb 117,57
zb 118,58
zb 119,59
zd 152,112,113
zd 153,114,115
zd 154,116,117
zd 155,118,119
zb 120,28
zb 121,29
zb 122,30
zb 123,31
zb 124,60
zb 125,61
zb 126,62
zb 127,63
zd 156,120,121
zd 157,122,123
zd 158,124,125
zd 159,126,127
zb 96,64
zb 97,65
zb 98,66
zb 99,67
zb 100,96
zb 101,97
zb 102,98
zb 103,99
zd 160,96,97
zd 161,98,99
zd 162,100,101
zd 163,102,103
zb 104,68
zb 105,69
zb 106,70
zb 107,71
zb 108,100
zb 109,101
zb 110,102
zb 111,103
zd 164,104,105
zd 165,106,107
zd 166,108,109
zd 167,110,111
zb 112,72
zb 113,73
zb 114,74
zb 115,75
zb 116,104
zb 117,105
zb 118,106
zb 119,107
zd 168,112,113
zd 169,114,115
zd 170,116,117
zd 171,118,119
zb 120,76
zb 121,77
zb 122,78
zb 123,79
zb 124,108
zb 125,109
zb 126,110
zb 127,111
zd 172,120,121
zd 173,122,123
zd 174,124,125
zd 175,126,127
zb 96,80
zb 97,81
zb 98,82
zb 99,83
zb 100,112
zb 101,113
zb 102,114
zb 103,115
zd 176,96,97
zd 177,98,99
zd 178,100,101
zd 179,102,103
zb 104,84
zb 105,85
zb 106,86
zb 107,87
zb 108,116
zb 109,117
zb 110,118
zb 111,119
zd 180,104,105
zd 181,106,107
zd 182,108,109
zd 183,110,111
zb 112,88
zb 113,89
zb 114,90
zb 115,91
zb 116,120
zb 117,121
zb 118,122
zb 119,123
zd 184,112,113
zd 185,114,115
zd 186,116,117
zd 187,118,119
zb 120,92
zb 121,93
zb 122,94
zb 123,95
zb 124,124
zb 125,125
zb 126,126
zb 127,127
zd 188,120,121
zd 189,122,123
zd 190,124,125
zd 191,126,127
zb 96,128
zb 97,129
zb 98,130
zb 99,131
zb 100,160
zb 101,161
zb 102,162
zb 103,163
zd 192,96,97
zd 193,98,99
zd 194,100,101
zd 195,102,103
zb 104,132
zb 105,133
zb 106,134
zb 107,135
zb 108,164
zb 109,165
zb 110,166
zb 111,167
zd 196,104,105
zd 197,106,107
zd 198,108,109
zd 199,110,111
zb 112,136
zb 113,137
zb 114,138
zb 115,139
zb 116,168
zb 117,169
zb 118,170
zb 119,171
zd 200,112,113
zd 201,114,115
zd 202,116,117
zd 203,118,119
zb 120,140
zb 121,141
zb 122,142
zb 123,143
zb 124,172
zb 125,173
zb 126,174
zb 127,175
zd 204,120,121
zd 205,122,123
zd 206,124,125
zd 207,126,127
zb 96,144
zb 97,145
zb 98,146
zb 99,147
zb 100,176
zb 101,177
zb 102,178
zb 103,179
zd 208,96,97
zd 209,98,99
zd 210,100,101
zd 211,102,103
zb 104,148
zb 105,149
zb 106,150
zb 107,151
zb 108,180
zb 109,181
zb 110,182
zb 111,183
zd 212,104,105
zd 213,106,107
zd 214,108,109
zd 215,110,111
zb 112,152
zb 113,153
zb 114,154
zb 115,155
zb 116,184
zb 117,185
zb 118,186
zb 119,187
zd 216,112,113
zd 217,114,115
zd 218,116,117
zd 219,118,119
zb 120,156
zb 121,157
zb 122,158
zb 123,159
zb 124,188
zb 125,189
zb 126,190
zb 127,191
zd 220,120,121
zd 221,122,123
zd 222,124,125
zd 223,126,127
zb 96,192
zb 97,193
zb 98,194
zb 99,195
zb 100,224
zb 101,225
zb 102,226
zb 103,227
zd 224,96,97
zd 225,98,99
zd 226,100,101
zd 227,102,103
zb 104,196
zb 105,197
zb 106,198
zb 107,199
zb 108,228
zb 109,229
zb 110,230
zb 111,231
zd 228,104,105
zd 229,106,107
zd 230,108,109
zd 231,110,111
zb 112,200
zb 113,201
zb 114,202
zb 115,203
zb 116,232
zb 117,233
zb 118,234
zb 119,235
zd 232,112,113
zd 233,114,115
zd 234,116,117
zd 235,118,119
zb 120,204
zb 121,205
zb 122,206
zb 123,207
zb 124,236
zb 125,237
zb 126,238
zb 127,239
zd 236,120,121
zd 237,122,123
zd 238,124,125
zd 239,126,127
zb 96,208
zb 97,209
zb 98,210
zb 99,211
zb 100,240
zb 101,241
zb 102,242
zb 103,243
zd 240,96,97
zd 241,98,99
zd 242,100,101
zd 243,102,103
zb 104,212
zb 105,213
zb 106,214
zb 107,215
zb 108,244
zb 109,245
zb 110,246
zb 111,247
zd 244,104,105
zd 245,106,107
zd 246,108,109
zd 247,110,111
zb 112,216
zb 113,217
zb 114,218
zb 115,219
zb 116,248
zb 117,249
zb 118,250
zb 119,251
zd 248,112,113
zd 249,114,115
zd 250,116,117
zd 251,118,119
zb 120,220
zb 121,221
zb 122,222
zb 123,223
zb 124,252
zb 125,253
zb 126,254
zb 127,255
zd 252,120,121
zd 253,122,123
zd 254,124,125
zd 255,126,127
s_mov_b64 s[56:57], s[28:29]
s_mov_b32 s58, s30
s_mov_b32 s59, 0x20000
s_mov_b32 s60, s37
s_mov_b32 s61, s38
s_mov_b32 s62, 0
s_mov_b32 s63, 0
s_mov_b32 s100, s101
s_nop 0
zz 128,30,63,0
s_nop 0
zz 132,30,63,256
zi 63,63,61
zz 136,30,63,0
s_nop 0
zz 140,30,63,256
zi 63,63,61
zz 144,30,63,0
s_nop 0
zz 148,30,63,256
zi 63,63,61
zz 152,30,63,0
s_nop 0
zz 156,30,63,256
zi 62,62,60
s_mov_b32 s63, s62
zz 160,30,63,0
s_nop 0
zz 164,30,63,256
zi 63,63,61
zz 168,30,63,0
s_nop 0
zz 172,30,63,256
zi 63,63,61
zz 176,30,63,0
s_nop 0
zz 180,30,63,256
zi 63,63,61
zz 184,30,63,0
s_nop 0
zz 188,30,63,256
zi 62,62,60
s_mov_b32 s63, s62
zz 192,30,63,0
s_nop 0
zz 196,30,63,256
zi 63,63,61
zz 200,30,63,0
s_nop 0
zz 204,30,63,256
zi 63,63,61
zz 208,30,63,0
s_nop 0
zz 212,30,63,256
zi 63,63,61
zz 216,30,63,0
s_nop 0
zz 220,30,63,256
zi 62,62,60
s_mov_b32 s63, s62
zz 224,30,63,0
s_nop 0
zz 228,30,63,256
zi 63,63,61
zz 232,30,63,0
s_nop 0
zz 236,30,63,256
zi 63,63,61
zz 240,30,63,0
s_nop 0
zz 244,30,63,256
zi 63,63,61
zz 248,30,63,0
s_nop 0
zz 252,30,63,256
s_mov_b32 s67, s101
s_getpc_b64 s[20:21]
bk_175:
s_sub_u32 s20, s20, bk_175-task_next
s_subb_u32 s21, s21, 0
s_setpc_b64 s[20:21]
t_att:
s_lshl_b32 s47, s47, 4
v_and_b32 v1, 63, v0
v_lshlrev_b32 v4, 4, v1
s_lshl_b32 s40, s46, 17
s_mul_i32 s41, s3, 4
zi 47,47,41
s_lshl_b32 s41, s47, 11
zi 41,41,40
v_and_b32 v120, 0x27, v1
v_bfe_u32 v121, v1, 3, 1
v_lshl_add_u32 v120, v121, 4, v120
v_bfe_u32 v121, v1, 4, 1
v_lshl_add_u32 v120, v121, 3, v120
v_lshlrev_b32 v5, 4, v120
s_min_u32 s41, s41, 4194304
zi 20,4,41
s_addc_u32 s21, s5, 0
zaz 20,20
s_addc_u32 s21, s21, 0
s_mov_b32 s22, 8192
s_mov_b32 s23, 0x20000
s_min_u32 s40, s40, 4194304
zi 24,4,40
s_addc_u32 s25, s5, 0
zs 24,24,4194304
s_addc_u32 s25, s25, 0
s_mov_b32 s26, 131072
s_mov_b32 s27, 0x20000
s_min_u32 s40, s40, 4194304
zi 28,4,40
s_addc_u32 s29, s5, 0
zs 28,28,8388608
s_addc_u32 s29, s29, 0
s_mov_b32 s30, 131072
s_mov_b32 s31, 0x20000
s_lshl_b32 s40, s47, 16
s_lshl_b32 s41, s46, 11
zi 40,40,41
s_min_u32 s40, s40, 4194304
zi 32,4,40
s_addc_u32 s33, s5, 0
zs 32,32,12582912
s_addc_u32 s33, s33, 0
s_mov_b32 s34, 262144
s_mov_b32 s35, 0x20000
s_mov_b32 s40, 0
buffer_load_dwordx4 a[0:3], v4, s[20:23], s40 offen offset:0
s_mov_b32 s40, 0
buffer_load_dwordx4 a[4:7], v4, s[20:23], s40 offen offset:1024
s_mov_b32 s40, 0
buffer_load_dwordx4 a[8:11], v4, s[20:23], s40 offen offset:2048
s_mov_b32 s40, 0
buffer_load_dwordx4 a[12:15], v4, s[20:23], s40 offen offset:3072
s_mov_b32 s40, 4096
buffer_load_dwordx4 a[16:19], v4, s[20:23], s40 offen offset:0
s_mov_b32 s40, 4096
buffer_load_dwordx4 a[20:23], v4, s[20:23], s40 offen offset:1024
s_mov_b32 s40, 4096
buffer_load_dwordx4 a[24:27], v4, s[20:23], s40 offen offset:2048
s_mov_b32 s40, 4096
buffer_load_dwordx4 a[28:31], v4, s[20:23], s40 offen offset:3072
s_mov_b32 s36, 0
s_mov_b32 s37, 0
zbc 64,4,37,0
zbc 68,4,37,1024
zs 37,37,2048
zbb 32,5,36,0
zbb 36,5,36,1024
zs 36,36,2048
zbc 72,4,37,0
zbc 76,4,37,1024
zs 37,37,2048
zbb 40,5,36,0
zbb 44,5,36,1024
zs 36,36,2048
zbc 80,4,37,0
zbc 84,4,37,1024
zs 37,37,2048
zbb 48,5,36,0
zbb 52,5,36,1024
zs 36,36,2048
v_bfe_u32 v120, v1, 2, 1
v_cmp_eq_u32 vcc, 0, v120
zax 121,0x3f803f80
v_and_b32 v123, 1, v1
v_cndmask_b32 v120, 0, v121, vcc
v_cndmask_b32 v122, v121, 0, vcc
v_mul_u32_u24 v123, 0xaaaa, v123
v_add_u32 v144, 0x4444, v123
v_accvgpr_write_b32 a176, v120
v_accvgpr_write_b32 a177, v120
v_accvgpr_write_b32 a178, v122
v_accvgpr_write_b32 a179, v122
s_mov_b32 s39, 0
zt 96
zt 97
zt 98
zt 99
zt 100
zt 101
zt 102
zt 103
zt 104
zt 105
zt 106
zt 107
zt 108
zt 109
zt 110
zt 111
zt 112
zt 113
zt 114
zt 115
zt 116
zt 117
zt 118
zt 119
zt 120
zt 121
zt 122
zt 123
zt 124
zt 125
zt 126
zt 127
zt 128
zt 129
zt 130
zt 131
zt 132
zt 133
zt 134
zt 135
zt 136
zt 137
zt 138
zt 139
zt 140
zt 141
zt 142
zt 143
zt 144
zt 145
zt 146
zt 147
zt 148
zt 149
zt 150
zt 151
zt 152
zt 153
zt 154
zt 155
zt 156
zt 157
zt 158
zt 159
zt 160
zt 161
zt 162
zt 163
zt 164
zt 165
zt 166
zt 167
zt 168
zt 169
zt 170
zt 171
zt 172
zt 173
zt 174
zt 175
zh 112
zh 113
zh 114
zh 115
zh 116
zh 117
zh 118
zh 119
zt 88
zt 89
zt 90
zt 91
zt 92
zt 93
zt 94
zt 95
s_waitcnt vmcnt(9)
v_mfma_f32_32x32x16_bf16 v[72:87], a[32:35], a[0:3], 0
s_waitcnt vmcnt(8)
zal 72,36,4,72
v_mfma_f32_32x32x16_bf16 v[88:103], a[32:35], a[8:11], 0
zal 88,36,12,88
s_nop 9
v_max_f32 v136, v72, v73
zw 136,74,75,136
zw 136,76,77,136
zw 136,78,79,136
zw 136,80,81,136
zw 136,82,83,136
zw 136,84,85,136
zw 136,86,87,136
zq 140,136
s_nop 1
zai 136,140
s_nop 0
v_max_f32 v136, v136, v140
v_sub_f32 v8, 0, v136
zq 9,8
zq 10,8
zq 11,8
zq 12,8
zq 13,8
zq 14,8
zq 15,8
zq 16,8
zq 17,8
zq 18,8
zq 19,8
zq 20,8
zq 21,8
zq 22,8
zq 23,8
v_mfma_f32_32x32x16_bf16 v[72:87], a[32:35], a[16:19], 0
zal 72,36,20,72
v_max_f32 v136, v88, v89
zw 136,90,91,136
zw 136,92,93,136
zw 136,94,95,136
zw 136,96,97,136
zw 136,98,99,136
zw 136,100,101,136
zw 136,102,103,136
zq 140,136
s_nop 1
zai 136,140
s_nop 0
v_max_f32 v136, v136, v140
v_sub_f32 v24, 0, v136
zq 25,24
zq 26,24
zq 27,24
zq 28,24
zq 29,24
zq 30,24
zq 31,24
zq 32,24
zq 33,24
zq 34,24
zq 35,24
zq 36,24
zq 37,24
zq 38,24
zq 39,24
v_mfma_f32_32x32x16_bf16 v[88:103], a[32:35], a[24:27], 0
zal 88,36,28,88
v_max_f32 v136, v72, v73
zw 136,74,75,136
zw 136,76,77,136
zw 136,78,79,136
zw 136,80,81,136
zw 136,82,83,136
zw 136,84,85,136
zw 136,86,87,136
zq 140,136
s_nop 1
zai 136,140
s_nop 0
v_max_f32 v136, v136, v140
v_sub_f32 v40, 0, v136
zq 41,40
zq 42,40
zq 43,40
zq 44,40
zq 45,40
zq 46,40
zq 47,40
zq 48,40
zq 49,40
zq 50,40
zq 51,40
zq 52,40
zq 53,40
zq 54,40
zq 55,40
s_nop 7
v_max_f32 v136, v88, v89
zw 136,90,91,136
zw 136,92,93,136
zw 136,94,95,136
zw 136,96,97,136
zw 136,98,99,136
zw 136,100,101,136
zw 136,102,103,136
zq 140,136
s_nop 1
zai 136,140
s_nop 0
v_max_f32 v136, v136, v140
v_sub_f32 v56, 0, v136
zq 57,56
zq 58,56
zq 59,56
zq 60,56
zq 61,56
zq 62,56
zq 63,56
zq 64,56
zq 65,56
zq 66,56
zq 67,56
zq 68,56
zq 69,56
zq 70,56
zq 71,56
aa_main_176:
zal 72,32,0,8
zal 72,36,4,72
s_mov_b32 s38, 16
s_nop 15
aa_loop_179:
zj 72,72
zj 73,73
zal 88,32,8,24
zj 74,74
zj 75,75
zj 76,76
zj 77,77
zal 88,36,12,88
zj 78,78
zj 79,79
zj 80,80
zj 81,81
zao 144,88,112,144
zj 82,82
zj 83,83
zj 84,84
zj 85,85
zao 144,92,116,144
zj 86,86
zbc 88,4,37,0
zbc 92,4,37,1024
zs 37,37,2048
zj 87,87
zd 104,72,73
zd 105,74,75
zd 106,76,77
zbd 172,176,112,144
zd 107,78,79
zd 108,80,81
zd 109,82,83
zd 110,84,85
zd 111,86,87
zj 88,88
zj 89,89
zal 72,32,16,40
zj 90,90
zj 91,91
zj 92,92
zj 93,93
zal 72,36,20,72
zj 94,94
zj 95,95
zj 96,96
zj 97,97
zao 96,64,104,96
zj 98,98
zj 99,99
zj 100,100
zj 101,101
zao 96,68,108,96
zj 102,102
zj 103,103
zd 112,88,89
zd 113,90,91
zd 114,92,93
zbd 160,176,104,144
zd 115,94,95
zd 116,96,97
zd 117,98,99
zd 118,100,101
zd 119,102,103
zj 72,72
zj 73,73
zal 88,32,24,56
zj 74,74
zj 75,75
zj 76,76
zj 77,77
zal 88,36,28,88
zj 78,78
zj 79,79
zj 80,80
zj 81,81
zao 112,64,112,112
zj 82,82
zj 83,83
zj 84,84
zj 85,85
zao 112,68,116,112
zj 86,86
zj 87,87
zd 104,72,73
zd 105,74,75
zd 106,76,77
zbd 164,176,112,144
zd 107,78,79
zd 108,80,81
zd 109,82,83
zd 110,84,85
zd 111,86,87
zj 88,88
zj 89,89
s_waitcnt vmcnt(7)
zal 72,40,0,8
zj 90,90
zj 91,91
zj 92,92
zj 93,93
s_waitcnt vmcnt(6)
zal 72,44,4,72
zj 94,94
zj 95,95
zj 96,96
zbb 56,5,36,0
zbb 60,5,36,1024
zs 36,36,2048
zj 97,97
zao 128,64,104,128
zj 98,98
zj 99,99
zj 100,100
zj 101,101
zao 128,68,108,128
zj 102,102
zj 103,103
zd 112,88,89
zd 113,90,91
zd 114,92,93
zbd 168,176,104,144
zd 115,94,95
zd 116,96,97
zd 117,98,99
zd 118,100,101
zd 119,102,103
zj 72,72
zj 73,73
zal 88,40,8,24
zj 74,74
zj 75,75
zj 76,76
zj 77,77
zal 88,44,12,88
zj 78,78
zj 79,79
zj 80,80
zj 81,81
zao 144,64,112,144
zj 82,82
zj 83,83
zj 84,84
zj 85,85
zao 144,68,116,144
zj 86,86
zbc 64,4,37,0
zbc 68,4,37,1024
zs 37,37,2048
zj 87,87
zd 104,72,73
zd 105,74,75
zd 106,76,77
zbd 172,176,112,144
zd 107,78,79
zd 108,80,81
zd 109,82,83
zd 110,84,85
zd 111,86,87
zj 88,88
zj 89,89
zal 72,40,16,40
zj 90,90
zj 91,91
zj 92,92
zj 93,93
zal 72,44,20,72
zj 94,94
zj 95,95
zj 96,96
zj 97,97
zao 96,72,104,96
zj 98,98
zj 99,99
zj 100,100
zj 101,101
zao 96,76,108,96
zj 102,102
zj 103,103
zd 112,88,89
zd 113,90,91
zd 114,92,93
zbd 160,176,104,144
zd 115,94,95
zd 116,96,97
zd 117,98,99
zd 118,100,101
zd 119,102,103
zj 72,72
zj 73,73
zal 88,40,24,56
zj 74,74
zj 75,75
zj 76,76
zj 77,77
zal 88,44,28,88
zj 78,78
zj 79,79
zj 80,80
zj 81,81
zao 112,72,112,112
zj 82,82
zj 83,83
zj 84,84
zj 85,85
zao 112,76,116,112
zj 86,86
zj 87,87
zd 104,72,73
zd 105,74,75
zd 106,76,77
zbd 164,176,112,144
zd 107,78,79
zd 108,80,81
zd 109,82,83
zd 110,84,85
zd 111,86,87
zj 88,88
zj 89,89
s_waitcnt vmcnt(7)
zal 72,48,0,8
zj 90,90
zj 91,91
zj 92,92
zj 93,93
s_waitcnt vmcnt(6)
zal 72,52,4,72
zj 94,94
zj 95,95
zj 96,96
zbb 32,5,36,0
zbb 36,5,36,1024
zs 36,36,2048
zj 97,97
zao 128,72,104,128
zj 98,98
zj 99,99
zj 100,100
zj 101,101
zao 128,76,108,128
zj 102,102
zj 103,103
zd 112,88,89
zd 113,90,91
zd 114,92,93
zbd 168,176,104,144
zd 115,94,95
zd 116,96,97
zd 117,98,99
zd 118,100,101
zd 119,102,103
zj 72,72
zj 73,73
zal 88,48,8,24
zj 74,74
zj 75,75
zj 76,76
zj 77,77
zal 88,52,12,88
zj 78,78
zj 79,79
zj 80,80
zj 81,81
zao 144,72,112,144
zj 82,82
zj 83,83
zj 84,84
zj 85,85
zao 144,76,116,144
zj 86,86
zbc 72,4,37,0
zbc 76,4,37,1024
zs 37,37,2048
zj 87,87
zd 104,72,73
zd 105,74,75
zd 106,76,77
zbd 172,176,112,144
zd 107,78,79
zd 108,80,81
zd 109,82,83
zd 110,84,85
zd 111,86,87
zj 88,88
zj 89,89
zal 72,48,16,40
zj 90,90
zj 91,91
zj 92,92
zj 93,93
zal 72,52,20,72
zj 94,94
zj 95,95
zj 96,96
zj 97,97
zao 96,80,104,96
zj 98,98
zj 99,99
zj 100,100
zj 101,101
zao 96,84,108,96
zj 102,102
zj 103,103
zd 112,88,89
zd 113,90,91
zd 114,92,93
zbd 160,176,104,144
zd 115,94,95
zd 116,96,97
zd 117,98,99
zd 118,100,101
zd 119,102,103
zj 72,72
zj 73,73
zal 88,48,24,56
zj 74,74
zj 75,75
zj 76,76
zj 77,77
zal 88,52,28,88
zj 78,78
zj 79,79
zj 80,80
zj 81,81
zao 112,80,112,112
zj 82,82
zj 83,83
zj 84,84
zj 85,85
zao 112,84,116,112
zj 86,86
zj 87,87
zd 104,72,73
zd 105,74,75
zd 106,76,77
zbd 164,176,112,144
zd 107,78,79
zd 108,80,81
zd 109,82,83
zd 110,84,85
zd 111,86,87
zj 88,88
zj 89,89
s_waitcnt vmcnt(7)
zal 72,56,0,8
zj 90,90
zj 91,91
zj 92,92
zj 93,93
s_waitcnt vmcnt(6)
zal 72,60,4,72
zj 94,94
zj 95,95
zj 96,96
zbb 40,5,36,0
zbb 44,5,36,1024
zs 36,36,2048
zj 97,97
zao 128,80,104,128
zj 98,98
zj 99,99
zj 100,100
zj 101,101
zao 128,84,108,128
zj 102,102
zj 103,103
zd 112,88,89
zd 113,90,91
zd 114,92,93
zbd 168,176,104,144
zd 115,94,95
zd 116,96,97
zd 117,98,99
zd 118,100,101
zd 119,102,103
zj 72,72
zj 73,73
zal 88,56,8,24
zj 74,74
zj 75,75
zj 76,76
zj 77,77
zal 88,60,12,88
zj 78,78
zj 79,79
zj 80,80
zj 81,81
zao 144,80,112,144
zj 82,82
zj 83,83
zj 84,84
zj 85,85
zao 144,84,116,144
zj 86,86
zbc 80,4,37,0
zbc 84,4,37,1024
zs 37,37,2048
zj 87,87
zd 104,72,73
zd 105,74,75
zd 106,76,77
zbd 172,176,112,144
zd 107,78,79
zd 108,80,81
zd 109,82,83
zd 110,84,85
zd 111,86,87
zj 88,88
zj 89,89
zal 72,56,16,40
zj 90,90
zj 91,91
zj 92,92
zj 93,93
zal 72,60,20,72
zj 94,94
zj 95,95
zj 96,96
zj 97,97
zao 96,88,104,96
zj 98,98
zj 99,99
zj 100,100
zj 101,101
zao 96,92,108,96
zj 102,102
zj 103,103
zd 112,88,89
zd 113,90,91
zd 114,92,93
zbd 160,176,104,144
zd 115,94,95
zd 116,96,97
zd 117,98,99
zd 118,100,101
zd 119,102,103
zj 72,72
zj 73,73
zal 88,56,24,56
zj 74,74
zj 75,75
zj 76,76
zj 77,77
zal 88,60,28,88
zj 78,78
zj 79,79
zj 80,80
zj 81,81
zao 112,88,112,112
zj 82,82
zj 83,83
zj 84,84
zj 85,85
zao 112,92,116,112
zj 86,86
zj 87,87
zd 104,72,73
zd 105,74,75
zd 106,76,77
zbd 164,176,112,144
zd 107,78,79
zd 108,80,81
zd 109,82,83
zd 110,84,85
zd 111,86,87
zj 88,88
zj 89,89
s_waitcnt vmcnt(7)
zal 72,32,0,8
zj 90,90
zj 91,91
zj 92,92
zj 93,93
s_waitcnt vmcnt(6)
zal 72,36,4,72
zj 94,94
zj 95,95
zj 96,96
zbb 48,5,36,0
zbb 52,5,36,1024
zs 36,36,2048
zj 97,97
zao 128,88,104,128
zj 98,98
zj 99,99
zj 100,100
zj 101,101
zao 128,92,108,128
zj 102,102
zj 103,103
zd 112,88,89
zd 113,90,91
zd 114,92,93
zbd 168,176,104,144
zd 115,94,95
zd 116,96,97
zd 117,98,99
zd 118,100,101
zd 119,102,103
s_sub_u32 s38, s38, 1
s_cmp_lg_u32 s38, 0
s_cbranch_scc1 aa_loop_179
zao 144,88,112,144
zao 144,92,116,144
zbd 172,176,112,144
s_waitcnt vmcnt(0)
s_nop 15
zh 137
zh 138
zb 136,160
zb 139,161
s_nop 0
zm 136,136,139
v_max_f32 v137, v137, v136
v_cmp_u_f32 vcc, v136, v136
v_rcp_f32 v136, v136
s_nop 0
v_cndmask_b32 v138, v138, -1, vcc
zb 72,96
zb 73,97
zb 74,98
zb 75,99
zb 76,100
zb 77,101
zb 78,102
zb 79,103
zb 80,104
zb 81,105
zb 82,106
zb 83,107
zb 84,108
zb 85,109
zb 86,110
zb 87,111
v_mul_f32 v72, v72, v136
v_mul_f32 v73, v73, v136
v_mul_f32 v74, v74, v136
v_mul_f32 v75, v75, v136
v_mul_f32 v76, v76, v136
v_mul_f32 v77, v77, v136
v_mul_f32 v78, v78, v136
v_mul_f32 v79, v79, v136
v_mul_f32 v80, v80, v136
v_mul_f32 v81, v81, v136
v_mul_f32 v82, v82, v136
v_mul_f32 v83, v83, v136
v_mul_f32 v84, v84, v136
v_mul_f32 v85, v85, v136
v_mul_f32 v86, v86, v136
v_mul_f32 v87, v87, v136
v_max3_f32 v137, |v72|, |v73|, v137
v_max3_f32 v137, |v74|, |v75|, v137
v_max3_f32 v137, |v76|, |v77|, v137
v_max3_f32 v137, |v78|, |v79|, v137
v_max3_f32 v137, |v80|, |v81|, v137
v_max3_f32 v137, |v82|, |v83|, v137
v_max3_f32 v137, |v84|, |v85|, v137
v_max3_f32 v137, |v86|, |v87|, v137
zd 8,72,73
zd 9,74,75
zd 10,76,77
zd 11,78,79
zd 12,80,81
zd 13,82,83
zd 14,84,85
zd 15,86,87
zb 136,164
zb 139,165
s_nop 0
zm 136,136,139
v_max_f32 v137, v137, v136
v_cmp_u_f32 vcc, v136, v136
v_rcp_f32 v136, v136
s_nop 0
v_cndmask_b32 v138, v138, -1, vcc
zb 88,112
zb 89,113
zb 90,114
zb 91,115
zb 92,116
zb 93,117
zb 94,118
zb 95,119
zb 96,120
zb 97,121
zb 98,122
zb 99,123
zb 100,124
zb 101,125
zb 102,126
zb 103,127
v_mul_f32 v88, v88, v136
v_mul_f32 v89, v89, v136
v_mul_f32 v90, v90, v136
v_mul_f32 v91, v91, v136
v_mul_f32 v92, v92, v136
v_mul_f32 v93, v93, v136
v_mul_f32 v94, v94, v136
v_mul_f32 v95, v95, v136
v_mul_f32 v96, v96, v136
v_mul_f32 v97, v97, v136
v_mul_f32 v98, v98, v136
v_mul_f32 v99, v99, v136
v_mul_f32 v100, v100, v136
v_mul_f32 v101, v101, v136
v_mul_f32 v102, v102, v136
v_mul_f32 v103, v103, v136
v_max3_f32 v137, |v88|, |v89|, v137
v_max3_f32 v137, |v90|, |v91|, v137
v_max3_f32 v137, |v92|, |v93|, v137
v_max3_f32 v137, |v94|, |v95|, v137
v_max3_f32 v137, |v96|, |v97|, v137
v_max3_f32 v137, |v98|, |v99|, v137
v_max3_f32 v137, |v100|, |v101|, v137
v_max3_f32 v137, |v102|, |v103|, v137
zd 24,88,89
zd 25,90,91
zd 26,92,93
zd 27,94,95
zd 28,96,97
zd 29,98,99
zd 30,100,101
zd 31,102,103
zb 136,168
zb 139,169
s_nop 0
zm 136,136,139
v_max_f32 v137, v137, v136
v_cmp_u_f32 vcc, v136, v136
v_rcp_f32 v136, v136
s_nop 0
v_cndmask_b32 v138, v138, -1, vcc
zb 72,128
zb 73,129
zb 74,130
zb 75,131
zb 76,132
zb 77,133
zb 78,134
zb 79,135
zb 80,136
zb 81,137
zb 82,138
zb 83,139
zb 84,140
zb 85,141
zb 86,142
zb 87,143
v_mul_f32 v72, v72, v136
v_mul_f32 v73, v73, v136
v_mul_f32 v74, v74, v136
v_mul_f32 v75, v75, v136
v_mul_f32 v76, v76, v136
v_mul_f32 v77, v77, v136
v_mul_f32 v78, v78, v136
v_mul_f32 v79, v79, v136
v_mul_f32 v80, v80, v136
v_mul_f32 v81, v81, v136
v_mul_f32 v82, v82, v136
v_mul_f32 v83, v83, v136
v_mul_f32 v84, v84, v136
v_mul_f32 v85, v85, v136
v_mul_f32 v86, v86, v136
v_mul_f32 v87, v87, v136
v_max3_f32 v137, |v72|, |v73|, v137
v_max3_f32 v137, |v74|, |v75|, v137
v_max3_f32 v137, |v76|, |v77|, v137
v_max3_f32 v137, |v78|, |v79|, v137
v_max3_f32 v137, |v80|, |v81|, v137
v_max3_f32 v137, |v82|, |v83|, v137
v_max3_f32 v137, |v84|, |v85|, v137
v_max3_f32 v137, |v86|, |v87|, v137
zd 40,72,73
zd 41,74,75
zd 42,76,77
zd 43,78,79
zd 44,80,81
zd 45,82,83
zd 46,84,85
zd 47,86,87
zb 136,172
zb 139,173
s_nop 0
zm 136,136,139
v_max_f32 v137, v137, v136
v_cmp_u_f32 vcc, v136, v136
v_rcp_f32 v136, v136
s_nop 0
v_cndmask_b32 v138, v138, -1, vcc
zb 88,144
zb 89,145
zb 90,146
zb 91,147
zb 92,148
zb 93,149
zb 94,150
zb 95,151
zb 96,152
zb 97,153
zb 98,154
zb 99,155
zb 100,156
zb 101,157
zb 102,158
zb 103,159
v_mul_f32 v88, v88, v136
v_mul_f32 v89, v89, v136
v_mul_f32 v90, v90, v136
v_mul_f32 v91, v91, v136
v_mul_f32 v92, v92, v136
v_mul_f32 v93, v93, v136
v_mul_f32 v94, v94, v136
v_mul_f32 v95, v95, v136
v_mul_f32 v96, v96, v136
v_mul_f32 v97, v97, v136
v_mul_f32 v98, v98, v136
v_mul_f32 v99, v99, v136
v_mul_f32 v100, v100, v136
v_mul_f32 v101, v101, v136
v_mul_f32 v102, v102, v136
v_mul_f32 v103, v103, v136
v_max3_f32 v137, |v88|, |v89|, v137
v_max3_f32 v137, |v90|, |v91|, v137
v_max3_f32 v137, |v92|, |v93|, v137
v_max3_f32 v137, |v94|, |v95|, v137
v_max3_f32 v137, |v96|, |v97|, v137
v_max3_f32 v137, |v98|, |v99|, v137
v_max3_f32 v137, |v100|, |v101|, v137
v_max3_f32 v137, |v102|, |v103|, v137
zd 56,88,89
zd 57,90,91
zd 58,92,93
zd 59,94,95
zd 60,96,97
zd 61,98,99
zd 62,100,101
zd 63,102,103
zax 136,0x5f800000
v_cmp_gt_f32 vcc, v137, v136
v_cmp_ne_u32 s[40:41], 0, v138
s_or_b64 vcc, vcc, s[40:41]
s_cbranch_vccz aa_fin_177
s_cmp_lg_u32 s39, 0
s_cbranch_scc1 aa_fin_177
s_mov_b32 s39, 1
s_mov_b32 s36, 0
s_mov_b32 s38, 64
zax 128,0xff800000
zax 129,0xff800000
zax 130,0xff800000
zax 131,0xff800000
aa_max_178:
zbb 32,5,36,0
zbb 36,5,36,1024
zs 36,36,2048
s_waitcnt vmcnt(1)
v_mfma_f32_32x32x16_bf16 v[72:87], a[32:35], a[0:3], 0
s_waitcnt vmcnt(0)
zal 72,36,4,72
s_nop 15
zw 128,72,73,128
zw 128,74,75,128
zw 128,76,77,128
zw 128,78,79,128
zw 128,80,81,128
zw 128,82,83,128
zw 128,84,85,128
zw 128,86,87,128
v_mfma_f32_32x32x16_bf16 v[88:103], a[32:35], a[8:11], 0
zal 88,36,12,88
s_nop 15
zw 129,88,89,129
zw 129,90,91,129
zw 129,92,93,129
zw 129,94,95,129
zw 129,96,97,129
zw 129,98,99,129
zw 129,100,101,129
zw 129,102,103,129
v_mfma_f32_32x32x16_bf16 v[72:87], a[32:35], a[16:19], 0
zal 72,36,20,72
s_nop 15
zw 130,72,73,130
zw 130,74,75,130
zw 130,76,77,130
zw 130,78,79,130
zw 130,80,81,130
zw 130,82,83,130
zw 130,84,85,130
zw 130,86,87,130
v_mfma_f32_32x32x16_bf16 v[88:103], a[32:35], a[24:27], 0
zal 88,36,28,88
s_nop 15
zw 131,88,89,131
zw 131,90,91,131
zw 131,92,93,131
zw 131,94,95,131
zw 131,96,97,131
zw 131,98,99,131
zw 131,100,101,131
zw 131,102,103,131
s_sub_u32 s38, s38, 1
s_cmp_lg_u32 s38, 0
s_cbranch_scc1 aa_max_178
zq 140,128
s_nop 1
zai 128,140
s_nop 0
v_max_f32 v128, v128, v140
v_sub_f32 v8, 0, v128
zq 9,8
zq 10,8
zq 11,8
zq 12,8
zq 13,8
zq 14,8
zq 15,8
zq 16,8
zq 17,8
zq 18,8
zq 19,8
zq 20,8
zq 21,8
zq 22,8
zq 23,8
zq 140,129
s_nop 1
zai 129,140
s_nop 0
v_max_f32 v129, v129, v140
v_sub_f32 v24, 0, v129
zq 25,24
zq 26,24
zq 27,24
zq 28,24
zq 29,24
zq 30,24
zq 31,24
zq 32,24
zq 33,24
zq 34,24
zq 35,24
zq 36,24
zq 37,24
zq 38,24
zq 39,24
zq 140,130
s_nop 1
zai 130,140
s_nop 0
v_max_f32 v130, v130, v140
v_sub_f32 v40, 0, v130
zq 41,40
zq 42,40
zq 43,40
zq 44,40
zq 45,40
zq 46,40
zq 47,40
zq 48,40
zq 49,40
zq 50,40
zq 51,40
zq 52,40
zq 53,40
zq 54,40
zq 55,40
zq 140,131
s_nop 1
zai 131,140
s_nop 0
v_max_f32 v131, v131, v140
v_sub_f32 v56, 0, v131
zq 57,56
zq 58,56
zq 59,56
zq 60,56
zq 61,56
zq 62,56
zq 63,56
zq 64,56
zq 65,56
zq 66,56
zq 67,56
zq 68,56
zq 69,56
zq 70,56
zq 71,56
s_mov_b32 s36, 0
s_mov_b32 s37, 0
zbc 64,4,37,0
zbc 68,4,37,1024
zs 37,37,2048
zbb 32,5,36,0
zbb 36,5,36,1024
zs 36,36,2048
zbc 72,4,37,0
zbc 76,4,37,1024
zs 37,37,2048
zbb 40,5,36,0
zbb 44,5,36,1024
zs 36,36,2048
zbc 80,4,37,0
zbc 84,4,37,1024
zs 37,37,2048
zbb 48,5,36,0
zbb 52,5,36,1024
zs 36,36,2048
zt 96
zt 97
zt 98
zt 99
zt 100
zt 101
zt 102
zt 103
zt 104
zt 105
zt 106
zt 107
zt 108
zt 109
zt 110
zt 111
zt 112
zt 113
zt 114
zt 115
zt 116
zt 117
zt 118
zt 119
zt 120
zt 121
zt 122
zt 123
zt 124
zt 125
zt 126
zt 127
zt 128
zt 129
zt 130
zt 131
zt 132
zt 133
zt 134
zt 135
zt 136
zt 137
zt 138
zt 139
zt 140
zt 141
zt 142
zt 143
zt 144
zt 145
zt 146
zt 147
zt 148
zt 149
zt 150
zt 151
zt 152
zt 153
zt 154
zt 155
zt 156
zt 157
zt 158
zt 159
zt 160
zt 161
zt 162
zt 163
zt 164
zt 165
zt 166
zt 167
zt 168
zt 169
zt 170
zt 171
zt 172
zt 173
zt 174
zt 175
zh 112
zh 113
zh 114
zh 115
zh 116
zh 117
zh 118
zh 119
zt 88
zt 89
zt 90
zt 91
zt 92
zt 93
zt 94
zt 95
s_waitcnt vmcnt(0)
s_branch aa_main_176
aa_fin_177:
s_mov_b32 s40, 0
buffer_store_dwordx4 v[8:11], v4, s[32:35], s40 offen offset:0 sc1
buffer_store_dwordx4 v[12:15], v4, s[32:35], s40 offen offset:1024 sc1
s_mov_b32 s40, 65536
buffer_store_dwordx4 v[24:27], v4, s[32:35], s40 offen offset:0 sc1
buffer_store_dwordx4 v[28:31], v4, s[32:35], s40 offen offset:1024 sc1
s_mov_b32 s40, 131072
buffer_store_dwordx4 v[40:43], v4, s[32:35], s40 offen offset:0 sc1
buffer_store_dwordx4 v[44:47], v4, s[32:35], s40 offen offset:1024 sc1
s_mov_b32 s40, 196608
buffer_store_dwordx4 v[56:59], v4, s[32:35], s40 offen offset:0 sc1
buffer_store_dwordx4 v[60:63], v4, s[32:35], s40 offen offset:1024 sc1
s_getpc_b64 s[20:21]
bk_180:
s_sub_u32 s20, s20, bk_180-task_next
s_subb_u32 s21, s21, 0
s_setpc_b64 s[20:21]
t_outa:
s_lshl_b32 s48, s47, 7
s_lshl_b32 s47, s46, 7
s_mov_b32 s42, 65536
s_mov_b32 s34, 16
s_mov_b32 s43, 2048
s_mov_b32 s35, 4096
s_mov_b32 s36, 131072
s_lshr_b32 s57, s47, 5
s_mul_i32 s57, s57, 65536
s_min_u32 s57, s57, 4194304
zs 59,57,12582912
zi 20,4,59
s_addc_u32 s21, s5, 0
s_sub_u32 s22, 4194304, s57
s_mov_b32 s23, 0x20000
s_lshl_b32 s57, s48, 1
s_lshr_b32 s59, s3, 1
s_mul_i32 s59, s59, 64
zi 59,59,47
s_lshl_b32 s59, s59, 12
zaz 59,59
zi 59,59,57
s_and_b32 s60, s3, 1
s_mul_i32 s60, s60, 128
zi 59,59,60
s_mov_b32 s41, 4096
s_mov_b32 s37, 131072
s_mov_b32 s38, 64
s_min_u32 s57, s57, 2097152
zi 24,74,57
s_addc_u32 s25, s75, 0
s_sub_u32 s26, 2097152, s57
s_mov_b32 s27, 0x20000
s_min_u32 s59, s59, 8388608
zi 28,86,59
s_addc_u32 s29, s87, 0
s_sub_u32 s30, 8388608, s59
s_mov_b32 s31, 0x20000
v_and_b32 v1, 63, v0
v_lshlrev_b32 v96, 4, v1
s_mul_i32 s39, s3, 4
zaz 39,39
s_lshr_b32 s40, s39, 2
s_mul_i32 s40, s40, s42
s_and_b32 s39, s39, 3
s_lshl_b32 s39, s39, 10
zi 39,39,40
v_add_u32 v4, s39, v96
s_mul_i32 s39, s3, 4
zac 39,39
s_lshr_b32 s40, s39, 2
s_mul_i32 s40, s40, s42
s_and_b32 s39, s39, 3
s_lshl_b32 s39, s39, 10
zi 39,39,40
v_add_u32 v5, s39, v96
s_mul_i32 s39, s3, 4
zav 39,39
s_lshr_b32 s40, s39, 2
s_mul_i32 s40, s40, s42
s_and_b32 s39, s39, 3
s_lshl_b32 s39, s39, 10
zi 39,39,40
v_add_u32 v6, s39, v96
s_mul_i32 s39, s3, 4
s_add_u32 s39, s39, 3
s_lshr_b32 s40, s39, 2
s_mul_i32 s40, s40, s42
s_and_b32 s39, s39, 3
s_lshl_b32 s39, s39, 10
zi 39,39,40
v_add_u32 v7, s39, v96
v_lshrrev_b32 v48, 4, v1
v_and_b32 v49, 15, v1
s_lshl_b32 s39, s3, 4
v_add_u32 v50, 0, v48
v_and_b32 v51, 3, v50
v_lshlrev_b32 v51, 2, v51
v_xor_b32 v51, v51, v49
v_add_u32 v50, s39, v50
v_mul_lo_u32 v50, v50, s43
v_lshl_add_u32 v8, v51, 4, v50
v_add_u32 v50, 4, v48
v_and_b32 v51, 3, v50
v_lshlrev_b32 v51, 2, v51
v_xor_b32 v51, v51, v49
v_add_u32 v50, s39, v50
v_mul_lo_u32 v50, v50, s43
v_lshl_add_u32 v9, v51, 4, v50
v_add_u32 v50, 8, v48
v_and_b32 v51, 3, v50
v_lshlrev_b32 v51, 2, v51
v_xor_b32 v51, v51, v49
v_add_u32 v50, s39, v50
v_mul_lo_u32 v50, v50, s43
v_lshl_add_u32 v10, v51, 4, v50
v_add_u32 v50, 12, v48
v_and_b32 v51, 3, v50
v_lshlrev_b32 v51, 2, v51
v_xor_b32 v51, v51, v49
v_add_u32 v50, s39, v50
v_mul_lo_u32 v50, v50, s43
v_lshl_add_u32 v11, v51, 4, v50
s_lshr_b32 s39, s3, 1
s_mul_i32 s39, s39, 8192
zs 39,39,65536
v_add_u32 v12, s39, v96
v_bfe_u32 v48, v1, 2, 2
v_lshrrev_b32 v49, 5, v1
v_mul_u32_u24 v49, 4, v49
v_add_u32 v49, v49, v48
v_mul_u32_u24 v49, 256, v49
v_and_b32 v50, 3, v1
v_and_b32 v51, 1, v50
v_lshrrev_b32 v50, 1, v50
v_lshl_add_u32 v50, v51, 1, v50
v_bfe_u32 v51, v1, 4, 1
v_lshl_add_u32 v50, v51, 2, v50
v_lshl_add_u32 v49, v50, 3, v49
s_and_b32 s39, s3, 1
s_mul_i32 s39, s39, 2
zaz 40,39
v_xor_b32 v50, s40, v48
v_lshl_add_u32 v13, v50, 6, v49
zac 40,39
v_xor_b32 v50, s40, v48
v_lshl_add_u32 v14, v50, 6, v49
s_lshl_b32 s44, s3, 12
s_lshl_b32 s45, s3, 12
s_mov_b32 s32, 0
s_mov_b32 s33, 0
s_barrier
zay 44
s_nop 0
zk 8,33
zf 45,65536
s_nop 0
zl 4,32
zf 44,1024
s_nop 0
zk 9,33
zf 45,66560
s_nop 0
zl 5,32
zf 44,2048
s_nop 0
zk 10,33
zf 45,67584
s_nop 0
zl 6,32
zf 44,3072
s_nop 0
zk 11,33
zf 45,68608
s_nop 0
zl 7,32
zi 32,32,35
zi 33,33,36
zf 44,16384
s_nop 0
zk 8,33
zf 45,81920
s_nop 0
zl 4,32
zf 44,17408
s_nop 0
zk 9,33
zf 45,82944
s_nop 0
zl 5,32
zf 44,18432
s_nop 0
zk 10,33
zf 45,83968
s_nop 0
zl 6,32
zf 44,19456
s_nop 0
zk 11,33
zf 45,84992
s_nop 0
zl 7,32
zi 32,32,35
zi 33,33,36
zf 44,32768
s_nop 0
zk 8,33
zf 45,98304
s_nop 0
zl 4,32
zf 44,33792
s_nop 0
zk 9,33
zf 45,99328
s_nop 0
zl 5,32
zf 44,34816
s_nop 0
zk 10,33
zf 45,100352
s_nop 0
zl 6,32
zf 44,35840
s_nop 0
zk 11,33
zf 45,101376
s_nop 0
zl 7,32
zi 32,32,35
zi 33,33,36
zf 44,49152
s_nop 0
zk 8,33
zf 45,114688
s_nop 0
zl 4,32
zf 44,50176
s_nop 0
zk 9,33
zf 45,115712
s_nop 0
zl 5,32
zf 44,51200
s_nop 0
zk 10,33
zf 45,116736
s_nop 0
zl 6,32
zf 44,52224
s_nop 0
zk 11,33
zf 45,117760
s_nop 0
zl 7,32
zi 32,32,35
zi 33,33,36
s_waitcnt vmcnt(24)
s_barrier
zg 16,12,0
zc 32,13,0
zc 34,13,2048
zc 36,14,0
zc 38,14,2048
zg 20,12,4096
s_waitcnt lgkmcnt(3)
zaw 0,32,16
zg 24,12,1024
zc 40,13,4096
s_waitcnt lgkmcnt(3)
zaw 16,36,16
zc 42,13,6144
zc 44,14,4096
s_waitcnt lgkmcnt(4)
zaw 32,32,20
zc 46,14,6144
zg 28,12,5120
zaw 48,36,20
s_waitcnt lgkmcnt(3)
ze 0,40,24,0
zg 16,12,2048
zc 32,13,8192
s_waitcnt lgkmcnt(3)
ze 16,44,24,16
zc 34,13,10240
zc 36,14,8192
s_waitcnt lgkmcnt(4)
ze 32,40,28,32
zc 38,14,10240
zg 20,12,6144
ze 48,44,28,48
s_waitcnt lgkmcnt(3)
ze 0,32,16,0
zg 24,12,3072
zc 40,13,12288
s_waitcnt lgkmcnt(3)
ze 16,36,16,16
zc 42,13,14336
zc 44,14,12288
s_waitcnt lgkmcnt(4)
ze 32,32,20,32
zc 46,14,14336
zg 28,12,7168
ze 48,36,20,48
s_sub_u32 s34, s34, 4
oa_loop_181:
s_waitcnt vmcnt(16) lgkmcnt(0)
s_barrier
zay 44
ze 0,40,24,0
zk 8,33
zg 16,12,16384
zc 32,13,16384
zf 45,65536
ze 16,44,24,16
zl 4,32
zc 34,13,18432
zc 36,14,16384
ze 32,40,28,32
zc 38,14,18432
zg 20,12,20480
ze 48,44,28,48
s_waitcnt lgkmcnt(3)
zf 44,1024
ze 0,32,16,0
zk 9,33
zg 24,12,17408
zc 40,13,20480
s_waitcnt lgkmcnt(3)
zf 45,66560
ze 16,36,16,16
zl 5,32
zc 42,13,22528
zc 44,14,20480
s_waitcnt lgkmcnt(4)
ze 32,32,20,32
zc 46,14,22528
zg 28,12,21504
ze 48,36,20,48
s_waitcnt lgkmcnt(3)
zf 44,2048
ze 0,40,24,0
zk 10,33
zg 16,12,18432
zc 32,13,24576
s_waitcnt lgkmcnt(3)
zf 45,67584
ze 16,44,24,16
zl 6,32
zc 34,13,26624
zc 36,14,24576
s_waitcnt lgkmcnt(4)
ze 32,40,28,32
zc 38,14,26624
zg 20,12,22528
ze 48,44,28,48
s_waitcnt lgkmcnt(3)
zf 44,3072
ze 0,32,16,0
zk 11,33
zg 24,12,19456
zc 40,13,28672
s_waitcnt lgkmcnt(3)
zf 45,68608
ze 16,36,16,16
zl 7,32
zc 42,13,30720
zc 44,14,28672
s_waitcnt lgkmcnt(4)
ze 32,32,20,32
zc 46,14,30720
zg 28,12,23552
ze 48,36,20,48
zi 32,32,35
zi 33,33,36
s_waitcnt vmcnt(16) lgkmcnt(0)
s_barrier
zf 44,16384
ze 0,40,24,0
zk 8,33
zg 16,12,32768
zc 32,13,32768
zf 45,81920
ze 16,44,24,16
zl 4,32
zc 34,13,34816
zc 36,14,32768
ze 32,40,28,32
zc 38,14,34816
zg 20,12,36864
ze 48,44,28,48
s_waitcnt lgkmcnt(3)
zf 44,17408
ze 0,32,16,0
zk 9,33
zg 24,12,33792
zc 40,13,36864
s_waitcnt lgkmcnt(3)
zf 45,82944
ze 16,36,16,16
zl 5,32
zc 42,13,38912
zc 44,14,36864
s_waitcnt lgkmcnt(4)
ze 32,32,20,32
zc 46,14,38912
zg 28,12,37888
ze 48,36,20,48
s_waitcnt lgkmcnt(3)
zf 44,18432
ze 0,40,24,0
zk 10,33
zg 16,12,34816
zc 32,13,40960
s_waitcnt lgkmcnt(3)
zf 45,83968
ze 16,44,24,16
zl 6,32
zc 34,13,43008
zc 36,14,40960
s_waitcnt lgkmcnt(4)
ze 32,40,28,32
zc 38,14,43008
zg 20,12,38912
ze 48,44,28,48
s_waitcnt lgkmcnt(3)
zf 44,19456
ze 0,32,16,0
zk 11,33
zg 24,12,35840
zc 40,13,45056
s_waitcnt lgkmcnt(3)
zf 45,84992
ze 16,36,16,16
zl 7,32
zc 42,13,47104
zc 44,14,45056
s_waitcnt lgkmcnt(4)
ze 32,32,20,32
zc 46,14,47104
zg 28,12,39936
ze 48,36,20,48
zi 32,32,35
zi 33,33,36
s_waitcnt vmcnt(16) lgkmcnt(0)
s_barrier
zf 44,32768
ze 0,40,24,0
zk 8,33
zg 16,12,49152
zc 32,13,49152
zf 45,98304
ze 16,44,24,16
zl 4,32
zc 34,13,51200
zc 36,14,49152
ze 32,40,28,32
zc 38,14,51200
zg 20,12,53248
ze 48,44,28,48
s_waitcnt lgkmcnt(3)
zf 44,33792
ze 0,32,16,0
zk 9,33
zg 24,12,50176
zc 40,13,53248
s_waitcnt lgkmcnt(3)
zf 45,99328
ze 16,36,16,16
zl 5,32
zc 42,13,55296
zc 44,14,53248
s_waitcnt lgkmcnt(4)
ze 32,32,20,32
zc 46,14,55296
zg 28,12,54272
ze 48,36,20,48
s_waitcnt lgkmcnt(3)
zf 44,34816
ze 0,40,24,0
zk 10,33
zg 16,12,51200
zc 32,13,57344
s_waitcnt lgkmcnt(3)
zf 45,100352
ze 16,44,24,16
zl 6,32
zc 34,13,59392
zc 36,14,57344
s_waitcnt lgkmcnt(4)
ze 32,40,28,32
zc 38,14,59392
zg 20,12,55296
ze 48,44,28,48
s_waitcnt lgkmcnt(3)
zf 44,35840
ze 0,32,16,0
zk 11,33
zg 24,12,52224
zc 40,13,61440
s_waitcnt lgkmcnt(3)
zf 45,101376
ze 16,36,16,16
zl 7,32
zc 42,13,63488
zc 44,14,61440
s_waitcnt lgkmcnt(4)
ze 32,32,20,32
zc 46,14,63488
zg 28,12,56320
ze 48,36,20,48
zi 32,32,35
zi 33,33,36
s_waitcnt vmcnt(16) lgkmcnt(0)
s_barrier
zf 44,49152
ze 0,40,24,0
zk 8,33
zg 16,12,0
zc 32,13,0
zf 45,114688
ze 16,44,24,16
zl 4,32
zc 34,13,2048
zc 36,14,0
ze 32,40,28,32
zc 38,14,2048
zg 20,12,4096
ze 48,44,28,48
s_waitcnt lgkmcnt(3)
zf 44,50176
ze 0,32,16,0
zk 9,33
zg 24,12,1024
zc 40,13,4096
s_waitcnt lgkmcnt(3)
zf 45,115712
ze 16,36,16,16
zl 5,32
zc 42,13,6144
zc 44,14,4096
s_waitcnt lgkmcnt(4)
ze 32,32,20,32
zc 46,14,6144
zg 28,12,5120
ze 48,36,20,48
s_waitcnt lgkmcnt(3)
zf 44,51200
ze 0,40,24,0
zk 10,33
zg 16,12,2048
zc 32,13,8192
s_waitcnt lgkmcnt(3)
zf 45,116736
ze 16,44,24,16
zl 6,32
zc 34,13,10240
zc 36,14,8192
s_waitcnt lgkmcnt(4)
ze 32,40,28,32
zc 38,14,10240
zg 20,12,6144
ze 48,44,28,48
s_waitcnt lgkmcnt(3)
zf 44,52224
ze 0,32,16,0
zk 11,33
zg 24,12,3072
zc 40,13,12288
s_waitcnt lgkmcnt(3)
zf 45,117760
ze 16,36,16,16
zl 7,32
zc 42,13,14336
zc 44,14,12288
s_waitcnt lgkmcnt(4)
ze 32,32,20,32
zc 46,14,14336
zg 28,12,7168
ze 48,36,20,48
zi 32,32,35
zi 33,33,36
s_sub_u32 s34, s34, 4
s_cmp_lg_u32 s34, 0
s_cbranch_scc1 oa_loop_181
s_waitcnt vmcnt(16) lgkmcnt(0)
s_barrier
ze 0,40,24,0
zg 16,12,16384
zc 32,13,16384
ze 16,44,24,16
zc 34,13,18432
zc 36,14,16384
ze 32,40,28,32
zc 38,14,18432
zg 20,12,20480
ze 48,44,28,48
s_waitcnt lgkmcnt(3)
ze 0,32,16,0
zg 24,12,17408
zc 40,13,20480
s_waitcnt lgkmcnt(3)
ze 16,36,16,16
zc 42,13,22528
zc 44,14,20480
s_waitcnt lgkmcnt(4)
ze 32,32,20,32
zc 46,14,22528
zg 28,12,21504
ze 48,36,20,48
s_waitcnt lgkmcnt(3)
ze 0,40,24,0
zg 16,12,18432
zc 32,13,24576
s_waitcnt lgkmcnt(3)
ze 16,44,24,16
zc 34,13,26624
zc 36,14,24576
s_waitcnt lgkmcnt(4)
ze 32,40,28,32
zc 38,14,26624
zg 20,12,22528
ze 48,44,28,48
s_waitcnt lgkmcnt(3)
ze 0,32,16,0
zg 24,12,19456
zc 40,13,28672
s_waitcnt lgkmcnt(3)
ze 16,36,16,16
zc 42,13,30720
zc 44,14,28672
s_waitcnt lgkmcnt(4)
ze 32,32,20,32
zc 46,14,30720
zg 28,12,23552
ze 48,36,20,48
s_waitcnt vmcnt(8) lgkmcnt(0)
s_barrier
ze 0,40,24,0
zg 16,12,32768
zc 32,13,32768
ze 16,44,24,16
zc 34,13,34816
zc 36,14,32768
ze 32,40,28,32
zc 38,14,34816
zg 20,12,36864
ze 48,44,28,48
s_waitcnt lgkmcnt(3)
ze 0,32,16,0
zg 24,12,33792
zc 40,13,36864
s_waitcnt lgkmcnt(3)
ze 16,36,16,16
zc 42,13,38912
zc 44,14,36864
s_waitcnt lgkmcnt(4)
ze 32,32,20,32
zc 46,14,38912
zg 28,12,37888
ze 48,36,20,48
s_waitcnt lgkmcnt(3)
ze 0,40,24,0
zg 16,12,34816
zc 32,13,40960
s_waitcnt lgkmcnt(3)
ze 16,44,24,16
zc 34,13,43008
zc 36,14,40960
s_waitcnt lgkmcnt(4)
ze 32,40,28,32
zc 38,14,43008
zg 20,12,38912
ze 48,44,28,48
s_waitcnt lgkmcnt(3)
ze 0,32,16,0
zg 24,12,35840
zc 40,13,45056
s_waitcnt lgkmcnt(3)
ze 16,36,16,16
zc 42,13,47104
zc 44,14,45056
s_waitcnt lgkmcnt(4)
ze 32,32,20,32
zc 46,14,47104
zg 28,12,39936
ze 48,36,20,48
s_waitcnt vmcnt(0) lgkmcnt(0)
s_barrier
ze 0,40,24,0
zg 16,12,49152
zc 32,13,49152
ze 16,44,24,16
zc 34,13,51200
zc 36,14,49152
ze 32,40,28,32
zc 38,14,51200
zg 20,12,53248
ze 48,44,28,48
s_waitcnt lgkmcnt(3)
ze 0,32,16,0
zg 24,12,50176
zc 40,13,53248
s_waitcnt lgkmcnt(3)
ze 16,36,16,16
zc 42,13,55296
zc 44,14,53248
s_waitcnt lgkmcnt(4)
ze 32,32,20,32
zc 46,14,55296
zg 28,12,54272
ze 48,36,20,48
s_waitcnt lgkmcnt(3)
ze 0,40,24,0
zg 16,12,51200
zc 32,13,57344
s_waitcnt lgkmcnt(3)
ze 16,44,24,16
zc 34,13,59392
zc 36,14,57344
s_waitcnt lgkmcnt(4)
ze 32,40,28,32
zc 38,14,59392
zg 20,12,55296
ze 48,44,28,48
s_waitcnt lgkmcnt(3)
ze 0,32,16,0
zg 24,12,52224
zc 40,13,61440
s_waitcnt lgkmcnt(3)
ze 16,36,16,16
zc 42,13,63488
zc 44,14,61440
s_waitcnt lgkmcnt(4)
ze 32,32,20,32
zc 46,14,63488
zg 28,12,56320
ze 48,36,20,48
s_waitcnt lgkmcnt(3)
ze 0,40,24,0
s_waitcnt lgkmcnt(1)
ze 16,44,24,16
s_waitcnt lgkmcnt(0)
ze 32,40,28,32
ze 48,44,28,48
v_and_b32 v92, 31, v1
v_mul_lo_u32 v92, v92, s41
v_lshrrev_b32 v93, 5, v1
v_lshl_add_u32 v92, v93, 4, v92
s_mov_b32 s39, 0
s_mov_b32 s40, s39
zb 48,0
zb 49,1
zb 50,2
zb 51,3
zb 52,4
zb 53,5
zb 54,6
zb 55,7
zd 88,48,49
zd 89,50,51
zd 90,52,53
zd 91,54,55
zas 88,92,40,0
zb 56,8
zb 57,9
zb 58,10
zb 59,11
zb 60,12
zb 61,13
zb 62,14
zb 63,15
zd 80,56,57
zd 81,58,59
zd 82,60,61
zd 83,62,63
zas 80,92,40,32
zi 40,40,38
zb 64,16
zb 65,17
zb 66,18
zb 67,19
zb 68,20
zb 69,21
zb 70,22
zb 71,23
zd 84,64,65
zd 85,66,67
zd 86,68,69
zd 87,70,71
zas 84,92,40,0
zb 72,24
zb 73,25
zb 74,26
zb 75,27
zb 76,28
zb 77,29
zb 78,30
zb 79,31
zd 88,72,73
zd 89,74,75
zd 90,76,77
zd 91,78,79
zas 88,92,40,32
zi 39,39,37
s_mov_b32 s40, s39
zb 48,32
zb 49,33
zb 50,34
zb 51,35
zb 52,36
zb 53,37
zb 54,38
zb 55,39
zd 80,48,49
zd 81,50,51
zd 82,52,53
zd 83,54,55
zas 80,92,40,0
zb 56,40
zb 57,41
zb 58,42
zb 59,43
zb 60,44
zb 61,45
zb 62,46
zb 63,47
zd 84,56,57
zd 85,58,59
zd 86,60,61
zd 87,62,63
zas 84,92,40,32
zi 40,40,38
zb 64,48
zb 65,49
zb 66,50
zb 67,51
zb 68,52
zb 69,53
zb 70,54
zb 71,55
zd 88,64,65
zd 89,66,67
zd 90,68,69
zd 91,70,71
zas 88,92,40,0
zb 72,56
zb 73,57
zb 74,58
zb 75,59
zb 76,60
zb 77,61
zb 78,62
zb 79,63
zd 80,72,73
zd 81,74,75
zd 82,76,77
zd 83,78,79
zas 80,92,40,32
s_getpc_b64 s[20:21]
bk_182:
s_sub_u32 s20, s20, bk_182-task_next
s_subb_u32 s21, s21, 0
s_setpc_b64 s[20:21]
t_outb:
s_lshl_b32 s48, s47, 8
s_lshl_b32 s47, s46, 7
s_mov_b32 s42, 262144
s_mov_b32 s34, 64
s_mov_b32 s43, 2048
s_mov_b32 s35, 4096
s_mov_b32 s36, 131072
s_lshr_b32 s57, s47, 5
s_mul_i32 s57, s57, 262144
s_min_u32 s57, s57, 16777216
zs 59,57,67108864
zi 20,4,59
s_addc_u32 s21, s5, 0
s_sub_u32 s22, 16777216, s57
s_mov_b32 s23, 0x20000
s_lshl_b32 s57, s48, 1
s_lshr_b32 s59, s3, 1
s_mul_i32 s59, s59, 64
zi 59,59,47
s_lshl_b32 s59, s59, 12
zs 59,59,2048
zi 59,59,57
s_and_b32 s60, s3, 1
s_mul_i32 s60, s60, 256
zi 59,59,60
s_mov_b32 s41, 4096
s_mov_b32 s37, 131072
s_mov_b32 s38, 64
s_min_u32 s57, s57, 8388608
zi 24,84,57
s_addc_u32 s25, s85, 0
s_sub_u32 s26, 8388608, s57
s_mov_b32 s27, 0x20000
s_min_u32 s59, s59, 8388608
zi 28,86,59
s_addc_u32 s29, s87, 0
s_sub_u32 s30, 8388608, s59
s_mov_b32 s31, 0x20000
v_and_b32 v1, 63, v0
v_lshlrev_b32 v124, 4, v1
s_mul_i32 s39, s3, 4
zaz 39,39
s_lshr_b32 s40, s39, 2
s_mul_i32 s40, s40, s42
s_and_b32 s39, s39, 3
s_lshl_b32 s39, s39, 10
zi 39,39,40
v_add_u32 v4, s39, v124
s_mul_i32 s39, s3, 4
zac 39,39
s_lshr_b32 s40, s39, 2
s_mul_i32 s40, s40, s42
s_and_b32 s39, s39, 3
s_lshl_b32 s39, s39, 10
zi 39,39,40
v_add_u32 v5, s39, v124
s_mul_i32 s39, s3, 4
zav 39,39
s_lshr_b32 s40, s39, 2
s_mul_i32 s40, s40, s42
s_and_b32 s39, s39, 3
s_lshl_b32 s39, s39, 10
zi 39,39,40
v_add_u32 v6, s39, v124
s_mul_i32 s39, s3, 4
s_add_u32 s39, s39, 3
s_lshr_b32 s40, s39, 2
s_mul_i32 s40, s40, s42
s_and_b32 s39, s39, 3
s_lshl_b32 s39, s39, 10
zi 39,39,40
v_add_u32 v7, s39, v124
v_lshrrev_b32 v76, 5, v1
v_and_b32 v77, 31, v1
s_lshl_b32 s39, s3, 4
v_add_u32 v78, 0, v76
v_and_b32 v79, 3, v78
v_lshlrev_b32 v79, 2, v79
v_xor_b32 v79, v79, v77
v_add_u32 v78, s39, v78
v_mul_lo_u32 v78, v78, s43
v_lshl_add_u32 v8, v79, 4, v78
v_add_u32 v78, 2, v76
v_and_b32 v79, 3, v78
v_lshlrev_b32 v79, 2, v79
v_xor_b32 v79, v79, v77
v_add_u32 v78, s39, v78
v_mul_lo_u32 v78, v78, s43
v_lshl_add_u32 v9, v79, 4, v78
v_add_u32 v78, 4, v76
v_and_b32 v79, 3, v78
v_lshlrev_b32 v79, 2, v79
v_xor_b32 v79, v79, v77
v_add_u32 v78, s39, v78
v_mul_lo_u32 v78, v78, s43
v_lshl_add_u32 v10, v79, 4, v78
v_add_u32 v78, 6, v76
v_and_b32 v79, 3, v78
v_lshlrev_b32 v79, 2, v79
v_xor_b32 v79, v79, v77
v_add_u32 v78, s39, v78
v_mul_lo_u32 v78, v78, s43
v_lshl_add_u32 v11, v79, 4, v78
v_add_u32 v78, 8, v76
v_and_b32 v79, 3, v78
v_lshlrev_b32 v79, 2, v79
v_xor_b32 v79, v79, v77
v_add_u32 v78, s39, v78
v_mul_lo_u32 v78, v78, s43
v_lshl_add_u32 v12, v79, 4, v78
v_add_u32 v78, 10, v76
v_and_b32 v79, 3, v78
v_lshlrev_b32 v79, 2, v79
v_xor_b32 v79, v79, v77
v_add_u32 v78, s39, v78
v_mul_lo_u32 v78, v78, s43
v_lshl_add_u32 v13, v79, 4, v78
v_add_u32 v78, 12, v76
v_and_b32 v79, 3, v78
v_lshlrev_b32 v79, 2, v79
v_xor_b32 v79, v79, v77
v_add_u32 v78, s39, v78
v_mul_lo_u32 v78, v78, s43
v_lshl_add_u32 v14, v79, 4, v78
v_add_u32 v78, 14, v76
v_and_b32 v79, 3, v78
v_lshlrev_b32 v79, 2, v79
v_xor_b32 v79, v79, v77
v_add_u32 v78, s39, v78
v_mul_lo_u32 v78, v78, s43
v_lshl_add_u32 v15, v79, 4, v78
s_lshr_b32 s39, s3, 1
s_mul_i32 s39, s39, 8192
zs 39,39,98304
v_add_u32 v16, s39, v124
v_bfe_u32 v76, v1, 2, 2
v_lshrrev_b32 v77, 5, v1
v_mul_u32_u24 v77, 4, v77
v_add_u32 v77, v77, v76
v_mul_u32_u24 v77, 512, v77
v_and_b32 v78, 3, v1
v_and_b32 v79, 1, v78
v_lshrrev_b32 v78, 1, v78
v_lshl_add_u32 v78, v79, 1, v78
v_bfe_u32 v79, v1, 4, 1
v_lshl_add_u32 v78, v79, 2, v78
v_lshl_add_u32 v77, v78, 3, v77
s_and_b32 s39, s3, 1
s_mul_i32 s39, s39, 4
zaz 40,39
v_xor_b32 v78, s40, v76
v_lshl_add_u32 v17, v78, 6, v77
v_add_u32 v21, 0x10000, v17
zac 40,39
v_xor_b32 v78, s40, v76
v_lshl_add_u32 v18, v78, 6, v77
v_add_u32 v22, 0x10000, v18
zav 40,39
v_xor_b32 v78, s40, v76
v_lshl_add_u32 v19, v78, 6, v77
v_add_u32 v23, 0x10000, v19
s_add_u32 s40, s39, 3
v_xor_b32 v78, s40, v76
v_lshl_add_u32 v20, v78, 6, v77
v_add_u32 v24, 0x10000, v20
s_lshl_b32 s44, s3, 13
s_lshl_b32 s45, s3, 12
s_mov_b32 s32, 0
s_mov_b32 s33, 0
s_barrier
zay 44
s_nop 0
zk 8,33
zf 45,98304
s_nop 0
zl 4,32
zf 44,1024
s_nop 0
zk 9,33
zf 45,99328
s_nop 0
zl 5,32
zf 44,2048
s_nop 0
zk 10,33
zf 45,100352
s_nop 0
zl 6,32
zf 44,3072
s_nop 0
zk 11,33
zf 45,101376
s_nop 0
zl 7,32
zf 44,4096
s_nop 0
zk 12,33
zf 44,5120
s_nop 0
zk 13,33
zf 44,6144
s_nop 0
zk 14,33
zf 44,7168
s_nop 0
zk 15,33
zi 32,32,35
zi 33,33,36
zf 44,32768
s_nop 0
zk 8,33
zf 45,114688
s_nop 0
zl 4,32
zf 44,33792
s_nop 0
zk 9,33
zf 45,115712
s_nop 0
zl 5,32
zf 44,34816
s_nop 0
zk 10,33
zf 45,116736
s_nop 0
zl 6,32
zf 44,35840
s_nop 0
zk 11,33
zf 45,117760
s_nop 0
zl 7,32
zf 44,36864
s_nop 0
zk 12,33
zf 44,37888
s_nop 0
zk 13,33
zf 44,38912
s_nop 0
zk 14,33
zf 44,39936
s_nop 0
zk 15,33
zi 32,32,35
zi 33,33,36
zf 44,65536
s_nop 0
zk 8,33
zf 45,131072
s_nop 0
zl 4,32
zf 44,66560
s_nop 0
zk 9,33
zf 45,132096
s_nop 0
zl 5,32
zf 44,67584
s_nop 0
zk 10,33
zf 45,133120
s_nop 0
zl 6,32
zf 44,68608
s_nop 0
zk 11,33
zf 45,134144
s_nop 0
zl 7,32
zf 44,69632
s_nop 0
zk 12,33
zf 44,70656
s_nop 0
zk 13,33
zf 44,71680
s_nop 0
zk 14,33
zf 44,72704
s_nop 0
zk 15,33
zi 32,32,35
zi 33,33,36
s_waitcnt vmcnt(24)
s_barrier
zg 28,16,0
zc 44,17,0
zc 46,17,8192
zc 48,18,0
zc 50,18,8192
zc 52,19,0
zc 54,19,8192
zc 56,20,0
zc 58,20,8192
zg 32,16,4096
s_waitcnt lgkmcnt(7)
zaw 0,44,28
zg 36,16,1024
zc 60,17,4096
s_waitcnt lgkmcnt(7)
zaw 16,48,28
zc 62,17,12288
zc 64,18,4096
s_waitcnt lgkmcnt(7)
zaw 32,52,28
zc 66,18,12288
zc 68,19,4096
s_waitcnt lgkmcnt(7)
zaw 48,56,28
zc 70,19,12288
zc 72,20,4096
s_waitcnt lgkmcnt(8)
zaw 64,44,32
zc 74,20,12288
zg 40,16,5120
zaw 80,48,32
zaw 96,52,32
zaw 112,56,32
s_waitcnt lgkmcnt(7)
ze 0,60,36,0
zg 28,16,2048
zc 44,17,16384
s_waitcnt lgkmcnt(7)
ze 16,64,36,16
zc 46,17,24576
zc 48,18,16384
s_waitcnt lgkmcnt(7)
ze 32,68,36,32
zc 50,18,24576
zc 52,19,16384
s_waitcnt lgkmcnt(7)
ze 48,72,36,48
zc 54,19,24576
zc 56,20,16384
s_waitcnt lgkmcnt(8)
ze 64,60,40,64
zc 58,20,24576
zg 32,16,6144
ze 80,64,40,80
ze 96,68,40,96
ze 112,72,40,112
s_waitcnt lgkmcnt(7)
ze 0,44,28,0
zg 36,16,3072
zc 60,17,20480
s_waitcnt lgkmcnt(7)
ze 16,48,28,16
zc 62,17,28672
zc 64,18,20480
s_waitcnt lgkmcnt(7)
ze 32,52,28,32
zc 66,18,28672
zc 68,19,20480
s_waitcnt lgkmcnt(7)
ze 48,56,28,48
zc 70,19,28672
zc 72,20,20480
s_waitcnt lgkmcnt(8)
ze 64,44,32,64
zc 74,20,28672
zg 40,16,7168
ze 80,48,32,80
ze 96,52,32,96
ze 112,56,32,112
s_waitcnt vmcnt(12) lgkmcnt(0)
s_barrier
zay 44
ze 0,60,36,0
zk 8,33
zg 28,16,16384
zc 44,17,32768
zf 45,98304
ze 16,64,36,16
zl 4,32
zc 46,17,40960
zc 48,18,32768
zf 44,1024
ze 32,68,36,32
zk 9,33
zc 50,18,40960
zc 52,19,32768
ze 48,72,36,48
zc 54,19,40960
zc 56,20,32768
ze 64,60,40,64
zc 58,20,40960
zg 32,16,20480
ze 80,64,40,80
ze 96,68,40,96
ze 112,72,40,112
s_waitcnt lgkmcnt(7)
zf 45,99328
ze 0,44,28,0
zl 5,32
zg 36,16,17408
zc 60,17,36864
s_waitcnt lgkmcnt(7)
zf 44,2048
ze 16,48,28,16
zk 10,33
zc 62,17,45056
zc 64,18,36864
s_waitcnt lgkmcnt(7)
zf 45,100352
ze 32,52,28,32
zl 6,32
zc 66,18,45056
zc 68,19,36864
s_waitcnt lgkmcnt(7)
ze 48,56,28,48
zc 70,19,45056
zc 72,20,36864
s_waitcnt lgkmcnt(8)
ze 64,44,32,64
zc 74,20,45056
zg 40,16,21504
ze 80,48,32,80
ze 96,52,32,96
ze 112,56,32,112
s_waitcnt lgkmcnt(7)
zf 44,3072
ze 0,60,36,0
zk 11,33
zg 28,16,18432
zc 44,17,49152
s_waitcnt lgkmcnt(7)
zf 45,101376
ze 16,64,36,16
zl 7,32
zc 46,17,57344
zc 48,18,49152
s_waitcnt lgkmcnt(7)
zf 44,4096
ze 32,68,36,32
zk 12,33
zc 50,18,57344
zc 52,19,49152
s_waitcnt lgkmcnt(7)
ze 48,72,36,48
zc 54,19,57344
zc 56,20,49152
s_waitcnt lgkmcnt(8)
ze 64,60,40,64
zc 58,20,57344
zg 32,16,22528
ze 80,64,40,80
ze 96,68,40,96
ze 112,72,40,112
s_waitcnt lgkmcnt(7)
zf 44,5120
ze 0,44,28,0
zk 13,33
zg 36,16,19456
zc 60,17,53248
s_waitcnt lgkmcnt(7)
zf 44,6144
ze 16,48,28,16
zk 14,33
zc 62,17,61440
zc 64,18,53248
s_waitcnt lgkmcnt(7)
zf 44,7168
ze 32,52,28,32
zk 15,33
zc 66,18,61440
zc 68,19,53248
s_waitcnt lgkmcnt(7)
ze 48,56,28,48
zc 70,19,61440
zc 72,20,53248
s_waitcnt lgkmcnt(8)
ze 64,44,32,64
zc 74,20,61440
zg 40,16,23552
ze 80,48,32,80
ze 96,52,32,96
ze 112,56,32,112
zi 32,32,35
zi 33,33,36
s_sub_u32 s34, s34, 4
ob_loop_183:
s_waitcnt vmcnt(12) lgkmcnt(0)
s_barrier
zf 44,32768
ze 0,60,36,0
zk 8,33
zg 28,16,32768
zc 44,21,0
zf 45,114688
ze 16,64,36,16
zl 4,32
zc 46,21,8192
zc 48,22,0
zf 44,33792
ze 32,68,36,32
zk 9,33
zc 50,22,8192
zc 52,23,0
ze 48,72,36,48
zc 54,23,8192
zc 56,24,0
ze 64,60,40,64
zc 58,24,8192
zg 32,16,36864
ze 80,64,40,80
ze 96,68,40,96
ze 112,72,40,112
s_waitcnt lgkmcnt(7)
zf 45,115712
ze 0,44,28,0
zl 5,32
zg 36,16,33792
zc 60,21,4096
s_waitcnt lgkmcnt(7)
zf 44,34816
ze 16,48,28,16
zk 10,33
zc 62,21,12288
zc 64,22,4096
s_waitcnt lgkmcnt(7)
zf 45,116736
ze 32,52,28,32
zl 6,32
zc 66,22,12288
zc 68,23,4096
s_waitcnt lgkmcnt(7)
ze 48,56,28,48
zc 70,23,12288
zc 72,24,4096
s_waitcnt lgkmcnt(8)
ze 64,44,32,64
zc 74,24,12288
zg 40,16,37888
ze 80,48,32,80
ze 96,52,32,96
ze 112,56,32,112
s_waitcnt lgkmcnt(7)
zf 44,35840
ze 0,60,36,0
zk 11,33
zg 28,16,34816
zc 44,21,16384
s_waitcnt lgkmcnt(7)
zf 45,117760
ze 16,64,36,16
zl 7,32
zc 46,21,24576
zc 48,22,16384
s_waitcnt lgkmcnt(7)
zf 44,36864
ze 32,68,36,32
zk 12,33
zc 50,22,24576
zc 52,23,16384
s_waitcnt lgkmcnt(7)
ze 48,72,36,48
zc 54,23,24576
zc 56,24,16384
s_waitcnt lgkmcnt(8)
ze 64,60,40,64
zc 58,24,24576
zg 32,16,38912
ze 80,64,40,80
ze 96,68,40,96
ze 112,72,40,112
s_waitcnt lgkmcnt(7)
zf 44,37888
ze 0,44,28,0
zk 13,33
zg 36,16,35840
zc 60,21,20480
s_waitcnt lgkmcnt(7)
zf 44,38912
ze 16,48,28,16
zk 14,33
zc 62,21,28672
zc 64,22,20480
s_waitcnt lgkmcnt(7)
zf 44,39936
ze 32,52,28,32
zk 15,33
zc 66,22,28672
zc 68,23,20480
s_waitcnt lgkmcnt(7)
ze 48,56,28,48
zc 70,23,28672
zc 72,24,20480
s_waitcnt lgkmcnt(8)
ze 64,44,32,64
zc 74,24,28672
zg 40,16,39936
ze 80,48,32,80
ze 96,52,32,96
ze 112,56,32,112
zi 32,32,35
zi 33,33,36
s_waitcnt vmcnt(12) lgkmcnt(0)
s_barrier
zf 44,65536
ze 0,60,36,0
zk 8,33
zg 28,16,0
zc 44,17,0
zf 45,131072
ze 16,64,36,16
zl 4,32
zc 46,17,8192
zc 48,18,0
zf 44,66560
ze 32,68,36,32
zk 9,33
zc 50,18,8192
zc 52,19,0
ze 48,72,36,48
zc 54,19,8192
zc 56,20,0
ze 64,60,40,64
zc 58,20,8192
zg 32,16,4096
ze 80,64,40,80
ze 96,68,40,96
ze 112,72,40,112
s_waitcnt lgkmcnt(7)
zf 45,132096
ze 0,44,28,0
zl 5,32
zg 36,16,1024
zc 60,17,4096
s_waitcnt lgkmcnt(7)
zf 44,67584
ze 16,48,28,16
zk 10,33
zc 62,17,12288
zc 64,18,4096
s_waitcnt lgkmcnt(7)
zf 45,133120
ze 32,52,28,32
zl 6,32
zc 66,18,12288
zc 68,19,4096
s_waitcnt lgkmcnt(7)
ze 48,56,28,48
zc 70,19,12288
zc 72,20,4096
s_waitcnt lgkmcnt(8)
ze 64,44,32,64
zc 74,20,12288
zg 40,16,5120
ze 80,48,32,80
ze 96,52,32,96
ze 112,56,32,112
s_waitcnt lgkmcnt(7)
zf 44,68608
ze 0,60,36,0
zk 11,33
zg 28,16,2048
zc 44,17,16384
s_waitcnt lgkmcnt(7)
zf 45,134144
ze 16,64,36,16
zl 7,32
zc 46,17,24576
zc 48,18,16384
s_waitcnt lgkmcnt(7)
zf 44,69632
ze 32,68,36,32
zk 12,33
zc 50,18,24576
zc 52,19,16384
s_waitcnt lgkmcnt(7)
ze 48,72,36,48
zc 54,19,24576
zc 56,20,16384
s_waitcnt lgkmcnt(8)
ze 64,60,40,64
zc 58,20,24576
zg 32,16,6144
ze 80,64,40,80
ze 96,68,40,96
ze 112,72,40,112
s_waitcnt lgkmcnt(7)
zf 44,70656
ze 0,44,28,0
zk 13,33
zg 36,16,3072
zc 60,17,20480
s_waitcnt lgkmcnt(7)
zf 44,71680
ze 16,48,28,16
zk 14,33
zc 62,17,28672
zc 64,18,20480
s_waitcnt lgkmcnt(7)
zf 44,72704
ze 32,52,28,32
zk 15,33
zc 66,18,28672
zc 68,19,20480
s_waitcnt lgkmcnt(7)
ze 48,56,28,48
zc 70,19,28672
zc 72,20,20480
s_waitcnt lgkmcnt(8)
ze 64,44,32,64
zc 74,20,28672
zg 40,16,7168
ze 80,48,32,80
ze 96,52,32,96
ze 112,56,32,112
zi 32,32,35
zi 33,33,36
s_waitcnt vmcnt(12) lgkmcnt(0)
s_barrier
zay 44
ze 0,60,36,0
zk 8,33
zg 28,16,16384
zc 44,17,32768
zf 45,98304
ze 16,64,36,16
zl 4,32
zc 46,17,40960
zc 48,18,32768
zf 44,1024
ze 32,68,36,32
zk 9,33
zc 50,18,40960
zc 52,19,32768
ze 48,72,36,48
zc 54,19,40960
zc 56,20,32768
ze 64,60,40,64
zc 58,20,40960
zg 32,16,20480
ze 80,64,40,80
ze 96,68,40,96
ze 112,72,40,112
s_waitcnt lgkmcnt(7)
zf 45,99328
ze 0,44,28,0
zl 5,32
zg 36,16,17408
zc 60,17,36864
s_waitcnt lgkmcnt(7)
zf 44,2048
ze 16,48,28,16
zk 10,33
zc 62,17,45056
zc 64,18,36864
s_waitcnt lgkmcnt(7)
zf 45,100352
ze 32,52,28,32
zl 6,32
zc 66,18,45056
zc 68,19,36864
s_waitcnt lgkmcnt(7)
ze 48,56,28,48
zc 70,19,45056
zc 72,20,36864
s_waitcnt lgkmcnt(8)
ze 64,44,32,64
zc 74,20,45056
zg 40,16,21504
ze 80,48,32,80
ze 96,52,32,96
ze 112,56,32,112
s_waitcnt lgkmcnt(7)
zf 44,3072
ze 0,60,36,0
zk 11,33
zg 28,16,18432
zc 44,17,49152
s_waitcnt lgkmcnt(7)
zf 45,101376
ze 16,64,36,16
zl 7,32
zc 46,17,57344
zc 48,18,49152
s_waitcnt lgkmcnt(7)
zf 44,4096
ze 32,68,36,32
zk 12,33
zc 50,18,57344
zc 52,19,49152
s_waitcnt lgkmcnt(7)
ze 48,72,36,48
zc 54,19,57344
zc 56,20,49152
s_waitcnt lgkmcnt(8)
ze 64,60,40,64
zc 58,20,57344
zg 32,16,22528
ze 80,64,40,80
ze 96,68,40,96
ze 112,72,40,112
s_waitcnt lgkmcnt(7)
zf 44,5120
ze 0,44,28,0
zk 13,33
zg 36,16,19456
zc 60,17,53248
s_waitcnt lgkmcnt(7)
zf 44,6144
ze 16,48,28,16
zk 14,33
zc 62,17,61440
zc 64,18,53248
s_waitcnt lgkmcnt(7)
zf 44,7168
ze 32,52,28,32
zk 15,33
zc 66,18,61440
zc 68,19,53248
s_waitcnt lgkmcnt(7)
ze 48,56,28,48
zc 70,19,61440
zc 72,20,53248
s_waitcnt lgkmcnt(8)
ze 64,44,32,64
zc 74,20,61440
zg 40,16,23552
ze 80,48,32,80
ze 96,52,32,96
ze 112,56,32,112
zi 32,32,35
zi 33,33,36
s_sub_u32 s34, s34, 3
s_cmp_lg_u32 s34, 0
s_cbranch_scc1 ob_loop_183
s_waitcnt vmcnt(12) lgkmcnt(0)
s_barrier
ze 0,60,36,0
zg 28,16,32768
zc 44,21,0
ze 16,64,36,16
zc 46,21,8192
zc 48,22,0
ze 32,68,36,32
zc 50,22,8192
zc 52,23,0
ze 48,72,36,48
zc 54,23,8192
zc 56,24,0
ze 64,60,40,64
zc 58,24,8192
zg 32,16,36864
ze 80,64,40,80
ze 96,68,40,96
ze 112,72,40,112
s_waitcnt lgkmcnt(7)
ze 0,44,28,0
zg 36,16,33792
zc 60,21,4096
s_waitcnt lgkmcnt(7)
ze 16,48,28,16
zc 62,21,12288
zc 64,22,4096
s_waitcnt lgkmcnt(7)
ze 32,52,28,32
zc 66,22,12288
zc 68,23,4096
s_waitcnt lgkmcnt(7)
ze 48,56,28,48
zc 70,23,12288
zc 72,24,4096
s_waitcnt lgkmcnt(8)
ze 64,44,32,64
zc 74,24,12288
zg 40,16,37888
ze 80,48,32,80
ze 96,52,32,96
ze 112,56,32,112
s_waitcnt lgkmcnt(7)
ze 0,60,36,0
zg 28,16,34816
zc 44,21,16384
s_waitcnt lgkmcnt(7)
ze 16,64,36,16
zc 46,21,24576
zc 48,22,16384
s_waitcnt lgkmcnt(7)
ze 32,68,36,32
zc 50,22,24576
zc 52,23,16384
s_waitcnt lgkmcnt(7)
ze 48,72,36,48
zc 54,23,24576
zc 56,24,16384
s_waitcnt lgkmcnt(8)
ze 64,60,40,64
zc 58,24,24576
zg 32,16,38912
ze 80,64,40,80
ze 96,68,40,96
ze 112,72,40,112
s_waitcnt lgkmcnt(7)
ze 0,44,28,0
zg 36,16,35840
zc 60,21,20480
s_waitcnt lgkmcnt(7)
ze 16,48,28,16
zc 62,21,28672
zc 64,22,20480
s_waitcnt lgkmcnt(7)
ze 32,52,28,32
zc 66,22,28672
zc 68,23,20480
s_waitcnt lgkmcnt(7)
ze 48,56,28,48
zc 70,23,28672
zc 72,24,20480
s_waitcnt lgkmcnt(8)
ze 64,44,32,64
zc 74,24,28672
zg 40,16,39936
ze 80,48,32,80
ze 96,52,32,96
ze 112,56,32,112
s_waitcnt vmcnt(0) lgkmcnt(0)
s_barrier
ze 0,60,36,0
zg 28,16,0
zc 44,17,0
ze 16,64,36,16
zc 46,17,8192
zc 48,18,0
ze 32,68,36,32
zc 50,18,8192
zc 52,19,0
ze 48,72,36,48
zc 54,19,8192
zc 56,20,0
ze 64,60,40,64
zc 58,20,8192
zg 32,16,4096
ze 80,64,40,80
ze 96,68,40,96
ze 112,72,40,112
s_waitcnt lgkmcnt(7)
ze 0,44,28,0
zg 36,16,1024
zc 60,17,4096
s_waitcnt lgkmcnt(7)
ze 16,48,28,16
zc 62,17,12288
zc 64,18,4096
s_waitcnt lgkmcnt(7)
ze 32,52,28,32
zc 66,18,12288
zc 68,19,4096
s_waitcnt lgkmcnt(7)
ze 48,56,28,48
zc 70,19,12288
zc 72,20,4096
s_waitcnt lgkmcnt(8)
ze 64,44,32,64
zc 74,20,12288
zg 40,16,5120
ze 80,48,32,80
ze 96,52,32,96
ze 112,56,32,112
s_waitcnt lgkmcnt(7)
ze 0,60,36,0
zg 28,16,2048
zc 44,17,16384
s_waitcnt lgkmcnt(7)
ze 16,64,36,16
zc 46,17,24576
zc 48,18,16384
s_waitcnt lgkmcnt(7)
ze 32,68,36,32
zc 50,18,24576
zc 52,19,16384
s_waitcnt lgkmcnt(7)
ze 48,72,36,48
zc 54,19,24576
zc 56,20,16384
s_waitcnt lgkmcnt(8)
ze 64,60,40,64
zc 58,20,24576
zg 32,16,6144
ze 80,64,40,80
ze 96,68,40,96
ze 112,72,40,112
s_waitcnt lgkmcnt(7)
ze 0,44,28,0
zg 36,16,3072
zc 60,17,20480
s_waitcnt lgkmcnt(7)
ze 16,48,28,16
zc 62,17,28672
zc 64,18,20480
s_waitcnt lgkmcnt(7)
ze 32,52,28,32
zc 66,18,28672
zc 68,19,20480
s_waitcnt lgkmcnt(7)
ze 48,56,28,48
zc 70,19,28672
zc 72,20,20480
s_waitcnt lgkmcnt(8)
ze 64,44,32,64
zc 74,20,28672
zg 40,16,7168
ze 80,48,32,80
ze 96,52,32,96
ze 112,56,32,112
s_waitcnt lgkmcnt(7)
ze 0,60,36,0
s_waitcnt lgkmcnt(5)
ze 16,64,36,16
s_waitcnt lgkmcnt(3)
ze 32,68,36,32
s_waitcnt lgkmcnt(1)
ze 48,72,36,48
s_waitcnt lgkmcnt(0)
ze 64,60,40,64
ze 80,64,40,80
ze 96,68,40,96
ze 112,72,40,112
v_and_b32 v120, 31, v1
v_mul_lo_u32 v120, v120, s41
v_lshrrev_b32 v121, 5, v1
v_lshl_add_u32 v120, v121, 4, v120
s_mov_b32 s39, 0
s_mov_b32 s40, s39
zb 76,0
zb 77,1
zb 78,2
zb 79,3
zb 80,4
zb 81,5
zb 82,6
zb 83,7
zd 116,76,77
zd 117,78,79
zd 118,80,81
zd 119,82,83
zas 116,120,40,0
zb 84,8
zb 85,9
zb 86,10
zb 87,11
zb 88,12
zb 89,13
zb 90,14
zb 91,15
zd 108,84,85
zd 109,86,87
zd 110,88,89
zd 111,90,91
zas 108,120,40,32
zi 40,40,38
zb 92,16
zb 93,17
zb 94,18
zb 95,19
zb 96,20
zb 97,21
zb 98,22
zb 99,23
zd 112,92,93
zd 113,94,95
zd 114,96,97
zd 115,98,99
zas 112,120,40,0
zb 100,24
zb 101,25
zb 102,26
zb 103,27
zb 104,28
zb 105,29
zb 106,30
zb 107,31
zd 116,100,101
zd 117,102,103
zd 118,104,105
zd 119,106,107
zas 116,120,40,32
zi 40,40,38
zb 76,32
zb 77,33
zb 78,34
zb 79,35
zb 80,36
zb 81,37
zb 82,38
zb 83,39
zd 108,76,77
zd 109,78,79
zd 110,80,81
zd 111,82,83
zas 108,120,40,0
zb 84,40
zb 85,41
zb 86,42
zb 87,43
zb 88,44
zb 89,45
zb 90,46
zb 91,47
zd 112,84,85
zd 113,86,87
zd 114,88,89
zd 115,90,91
zas 112,120,40,32
zi 40,40,38
zb 92,48
zb 93,49
zb 94,50
zb 95,51
zb 96,52
zb 97,53
zb 98,54
zb 99,55
zd 116,92,93
zd 117,94,95
zd 118,96,97
zd 119,98,99
zas 116,120,40,0
zb 100,56
zb 101,57
zb 102,58
zb 103,59
zb 104,60
zb 105,61
zb 106,62
zb 107,63
zd 108,100,101
zd 109,102,103
zd 110,104,105
zd 111,106,107
zas 108,120,40,32
zi 39,39,37
s_mov_b32 s40, s39
zb 76,64
zb 77,65
zb 78,66
zb 79,67
zb 80,68
zb 81,69
zb 82,70
zb 83,71
zd 112,76,77
zd 113,78,79
zd 114,80,81
zd 115,82,83
zas 112,120,40,0
zb 84,72
zb 85,73
zb 86,74
zb 87,75
zb 88,76
zb 89,77
zb 90,78
zb 91,79
zd 116,84,85
zd 117,86,87
zd 118,88,89
zd 119,90,91
zas 116,120,40,32
zi 40,40,38
zb 92,80
zb 93,81
zb 94,82
zb 95,83
zb 96,84
zb 97,85
zb 98,86
zb 99,87
zd 108,92,93
zd 109,94,95
zd 110,96,97
zd 111,98,99
zas 108,120,40,0
zb 100,88
zb 101,89
zb 102,90
zb 103,91
zb 104,92
zb 105,93
zb 106,94
zb 107,95
zd 112,100,101
zd 113,102,103
zd 114,104,105
zd 115,106,107
zas 112,120,40,32
zi 40,40,38
zb 76,96
zb 77,97
zb 78,98
zb 79,99
zb 80,100
zb 81,101
zb 82,102
zb 83,103
zd 116,76,77
zd 117,78,79
zd 118,80,81
zd 119,82,83
zas 116,120,40,0
zb 84,104
zb 85,105
zb 86,106
zb 87,107
zb 88,108
zb 89,109
zb 90,110
zb 91,111
zd 108,84,85
zd 109,86,87
zd 110,88,89
zd 111,90,91
zas 108,120,40,32
zi 40,40,38
zb 92,112
zb 93,113
zb 94,114
zb 95,115
zb 96,116
zb 97,117
zb 98,118
zb 99,119
zd 112,92,93
zd 113,94,95
zd 114,96,97
zd 115,98,99
zas 112,120,40,0
zb 100,120
zb 101,121
zb 102,122
zb 103,123
zb 104,124
zb 105,125
zb 106,126
zb 107,127
zd 116,100,101
zd 117,102,103
zd 118,104,105
zd 119,106,107
zas 116,120,40,32
s_getpc_b64 s[20:21]
bk_184:
s_sub_u32 s20, s20, bk_184-task_next
s_subb_u32 s21, s21, 0
s_setpc_b64 s[20:21]
t_outb1:
s_lshl_b32 s48, s47, 7
s_lshl_b32 s47, s46, 7
s_mov_b32 s42, 262144
s_mov_b32 s34, 64
s_mov_b32 s43, 2048
s_mov_b32 s35, 4096
s_mov_b32 s36, 131072
s_lshr_b32 s57, s47, 5
s_mul_i32 s57, s57, 262144
s_min_u32 s57, s57, 16777216
zs 59,57,67108864
zi 20,4,59
s_addc_u32 s21, s5, 0
s_sub_u32 s22, 16777216, s57
s_mov_b32 s23, 0x20000
s_lshl_b32 s57, s48, 1
s_lshr_b32 s59, s3, 1
s_mul_i32 s59, s59, 64
zi 59,59,47
s_lshl_b32 s59, s59, 12
zs 59,59,2048
zi 59,59,57
s_and_b32 s60, s3, 1
s_mul_i32 s60, s60, 128
zi 59,59,60
s_mov_b32 s41, 4096
s_mov_b32 s37, 131072
s_mov_b32 s38, 64
s_min_u32 s57, s57, 8388608
zi 24,84,57
s_addc_u32 s25, s85, 0
s_sub_u32 s26, 8388608, s57
s_mov_b32 s27, 0x20000
s_min_u32 s59, s59, 8388608
zi 28,86,59
s_addc_u32 s29, s87, 0
s_sub_u32 s30, 8388608, s59
s_mov_b32 s31, 0x20000
v_and_b32 v1, 63, v0
v_lshlrev_b32 v96, 4, v1
s_mul_i32 s39, s3, 4
zaz 39,39
s_lshr_b32 s40, s39, 2
s_mul_i32 s40, s40, s42
s_and_b32 s39, s39, 3
s_lshl_b32 s39, s39, 10
zi 39,39,40
v_add_u32 v4, s39, v96
s_mul_i32 s39, s3, 4
zac 39,39
s_lshr_b32 s40, s39, 2
s_mul_i32 s40, s40, s42
s_and_b32 s39, s39, 3
s_lshl_b32 s39, s39, 10
zi 39,39,40
v_add_u32 v5, s39, v96
s_mul_i32 s39, s3, 4
zav 39,39
s_lshr_b32 s40, s39, 2
s_mul_i32 s40, s40, s42
s_and_b32 s39, s39, 3
s_lshl_b32 s39, s39, 10
zi 39,39,40
v_add_u32 v6, s39, v96
s_mul_i32 s39, s3, 4
s_add_u32 s39, s39, 3
s_lshr_b32 s40, s39, 2
s_mul_i32 s40, s40, s42
s_and_b32 s39, s39, 3
s_lshl_b32 s39, s39, 10
zi 39,39,40
v_add_u32 v7, s39, v96
v_lshrrev_b32 v48, 4, v1
v_and_b32 v49, 15, v1
s_lshl_b32 s39, s3, 4
v_add_u32 v50, 0, v48
v_and_b32 v51, 3, v50
v_lshlrev_b32 v51, 2, v51
v_xor_b32 v51, v51, v49
v_add_u32 v50, s39, v50
v_mul_lo_u32 v50, v50, s43
v_lshl_add_u32 v8, v51, 4, v50
v_add_u32 v50, 4, v48
v_and_b32 v51, 3, v50
v_lshlrev_b32 v51, 2, v51
v_xor_b32 v51, v51, v49
v_add_u32 v50, s39, v50
v_mul_lo_u32 v50, v50, s43
v_lshl_add_u32 v9, v51, 4, v50
v_add_u32 v50, 8, v48
v_and_b32 v51, 3, v50
v_lshlrev_b32 v51, 2, v51
v_xor_b32 v51, v51, v49
v_add_u32 v50, s39, v50
v_mul_lo_u32 v50, v50, s43
v_lshl_add_u32 v10, v51, 4, v50
v_add_u32 v50, 12, v48
v_and_b32 v51, 3, v50
v_lshlrev_b32 v51, 2, v51
v_xor_b32 v51, v51, v49
v_add_u32 v50, s39, v50
v_mul_lo_u32 v50, v50, s43
v_lshl_add_u32 v11, v51, 4, v50
s_lshr_b32 s39, s3, 1
s_mul_i32 s39, s39, 8192
zs 39,39,65536
v_add_u32 v12, s39, v96
v_bfe_u32 v48, v1, 2, 2
v_lshrrev_b32 v49, 5, v1
v_mul_u32_u24 v49, 4, v49
v_add_u32 v49, v49, v48
v_mul_u32_u24 v49, 256, v49
v_and_b32 v50, 3, v1
v_and_b32 v51, 1, v50
v_lshrrev_b32 v50, 1, v50
v_lshl_add_u32 v50, v51, 1, v50
v_bfe_u32 v51, v1, 4, 1
v_lshl_add_u32 v50, v51, 2, v50
v_lshl_add_u32 v49, v50, 3, v49
s_and_b32 s39, s3, 1
s_mul_i32 s39, s39, 2
zaz 40,39
v_xor_b32 v50, s40, v48
v_lshl_add_u32 v13, v50, 6, v49
zac 40,39
v_xor_b32 v50, s40, v48
v_lshl_add_u32 v14, v50, 6, v49
s_lshl_b32 s44, s3, 12
s_lshl_b32 s45, s3, 12
s_mov_b32 s32, 0
s_mov_b32 s33, 0
s_barrier
zay 44
s_nop 0
zk 8,33
zf 45,65536
s_nop 0
zl 4,32
zf 44,1024
s_nop 0
zk 9,33
zf 45,66560
s_nop 0
zl 5,32
zf 44,2048
s_nop 0
zk 10,33
zf 45,67584
s_nop 0
zl 6,32
zf 44,3072
s_nop 0
zk 11,33
zf 45,68608
s_nop 0
zl 7,32
zi 32,32,35
zi 33,33,36
zf 44,16384
s_nop 0
zk 8,33
zf 45,81920
s_nop 0
zl 4,32
zf 44,17408
s_nop 0
zk 9,33
zf 45,82944
s_nop 0
zl 5,32
zf 44,18432
s_nop 0
zk 10,33
zf 45,83968
s_nop 0
zl 6,32
zf 44,19456
s_nop 0
zk 11,33
zf 45,84992
s_nop 0
zl 7,32
zi 32,32,35
zi 33,33,36
zf 44,32768
s_nop 0
zk 8,33
zf 45,98304
s_nop 0
zl 4,32
zf 44,33792
s_nop 0
zk 9,33
zf 45,99328
s_nop 0
zl 5,32
zf 44,34816
s_nop 0
zk 10,33
zf 45,100352
s_nop 0
zl 6,32
zf 44,35840
s_nop 0
zk 11,33
zf 45,101376
s_nop 0
zl 7,32
zi 32,32,35
zi 33,33,36
zf 44,49152
s_nop 0
zk 8,33
zf 45,114688
s_nop 0
zl 4,32
zf 44,50176
s_nop 0
zk 9,33
zf 45,115712
s_nop 0
zl 5,32
zf 44,51200
s_nop 0
zk 10,33
zf 45,116736
s_nop 0
zl 6,32
zf 44,52224
s_nop 0
zk 11,33
zf 45,117760
s_nop 0
zl 7,32
zi 32,32,35
zi 33,33,36
s_waitcnt vmcnt(24)
s_barrier
zg 16,12,0
zc 32,13,0
zc 34,13,4096
zc 36,14,0
zc 38,14,4096
zg 20,12,4096
s_waitcnt lgkmcnt(3)
zaw 0,32,16
zg 24,12,1024
zc 40,13,2048
s_waitcnt lgkmcnt(3)
zaw 16,36,16
zc 42,13,6144
zc 44,14,2048
s_waitcnt lgkmcnt(4)
zaw 32,32,20
zc 46,14,6144
zg 28,12,5120
zaw 48,36,20
s_waitcnt lgkmcnt(3)
ze 0,40,24,0
zg 16,12,2048
zc 32,13,8192
s_waitcnt lgkmcnt(3)
ze 16,44,24,16
zc 34,13,12288
zc 36,14,8192
s_waitcnt lgkmcnt(4)
ze 32,40,28,32
zc 38,14,12288
zg 20,12,6144
ze 48,44,28,48
s_waitcnt lgkmcnt(3)
ze 0,32,16,0
zg 24,12,3072
zc 40,13,10240
s_waitcnt lgkmcnt(3)
ze 16,36,16,16
zc 42,13,14336
zc 44,14,10240
s_waitcnt lgkmcnt(4)
ze 32,32,20,32
zc 46,14,14336
zg 28,12,7168
ze 48,36,20,48
s_sub_u32 s34, s34, 4
o1_loop_185:
s_waitcnt vmcnt(16) lgkmcnt(0)
s_barrier
zay 44
ze 0,40,24,0
zk 8,33
zg 16,12,16384
zc 32,13,16384
zf 45,65536
ze 16,44,24,16
zl 4,32
zc 34,13,20480
zc 36,14,16384
ze 32,40,28,32
zc 38,14,20480
zg 20,12,20480
ze 48,44,28,48
s_waitcnt lgkmcnt(3)
zf 44,1024
ze 0,32,16,0
zk 9,33
zg 24,12,17408
zc 40,13,18432
s_waitcnt lgkmcnt(3)
zf 45,66560
ze 16,36,16,16
zl 5,32
zc 42,13,22528
zc 44,14,18432
s_waitcnt lgkmcnt(4)
ze 32,32,20,32
zc 46,14,22528
zg 28,12,21504
ze 48,36,20,48
s_waitcnt lgkmcnt(3)
zf 44,2048
ze 0,40,24,0
zk 10,33
zg 16,12,18432
zc 32,13,24576
s_waitcnt lgkmcnt(3)
zf 45,67584
ze 16,44,24,16
zl 6,32
zc 34,13,28672
zc 36,14,24576
s_waitcnt lgkmcnt(4)
ze 32,40,28,32
zc 38,14,28672
zg 20,12,22528
ze 48,44,28,48
s_waitcnt lgkmcnt(3)
zf 44,3072
ze 0,32,16,0
zk 11,33
zg 24,12,19456
zc 40,13,26624
s_waitcnt lgkmcnt(3)
zf 45,68608
ze 16,36,16,16
zl 7,32
zc 42,13,30720
zc 44,14,26624
s_waitcnt lgkmcnt(4)
ze 32,32,20,32
zc 46,14,30720
zg 28,12,23552
ze 48,36,20,48
zi 32,32,35
zi 33,33,36
s_waitcnt vmcnt(16) lgkmcnt(0)
s_barrier
zf 44,16384
ze 0,40,24,0
zk 8,33
zg 16,12,32768
zc 32,13,32768
zf 45,81920
ze 16,44,24,16
zl 4,32
zc 34,13,36864
zc 36,14,32768
ze 32,40,28,32
zc 38,14,36864
zg 20,12,36864
ze 48,44,28,48
s_waitcnt lgkmcnt(3)
zf 44,17408
ze 0,32,16,0
zk 9,33
zg 24,12,33792
zc 40,13,34816
s_waitcnt lgkmcnt(3)
zf 45,82944
ze 16,36,16,16
zl 5,32
zc 42,13,38912
zc 44,14,34816
s_waitcnt lgkmcnt(4)
ze 32,32,20,32
zc 46,14,38912
zg 28,12,37888
ze 48,36,20,48
s_waitcnt lgkmcnt(3)
zf 44,18432
ze 0,40,24,0
zk 10,33
zg 16,12,34816
zc 32,13,40960
s_waitcnt lgkmcnt(3)
zf 45,83968
ze 16,44,24,16
zl 6,32
zc 34,13,45056
zc 36,14,40960
s_waitcnt lgkmcnt(4)
ze 32,40,28,32
zc 38,14,45056
zg 20,12,38912
ze 48,44,28,48
s_waitcnt lgkmcnt(3)
zf 44,19456
ze 0,32,16,0
zk 11,33
zg 24,12,35840
zc 40,13,43008
s_waitcnt lgkmcnt(3)
zf 45,84992
ze 16,36,16,16
zl 7,32
zc 42,13,47104
zc 44,14,43008
s_waitcnt lgkmcnt(4)
ze 32,32,20,32
zc 46,14,47104
zg 28,12,39936
ze 48,36,20,48
zi 32,32,35
zi 33,33,36
s_waitcnt vmcnt(16) lgkmcnt(0)
s_barrier
zf 44,32768
ze 0,40,24,0
zk 8,33
zg 16,12,49152
zc 32,13,49152
zf 45,98304
ze 16,44,24,16
zl 4,32
zc 34,13,53248
zc 36,14,49152
ze 32,40,28,32
zc 38,14,53248
zg 20,12,53248
ze 48,44,28,48
s_waitcnt lgkmcnt(3)
zf 44,33792
ze 0,32,16,0
zk 9,33
zg 24,12,50176
zc 40,13,51200
s_waitcnt lgkmcnt(3)
zf 45,99328
ze 16,36,16,16
zl 5,32
zc 42,13,55296
zc 44,14,51200
s_waitcnt lgkmcnt(4)
ze 32,32,20,32
zc 46,14,55296
zg 28,12,54272
ze 48,36,20,48
s_waitcnt lgkmcnt(3)
zf 44,34816
ze 0,40,24,0
zk 10,33
zg 16,12,51200
zc 32,13,57344
s_waitcnt lgkmcnt(3)
zf 45,100352
ze 16,44,24,16
zl 6,32
zc 34,13,61440
zc 36,14,57344
s_waitcnt lgkmcnt(4)
ze 32,40,28,32
zc 38,14,61440
zg 20,12,55296
ze 48,44,28,48
s_waitcnt lgkmcnt(3)
zf 44,35840
ze 0,32,16,0
zk 11,33
zg 24,12,52224
zc 40,13,59392
s_waitcnt lgkmcnt(3)
zf 45,101376
ze 16,36,16,16
zl 7,32
zc 42,13,63488
zc 44,14,59392
s_waitcnt lgkmcnt(4)
ze 32,32,20,32
zc 46,14,63488
zg 28,12,56320
ze 48,36,20,48
zi 32,32,35
zi 33,33,36
s_waitcnt vmcnt(16) lgkmcnt(0)
s_barrier
zf 44,49152
ze 0,40,24,0
zk 8,33
zg 16,12,0
zc 32,13,0
zf 45,114688
ze 16,44,24,16
zl 4,32
zc 34,13,4096
zc 36,14,0
ze 32,40,28,32
zc 38,14,4096
zg 20,12,4096
ze 48,44,28,48
s_waitcnt lgkmcnt(3)
zf 44,50176
ze 0,32,16,0
zk 9,33
zg 24,12,1024
zc 40,13,2048
s_waitcnt lgkmcnt(3)
zf 45,115712
ze 16,36,16,16
zl 5,32
zc 42,13,6144
zc 44,14,2048
s_waitcnt lgkmcnt(4)
ze 32,32,20,32
zc 46,14,6144
zg 28,12,5120
ze 48,36,20,48
s_waitcnt lgkmcnt(3)
zf 44,51200
ze 0,40,24,0
zk 10,33
zg 16,12,2048
zc 32,13,8192
s_waitcnt lgkmcnt(3)
zf 45,116736
ze 16,44,24,16
zl 6,32
zc 34,13,12288
zc 36,14,8192
s_waitcnt lgkmcnt(4)
ze 32,40,28,32
zc 38,14,12288
zg 20,12,6144
ze 48,44,28,48
s_waitcnt lgkmcnt(3)
zf 44,52224
ze 0,32,16,0
zk 11,33
zg 24,12,3072
zc 40,13,10240
s_waitcnt lgkmcnt(3)
zf 45,117760
ze 16,36,16,16
zl 7,32
zc 42,13,14336
zc 44,14,10240
s_waitcnt lgkmcnt(4)
ze 32,32,20,32
zc 46,14,14336
zg 28,12,7168
ze 48,36,20,48
zi 32,32,35
zi 33,33,36
s_sub_u32 s34, s34, 4
s_cmp_lg_u32 s34, 0
s_cbranch_scc1 o1_loop_185
s_waitcnt vmcnt(16) lgkmcnt(0)
s_barrier
ze 0,40,24,0
zg 16,12,16384
zc 32,13,16384
ze 16,44,24,16
zc 34,13,20480
zc 36,14,16384
ze 32,40,28,32
zc 38,14,20480
zg 20,12,20480
ze 48,44,28,48
s_waitcnt lgkmcnt(3)
ze 0,32,16,0
zg 24,12,17408
zc 40,13,18432
s_waitcnt lgkmcnt(3)
ze 16,36,16,16
zc 42,13,22528
zc 44,14,18432
s_waitcnt lgkmcnt(4)
ze 32,32,20,32
zc 46,14,22528
zg 28,12,21504
ze 48,36,20,48
s_waitcnt lgkmcnt(3)
ze 0,40,24,0
zg 16,12,18432
zc 32,13,24576
s_waitcnt lgkmcnt(3)
ze 16,44,24,16
zc 34,13,28672
zc 36,14,24576
s_waitcnt lgkmcnt(4)
ze 32,40,28,32
zc 38,14,28672
zg 20,12,22528
ze 48,44,28,48
s_waitcnt lgkmcnt(3)
ze 0,32,16,0
zg 24,12,19456
zc 40,13,26624
s_waitcnt lgkmcnt(3)
ze 16,36,16,16
zc 42,13,30720
zc 44,14,26624
s_waitcnt lgkmcnt(4)
ze 32,32,20,32
zc 46,14,30720
zg 28,12,23552
ze 48,36,20,48
s_waitcnt vmcnt(8) lgkmcnt(0)
s_barrier
ze 0,40,24,0
zg 16,12,32768
zc 32,13,32768
ze 16,44,24,16
zc 34,13,36864
zc 36,14,32768
ze 32,40,28,32
zc 38,14,36864
zg 20,12,36864
ze 48,44,28,48
s_waitcnt lgkmcnt(3)
ze 0,32,16,0
zg 24,12,33792
zc 40,13,34816
s_waitcnt lgkmcnt(3)
ze 16,36,16,16
zc 42,13,38912
zc 44,14,34816
s_waitcnt lgkmcnt(4)
ze 32,32,20,32
zc 46,14,38912
zg 28,12,37888
ze 48,36,20,48
s_waitcnt lgkmcnt(3)
ze 0,40,24,0
zg 16,12,34816
zc 32,13,40960
s_waitcnt lgkmcnt(3)
ze 16,44,24,16
zc 34,13,45056
zc 36,14,40960
s_waitcnt lgkmcnt(4)
ze 32,40,28,32
zc 38,14,45056
zg 20,12,38912
ze 48,44,28,48
s_waitcnt lgkmcnt(3)
ze 0,32,16,0
zg 24,12,35840
zc 40,13,43008
s_waitcnt lgkmcnt(3)
ze 16,36,16,16
zc 42,13,47104
zc 44,14,43008
s_waitcnt lgkmcnt(4)
ze 32,32,20,32
zc 46,14,47104
zg 28,12,39936
ze 48,36,20,48
s_waitcnt vmcnt(0) lgkmcnt(0)
s_barrier
ze 0,40,24,0
zg 16,12,49152
zc 32,13,49152
ze 16,44,24,16
zc 34,13,53248
zc 36,14,49152
ze 32,40,28,32
zc 38,14,53248
zg 20,12,53248
ze 48,44,28,48
s_waitcnt lgkmcnt(3)
ze 0,32,16,0
zg 24,12,50176
zc 40,13,51200
s_waitcnt lgkmcnt(3)
ze 16,36,16,16
zc 42,13,55296
zc 44,14,51200
s_waitcnt lgkmcnt(4)
ze 32,32,20,32
zc 46,14,55296
zg 28,12,54272
ze 48,36,20,48
s_waitcnt lgkmcnt(3)
ze 0,40,24,0
zg 16,12,51200
zc 32,13,57344
s_waitcnt lgkmcnt(3)
ze 16,44,24,16
zc 34,13,61440
zc 36,14,57344
s_waitcnt lgkmcnt(4)
ze 32,40,28,32
zc 38,14,61440
zg 20,12,55296
ze 48,44,28,48
s_waitcnt lgkmcnt(3)
ze 0,32,16,0
zg 24,12,52224
zc 40,13,59392
s_waitcnt lgkmcnt(3)
ze 16,36,16,16
zc 42,13,63488
zc 44,14,59392
s_waitcnt lgkmcnt(4)
ze 32,32,20,32
zc 46,14,63488
zg 28,12,56320
ze 48,36,20,48
s_waitcnt lgkmcnt(3)
ze 0,40,24,0
s_waitcnt lgkmcnt(1)
ze 16,44,24,16
s_waitcnt lgkmcnt(0)
ze 32,40,28,32
ze 48,44,28,48
v_and_b32 v92, 31, v1
v_mul_lo_u32 v92, v92, s41
v_lshrrev_b32 v93, 5, v1
v_lshl_add_u32 v92, v93, 4, v92
s_mov_b32 s39, 0
s_mov_b32 s40, s39
zb 48,0
zb 49,1
zb 50,2
zb 51,3
zb 52,4
zb 53,5
zb 54,6
zb 55,7
zd 88,48,49
zd 89,50,51
zd 90,52,53
zd 91,54,55
zas 88,92,40,0
zb 56,8
zb 57,9
zb 58,10
zb 59,11
zb 60,12
zb 61,13
zb 62,14
zb 63,15
zd 80,56,57
zd 81,58,59
zd 82,60,61
zd 83,62,63
zas 80,92,40,32
zi 40,40,38
zb 64,16
zb 65,17
zb 66,18
zb 67,19
zb 68,20
zb 69,21
zb 70,22
zb 71,23
zd 84,64,65
zd 85,66,67
zd 86,68,69
zd 87,70,71
zas 84,92,40,0
zb 72,24
zb 73,25
zb 74,26
zb 75,27
zb 76,28
zb 77,29
zb 78,30
zb 79,31
zd 88,72,73
zd 89,74,75
zd 90,76,77
zd 91,78,79
zas 88,92,40,32
zi 39,39,37
s_mov_b32 s40, s39
zb 48,32
zb 49,33
zb 50,34
zb 51,35
zb 52,36
zb 53,37
zb 54,38
zb 55,39
zd 80,48,49
zd 81,50,51
zd 82,52,53
zd 83,54,55
zas 80,92,40,0
zb 56,40
zb 57,41
zb 58,42
zb 59,43
zb 60,44
zb 61,45
zb 62,46
zb 63,47
zd 84,56,57
zd 85,58,59
zd 86,60,61
zd 87,62,63
zas 84,92,40,32
zi 40,40,38
zb 64,48
zb 65,49
zb 66,50
zb 67,51
zb 68,52
zb 69,53
zb 70,54
zb 71,55
zd 88,64,65
zd 89,66,67
zd 90,68,69
zd 91,70,71
zas 88,92,40,0
zb 72,56
zb 73,57
zb 74,58
zb 75,59
zb 76,60
zb 77,61
zb 78,62
zb 79,63
zd 80,72,73
zd 81,74,75
zd 82,76,77
zd 83,78,79
zas 80,92,40,32
s_getpc_b64 s[20:21]
bk_186:
s_sub_u32 s20, s20, bk_186-task_next
s_subb_u32 s21, s21, 0
s_setpc_b64 s[20:21]
t_outs:
s_and_b32 s49, s48, 15
s_lshr_b32 s58, s48, 4
s_and_b32 s58, s58, 3
s_sub_u32 s61, s46, 12
s_lshl_b32 s61, s61, 3
zi 61,61,47
s_and_b32 s61, s61, 31
s_lshl_b32 s48, s47, 7
s_lshl_b32 s47, s46, 7
s_mov_b32 s42, 262144
s_mov_b32 s34, 64
s_mov_b32 s43, 2048
s_mov_b32 s35, 4096
s_mov_b32 s36, 131072
s_lshr_b32 s57, s47, 5
s_mul_i32 s57, s57, 262144
s_min_u32 s57, s57, 16777216
zs 59,57,67108864
zi 20,4,59
s_addc_u32 s21, s5, 0
s_sub_u32 s22, 16777216, s57
s_mov_b32 s23, 0x20000
s_lshl_b32 s57, s48, 1
s_lshr_b32 s59, s3, 1
s_mul_i32 s59, s59, 64
zi 59,59,47
s_lshl_b32 s59, s59, 12
zs 59,59,2048
zi 59,59,57
s_and_b32 s60, s3, 1
s_mul_i32 s60, s60, 128
zi 59,59,60
s_mov_b32 s41, 4096
s_mov_b32 s37, 131072
s_mov_b32 s38, 64
s_min_u32 s57, s57, 8388608
zi 24,84,57
s_addc_u32 s25, s85, 0
s_sub_u32 s26, 8388608, s57
s_mov_b32 s27, 0x20000
s_min_u32 s59, s59, 8388608
zi 28,86,59
s_addc_u32 s29, s87, 0
s_sub_u32 s30, 8388608, s59
s_mov_b32 s31, 0x20000
s_lshl_b32 s34, 8, s58
s_lshl_b32 s49, s49, s58
s_lshl_b32 s57, s49, 15
zi 20,20,57
s_addc_u32 s21, s21, 0
s_sub_u32 s22, s22, s57
s_lshl_b32 s57, s49, 20
zi 24,24,57
s_addc_u32 s25, s25, 0
s_sub_u32 s26, s26, s57
v_and_b32 v1, 63, v0
v_lshlrev_b32 v96, 4, v1
s_mul_i32 s39, s3, 4
zaz 39,39
s_lshr_b32 s40, s39, 2
s_mul_i32 s40, s40, s42
s_and_b32 s39, s39, 3
s_lshl_b32 s39, s39, 10
zi 39,39,40
v_add_u32 v4, s39, v96
s_mul_i32 s39, s3, 4
zac 39,39
s_lshr_b32 s40, s39, 2
s_mul_i32 s40, s40, s42
s_and_b32 s39, s39, 3
s_lshl_b32 s39, s39, 10
zi 39,39,40
v_add_u32 v5, s39, v96
s_mul_i32 s39, s3, 4
zav 39,39
s_lshr_b32 s40, s39, 2
s_mul_i32 s40, s40, s42
s_and_b32 s39, s39, 3
s_lshl_b32 s39, s39, 10
zi 39,39,40
v_add_u32 v6, s39, v96
s_mul_i32 s39, s3, 4
s_add_u32 s39, s39, 3
s_lshr_b32 s40, s39, 2
s_mul_i32 s40, s40, s42
s_and_b32 s39, s39, 3
s_lshl_b32 s39, s39, 10
zi 39,39,40
v_add_u32 v7, s39, v96
v_lshrrev_b32 v48, 4, v1
v_and_b32 v49, 15, v1
s_lshl_b32 s39, s3, 4
v_add_u32 v50, 0, v48
v_and_b32 v51, 3, v50
v_lshlrev_b32 v51, 2, v51
v_xor_b32 v51, v51, v49
v_add_u32 v50, s39, v50
v_mul_lo_u32 v50, v50, s43
v_lshl_add_u32 v8, v51, 4, v50
v_add_u32 v50, 4, v48
v_and_b32 v51, 3, v50
v_lshlrev_b32 v51, 2, v51
v_xor_b32 v51, v51, v49
v_add_u32 v50, s39, v50
v_mul_lo_u32 v50, v50, s43
v_lshl_add_u32 v9, v51, 4, v50
v_add_u32 v50, 8, v48
v_and_b32 v51, 3, v50
v_lshlrev_b32 v51, 2, v51
v_xor_b32 v51, v51, v49
v_add_u32 v50, s39, v50
v_mul_lo_u32 v50, v50, s43
v_lshl_add_u32 v10, v51, 4, v50
v_add_u32 v50, 12, v48
v_and_b32 v51, 3, v50
v_lshlrev_b32 v51, 2, v51
v_xor_b32 v51, v51, v49
v_add_u32 v50, s39, v50
v_mul_lo_u32 v50, v50, s43
v_lshl_add_u32 v11, v51, 4, v50
s_lshr_b32 s39, s3, 1
s_mul_i32 s39, s39, 8192
zs 39,39,65536
v_add_u32 v12, s39, v96
v_bfe_u32 v48, v1, 2, 2
v_lshrrev_b32 v49, 5, v1
v_mul_u32_u24 v49, 4, v49
v_add_u32 v49, v49, v48
v_mul_u32_u24 v49, 256, v49
v_and_b32 v50, 3, v1
v_and_b32 v51, 1, v50
v_lshrrev_b32 v50, 1, v50
v_lshl_add_u32 v50, v51, 1, v50
v_bfe_u32 v51, v1, 4, 1
v_lshl_add_u32 v50, v51, 2, v50
v_lshl_add_u32 v49, v50, 3, v49
s_and_b32 s39, s3, 1
s_mul_i32 s39, s39, 2
zaz 40,39
v_xor_b32 v50, s40, v48
v_lshl_add_u32 v13, v50, 6, v49
zac 40,39
v_xor_b32 v50, s40, v48
v_lshl_add_u32 v14, v50, 6, v49
s_lshl_b32 s44, s3, 12
s_lshl_b32 s45, s3, 12
s_mov_b32 s32, 0
s_mov_b32 s33, 0
s_barrier
zay 44
s_nop 0
zk 8,33
zf 44,1024
s_nop 0
zk 9,33
zf 44,2048
s_nop 0
zk 10,33
zf 44,3072
s_nop 0
zk 11,33
zi 33,33,36
zf 44,16384
s_nop 0
zk 8,33
zf 44,17408
s_nop 0
zk 9,33
zf 44,18432
s_nop 0
zk 10,33
zf 44,19456
s_nop 0
zk 11,33
zi 33,33,36
zf 44,32768
s_nop 0
zk 8,33
zf 44,33792
s_nop 0
zk 9,33
zf 44,34816
s_nop 0
zk 10,33
zf 44,35840
s_nop 0
zk 11,33
zi 33,33,36
zf 44,49152
s_nop 0
zk 8,33
zf 44,50176
s_nop 0
zk 9,33
zf 44,51200
s_nop 0
zk 10,33
zf 44,52224
s_nop 0
zk 11,33
zi 33,33,36
s_and_b32 s50, s66, 0xffff
s_cmp_eq_u32 s50, 0xffff
s_cbranch_scc1 wc_187_n
s_cmp_lg_u32 s3, 0
s_cbranch_scc1 wc_187_b
s_lshl_b32 s50, s50, 8
zs 50,50,85983232
s_lshr_b32 s51, s66, 16
zak 2,50
s_mov_b32 s52, 0
s_mov_b64 exec, 1
wc_187_p:
s_cmp_lg_u32 s13, 0
s_cbranch_scc1 wc_187_x
buffer_load_dword v3, v2, s[4:7], 0 offen offset:0 sc1
zac 52,52
s_cmp_ge_u32 s52, 2097152
s_cselect_b32 s13, 1, 0
s_waitcnt vmcnt(0)
v_readfirstlane_b32 s53, v3
s_cmp_lt_u32 s53, s51
s_cbranch_scc1 wc_187_p
wc_187_x:
s_mov_b64 exec, -1
wc_187_b:
s_barrier
wc_187_n:
zf 45,65536
s_nop 0
zl 4,32
zf 45,66560
s_nop 0
zl 5,32
zf 45,67584
s_nop 0
zl 6,32
zf 45,68608
s_nop 0
zl 7,32
zi 32,32,35
zf 45,81920
s_nop 0
zl 4,32
zf 45,82944
s_nop 0
zl 5,32
zf 45,83968
s_nop 0
zl 6,32
zf 45,84992
s_nop 0
zl 7,32
zi 32,32,35
zf 45,98304
s_nop 0
zl 4,32
zf 45,99328
s_nop 0
zl 5,32
zf 45,100352
s_nop 0
zl 6,32
zf 45,101376
s_nop 0
zl 7,32
zi 32,32,35
zf 45,114688
s_nop 0
zl 4,32
zf 45,115712
s_nop 0
zl 5,32
zf 45,116736
s_nop 0
zl 6,32
zf 45,117760
s_nop 0
zl 7,32
zi 32,32,35
s_waitcnt vmcnt(12)
s_barrier
zg 16,12,0
zc 32,13,0
zc 34,13,4096
zc 36,14,0
zc 38,14,4096
zg 20,12,4096
s_waitcnt lgkmcnt(3)
zaw 0,32,16
zg 24,12,1024
zc 40,13,2048
s_waitcnt lgkmcnt(3)
zaw 16,36,16
zc 42,13,6144
zc 44,14,2048
s_waitcnt lgkmcnt(4)
zaw 32,32,20
zc 46,14,6144
zg 28,12,5120
zaw 48,36,20
s_waitcnt lgkmcnt(3)
ze 0,40,24,0
zg 16,12,2048
zc 32,13,8192
s_waitcnt lgkmcnt(3)
ze 16,44,24,16
zc 34,13,12288
zc 36,14,8192
s_waitcnt lgkmcnt(4)
ze 32,40,28,32
zc 38,14,12288
zg 20,12,6144
ze 48,44,28,48
s_waitcnt lgkmcnt(3)
ze 0,32,16,0
zg 24,12,3072
zc 40,13,10240
s_waitcnt lgkmcnt(3)
ze 16,36,16,16
zc 42,13,14336
zc 44,14,10240
s_waitcnt lgkmcnt(4)
ze 32,32,20,32
zc 46,14,14336
zg 28,12,7168
ze 48,36,20,48
s_waitcnt vmcnt(8) lgkmcnt(0)
s_barrier
zay 44
ze 0,40,24,0
zk 8,33
zg 16,12,16384
zc 32,13,16384
zf 45,65536
ze 16,44,24,16
zl 4,32
zc 34,13,20480
zc 36,14,16384
ze 32,40,28,32
zc 38,14,20480
zg 20,12,20480
ze 48,44,28,48
s_waitcnt lgkmcnt(3)
zf 44,1024
ze 0,32,16,0
zk 9,33
zg 24,12,17408
zc 40,13,18432
s_waitcnt lgkmcnt(3)
zf 45,66560
ze 16,36,16,16
zl 5,32
zc 42,13,22528
zc 44,14,18432
s_waitcnt lgkmcnt(4)
ze 32,32,20,32
zc 46,14,22528
zg 28,12,21504
ze 48,36,20,48
s_waitcnt lgkmcnt(3)
zf 44,2048
ze 0,40,24,0
zk 10,33
zg 16,12,18432
zc 32,13,24576
s_waitcnt lgkmcnt(3)
zf 45,67584
ze 16,44,24,16
zl 6,32
zc 34,13,28672
zc 36,14,24576
s_waitcnt lgkmcnt(4)
ze 32,40,28,32
zc 38,14,28672
zg 20,12,22528
ze 48,44,28,48
s_waitcnt lgkmcnt(3)
zf 44,3072
ze 0,32,16,0
zk 11,33
zg 24,12,19456
zc 40,13,26624
s_waitcnt lgkmcnt(3)
zf 45,68608
ze 16,36,16,16
zl 7,32
zc 42,13,30720
zc 44,14,26624
s_waitcnt lgkmcnt(4)
ze 32,32,20,32
zc 46,14,30720
zg 28,12,23552
ze 48,36,20,48
zi 32,32,35
zi 33,33,36
s_waitcnt vmcnt(12) lgkmcnt(0)
s_barrier
zf 44,16384
ze 0,40,24,0
zk 8,33
zg 16,12,32768
zc 32,13,32768
zf 45,81920
ze 16,44,24,16
zl 4,32
zc 34,13,36864
zc 36,14,32768
ze 32,40,28,32
zc 38,14,36864
zg 20,12,36864
ze 48,44,28,48
s_waitcnt lgkmcnt(3)
zf 44,17408
ze 0,32,16,0
zk 9,33
zg 24,12,33792
zc 40,13,34816
s_waitcnt lgkmcnt(3)
zf 45,82944
ze 16,36,16,16
zl 5,32
zc 42,13,38912
zc 44,14,34816
s_waitcnt lgkmcnt(4)
ze 32,32,20,32
zc 46,14,38912
zg 28,12,37888
ze 48,36,20,48
s_waitcnt lgkmcnt(3)
zf 44,18432
ze 0,40,24,0
zk 10,33
zg 16,12,34816
zc 32,13,40960
s_waitcnt lgkmcnt(3)
zf 45,83968
ze 16,44,24,16
zl 6,32
zc 34,13,45056
zc 36,14,40960
s_waitcnt lgkmcnt(4)
ze 32,40,28,32
zc 38,14,45056
zg 20,12,38912
ze 48,44,28,48
s_waitcnt lgkmcnt(3)
zf 44,19456
ze 0,32,16,0
zk 11,33
zg 24,12,35840
zc 40,13,43008
s_waitcnt lgkmcnt(3)
zf 45,84992
ze 16,36,16,16
zl 7,32
zc 42,13,47104
zc 44,14,43008
s_waitcnt lgkmcnt(4)
ze 32,32,20,32
zc 46,14,47104
zg 28,12,39936
ze 48,36,20,48
zi 32,32,35
zi 33,33,36
s_waitcnt vmcnt(16) lgkmcnt(0)
s_barrier
zf 44,32768
ze 0,40,24,0
zk 8,33
zg 16,12,49152
zc 32,13,49152
zf 45,98304
ze 16,44,24,16
zl 4,32
zc 34,13,53248
zc 36,14,49152
ze 32,40,28,32
zc 38,14,53248
zg 20,12,53248
ze 48,44,28,48
s_waitcnt lgkmcnt(3)
zf 44,33792
ze 0,32,16,0
zk 9,33
zg 24,12,50176
zc 40,13,51200
s_waitcnt lgkmcnt(3)
zf 45,99328
ze 16,36,16,16
zl 5,32
zc 42,13,55296
zc 44,14,51200
s_waitcnt lgkmcnt(4)
ze 32,32,20,32
zc 46,14,55296
zg 28,12,54272
ze 48,36,20,48
s_waitcnt lgkmcnt(3)
zf 44,34816
ze 0,40,24,0
zk 10,33
zg 16,12,51200
zc 32,13,57344
s_waitcnt lgkmcnt(3)
zf 45,100352
ze 16,44,24,16
zl 6,32
zc 34,13,61440
zc 36,14,57344
s_waitcnt lgkmcnt(4)
ze 32,40,28,32
zc 38,14,61440
zg 20,12,55296
ze 48,44,28,48
s_waitcnt lgkmcnt(3)
zf 44,35840
ze 0,32,16,0
zk 11,33
zg 24,12,52224
zc 40,13,59392
s_waitcnt lgkmcnt(3)
zf 45,101376
ze 16,36,16,16
zl 7,32
zc 42,13,63488
zc 44,14,59392
s_waitcnt lgkmcnt(4)
ze 32,32,20,32
zc 46,14,63488
zg 28,12,56320
ze 48,36,20,48
zi 32,32,35
zi 33,33,36
s_waitcnt vmcnt(16) lgkmcnt(0)
s_barrier
zf 44,49152
ze 0,40,24,0
zk 8,33
zg 16,12,0
zc 32,13,0
zf 45,114688
ze 16,44,24,16
zl 4,32
zc 34,13,4096
zc 36,14,0
ze 32,40,28,32
zc 38,14,4096
zg 20,12,4096
ze 48,44,28,48
s_waitcnt lgkmcnt(3)
zf 44,50176
ze 0,32,16,0
zk 9,33
zg 24,12,1024
zc 40,13,2048
s_waitcnt lgkmcnt(3)
zf 45,115712
ze 16,36,16,16
zl 5,32
zc 42,13,6144
zc 44,14,2048
s_waitcnt lgkmcnt(4)
ze 32,32,20,32
zc 46,14,6144
zg 28,12,5120
ze 48,36,20,48
s_waitcnt lgkmcnt(3)
zf 44,51200
ze 0,40,24,0
zk 10,33
zg 16,12,2048
zc 32,13,8192
s_waitcnt lgkmcnt(3)
zf 45,116736
ze 16,44,24,16
zl 6,32
zc 34,13,12288
zc 36,14,8192
s_waitcnt lgkmcnt(4)
ze 32,40,28,32
zc 38,14,12288
zg 20,12,6144
ze 48,44,28,48
s_waitcnt lgkmcnt(3)
zf 44,52224
ze 0,32,16,0
zk 11,33
zg 24,12,3072
zc 40,13,10240
s_waitcnt lgkmcnt(3)
zf 45,117760
ze 16,36,16,16
zl 7,32
zc 42,13,14336
zc 44,14,10240
s_waitcnt lgkmcnt(4)
ze 32,32,20,32
zc 46,14,14336
zg 28,12,7168
ze 48,36,20,48
zi 32,32,35
zi 33,33,36
s_sub_u32 s34, s34, 8
s_cmp_eq_u32 s34, 0
s_cbranch_scc1 os_loop_188_x
os_loop_188:
s_waitcnt vmcnt(16) lgkmcnt(0)
s_barrier
zay 44
ze 0,40,24,0
zk 8,33
zg 16,12,16384
zc 32,13,16384
zf 45,65536
ze 16,44,24,16
zl 4,32
zc 34,13,20480
zc 36,14,16384
ze 32,40,28,32
zc 38,14,20480
zg 20,12,20480
ze 48,44,28,48
s_waitcnt lgkmcnt(3)
zf 44,1024
ze 0,32,16,0
zk 9,33
zg 24,12,17408
zc 40,13,18432
s_waitcnt lgkmcnt(3)
zf 45,66560
ze 16,36,16,16
zl 5,32
zc 42,13,22528
zc 44,14,18432
s_waitcnt lgkmcnt(4)
ze 32,32,20,32
zc 46,14,22528
zg 28,12,21504
ze 48,36,20,48
s_waitcnt lgkmcnt(3)
zf 44,2048
ze 0,40,24,0
zk 10,33
zg 16,12,18432
zc 32,13,24576
s_waitcnt lgkmcnt(3)
zf 45,67584
ze 16,44,24,16
zl 6,32
zc 34,13,28672
zc 36,14,24576
s_waitcnt lgkmcnt(4)
ze 32,40,28,32
zc 38,14,28672
zg 20,12,22528
ze 48,44,28,48
s_waitcnt lgkmcnt(3)
zf 44,3072
ze 0,32,16,0
zk 11,33
zg 24,12,19456
zc 40,13,26624
s_waitcnt lgkmcnt(3)
zf 45,68608
ze 16,36,16,16
zl 7,32
zc 42,13,30720
zc 44,14,26624
s_waitcnt lgkmcnt(4)
ze 32,32,20,32
zc 46,14,30720
zg 28,12,23552
ze 48,36,20,48
zi 32,32,35
zi 33,33,36
s_waitcnt vmcnt(16) lgkmcnt(0)
s_barrier
zf 44,16384
ze 0,40,24,0
zk 8,33
zg 16,12,32768
zc 32,13,32768
zf 45,81920
ze 16,44,24,16
zl 4,32
zc 34,13,36864
zc 36,14,32768
ze 32,40,28,32
zc 38,14,36864
zg 20,12,36864
ze 48,44,28,48
s_waitcnt lgkmcnt(3)
zf 44,17408
ze 0,32,16,0
zk 9,33
zg 24,12,33792
zc 40,13,34816
s_waitcnt lgkmcnt(3)
zf 45,82944
ze 16,36,16,16
zl 5,32
zc 42,13,38912
zc 44,14,34816
s_waitcnt lgkmcnt(4)
ze 32,32,20,32
zc 46,14,38912
zg 28,12,37888
ze 48,36,20,48
s_waitcnt lgkmcnt(3)
zf 44,18432
ze 0,40,24,0
zk 10,33
zg 16,12,34816
zc 32,13,40960
s_waitcnt lgkmcnt(3)
zf 45,83968
ze 16,44,24,16
zl 6,32
zc 34,13,45056
zc 36,14,40960
s_waitcnt lgkmcnt(4)
ze 32,40,28,32
zc 38,14,45056
zg 20,12,38912
ze 48,44,28,48
s_waitcnt lgkmcnt(3)
zf 44,19456
ze 0,32,16,0
zk 11,33
zg 24,12,35840
zc 40,13,43008
s_waitcnt lgkmcnt(3)
zf 45,84992
ze 16,36,16,16
zl 7,32
zc 42,13,47104
zc 44,14,43008
s_waitcnt lgkmcnt(4)
ze 32,32,20,32
zc 46,14,47104
zg 28,12,39936
ze 48,36,20,48
zi 32,32,35
zi 33,33,36
s_waitcnt vmcnt(16) lgkmcnt(0)
s_barrier
zf 44,32768
ze 0,40,24,0
zk 8,33
zg 16,12,49152
zc 32,13,49152
zf 45,98304
ze 16,44,24,16
zl 4,32
zc 34,13,53248
zc 36,14,49152
ze 32,40,28,32
zc 38,14,53248
zg 20,12,53248
ze 48,44,28,48
s_waitcnt lgkmcnt(3)
zf 44,33792
ze 0,32,16,0
zk 9,33
zg 24,12,50176
zc 40,13,51200
s_waitcnt lgkmcnt(3)
zf 45,99328
ze 16,36,16,16
zl 5,32
zc 42,13,55296
zc 44,14,51200
s_waitcnt lgkmcnt(4)
ze 32,32,20,32
zc 46,14,55296
zg 28,12,54272
ze 48,36,20,48
s_waitcnt lgkmcnt(3)
zf 44,34816
ze 0,40,24,0
zk 10,33
zg 16,12,51200
zc 32,13,57344
s_waitcnt lgkmcnt(3)
zf 45,100352
ze 16,44,24,16
zl 6,32
zc 34,13,61440
zc 36,14,57344
s_waitcnt lgkmcnt(4)
ze 32,40,28,32
zc 38,14,61440
zg 20,12,55296
ze 48,44,28,48
s_waitcnt lgkmcnt(3)
zf 44,35840
ze 0,32,16,0
zk 11,33
zg 24,12,52224
zc 40,13,59392
s_waitcnt lgkmcnt(3)
zf 45,101376
ze 16,36,16,16
zl 7,32
zc 42,13,63488
zc 44,14,59392
s_waitcnt lgkmcnt(4)
ze 32,32,20,32
zc 46,14,63488
zg 28,12,56320
ze 48,36,20,48
zi 32,32,35
zi 33,33,36
s_waitcnt vmcnt(16) lgkmcnt(0)
s_barrier
zf 44,49152
ze 0,40,24,0
zk 8,33
zg 16,12,0
zc 32,13,0
zf 45,114688
ze 16,44,24,16
zl 4,32
zc 34,13,4096
zc 36,14,0
ze 32,40,28,32
zc 38,14,4096
zg 20,12,4096
ze 48,44,28,48
s_waitcnt lgkmcnt(3)
zf 44,50176
ze 0,32,16,0
zk 9,33
zg 24,12,1024
zc 40,13,2048
s_waitcnt lgkmcnt(3)
zf 45,115712
ze 16,36,16,16
zl 5,32
zc 42,13,6144
zc 44,14,2048
s_waitcnt lgkmcnt(4)
ze 32,32,20,32
zc 46,14,6144
zg 28,12,5120
ze 48,36,20,48
s_waitcnt lgkmcnt(3)
zf 44,51200
ze 0,40,24,0
zk 10,33
zg 16,12,2048
zc 32,13,8192
s_waitcnt lgkmcnt(3)
zf 45,116736
ze 16,44,24,16
zl 6,32
zc 34,13,12288
zc 36,14,8192
s_waitcnt lgkmcnt(4)
ze 32,40,28,32
zc 38,14,12288
zg 20,12,6144
ze 48,44,28,48
s_waitcnt lgkmcnt(3)
zf 44,52224
ze 0,32,16,0
zk 11,33
zg 24,12,3072
zc 40,13,10240
s_waitcnt lgkmcnt(3)
zf 45,117760
ze 16,36,16,16
zl 7,32
zc 42,13,14336
zc 44,14,10240
s_waitcnt lgkmcnt(4)
ze 32,32,20,32
zc 46,14,14336
zg 28,12,7168
ze 48,36,20,48
zi 32,32,35
zi 33,33,36
s_sub_u32 s34, s34, 4
s_cmp_lg_u32 s34, 0
s_cbranch_scc1 os_loop_188
os_loop_188_x:
s_waitcnt vmcnt(16) lgkmcnt(0)
s_barrier
ze 0,40,24,0
zg 16,12,16384
zc 32,13,16384
ze 16,44,24,16
zc 34,13,20480
zc 36,14,16384
ze 32,40,28,32
zc 38,14,20480
zg 20,12,20480
ze 48,44,28,48
s_waitcnt lgkmcnt(3)
ze 0,32,16,0
zg 24,12,17408
zc 40,13,18432
s_waitcnt lgkmcnt(3)
ze 16,36,16,16
zc 42,13,22528
zc 44,14,18432
s_waitcnt lgkmcnt(4)
ze 32,32,20,32
zc 46,14,22528
zg 28,12,21504
ze 48,36,20,48
s_waitcnt lgkmcnt(3)
ze 0,40,24,0
zg 16,12,18432
zc 32,13,24576
s_waitcnt lgkmcnt(3)
ze 16,44,24,16
zc 34,13,28672
zc 36,14,24576
s_waitcnt lgkmcnt(4)
ze 32,40,28,32
zc 38,14,28672
zg 20,12,22528
ze 48,44,28,48
s_waitcnt lgkmcnt(3)
ze 0,32,16,0
zg 24,12,19456
zc 40,13,26624
s_waitcnt lgkmcnt(3)
ze 16,36,16,16
zc 42,13,30720
zc 44,14,26624
s_waitcnt lgkmcnt(4)
ze 32,32,20,32
zc 46,14,30720
zg 28,12,23552
ze 48,36,20,48
s_waitcnt vmcnt(8) lgkmcnt(0)
s_barrier
ze 0,40,24,0
zg 16,12,32768
zc 32,13,32768
ze 16,44,24,16
zc 34,13,36864
zc 36,14,32768
ze 32,40,28,32
zc 38,14,36864
zg 20,12,36864
ze 48,44,28,48
s_waitcnt lgkmcnt(3)
ze 0,32,16,0
zg 24,12,33792
zc 40,13,34816
s_waitcnt lgkmcnt(3)
ze 16,36,16,16
zc 42,13,38912
zc 44,14,34816
s_waitcnt lgkmcnt(4)
ze 32,32,20,32
zc 46,14,38912
zg 28,12,37888
ze 48,36,20,48
s_waitcnt lgkmcnt(3)
ze 0,40,24,0
zg 16,12,34816
zc 32,13,40960
s_waitcnt lgkmcnt(3)
ze 16,44,24,16
zc 34,13,45056
zc 36,14,40960
s_waitcnt lgkmcnt(4)
ze 32,40,28,32
zc 38,14,45056
zg 20,12,38912
ze 48,44,28,48
s_waitcnt lgkmcnt(3)
ze 0,32,16,0
zg 24,12,35840
zc 40,13,43008
s_waitcnt lgkmcnt(3)
ze 16,36,16,16
zc 42,13,47104
zc 44,14,43008
s_waitcnt lgkmcnt(4)
ze 32,32,20,32
zc 46,14,47104
zg 28,12,39936
ze 48,36,20,48
s_waitcnt vmcnt(0) lgkmcnt(0)
s_barrier
ze 0,40,24,0
zg 16,12,49152
zc 32,13,49152
ze 16,44,24,16
zc 34,13,53248
zc 36,14,49152
ze 32,40,28,32
zc 38,14,53248
zg 20,12,53248
ze 48,44,28,48
s_waitcnt lgkmcnt(3)
ze 0,32,16,0
zg 24,12,50176
zc 40,13,51200
s_waitcnt lgkmcnt(3)
ze 16,36,16,16
zc 42,13,55296
zc 44,14,51200
s_waitcnt lgkmcnt(4)
ze 32,32,20,32
zc 46,14,55296
zg 28,12,54272
ze 48,36,20,48
s_waitcnt lgkmcnt(3)
ze 0,40,24,0
zg 16,12,51200
zc 32,13,57344
s_waitcnt lgkmcnt(3)
ze 16,44,24,16
zc 34,13,61440
zc 36,14,57344
s_waitcnt lgkmcnt(4)
ze 32,40,28,32
zc 38,14,61440
zg 20,12,55296
ze 48,44,28,48
s_waitcnt lgkmcnt(3)
ze 0,32,16,0
zg 24,12,52224
zc 40,13,59392
s_waitcnt lgkmcnt(3)
ze 16,36,16,16
zc 42,13,63488
zc 44,14,59392
s_waitcnt lgkmcnt(4)
ze 32,32,20,32
zc 46,14,63488
zg 28,12,56320
ze 48,36,20,48
s_waitcnt lgkmcnt(3)
ze 0,40,24,0
s_waitcnt lgkmcnt(1)
ze 16,44,24,16
s_waitcnt lgkmcnt(0)
ze 32,40,28,32
ze 48,44,28,48
s_lshl_b32 s62, s61, 19
s_lshl_b32 s63, s3, 14
zi 62,62,63
zs 62,62,146800640
s_lshr_b32 s63, s49, s58
s_lshl_b32 s63, s63, 16
zi 63,63,62
s_nop 7
s_nop 7
zbk 0,96,63,0
zbk 4,96,63,1024
zbk 8,96,63,2048
zbk 12,96,63,3072
zs 63,63,4096
zbk 16,96,63,0
zbk 20,96,63,1024
zbk 24,96,63,2048
zbk 28,96,63,3072
zs 63,63,4096
zbk 32,96,63,0
zbk 36,96,63,1024
zbk 40,96,63,2048
zbk 44,96,63,3072
zs 63,63,4096
zbk 48,96,63,0
zbk 52,96,63,1024
zbk 56,96,63,2048
zbk 60,96,63,3072
zs 63,61,65708
s_and_b32 s46, s63, 0xffff
s_cmp_eq_u32 s46, 0xffff
s_cbranch_scc1 sg_189_n
s_waitcnt vmcnt(0)
s_barrier
s_cmp_lg_u32 s3, 0
s_cbranch_scc1 sg_189_n
s_lshl_b32 s46, s46, 8
zs 46,46,85983232
s_lshr_b32 s47, s63, 16
zak 2,46
zak 3,47
s_mov_b64 exec, 1
buffer_atomic_add v3, v2, s[4:7], 0 offen
s_mov_b64 exec, -1
sg_189_n:
s_lshr_b32 s63, 8, s58
s_lshl_b32 s63, s63, 16
zi 63,63,61
zs 63,63,172
s_and_b32 s20, s63, 0xffff
s_cmp_eq_u32 s20, 0xffff
s_cbranch_scc1 wc_190_n
s_cmp_lg_u32 s3, 0
s_cbranch_scc1 wc_190_b
s_lshl_b32 s20, s20, 8
zs 20,20,85983232
s_lshr_b32 s21, s63, 16
zak 2,20
s_mov_b32 s22, 0
s_mov_b64 exec, 1
wc_190_p:
s_cmp_lg_u32 s13, 0
s_cbranch_scc1 wc_190_x
buffer_load_dword v3, v2, s[4:7], 0 offen offset:0 sc1
zac 22,22
s_cmp_ge_u32 s22, 2097152
s_cselect_b32 s13, 1, 0
s_waitcnt vmcnt(0)
v_readfirstlane_b32 s23, v3
s_cmp_lt_u32 s23, s21
s_cbranch_scc1 wc_190_p
wc_190_x:
s_mov_b64 exec, -1
wc_190_b:
s_barrier
wc_190_n:
s_lshl_b32 s63, s49, 11
zi 62,62,63
s_cmp_eq_u32 s58, 0
s_cbranch_scc0 t_red1
zaz 50,62
zp 128,96,50,0
zp 132,96,50,1024
zs 50,62,65536
zp 136,96,50,0
zp 140,96,50,1024
zs 50,62,131072
zp 144,96,50,0
zp 148,96,50,1024
zs 50,62,196608
zp 152,96,50,0
zp 156,96,50,1024
zs 50,62,262144
zp 160,96,50,0
zp 164,96,50,1024
zs 50,62,327680
zp 168,96,50,0
zp 172,96,50,1024
zs 50,62,393216
zp 176,96,50,0
zp 180,96,50,1024
zs 50,62,458752
zp 184,96,50,0
zp 188,96,50,1024
v_and_b32 v92, 31, v1
v_mul_u32_u24 v92, 4096, v92
v_lshrrev_b32 v93, 5, v1
v_lshl_add_u32 v92, v93, 4, v92
s_waitcnt vmcnt(12)
zah 128,128,136
zah 130,130,138
zah 132,132,140
zah 134,134,142
s_waitcnt vmcnt(10)
zah 128,128,144
zah 130,130,146
zah 132,132,148
zah 134,134,150
s_waitcnt vmcnt(8)
zah 128,128,152
zah 130,130,154
zah 132,132,156
zah 134,134,158
s_waitcnt vmcnt(6)
zah 128,128,160
zah 130,130,162
zah 132,132,164
zah 134,134,166
s_waitcnt vmcnt(4)
zah 128,128,168
zah 130,130,170
zah 132,132,172
zah 134,134,174
s_waitcnt vmcnt(2)
zah 128,128,176
zah 130,130,178
zah 132,132,180
zah 134,134,182
s_waitcnt vmcnt(0)
zah 128,128,184
zah 130,130,186
zah 132,132,188
zah 134,134,190
zd 48,128,129
zd 49,130,131
zd 50,132,133
zd 51,134,135
zaz 51,49
s_lshr_b32 s50, s51, 2
s_mul_i32 s50, s50, 131072
s_and_b32 s51, s51, 3
s_lshl_b32 s51, s51, 5
zi 50,50,51
buffer_store_dwordx4 v[48:51], v92, s[28:31], s50 offen
s_getpc_b64 s[20:21]
bk_191:
s_sub_u32 s20, s20, bk_191-task_next
s_subb_u32 s21, s21, 0
s_setpc_b64 s[20:21]
t_red1:
s_cmp_eq_u32 s58, 1
s_cbranch_scc0 t_red2
zaz 50,62
zp 128,96,50,0
zp 132,96,50,1024
zs 50,62,65536
zp 136,96,50,0
zp 140,96,50,1024
zs 50,62,131072
zp 144,96,50,0
zp 148,96,50,1024
zs 50,62,196608
zp 152,96,50,0
zp 156,96,50,1024
zs 50,62,2048
zp 160,96,50,0
zp 164,96,50,1024
zs 50,62,67584
zp 168,96,50,0
zp 172,96,50,1024
zs 50,62,133120
zp 176,96,50,0
zp 180,96,50,1024
zs 50,62,198656
zp 184,96,50,0
zp 188,96,50,1024
v_and_b32 v92, 31, v1
v_mul_u32_u24 v92, 4096, v92
v_lshrrev_b32 v93, 5, v1
v_lshl_add_u32 v92, v93, 4, v92
s_waitcnt vmcnt(12)
zah 128,128,136
zah 130,130,138
zah 132,132,140
zah 134,134,142
s_waitcnt vmcnt(10)
zah 128,128,144
zah 130,130,146
zah 132,132,148
zah 134,134,150
s_waitcnt vmcnt(8)
zah 128,128,152
zah 130,130,154
zah 132,132,156
zah 134,134,158
zd 48,128,129
zd 49,130,131
zd 50,132,133
zd 51,134,135
zaz 51,49
s_lshr_b32 s50, s51, 2
s_mul_i32 s50, s50, 131072
s_and_b32 s51, s51, 3
s_lshl_b32 s51, s51, 5
zi 50,50,51
buffer_store_dwordx4 v[48:51], v92, s[28:31], s50 offen
s_waitcnt vmcnt(5)
zah 160,160,168
zah 162,162,170
zah 164,164,172
zah 166,166,174
s_waitcnt vmcnt(3)
zah 160,160,176
zah 162,162,178
zah 164,164,180
zah 166,166,182
s_waitcnt vmcnt(1)
zah 160,160,184
zah 162,162,186
zah 164,164,188
zah 166,166,190
zd 52,160,161
zd 53,162,163
zd 54,164,165
zd 55,166,167
zac 51,49
s_lshr_b32 s50, s51, 2
s_mul_i32 s50, s50, 131072
s_and_b32 s51, s51, 3
s_lshl_b32 s51, s51, 5
zi 50,50,51
buffer_store_dwordx4 v[52:55], v92, s[28:31], s50 offen
s_getpc_b64 s[20:21]
bk_192:
s_sub_u32 s20, s20, bk_192-task_next
s_subb_u32 s21, s21, 0
s_setpc_b64 s[20:21]
t_red2:
zaz 50,62
zp 128,96,50,0
zp 132,96,50,1024
zs 50,62,65536
zp 136,96,50,0
zp 140,96,50,1024
zs 50,62,2048
zp 144,96,50,0
zp 148,96,50,1024
zs 50,62,67584
zp 152,96,50,0
zp 156,96,50,1024
zs 50,62,4096
zp 160,96,50,0
zp 164,96,50,1024
zs 50,62,69632
zp 168,96,50,0
zp 172,96,50,1024
zs 50,62,6144
zp 176,96,50,0
zp 180,96,50,1024
zs 50,62,71680
zp 184,96,50,0
zp 188,96,50,1024
v_and_b32 v92, 31, v1
v_mul_u32_u24 v92, 4096, v92
v_lshrrev_b32 v93, 5, v1
v_lshl_add_u32 v92, v93, 4, v92
s_waitcnt vmcnt(12)
zah 128,128,136
zah 130,130,138
zah 132,132,140
zah 134,134,142
zd 48,128,129
zd 49,130,131
zd 50,132,133
zd 51,134,135
zaz 51,49
s_lshr_b32 s50, s51, 2
s_mul_i32 s50, s50, 131072
s_and_b32 s51, s51, 3
s_lshl_b32 s51, s51, 5
zi 50,50,51
buffer_store_dwordx4 v[48:51], v92, s[28:31], s50 offen
s_waitcnt vmcnt(9)
zah 144,144,152
zah 146,146,154
zah 148,148,156
zah 150,150,158
zd 52,144,145
zd 53,146,147
zd 54,148,149
zd 55,150,151
zac 51,49
s_lshr_b32 s50, s51, 2
s_mul_i32 s50, s50, 131072
s_and_b32 s51, s51, 3
s_lshl_b32 s51, s51, 5
zi 50,50,51
buffer_store_dwordx4 v[52:55], v92, s[28:31], s50 offen
s_waitcnt vmcnt(6)
zah 160,160,168
zah 162,162,170
zah 164,164,172
zah 166,166,174
zd 56,160,161
zd 57,162,163
zd 58,164,165
zd 59,166,167
zav 51,49
s_lshr_b32 s50, s51, 2
s_mul_i32 s50, s50, 131072
s_and_b32 s51, s51, 3
s_lshl_b32 s51, s51, 5
zi 50,50,51
buffer_store_dwordx4 v[56:59], v92, s[28:31], s50 offen
s_waitcnt vmcnt(3)
zah 176,176,184
zah 178,178,186
zah 180,180,188
zah 182,182,190
zd 60,176,177
zd 61,178,179
zd 62,180,181
zd 63,182,183
s_add_u32 s51, s49, 3
s_lshr_b32 s50, s51, 2
s_mul_i32 s50, s50, 131072
s_and_b32 s51, s51, 3
s_lshl_b32 s51, s51, 5
zi 50,50,51
buffer_store_dwordx4 v[60:63], v92, s[28:31], s50 offen
s_getpc_b64 s[20:21]
bk_193:
s_sub_u32 s20, s20, bk_193-task_next
s_subb_u32 s21, s21, 0
s_setpc_b64 s[20:21]
t_xat:
s_lshl_b32 s46, s46, 2
zi 46,46,3
s_cmp_eq_u32 s48, 1
s_cbranch_scc0 t_xat4
v_and_b32 v1, 63, v0
v_lshrrev_b32 v213, 5, v1
v_bfe_u32 v214, v1, 4, 1
v_and_b32 v215, 15, v1
v_lshlrev_b32 v213, 10, v213
v_lshl_add_u32 v213, v214, 9, v213
v_lshl_add_u32 v228, v215, 4, v213
v_add_u32 v229, 4096, v228
v_lshlrev_b32 v230, 4, v1
v_add_u32 v231, 3072, v230
v_lshlrev_b32 v232, 3, v1
v_add_u32 v232, 1024, v232
v_add_u32 v233, 3072, v232
zax 212,0xff800000
v_cmp_lt_u32 vcc, 31, v1
v_lshrrev_b32 v213, 4, v1
v_lshlrev_b32 v213, 2, v213
v_cndmask_b32 v220, v212, 0, vcc
zq 221,220
zq 222,220
zq 223,220
v_add_u32 v214, 0, v213
v_cmp_le_u32 vcc, v214, v215
s_nop 1
v_cndmask_b32 v224, v212, 0, vcc
v_add_u32 v214, 1, v213
v_cmp_le_u32 vcc, v214, v215
s_nop 1
v_cndmask_b32 v225, v212, 0, vcc
v_add_u32 v214, 2, v213
v_cmp_le_u32 vcc, v214, v215
s_nop 1
v_cndmask_b32 v226, v212, 0, vcc
v_add_u32 v214, 3, v213
v_cmp_le_u32 vcc, v214, v215
s_nop 1
v_cndmask_b32 v227, v212, 0, vcc
s_lshl_b32 s60, s47, 19
s_lshl_b32 s61, s46, 13
zi 60,60,61
zs 50,60,16777216
zs 51,60,33554432
zs 52,60,50331648
s_mul_i32 s60, s46, 196608
s_mul_i32 s61, s47, 6144
zi 60,60,61
zs 53,60,92274688
s_lshl_b32 s60, s46, 18
s_lshl_b32 s61, s47, 13
zi 60,60,61
zs 54,60,67108864
zp 4,228,50,0
zp 20,228,50,256
zp 36,228,51,0
zp 52,228,51,256
zp 8,228,50,2048
zp 24,228,50,2304
zp 40,228,51,2048
zp 56,228,51,2304
zp 12,229,50,0
zp 28,229,50,256
zp 44,229,51,0
zp 60,229,51,256
zp 16,229,50,2048
zp 32,229,50,2304
zp 48,229,51,2048
zp 64,229,51,2304
zp 68,228,52,0
zp 72,228,52,256
zp 76,228,52,2048
zp 80,228,52,2304
zp 84,229,52,0
zp 88,229,52,256
zp 92,229,52,2048
zp 96,229,52,2304
s_and_b32 s56, s66, 0xffff
s_cmp_eq_u32 s56, 0xffff
s_cbranch_scc1 wc_194_n
s_cmp_lg_u32 s3, 0
s_cbranch_scc1 wc_194_b
s_lshl_b32 s56, s56, 8
zs 56,56,85983232
s_lshr_b32 s57, s66, 16
zak 2,56
s_mov_b32 s58, 0
s_mov_b64 exec, 1
wc_194_p:
s_cmp_lg_u32 s13, 0
s_cbranch_scc1 wc_194_x
buffer_load_dword v3, v2, s[4:7], 0 offen offset:0 sc1
zac 58,58
s_cmp_ge_u32 s58, 2097152
s_cselect_b32 s13, 1, 0
s_waitcnt vmcnt(0)
v_readfirstlane_b32 s59, v3
s_cmp_lt_u32 s59, s57
s_cbranch_scc1 wc_194_p
wc_194_x:
s_mov_b64 exec, -1
wc_194_b:
s_barrier
wc_194_n:
zp 100,230,53,0
zp 104,230,53,1536
zp 108,231,53,0
zp 112,231,53,1536
zbn 116,232,53,0
zbn 118,232,53,1536
zbn 120,233,53,0
zbn 122,233,53,1536
zs 50,50,524288
zs 51,51,524288
zs 52,52,524288
zs 53,53,6144
s_waitcnt vmcnt(7)
zv 124,100,4,220
zv 132,100,20,220
zv 128,36,4,224
zab 136,36,20
zv 140,52,20,224
s_waitcnt vmcnt(6)
zv 124,104,8,124
zv 132,104,24,132
zv 128,40,8,128
zv 136,40,24,136
zv 140,56,24,140
s_waitcnt vmcnt(5)
zv 124,108,12,124
zv 132,108,28,132
zv 128,44,12,128
zv 136,44,28,136
zv 140,60,28,140
s_waitcnt vmcnt(4)
zv 124,112,16,124
zv 132,112,32,132
zv 128,48,16,128
zv 136,48,32,136
zv 140,64,32,140
s_nop 7
zw 212,124,125,126
zw 212,127,128,212
zw 212,129,130,212
v_max_f32 v212, v131, v212
zq 213,212
s_nop 1
zu 212,213
v_max_f32 v212, v212, v213
zq 213,212
s_nop 1
zai 212,213
v_max_f32 v212, v212, v213
zad 124,124,212
zad 126,126,212
zad 128,128,212
zad 130,130,212
zj 124,124
zj 125,125
zj 126,126
zj 127,127
zj 128,128
zj 129,129
zj 130,130
zj 131,131
s_nop 0
zm 212,124,125
zm 212,212,126
zm 212,212,127
zm 212,212,128
zm 212,212,129
zm 212,212,130
zm 212,212,131
zq 213,212
s_nop 1
zu 212,213
zm 212,212,213
zq 213,212
s_nop 1
zai 212,213
zm 212,212,213
v_rcp_f32 v212, v212
s_nop 0
zaa 124,124,212
zaa 126,126,212
zaa 128,128,212
zaa 130,130,212
zd 180,128,129
zd 181,130,131
zh 182
zh 183
zd 184,124,125
zd 185,126,127
zh 186
zh 187
zq 216,184
zq 217,185
s_nop 1
zai 216,186
zai 217,187
zw 214,132,133,134
zw 214,135,136,214
zw 214,137,138,214
zw 214,139,140,214
zw 214,141,142,214
v_max_f32 v214, v143, v214
zq 215,214
s_nop 1
zu 214,215
v_max_f32 v214, v214, v215
zq 215,214
s_nop 1
zai 214,215
v_max_f32 v214, v214, v215
zad 132,132,214
zad 134,134,214
zad 136,136,214
zad 138,138,214
zad 140,140,214
zad 142,142,214
zj 132,132
zj 133,133
zj 134,134
zj 135,135
zj 136,136
zj 137,137
zj 138,138
zj 139,139
zj 140,140
zj 141,141
zj 142,142
zj 143,143
s_nop 0
zm 214,132,133
zm 214,214,134
zm 214,214,135
zm 214,214,136
zm 214,214,137
zm 214,214,138
zm 214,214,139
zm 214,214,140
zm 214,214,141
zm 214,214,142
zm 214,214,143
zq 215,214
s_nop 1
zu 214,215
zm 214,214,215
zq 215,214
s_nop 1
zai 214,215
zm 214,214,215
v_rcp_f32 v214, v214
s_nop 0
zaa 132,132,214
zaa 134,134,214
zaa 136,136,214
zaa 138,138,214
zaa 140,140,214
zaa 142,142,214
zd 188,136,137
zd 189,138,139
zd 190,140,141
zd 191,142,143
zd 192,132,133
zd 193,134,135
zh 194
zh 195
zq 216,192
zq 217,193
s_nop 1
zai 216,194
zai 217,195
s_waitcnt vmcnt(0)
s_nop 1
zab 148,68,180
zab 152,72,180
zab 156,76,180
zab 160,80,180
zab 164,84,180
zab 168,88,180
zab 172,92,180
zab 176,96,180
zae 148,116,186,148
zae 152,116,184,152
zae 156,118,186,156
zae 160,118,184,160
zae 164,120,186,164
zae 168,120,184,168
zae 172,122,186,172
zae 176,122,184,176
s_nop 1
zd 196,148,149
zd 197,150,151
zd 198,152,153
zd 199,154,155
zam 196,228,54,0
zd 200,156,157
zd 201,158,159
zd 202,160,161
zd 203,162,163
zam 200,228,54,2048
zd 204,164,165
zd 205,166,167
zd 206,168,169
zd 207,170,171
zam 204,229,54,0
zd 208,172,173
zd 209,174,175
zd 210,176,177
zd 211,178,179
zam 208,229,54,2048
s_nop 1
s_nop 1
zab 148,68,188
zab 152,72,188
zab 156,76,188
zab 160,80,188
zab 164,84,188
zab 168,88,188
zab 172,92,188
zab 176,96,188
zae 148,116,194,148
zae 152,116,192,152
zae 156,118,194,156
zae 160,118,192,160
zae 164,120,194,164
zae 168,120,192,168
zae 172,122,194,172
zae 176,122,192,176
s_nop 1
zd 196,148,149
zd 197,150,151
zd 198,152,153
zd 199,154,155
zam 196,228,54,256
zd 200,156,157
zd 201,158,159
zd 202,160,161
zd 203,162,163
zam 200,228,54,2304
zd 204,164,165
zd 205,166,167
zd 206,168,169
zd 207,170,171
zam 204,229,54,256
zd 208,172,173
zd 209,174,175
zd 210,176,177
zd 211,178,179
zam 208,229,54,2304
s_nop 1
zs 54,54,8192
s_getpc_b64 s[20:21]
bk_195:
s_sub_u32 s20, s20, bk_195-task_next
s_subb_u32 s21, s21, 0
s_setpc_b64 s[20:21]
t_xat4:
v_and_b32 v1, 63, v0
v_lshrrev_b32 v213, 5, v1
v_bfe_u32 v214, v1, 4, 1
v_and_b32 v215, 15, v1
v_lshlrev_b32 v213, 10, v213
v_lshl_add_u32 v213, v214, 9, v213
v_lshl_add_u32 v228, v215, 4, v213
v_add_u32 v229, 4096, v228
v_lshlrev_b32 v230, 4, v1
v_add_u32 v231, 3072, v230
v_lshlrev_b32 v232, 3, v1
v_add_u32 v232, 1024, v232
v_add_u32 v233, 3072, v232
zax 212,0xff800000
v_cmp_lt_u32 vcc, 31, v1
v_lshrrev_b32 v213, 4, v1
v_lshlrev_b32 v213, 2, v213
v_cndmask_b32 v220, v212, 0, vcc
zq 221,220
zq 222,220
zq 223,220
v_add_u32 v214, 0, v213
v_cmp_le_u32 vcc, v214, v215
s_nop 1
v_cndmask_b32 v224, v212, 0, vcc
v_add_u32 v214, 1, v213
v_cmp_le_u32 vcc, v214, v215
s_nop 1
v_cndmask_b32 v225, v212, 0, vcc
v_add_u32 v214, 2, v213
v_cmp_le_u32 vcc, v214, v215
s_nop 1
v_cndmask_b32 v226, v212, 0, vcc
v_add_u32 v214, 3, v213
v_cmp_le_u32 vcc, v214, v215
s_nop 1
v_cndmask_b32 v227, v212, 0, vcc
s_lshl_b32 s60, s47, 19
s_lshl_b32 s61, s46, 13
zi 60,60,61
zs 50,60,16777216
zs 51,60,33554432
zs 52,60,50331648
s_mul_i32 s60, s46, 196608
s_mul_i32 s61, s47, 6144
zi 60,60,61
zs 53,60,92274688
s_lshl_b32 s60, s46, 18
s_lshl_b32 s61, s47, 13
zi 60,60,61
zs 54,60,67108864
zp 4,228,50,0
zp 20,228,50,256
zp 100,230,53,0
zp 36,228,51,0
zp 52,228,51,256
zp 8,228,50,2048
zp 24,228,50,2304
zp 104,230,53,1536
zp 40,228,51,2048
zp 56,228,51,2304
zp 12,229,50,0
zp 28,229,50,256
zp 108,231,53,0
zp 44,229,51,0
zp 60,229,51,256
zp 16,229,50,2048
zp 32,229,50,2304
zp 112,231,53,1536
zp 48,229,51,2048
zp 64,229,51,2304
zp 68,228,52,0
zp 72,228,52,256
zp 76,228,52,2048
zp 80,228,52,2304
zp 84,229,52,0
zp 88,229,52,256
zp 92,229,52,2048
zp 96,229,52,2304
zbn 116,232,53,0
zbn 118,232,53,1536
zbn 120,233,53,0
zbn 122,233,53,1536
zs 50,50,524288
zs 51,51,524288
zs 52,52,524288
zs 53,53,6144
s_waitcnt vmcnt(29)
zv 124,100,4,220
zv 132,100,20,220
s_waitcnt vmcnt(27)
zv 128,36,4,224
zab 136,36,20
zv 140,52,20,224
s_waitcnt vmcnt(24)
zv 124,104,8,124
zv 132,104,24,132
s_waitcnt vmcnt(22)
zv 128,40,8,128
zv 136,40,24,136
zv 140,56,24,140
zaj 0,228,50,0
s_waitcnt vmcnt(20)
zv 124,108,12,124
zv 132,108,28,132
s_waitcnt vmcnt(18)
zv 128,44,12,128
zv 136,44,28,136
zv 140,60,28,140
s_waitcnt vmcnt(15)
zv 124,112,16,124
zv 132,112,32,132
s_waitcnt vmcnt(13)
zv 128,48,16,128
zv 136,48,32,136
zv 140,64,32,140
zaj 16,228,50,256
s_nop 7
zw 212,124,125,126
zw 212,127,128,212
zw 212,129,130,212
v_max_f32 v212, v131, v212
zq 213,212
s_nop 1
zu 212,213
v_max_f32 v212, v212, v213
zq 213,212
s_nop 1
zai 212,213
zaj 96,230,53,0
v_max_f32 v212, v212, v213
zad 124,124,212
zad 126,126,212
zad 128,128,212
zad 130,130,212
zj 124,124
zj 125,125
zj 126,126
zj 127,127
zj 128,128
zj 129,129
zj 130,130
zj 131,131
s_nop 0
zm 212,124,125
zaj 32,228,51,0
zm 212,212,126
zm 212,212,127
zm 212,212,128
zm 212,212,129
zm 212,212,130
zm 212,212,131
zq 213,212
s_nop 1
zu 212,213
zm 212,212,213
zaj 48,228,51,256
zq 213,212
s_nop 1
zai 212,213
zm 212,212,213
v_rcp_f32 v212, v212
s_nop 0
zaa 124,124,212
zaa 126,126,212
zaa 128,128,212
zaa 130,130,212
zaj 4,228,50,2048
zd 180,128,129
zd 181,130,131
zh 182
zh 183
zd 184,124,125
zd 185,126,127
zh 186
zh 187
zq 216,184
zq 217,185
s_nop 1
zai 216,186
zaj 20,228,50,2304
zai 217,187
zw 214,132,133,134
zw 214,135,136,214
zw 214,137,138,214
zw 214,139,140,214
zw 214,141,142,214
v_max_f32 v214, v143, v214
zq 215,214
s_nop 1
zu 214,215
zaj 100,230,53,1536
v_max_f32 v214, v214, v215
zq 215,214
s_nop 1
zai 214,215
v_max_f32 v214, v214, v215
zad 132,132,214
zad 134,134,214
zad 136,136,214
zad 138,138,214
zad 140,140,214
zaj 36,228,51,2048
zad 142,142,214
zj 132,132
zj 133,133
zj 134,134
zj 135,135
zj 136,136
zj 137,137
zj 138,138
zj 139,139
zj 140,140
zj 141,141
zj 142,142
zj 143,143
s_nop 0
zm 214,132,133
zaj 52,228,51,2304
zm 214,214,134
zm 214,214,135
zm 214,214,136
zm 214,214,137
zm 214,214,138
zm 214,214,139
zm 214,214,140
zm 214,214,141
zm 214,214,142
zm 214,214,143
zaj 8,229,50,0
zq 215,214
s_nop 1
zu 214,215
zm 214,214,215
zq 215,214
s_nop 1
zai 214,215
zm 214,214,215
v_rcp_f32 v214, v214
s_nop 0
zaa 132,132,214
zaj 24,229,50,256
zaa 134,134,214
zaa 136,136,214
zaa 138,138,214
zaa 140,140,214
zaa 142,142,214
zd 188,136,137
zd 189,138,139
zd 190,140,141
zd 191,142,143
zd 192,132,133
zaj 104,231,53,0
zd 193,134,135
zh 194
zh 195
zq 216,192
zq 217,193
s_nop 1
zai 216,194
zai 217,195
s_waitcnt vmcnt(13)
s_nop 1
zab 148,68,180
zaj 40,229,51,0
zab 152,72,180
zab 156,76,180
zab 160,80,180
zab 164,84,180
zab 168,88,180
zab 172,92,180
zab 176,96,180
zae 148,116,186,148
zae 152,116,184,152
zae 156,118,186,156
zaj 56,229,51,256
zae 160,118,184,160
zae 164,120,186,164
zae 168,120,184,168
zae 172,122,186,172
zae 176,122,184,176
s_nop 1
zd 196,148,149
zd 197,150,151
zd 198,152,153
zd 199,154,155
zaj 12,229,50,2048
zam 196,228,54,0
zd 200,156,157
zd 201,158,159
zd 202,160,161
zd 203,162,163
zam 200,228,54,2048
zd 204,164,165
zd 205,166,167
zd 206,168,169
zd 207,170,171
zam 204,229,54,0
zd 208,172,173
zd 209,174,175
zaj 28,229,50,2304
zd 210,176,177
zd 211,178,179
zam 208,229,54,2048
s_nop 1
s_nop 1
zab 148,68,188
zab 152,72,188
zab 156,76,188
zab 160,80,188
zab 164,84,188
zab 168,88,188
zaj 108,231,53,1536
zab 172,92,188
zab 176,96,188
zae 148,116,194,148
zae 152,116,192,152
zae 156,118,194,156
zae 160,118,192,160
zae 164,120,194,164
zae 168,120,192,168
zae 172,122,194,172
zae 176,122,192,176
zaj 44,229,51,2048
s_nop 1
zd 196,148,149
zd 197,150,151
zd 198,152,153
zd 199,154,155
zam 196,228,54,256
zd 200,156,157
zd 201,158,159
zd 202,160,161
zd 203,162,163
zam 200,228,54,2304
zd 204,164,165
zaj 60,229,51,2304
zd 205,166,167
zd 206,168,169
zd 207,170,171
zam 204,229,54,256
zd 208,172,173
zd 209,174,175
zd 210,176,177
zd 211,178,179
zam 208,229,54,2304
s_nop 1
zaj 64,228,52,0
zaj 68,228,52,256
zaj 72,228,52,2048
zaj 76,228,52,2304
zaj 80,229,52,0
zaj 84,229,52,256
zaj 88,229,52,2048
zaj 92,229,52,2304
buffer_load_dwordx2 a[112:113], v232, s[4:7], s53 offen offset:0
buffer_load_dwordx2 a[114:115], v232, s[4:7], s53 offen offset:1536
buffer_load_dwordx2 a[116:117], v233, s[4:7], s53 offen offset:0
buffer_load_dwordx2 a[118:119], v233, s[4:7], s53 offen offset:1536
zs 50,50,524288
zs 51,51,524288
zs 52,52,524288
zs 53,53,6144
zs 54,54,8192
s_waitcnt vmcnt(37)
zan 124,96,0,220
zan 132,96,16,220
s_waitcnt vmcnt(35)
zan 128,32,0,224
v_mfma_f32_16x16x32_bf16 v[136:139], a[32:35], a[16:19], 0
zan 140,48,16,224
s_waitcnt vmcnt(32)
zan 124,100,4,124
zan 132,100,20,132
s_waitcnt vmcnt(30)
zan 128,36,4,128
zan 136,36,20,136
zan 140,52,20,140
zp 4,228,50,0
s_waitcnt vmcnt(28)
zan 124,104,8,124
zan 132,104,24,132
s_waitcnt vmcnt(26)
zan 128,40,8,128
zan 136,40,24,136
zan 140,56,24,140
s_waitcnt vmcnt(19)
zan 124,108,12,124
zan 132,108,28,132
s_waitcnt vmcnt(15)
zan 128,44,12,128
zan 136,44,28,136
zan 140,60,28,140
zp 20,228,50,256
s_nop 7
zw 212,124,125,126
zw 212,127,128,212
zw 212,129,130,212
v_max_f32 v212, v131, v212
zq 213,212
s_nop 1
zu 212,213
v_max_f32 v212, v212, v213
zq 213,212
s_nop 1
zai 212,213
zp 100,230,53,0
v_max_f32 v212, v212, v213
zad 124,124,212
zad 126,126,212
zad 128,128,212
zad 130,130,212
zj 124,124
zj 125,125
zj 126,126
zj 127,127
zj 128,128
zj 129,129
zj 130,130
zj 131,131
s_nop 0
zm 212,124,125
zp 36,228,51,0
zm 212,212,126
zm 212,212,127
zm 212,212,128
zm 212,212,129
zm 212,212,130
zm 212,212,131
zq 213,212
s_nop 1
zu 212,213
zm 212,212,213
zp 52,228,51,256
zq 213,212
s_nop 1
zai 212,213
zm 212,212,213
v_rcp_f32 v212, v212
s_nop 0
zaa 124,124,212
zaa 126,126,212
zaa 128,128,212
zaa 130,130,212
zp 8,228,50,2048
zd 180,128,129
zd 181,130,131
zh 182
zh 183
zd 184,124,125
zd 185,126,127
zh 186
zh 187
zq 216,184
zq 217,185
s_nop 1
zai 216,186
zp 24,228,50,2304
zai 217,187
zw 214,132,133,134
zw 214,135,136,214
zw 214,137,138,214
zw 214,139,140,214
zw 214,141,142,214
v_max_f32 v214, v143, v214
zq 215,214
s_nop 1
zu 214,215
zp 104,230,53,1536
v_max_f32 v214, v214, v215
zq 215,214
s_nop 1
zai 214,215
v_max_f32 v214, v214, v215
zad 132,132,214
zad 134,134,214
zad 136,136,214
zad 138,138,214
zad 140,140,214
zp 40,228,51,2048
zad 142,142,214
zj 132,132
zj 133,133
zj 134,134
zj 135,135
zj 136,136
zj 137,137
zj 138,138
zj 139,139
zj 140,140
zj 141,141
zj 142,142
zj 143,143
s_nop 0
zm 214,132,133
zp 56,228,51,2304
zm 214,214,134
zm 214,214,135
zm 214,214,136
zm 214,214,137
zm 214,214,138
zm 214,214,139
zm 214,214,140
zm 214,214,141
zm 214,214,142
zm 214,214,143
zp 12,229,50,0
zq 215,214
s_nop 1
zu 214,215
zm 214,214,215
zq 215,214
s_nop 1
zai 214,215
zm 214,214,215
v_rcp_f32 v214, v214
s_nop 0
zaa 132,132,214
zp 28,229,50,256
zaa 134,134,214
zaa 136,136,214
zaa 138,138,214
zaa 140,140,214
zaa 142,142,214
zd 188,136,137
zd 189,138,139
zd 190,140,141
zd 191,142,143
zd 192,132,133
zp 108,231,53,0
zd 193,134,135
zh 194
zh 195
zq 216,192
zq 217,193
s_nop 1
zai 216,194
zai 217,195
s_waitcnt vmcnt(13)
s_nop 1
zat 148,64,180
zp 44,229,51,0
zat 152,68,180
zat 156,72,180
zat 160,76,180
zat 164,80,180
zat 168,84,180
zat 172,88,180
zat 176,92,180
zau 148,112,186,148
zau 152,112,184,152
zau 156,114,186,156
zp 60,229,51,256
zau 160,114,184,160
zau 164,116,186,164
zau 168,116,184,168
zau 172,118,186,172
zau 176,118,184,176
s_nop 1
zd 196,148,149
zd 197,150,151
zd 198,152,153
zd 199,154,155
zp 16,229,50,2048
zam 196,228,54,0
zd 200,156,157
zd 201,158,159
zd 202,160,161
zd 203,162,163
zam 200,228,54,2048
zd 204,164,165
zd 205,166,167
zd 206,168,169
zd 207,170,171
zam 204,229,54,0
zd 208,172,173
zd 209,174,175
zp 32,229,50,2304
zd 210,176,177
zd 211,178,179
zam 208,229,54,2048
s_nop 1
s_nop 1
zat 148,64,188
zat 152,68,188
zat 156,72,188
zat 160,76,188
zat 164,80,188
zat 168,84,188
zp 112,231,53,1536
zat 172,88,188
zat 176,92,188
zau 148,112,194,148
zau 152,112,192,152
zau 156,114,194,156
zau 160,114,192,160
zau 164,116,194,164
zau 168,116,192,168
zau 172,118,194,172
zau 176,118,192,176
zp 48,229,51,2048
s_nop 1
zd 196,148,149
zd 197,150,151
zd 198,152,153
zd 199,154,155
zam 196,228,54,256
zd 200,156,157
zd 201,158,159
zd 202,160,161
zd 203,162,163
zam 200,228,54,2304
zd 204,164,165
zp 64,229,51,2304
zd 205,166,167
zd 206,168,169
zd 207,170,171
zam 204,229,54,256
zd 208,172,173
zd 209,174,175
zd 210,176,177
zd 211,178,179
zam 208,229,54,2304
s_nop 1
zp 68,228,52,0
zp 72,228,52,256
zp 76,228,52,2048
zp 80,228,52,2304
zp 84,229,52,0
zp 88,229,52,256
zp 92,229,52,2048
zp 96,229,52,2304
zbn 116,232,53,0
zbn 118,232,53,1536
zbn 120,233,53,0
zbn 122,233,53,1536
zs 50,50,524288
zs 51,51,524288
zs 52,52,524288
zs 53,53,6144
zs 54,54,8192
s_waitcnt vmcnt(37)
zv 124,100,4,220
zv 132,100,20,220
s_waitcnt vmcnt(35)
zv 128,36,4,224
zab 136,36,20
zv 140,52,20,224
s_waitcnt vmcnt(32)
zv 124,104,8,124
zv 132,104,24,132
s_waitcnt vmcnt(30)
zv 128,40,8,128
zv 136,40,24,136
zv 140,56,24,140
zaj 0,228,50,0
s_waitcnt vmcnt(28)
zv 124,108,12,124
zv 132,108,28,132
s_waitcnt vmcnt(26)
zv 128,44,12,128
zv 136,44,28,136
zv 140,60,28,140
s_waitcnt vmcnt(19)
zv 124,112,16,124
zv 132,112,32,132
s_waitcnt vmcnt(15)
zv 128,48,16,128
zv 136,48,32,136
zv 140,64,32,140
zaj 16,228,50,256
s_nop 7
zw 212,124,125,126
zw 212,127,128,212
zw 212,129,130,212
v_max_f32 v212, v131, v212
zq 213,212
s_nop 1
zu 212,213
v_max_f32 v212, v212, v213
zq 213,212
s_nop 1
zai 212,213
zaj 96,230,53,0
v_max_f32 v212, v212, v213
zad 124,124,212
zad 126,126,212
zad 128,128,212
zad 130,130,212
zj 124,124
zj 125,125
zj 126,126
zj 127,127
zj 128,128
zj 129,129
zj 130,130
zj 131,131
s_nop 0
zm 212,124,125
zaj 32,228,51,0
zm 212,212,126
zm 212,212,127
zm 212,212,128
zm 212,212,129
zm 212,212,130
zm 212,212,131
zq 213,212
s_nop 1
zu 212,213
zm 212,212,213
zaj 48,228,51,256
zq 213,212
s_nop 1
zai 212,213
zm 212,212,213
v_rcp_f32 v212, v212
s_nop 0
zaa 124,124,212
zaa 126,126,212
zaa 128,128,212
zaa 130,130,212
zaj 4,228,50,2048
zd 180,128,129
zd 181,130,131
zh 182
zh 183
zd 184,124,125
zd 185,126,127
zh 186
zh 187
zq 216,184
zq 217,185
s_nop 1
zai 216,186
zaj 20,228,50,2304
zai 217,187
zw 214,132,133,134
zw 214,135,136,214
zw 214,137,138,214
zw 214,139,140,214
zw 214,141,142,214
v_max_f32 v214, v143, v214
zq 215,214
s_nop 1
zu 214,215
zaj 100,230,53,1536
v_max_f32 v214, v214, v215
zq 215,214
s_nop 1
zai 214,215
v_max_f32 v214, v214, v215
zad 132,132,214
zad 134,134,214
zad 136,136,214
zad 138,138,214
zad 140,140,214
zaj 36,228,51,2048
zad 142,142,214
zj 132,132
zj 133,133
zj 134,134
zj 135,135
zj 136,136
zj 137,137
zj 138,138
zj 139,139
zj 140,140
zj 141,141
zj 142,142
zj 143,143
s_nop 0
zm 214,132,133
zaj 52,228,51,2304
zm 214,214,134
zm 214,214,135
zm 214,214,136
zm 214,214,137
zm 214,214,138
zm 214,214,139
zm 214,214,140
zm 214,214,141
zm 214,214,142
zm 214,214,143
zaj 8,229,50,0
zq 215,214
s_nop 1
zu 214,215
zm 214,214,215
zq 215,214
s_nop 1
zai 214,215
zm 214,214,215
v_rcp_f32 v214, v214
s_nop 0
zaa 132,132,214
zaj 24,229,50,256
zaa 134,134,214
zaa 136,136,214
zaa 138,138,214
zaa 140,140,214
zaa 142,142,214
zd 188,136,137
zd 189,138,139
zd 190,140,141
zd 191,142,143
zd 192,132,133
zaj 104,231,53,0
zd 193,134,135
zh 194
zh 195
zq 216,192
zq 217,193
s_nop 1
zai 216,194
zai 217,195
s_waitcnt vmcnt(13)
s_nop 1
zab 148,68,180
zaj 40,229,51,0
zab 152,72,180
zab 156,76,180
zab 160,80,180
zab 164,84,180
zab 168,88,180
zab 172,92,180
zab 176,96,180
zae 148,116,186,148
zae 152,116,184,152
zae 156,118,186,156
zaj 56,229,51,256
zae 160,118,184,160
zae 164,120,186,164
zae 168,120,184,168
zae 172,122,186,172
zae 176,122,184,176
s_nop 1
zd 196,148,149
zd 197,150,151
zd 198,152,153
zd 199,154,155
zaj 12,229,50,2048
zam 196,228,54,0
zd 200,156,157
zd 201,158,159
zd 202,160,161
zd 203,162,163
zam 200,228,54,2048
zd 204,164,165
zd 205,166,167
zd 206,168,169
zd 207,170,171
zam 204,229,54,0
zd 208,172,173
zd 209,174,175
zaj 28,229,50,2304
zd 210,176,177
zd 211,178,179
zam 208,229,54,2048
s_nop 1
s_nop 1
zab 148,68,188
zab 152,72,188
zab 156,76,188
zab 160,80,188
zab 164,84,188
zab 168,88,188
zaj 108,231,53,1536
zab 172,92,188
zab 176,96,188
zae 148,116,194,148
zae 152,116,192,152
zae 156,118,194,156
zae 160,118,192,160
zae 164,120,194,164
zae 168,120,192,168
zae 172,122,194,172
zae 176,122,192,176
zaj 44,229,51,2048
s_nop 1
zd 196,148,149
zd 197,150,151
zd 198,152,153
zd 199,154,155
zam 196,228,54,256
zd 200,156,157
zd 201,158,159
zd 202,160,161
zd 203,162,163
zam 200,228,54,2304
zd 204,164,165
zaj 60,229,51,2304
zd 205,166,167
zd 206,168,169
zd 207,170,171
zam 204,229,54,256
zd 208,172,173
zd 209,174,175
zd 210,176,177
zd 211,178,179
zam 208,229,54,2304
s_nop 1
zaj 64,228,52,0
zaj 68,228,52,256
zaj 72,228,52,2048
zaj 76,228,52,2304
zaj 80,229,52,0
zaj 84,229,52,256
zaj 88,229,52,2048
zaj 92,229,52,2304
buffer_load_dwordx2 a[112:113], v232, s[4:7], s53 offen offset:0
buffer_load_dwordx2 a[114:115], v232, s[4:7], s53 offen offset:1536
buffer_load_dwordx2 a[116:117], v233, s[4:7], s53 offen offset:0
buffer_load_dwordx2 a[118:119], v233, s[4:7], s53 offen offset:1536
zs 50,50,524288
zs 51,51,524288
zs 52,52,524288
zs 53,53,6144
zs 54,54,8192
s_waitcnt vmcnt(37)
zan 124,96,0,220
zan 132,96,16,220
s_waitcnt vmcnt(35)
zan 128,32,0,224
v_mfma_f32_16x16x32_bf16 v[136:139], a[32:35], a[16:19], 0
zan 140,48,16,224
s_waitcnt vmcnt(32)
zan 124,100,4,124
zan 132,100,20,132
s_waitcnt vmcnt(30)
zan 128,36,4,128
zan 136,36,20,136
zan 140,52,20,140
s_waitcnt vmcnt(27)
zan 124,104,8,124
zan 132,104,24,132
s_waitcnt vmcnt(25)
zan 128,40,8,128
zan 136,40,24,136
zan 140,56,24,140
s_waitcnt vmcnt(18)
zan 124,108,12,124
zan 132,108,28,132
s_waitcnt vmcnt(14)
zan 128,44,12,128
zan 136,44,28,136
zan 140,60,28,140
s_nop 7
zw 212,124,125,126
zw 212,127,128,212
zw 212,129,130,212
v_max_f32 v212, v131, v212
zq 213,212
s_nop 1
zu 212,213
v_max_f32 v212, v212, v213
zq 213,212
s_nop 1
zai 212,213
v_max_f32 v212, v212, v213
zad 124,124,212
zad 126,126,212
zad 128,128,212
zad 130,130,212
zj 124,124
zj 125,125
zj 126,126
zj 127,127
zj 128,128
zj 129,129
zj 130,130
zj 131,131
s_nop 0
zm 212,124,125
zm 212,212,126
zm 212,212,127
zm 212,212,128
zm 212,212,129
zm 212,212,130
zm 212,212,131
zq 213,212
s_nop 1
zu 212,213
zm 212,212,213
zq 213,212
s_nop 1
zai 212,213
zm 212,212,213
v_rcp_f32 v212, v212
s_nop 0
zaa 124,124,212
zaa 126,126,212
zaa 128,128,212
zaa 130,130,212
zd 180,128,129
zd 181,130,131
zh 182
zh 183
zd 184,124,125
zd 185,126,127
zh 186
zh 187
zq 216,184
zq 217,185
s_nop 1
zai 216,186
zai 217,187
zw 214,132,133,134
zw 214,135,136,214
zw 214,137,138,214
zw 214,139,140,214
zw 214,141,142,214
v_max_f32 v214, v143, v214
zq 215,214
s_nop 1
zu 214,215
v_max_f32 v214, v214, v215
zq 215,214
s_nop 1
zai 214,215
v_max_f32 v214, v214, v215
zad 132,132,214
zad 134,134,214
zad 136,136,214
zad 138,138,214
zad 140,140,214
zad 142,142,214
zj 132,132
zj 133,133
zj 134,134
zj 135,135
zj 136,136
zj 137,137
zj 138,138
zj 139,139
zj 140,140
zj 141,141
zj 142,142
zj 143,143
s_nop 0
zm 214,132,133
zm 214,214,134
zm 214,214,135
zm 214,214,136
zm 214,214,137
zm 214,214,138
zm 214,214,139
zm 214,214,140
zm 214,214,141
zm 214,214,142
zm 214,214,143
zq 215,214
s_nop 1
zu 214,215
zm 214,214,215
zq 215,214
s_nop 1
zai 214,215
zm 214,214,215
v_rcp_f32 v214, v214
s_nop 0
zaa 132,132,214
zaa 134,134,214
zaa 136,136,214
zaa 138,138,214
zaa 140,140,214
zaa 142,142,214
zd 188,136,137
zd 189,138,139
zd 190,140,141
zd 191,142,143
zd 192,132,133
zd 193,134,135
zh 194
zh 195
zq 216,192
zq 217,193
s_nop 1
zai 216,194
zai 217,195
s_waitcnt vmcnt(0)
s_nop 1
zat 148,64,180
zat 152,68,180
zat 156,72,180
zat 160,76,180
zat 164,80,180
zat 168,84,180
zat 172,88,180
zat 176,92,180
zau 148,112,186,148
zau 152,112,184,152
zau 156,114,186,156
zau 160,114,184,160
zau 164,116,186,164
zau 168,116,184,168
zau 172,118,186,172
zau 176,118,184,176
s_nop 1
zd 196,148,149
zd 197,150,151
zd 198,152,153
zd 199,154,155
zam 196,228,54,0
zd 200,156,157
zd 201,158,159
zd 202,160,161
zd 203,162,163
zam 200,228,54,2048
zd 204,164,165
zd 205,166,167
zd 206,168,169
zd 207,170,171
zam 204,229,54,0
zd 208,172,173
zd 209,174,175
zd 210,176,177
zd 211,178,179
zam 208,229,54,2048
s_nop 1
s_nop 1
zat 148,64,188
zat 152,68,188
zat 156,72,188
zat 160,76,188
zat 164,80,188
zat 168,84,188
zat 172,88,188
zat 176,92,188
zau 148,112,194,148
zau 152,112,192,152
zau 156,114,194,156
zau 160,114,192,160
zau 164,116,194,164
zau 168,116,192,168
zau 172,118,194,172
zau 176,118,192,176
s_nop 1
zd 196,148,149
zd 197,150,151
zd 198,152,153
zd 199,154,155
zam 196,228,54,256
zd 200,156,157
zd 201,158,159
zd 202,160,161
zd 203,162,163
zam 200,228,54,2304
zd 204,164,165
zd 205,166,167
zd 206,168,169
zd 207,170,171
zam 204,229,54,256
zd 208,172,173
zd 209,174,175
zd 210,176,177
zd 211,178,179
zam 208,229,54,2304
s_nop 1
zs 54,54,8192
s_getpc_b64 s[20:21]
bk_196:
s_sub_u32 s20, s20, bk_196-task_next
s_subb_u32 s21, s21, 0
s_setpc_b64 s[20:21]
.p2align 6
.type task_table,@object
task_table:
.long 513,65535,65535,262144,66049,65535,65535,262208
.long 197122,65535,65535,524312,2,65535,65535,65688
.long 459266,65535,65535,524344,3,1573016,65535,65692
.long 2054,2097296,65535,65535,0,65535,65535,65535
.long 0,65535,65535,65535,0,65535,65535,65535
.long 0,65535,65535,65535,0,65535,65535,65535
.long 0,65535,65535,65535,0,65535,65535,65535
.long 0,65535,65535,65535,0,65535,65535,65535
.long 769,65535,65535,262144,66305,65535,65535,262208
.long 197378,65535,65535,524312,65538,65535,65535,65688
.long 459522,65535,65535,524344,259,1573016,65535,65692
.long 67590,2097296,65535,65535,0,65535,65535,65535
.long 0,65535,65535,65535,0,65535,65535,65535
.long 0,65535,65535,65535,0,65535,65535,65535
.long 0,65535,65535,65535,0,65535,65535,65535
.long 0,65535,65535,65535,0,65535,65535,65535
.long 16777729,65535,65535,262144,16843265,65535,65535,262208
.long 16974338,65535,65535,524312,131074,65535,65535,65688
.long 17236482,65535,65535,524344,515,1573016,65535,65692
.long 133126,2097296,65535,65535,0,65535,65535,65535
.long 0,65535,65535,65535,0,65535,65535,65535
.long 0,65535,65535,65535,0,65535,65535,65535
.long 0,65535,65535,65535,0,65535,65535,65535
.long 0,65535,65535,65535,0,65535,65535,65535
.long 16777985,65535,65535,262144,16843521,65535,65535,262208
.long 16974594,65535,65535,524312,196610,65535,65535,65688
.long 17236738,65535,65535,524344,771,1573016,65535,65692
.long 198662,2097296,65535,65535,0,65535,65535,65535
.long 0,65535,65535,65535,0,65535,65535,65535
.long 0,65535,65535,65535,0,65535,65535,65535
.long 0,65535,65535,65535,0,65535,65535,65535
.long 0,65535,65535,65535,0,65535,65535,65535
.long 33554945,65535,65535,262144,33620481,65535,65535,262208
.long 33751554,65535,65535,524313,262146,65535,65535,65688
.long 34013698,65535,65535,524345,1027,1573016,65535,65692
.long 67111429,131184,2883744,262290,2568,2097298,65535,65535
.long 394244,2097309,65535,65535,0,65535,65535,65535
.long 0,65535,65535,65535,0,65535,65535,65535
.long 0,65535,65535,65535,0,65535,65535,65535
.long 0,65535,65535,65535,0,65535,65535,65535
.long 33555201,65535,65535,262144,33620737,65535,65535,262208
.long 33751810,65535,65535,524313,327682,65535,65535,65688
.long 34013954,65535,65535,524345,1283,1573016,65535,65692
.long 67373573,131185,2883744,262290,68104,2097298,65535,65535
.long 459780,2097309,65535,65535,0,65535,65535,65535
.long 0,65535,65535,65535,0,65535,65535,65535
.long 0,65535,65535,65535,0,65535,65535,65535
.long 0,65535,65535,65535,0,65535,65535,65535
.long 50332161,65535,65535,262144,50397697,65535,65535,262208
.long 50528770,65535,65535,524313,393218,65535,65535,65688
.long 50790914,65535,65535,524345,1539,1573016,65535,65692
.long 67111685,131184,3145888,262291,2824,2097299,65535,65535
.long 0,65535,65535,65535,0,65535,65535,65535
.long 0,65535,65535,65535,0,65535,65535,65535
.long 0,65535,65535,65535,0,65535,65535,65535
.long 0,65535,65535,65535,0,65535,65535,65535
.long 50332417,65535,65535,262144,50397953,65535,65535,262208
.long 50529026,65535,65535,524313,458754,65535,65535,65688
.long 50791170,65535,65535,524345,1795,1573016,65535,65692
.long 67373829,131185,3145888,262291,68360,2097299,65535,65535
.long 0,65535,65535,65535,0,65535,65535,65535
.long 0,65535,65535,65535,0,65535,65535,65535
.long 0,65535,65535,65535,0,65535,65535,65535
.long 0,65535,65535,65535,0,65535,65535,65535
.long 67109377,65535,65535,262145,67174913,65535,65535,262209
.long 262658,65535,65535,524320,67108866,65535,65535,65688
.long 131330,65535,65535,65624,65539,1573016,65535,65693
.long 6,2097288,65535,65535,2052,2097310,65535,65535
.long 0,65535,65535,65535,0,65535,65535,65535
.long 0,65535,65535,65535,0,65535,65535,65535
.long 0,65535,65535,65535,0,65535,65535,65535
.long 0,65535,65535,65535,0,65535,65535,65535
.long 67109633,65535,65535,262145,67175169,65535,65535,262209
.long 262914,65535,65535,524320,67174402,65535,65535,65688
.long 16908546,65535,65535,65624,65795,1573016,65535,65693
.long 65542,2097288,65535,65535,67588,2097310,65535,65535
.long 0,65535,65535,65535,0,65535,65535,65535
.long 0,65535,65535,65535,0,65535,65535,65535
.long 0,65535,65535,65535,0,65535,65535,65535
.long 0,65535,65535,65535,0,65535,65535,65535
.long 83886593,65535,65535,262145,83952129,65535,65535,262209
.long 17039874,65535,65535,524320,67239938,65535,65535,65688
.long 33685762,65535,65535,65625,66051,1573016,65535,65693
.long 131078,2097288,65535,65535,133124,2097310,65535,65535
.long 0,65535,65535,65535,0,65535,65535,65535
.long 0,65535,65535,65535,0,65535,65535,65535
.long 0,65535,65535,65535,0,65535,65535,65535
.long 0,65535,65535,65535,0,65535,65535,65535
.long 83886849,65535,65535,262145,83952385,65535,65535,262209
.long 17040130,65535,65535,524320,67305474,65535,65535,65688
.long 50462978,65535,65535,65625,66307,1573016,65535,65693
.long 196614,2097288,65535,65535,198660,2097310,65535,65535
.long 0,65535,65535,65535,0,65535,65535,65535
.long 0,65535,65535,65535,0,65535,65535,65535
.long 0,65535,65535,65535,0,65535,65535,65535
.long 0,65535,65535,65535,0,65535,65535,65535
.long 0x6000201,65535,65535,262145,0x6010201,65535,65535,262209
.long 33817090,65535,65535,524321,67371010,65535,65535,65688
.long 196866,65535,65535,65632,66563,1573016,65535,65693
.long 1030,2097292,65535,65535,264196,2097310,65535,65535
.long 0,65535,65535,65535,0,65535,65535,65535
.long 0,65535,65535,65535,0,65535,65535,65535
.long 0,65535,65535,65535,0,65535,65535,65535
.long 0,65535,65535,65535,0,65535,65535,65535
.long 0x6000301,65535,65535,262145,0x6010301,65535,65535,262209
.long 33817346,65535,65535,524321,67436546,65535,65535,65688
.long 16974082,65535,65535,65632,66819,1573016,65535,65693
.long 66566,2097292,65535,65535,329732,2097310,65535,65535
.long 0,65535,65535,65535,0,65535,65535,65535
.long 0,65535,65535,65535,0,65535,65535,65535
.long 0,65535,65535,65535,0,65535,65535,65535
.long 0,65535,65535,65535,0,65535,65535,65535
.long 0x7000201,65535,65535,262145,0x7010201,65535,65535,262209
.long 50594306,65535,65535,524321,67502082,65535,65535,65688
.long 33751298,65535,65535,65633,67075,1573016,65535,65693
.long 132102,2097292,65535,65535,395268,2097310,65535,65535
.long 0,65535,65535,65535,0,65535,65535,65535
.long 0,65535,65535,65535,0,65535,65535,65535
.long 0,65535,65535,65535,0,65535,65535,65535
.long 0,65535,65535,65535,0,65535,65535,65535
.long 0x7000301,65535,65535,262145,0x7010301,65535,65535,262209
.long 50594562,65535,65535,524321,67567618,65535,65535,65688
.long 50528514,65535,65535,65633,67331,1573016,65535,65693
.long 197638,2097292,65535,65535,460804,2097310,65535,65535
.long 0,65535,65535,65535,0,65535,65535,65535
.long 0,65535,65535,65535,0,65535,65535,65535
.long 0,65535,65535,65535,0,65535,65535,65535
.long 0,65535,65535,65535,0,65535,65535,65535
.long 66050,65535,65535,524296,328194,65535,65535,524328
.long 0x8000002,65535,65535,65688,262402,65535,65535,65640
.long 67108869,131144,262304,262280,196611,1573016,65535,65695
.long 4,2097308,65535,65535,16780293,131192,3408032,65740
.long 16780549,131192,3670176,65748,16780805,131200,3932320,65756
.long 16781061,131200,262380,65764,0,65535,65535,65535
.long 0,65535,65535,65535,0,65535,65535,65535
.long 0,65535,65535,65535,0,65535,65535,65535
.long 66306,65535,65535,524296,328450,65535,65535,524328
.long 0x8010002,65535,65535,65688,17039618,65535,65535,65640
.long 67371013,131145,262304,262280,196867,1573016,65535,65695
.long 65540,2097308,65535,65535,16845829,131192,3408032,65740
.long 16846085,131192,3670176,65748,16846341,131200,3932320,65756
.long 16846597,131200,262381,65764,0,65535,65535,65535
.long 0,65535,65535,65535,0,65535,65535,65535
.long 0,65535,65535,65535,0,65535,65535,65535
.long 16843266,65535,65535,524296,17105410,65535,65535,524328
.long 0x8020002,65535,65535,65688,33816834,65535,65535,65641
.long 67109893,131160,1310880,262284,197123,1573016,65535,65695
.long 131076,2097308,65535,65535,16911365,131192,3408032,65740
.long 16911621,131192,3670176,65748,16911877,131200,3932320,65756
.long 16912133,131200,262382,65764,0,65535,65535,65535
.long 0,65535,65535,65535,0,65535,65535,65535
.long 0,65535,65535,65535,0,65535,65535,65535
.long 16843522,65535,65535,524296,17105666,65535,65535,524328
.long 0x8030002,65535,65535,65688,50594050,65535,65535,65641
.long 67372037,131161,1310880,262284,197379,1573016,65535,65695
.long 196612,2097308,65535,65535,16976901,131192,3408032,65740
.long 16977157,131192,3670176,65748,16977413,131200,3932320,65756
.long 16977669,131200,262383,65764,0,65535,65535,65535
.long 0,65535,65535,65535,0,65535,65535,65535
.long 0,65535,65535,65535,0,65535,65535,65535
.long 33620482,65535,65535,524297,33882626,65535,65535,524329
.long 0x8040002,65535,65535,65688,327938,65535,65535,65648
.long 67109125,131144,524448,262281,197635,1573016,65535,65695
.long 262148,2097308,65535,65535,17042437,131193,3408032,65740
.long 17042693,131193,3670176,65748,17042949,131201,3932320,65756
.long 17043205,131201,262384,65765,0,65535,65535,65535
.long 0,65535,65535,65535,0,65535,65535,65535
.long 0,65535,65535,65535,0,65535,65535,65535
.long 33620738,65535,65535,524297,33882882,65535,65535,524329
.long 0x8050002,65535,65535,65688,17105154,65535,65535,65648
.long 67371269,131145,524448,262281,197891,1573016,65535,65695
.long 327684,2097308,65535,65535,17107973,131193,3408032,65740
.long 17108229,131193,3670176,65748,17108485,131201,3932320,65756
.long 17108741,131201,262385,65765,0,65535,65535,65535
.long 0,65535,65535,65535,0,65535,65535,65535
.long 0,65535,65535,65535,0,65535,65535,65535
.long 50397698,65535,65535,524297,50659842,65535,65535,524329
.long 0x8060002,65535,65535,65688,33882370,65535,65535,65649
.long 67110149,131160,1573024,262285,198147,1573016,65535,65695
.long 393220,2097308,65535,65535,17173509,131193,3408032,65740
.long 17173765,131193,3670176,65748,17174021,131201,3932320,65756
.long 17174277,131201,262386,65765,0,65535,65535,65535
.long 0,65535,65535,65535,0,65535,65535,65535
.long 0,65535,65535,65535,0,65535,65535,65535
.long 50397954,65535,65535,524297,50660098,65535,65535,524329
.long 0x8070002,65535,65535,65688,50659586,65535,65535,65649
.long 67372293,131161,1573024,262285,198403,1573016,65535,65695
.long 458756,2097308,65535,65535,17239045,131193,3408032,65740
.long 17239301,131193,3670176,65748,17239557,131201,3932320,65756
.long 17239813,131201,262387,65765,0,65535,65535,65535
.long 0,65535,65535,65535,0,65535,65535,65535
.long 0,65535,65535,65535,0,65535,65535,65535
.long 131586,65535,65535,524304,393730,65535,65535,524336
.long 258,65535,65535,65608,393474,65535,65535,65656
.long 67109381,131152,786592,262282,67110917,131176,2359456,262288
.long 131075,1573016,65535,65694,263172,2097309,65535,65535
.long 536874247,65535,1048788,65535,0,65535,65535,65535
.long 0,65535,65535,65535,0,65535,65535,65535
.long 0,65535,65535,65535,0,65535,65535,65535
.long 0,65535,65535,65535,0,65535,65535,65535
.long 131842,65535,65535,524304,393986,65535,65535,524336
.long 16777474,65535,65535,65608,17170690,65535,65535,65656
.long 67371525,131153,786592,262282,67373061,131177,2359456,262288
.long 131331,1573016,65535,65694,328708,2097309,65535,65535
.long 537005319,65535,1048788,65535,0,65535,65535,65535
.long 0,65535,65535,65535,0,65535,65535,65535
.long 0,65535,65535,65535,0,65535,65535,65535
.long 0,65535,65535,65535,0,65535,65535,65535
.long 16908802,65535,65535,524304,17170946,65535,65535,524336
.long 33554690,65535,65535,65609,33947906,65535,65535,65657
.long 67110405,131168,1835168,262286,67111173,131176,2621600,262289
.long 131587,1573016,65535,65694,537136391,65535,1048788,65535
.long 0,65535,65535,65535,0,65535,65535,65535
.long 0,65535,65535,65535,0,65535,65535,65535
.long 0,65535,65535,65535,0,65535,65535,65535
.long 0,65535,65535,65535,0,65535,65535,65535
.long 16909058,65535,65535,524304,17171202,65535,65535,524336
.long 50331906,65535,65535,65609,50725122,65535,65535,65657
.long 67372549,131169,1835168,262286,67373317,131177,2621600,262289
.long 131843,1573016,65535,65694,537267463,65535,1048788,65535
.long 0,65535,65535,65535,0,65535,65535,65535
.long 0,65535,65535,65535,0,65535,65535,65535
.long 0,65535,65535,65535,0,65535,65535,65535
.long 0,65535,65535,65535,0,65535,65535,65535
.long 33686018,65535,65535,524305,33948162,65535,65535,524337
.long 65794,65535,65535,65616,459010,65535,65535,65664
.long 67109637,131152,1048736,262283,132099,1573016,65535,65694
.long 1028,2097309,65535,65535,536873991,65535,1048780,65535
.long 0,65535,65535,65535,0,65535,65535,65535
.long 0,65535,65535,65535,0,65535,65535,65535
.long 0,65535,65535,65535,0,65535,65535,65535
.long 0,65535,65535,65535,0,65535,65535,65535
.long 33686274,65535,65535,524305,33948418,65535,65535,524337
.long 16843010,65535,65535,65616,17236226,65535,65535,65664
.long 67371781,131153,1048736,262283,132355,1573016,65535,65694
.long 66564,2097309,65535,65535,537005063,65535,1048780,65535
.long 0,65535,65535,65535,0,65535,65535,65535
.long 0,65535,65535,65535,0,65535,65535,65535
.long 0,65535,65535,65535,0,65535,65535,65535
.long 0,65535,65535,65535,0,65535,65535,65535
.long 50463234,65535,65535,524305,50725378,65535,65535,524337
.long 33620226,65535,65535,65617,34013442,65535,65535,65665
.long 67110661,131168,2097312,262287,132611,1573016,65535,65694
.long 132100,2097309,65535,65535,537136135,65535,1048780,65535
.long 0,65535,65535,65535,0,65535,65535,65535
.long 0,65535,65535,65535,0,65535,65535,65535
.long 0,65535,65535,65535,0,65535,65535,65535
.long 0,65535,65535,65535,0,65535,65535,65535
.long 50463490,65535,65535,524305,50725634,65535,65535,524337
.long 50397442,65535,65535,65617,50790658,65535,65535,65665
.long 67372805,131169,2097312,262287,132867,1573016,65535,65694
.long 197636,2097309,65535,65535,537267207,65535,1048780,65535
.long 0,65535,65535,65535,0,65535,65535,65535
.long 0,65535,65535,65535,0,65535,65535,65535
.long 0,65535,65535,65535,0,65535,65535,65535
.long 0,65535,65535,65535,0,65535,65535,65535
.long 0x8000201,65535,65535,262146,0x8010201,65535,65535,262210
.long 67305986,65535,65535,524314,16777218,65535,65535,65689
.long 67568130,65535,65535,524346,2051,1573017,65535,65692
.long 2310,2097297,65535,65535,0,65535,65535,65535
.long 0,65535,65535,65535,0,65535,65535,65535
.long 0,65535,65535,65535,0,65535,65535,65535
.long 0,65535,65535,65535,0,65535,65535,65535
.long 0,65535,65535,65535,0,65535,65535,65535
.long 0x8000301,65535,65535,262146,0x8010301,65535,65535,262210
.long 67306242,65535,65535,524314,16842754,65535,65535,65689
.long 67568386,65535,65535,524346,2307,1573017,65535,65692
.long 67846,2097297,65535,65535,0,65535,65535,65535
.long 0,65535,65535,65535,0,65535,65535,65535
.long 0,65535,65535,65535,0,65535,65535,65535
.long 0,65535,65535,65535,0,65535,65535,65535
.long 0,65535,65535,65535,0,65535,65535,65535
.long 0x9000201,65535,65535,262146,0x9010201,65535,65535,262210
.long 84083202,65535,65535,524314,16908290,65535,65535,65689
.long 84345346,65535,65535,524346,2563,1573017,65535,65692
.long 133382,2097297,65535,65535,0,65535,65535,65535
.long 0,65535,65535,65535,0,65535,65535,65535
.long 0,65535,65535,65535,0,65535,65535,65535
.long 0,65535,65535,65535,0,65535,65535,65535
.long 0,65535,65535,65535,0,65535,65535,65535
.long 0x9000301,65535,65535,262146,0x9010301,65535,65535,262210
.long 84083458,65535,65535,524314,16973826,65535,65535,65689
.long 84345602,65535,65535,524346,2819,1573017,65535,65692
.long 198918,2097297,65535,65535,0,65535,65535,65535
.long 0,65535,65535,65535,0,65535,65535,65535
.long 0,65535,65535,65535,0,65535,65535,65535
.long 0,65535,65535,65535,0,65535,65535,65535
.long 0,65535,65535,65535,0,65535,65535,65535
.long 0xa000201,65535,65535,262146,0xa010201,65535,65535,262210
.long 0x6030202,65535,65535,524315,17039362,65535,65535,65689
.long 0x6070202,65535,65535,524347,3075,1573017,65535,65692
.long 67635717,131186,2883745,262290,133640,2097298,65535,65535
.long 394500,2097309,65535,65535,0,65535,65535,65535
.long 0,65535,65535,65535,0,65535,65535,65535
.long 0,65535,65535,65535,0,65535,65535,65535
.long 0,65535,65535,65535,0,65535,65535,65535
.long 0xa000301,65535,65535,262146,0xa010301,65535,65535,262210
.long 0x6030302,65535,65535,524315,17104898,65535,65535,65689
.long 0x6070302,65535,65535,524347,3331,1573017,65535,65692
.long 67897861,131187,2883745,262290,199176,2097298,65535,65535
.long 460036,2097309,65535,65535,0,65535,65535,65535
.long 0,65535,65535,65535,0,65535,65535,65535
.long 0,65535,65535,65535,0,65535,65535,65535
.long 0,65535,65535,65535,0,65535,65535,65535
.long 0xb000201,65535,65535,262146,0xb010201,65535,65535,262210
.long 0x7030202,65535,65535,524315,17170434,65535,65535,65689
.long 0x7070202,65535,65535,524347,3587,1573017,65535,65692
.long 67635973,131186,3145889,262291,133896,2097299,65535,65535
.long 0,65535,65535,65535,0,65535,65535,65535
.long 0,65535,65535,65535,0,65535,65535,65535
.long 0,65535,65535,65535,0,65535,65535,65535
.long 0,65535,65535,65535,0,65535,65535,65535
.long 0xb000301,65535,65535,262146,0xb010301,65535,65535,262210
.long 0x7030302,65535,65535,524315,17235970,65535,65535,65689
.long 0x7070302,65535,65535,524347,3843,1573017,65535,65692
.long 67898117,131187,3145889,262291,199432,2097299,65535,65535
.long 0,65535,65535,65535,0,65535,65535,65535
.long 0,65535,65535,65535,0,65535,65535,65535
.long 0,65535,65535,65535,0,65535,65535,65535
.long 0,65535,65535,65535,0,65535,65535,65535
.long 0xc000201,65535,65535,262147,0xc010201,65535,65535,262211
.long 67371522,65535,65535,524322,83886082,65535,65535,65689
.long 67240194,65535,65535,65626,67587,1573017,65535,65693
.long 262,2097289,65535,65535,2308,2097310,65535,65535
.long 0,65535,65535,65535,0,65535,65535,65535
.long 0,65535,65535,65535,0,65535,65535,65535
.long 0,65535,65535,65535,0,65535,65535,65535
.long 0,65535,65535,65535,0,65535,65535,65535
.long 0xc000301,65535,65535,262147,0xc010301,65535,65535,262211
.long 67371778,65535,65535,524322,83951618,65535,65535,65689
.long 84017410,65535,65535,65626,67843,1573017,65535,65693
.long 65798,2097289,65535,65535,67844,2097310,65535,65535
.long 0,65535,65535,65535,0,65535,65535,65535
.long 0,65535,65535,65535,0,65535,65535,65535
.long 0,65535,65535,65535,0,65535,65535,65535
.long 0,65535,65535,65535,0,65535,65535,65535
.long 0xd000201,65535,65535,262147,0xd010201,65535,65535,262211
.long 84148738,65535,65535,524322,84017154,65535,65535,65689
.long 0x6020102,65535,65535,65627,68099,1573017,65535,65693
.long 131334,2097289,65535,65535,133380,2097310,65535,65535
.long 0,65535,65535,65535,0,65535,65535,65535
.long 0,65535,65535,65535,0,65535,65535,65535
.long 0,65535,65535,65535,0,65535,65535,65535
.long 0,65535,65535,65535,0,65535,65535,65535
.long 0xd000301,65535,65535,262147,0xd010301,65535,65535,262211
.long 84148994,65535,65535,524322,84082690,65535,65535,65689
.long 0x7020102,65535,65535,65627,68355,1573017,65535,65693
.long 196870,2097289,65535,65535,198916,2097310,65535,65535
.long 0,65535,65535,65535,0,65535,65535,65535
.long 0,65535,65535,65535,0,65535,65535,65535
.long 0,65535,65535,65535,0,65535,65535,65535
.long 0,65535,65535,65535,0,65535,65535,65535
.long 0xe000201,65535,65535,262147,0xe010201,65535,65535,262211
.long 0x6040202,65535,65535,524323,84148226,65535,65535,65689
.long 67305730,65535,65535,65634,68611,1573017,65535,65693
.long 1286,2097293,65535,65535,264452,2097310,65535,65535
.long 0,65535,65535,65535,0,65535,65535,65535
.long 0,65535,65535,65535,0,65535,65535,65535
.long 0,65535,65535,65535,0,65535,65535,65535
.long 0,65535,65535,65535,0,65535,65535,65535
.long 0xe000301,65535,65535,262147,0xe010301,65535,65535,262211
.long 0x6040302,65535,65535,524323,84213762,65535,65535,65689
.long 84082946,65535,65535,65634,68867,1573017,65535,65693
.long 66822,2097293,65535,65535,329988,2097310,65535,65535
.long 0,65535,65535,65535,0,65535,65535,65535
.long 0,65535,65535,65535,0,65535,65535,65535
.long 0,65535,65535,65535,0,65535,65535,65535
.long 0,65535,65535,65535,0,65535,65535,65535
.long 0xf000201,65535,65535,262147,0xf010201,65535,65535,262211
.long 0x7040202,65535,65535,524323,84279298,65535,65535,65689
.long 0x6030102,65535,65535,65635,69123,1573017,65535,65693
.long 132358,2097293,65535,65535,395524,2097310,65535,65535
.long 0,65535,65535,65535,0,65535,65535,65535
.long 0,65535,65535,65535,0,65535,65535,65535
.long 0,65535,65535,65535,0,65535,65535,65535
.long 0,65535,65535,65535,0,65535,65535,65535
.long 0xf000301,65535,65535,262147,0xf010301,65535,65535,262211
.long 0x7040302,65535,65535,524323,84344834,65535,65535,65689
.long 0x7030102,65535,65535,65635,69379,1573017,65535,65693
.long 197894,2097293,65535,65535,461060,2097310,65535,65535
.long 0,65535,65535,65535,0,65535,65535,65535
.long 0,65535,65535,65535,0,65535,65535,65535
.long 0,65535,65535,65535,0,65535,65535,65535
.long 0,65535,65535,65535,0,65535,65535,65535
.long 67174914,65535,65535,524298,67437058,65535,65535,524330
.long 0x9000002,65535,65535,65689,67371266,65535,65535,65642
.long 67633157,131146,262305,262280,198659,1573017,65535,65695
.long 260,2097308,65535,65535,17304581,131194,3408033,65740
.long 17304837,131194,3670177,65748,17305093,131202,3932321,65757
.long 17305349,131202,262388,65766,0,65535,65535,65535
.long 0,65535,65535,65535,0,65535,65535,65535
.long 0,65535,65535,65535,0,65535,65535,65535
.long 67175170,65535,65535,524298,67437314,65535,65535,524330
.long 0x9010002,65535,65535,65689,84148482,65535,65535,65642
.long 67895301,131147,262305,262280,198915,1573017,65535,65695
.long 65796,2097308,65535,65535,17370117,131194,3408033,65740
.long 17370373,131194,3670177,65748,17370629,131202,3932321,65757
.long 17370885,131202,262389,65766,0,65535,65535,65535
.long 0,65535,65535,65535,0,65535,65535,65535
.long 0,65535,65535,65535,0,65535,65535,65535
.long 83952130,65535,65535,524298,84214274,65535,65535,524330
.long 0x9020002,65535,65535,65689,0x6040102,65535,65535,65643
.long 67634181,131162,1310881,262284,199171,1573017,65535,65695
.long 131332,2097308,65535,65535,17435653,131194,3408033,65740
.long 17435909,131194,3670177,65748,17436165,131202,3932321,65757
.long 17436421,131202,262390,65766,0,65535,65535,65535
.long 0,65535,65535,65535,0,65535,65535,65535
.long 0,65535,65535,65535,0,65535,65535,65535
.long 83952386,65535,65535,524298,84214530,65535,65535,524330
.long 0x9030002,65535,65535,65689,0x7040102,65535,65535,65643
.long 67896325,131163,1310881,262284,199427,1573017,65535,65695
.long 196868,2097308,65535,65535,17501189,131194,3408033,65740
.long 17501445,131194,3670177,65748,17501701,131202,3932321,65757
.long 17501957,131202,262391,65766,0,65535,65535,65535
.long 0,65535,65535,65535,0,65535,65535,65535
.long 0,65535,65535,65535,0,65535,65535,65535
.long 0x6010202,65535,65535,524299,0x6050202,65535,65535,524331
.long 0x9040002,65535,65535,65689,67436802,65535,65535,65650
.long 67633413,131146,524449,262281,199683,1573017,65535,65695
.long 262404,2097308,65535,65535,17566725,131195,3408033,65740
.long 17566981,131195,3670177,65748,17567237,131203,3932321,65757
.long 17567493,131203,262392,65767,0,65535,65535,65535
.long 0,65535,65535,65535,0,65535,65535,65535
.long 0,65535,65535,65535,0,65535,65535,65535
.long 0x6010302,65535,65535,524299,0x6050302,65535,65535,524331
.long 0x9050002,65535,65535,65689,84214018,65535,65535,65650
.long 67895557,131147,524449,262281,199939,1573017,65535,65695
.long 327940,2097308,65535,65535,17632261,131195,3408033,65740
.long 17632517,131195,3670177,65748,17632773,131203,3932321,65757
.long 17633029,131203,262393,65767,0,65535,65535,65535
.long 0,65535,65535,65535,0,65535,65535,65535
.long 0,65535,65535,65535,0,65535,65535,65535
.long 0x7010202,65535,65535,524299,0x7050202,65535,65535,524331
.long 0x9060002,65535,65535,65689,0x6050102,65535,65535,65651
.long 67634437,131162,1573025,262285,200195,1573017,65535,65695
.long 393476,2097308,65535,65535,17697797,131195,3408033,65740
.long 17698053,131195,3670177,65748,17698309,131203,3932321,65757
.long 17698565,131203,262394,65767,0,65535,65535,65535
.long 0,65535,65535,65535,0,65535,65535,65535
.long 0,65535,65535,65535,0,65535,65535,65535
.long 0x7010302,65535,65535,524299,0x7050302,65535,65535,524331
.long 0x9070002,65535,65535,65689,0x7050102,65535,65535,65651
.long 67896581,131163,1573025,262285,200451,1573017,65535,65695
.long 459012,2097308,65535,65535,17763333,131195,3408033,65740
.long 17763589,131195,3670177,65748,17763845,131203,3932321,65757
.long 17764101,131203,262395,65767,0,65535,65535,65535
.long 0,65535,65535,65535,0,65535,65535,65535
.long 0,65535,65535,65535,0,65535,65535,65535
.long 67240450,65535,65535,524306,67502594,65535,65535,524338
.long 67109122,65535,65535,65610,67502338,65535,65535,65658
.long 67633669,131154,786593,262282,67635205,131178,2359457,262288
.long 133123,1573017,65535,65694,263428,2097309,65535,65535
.long 536939783,65535,1048788,65535,0,65535,65535,65535
.long 0,65535,65535,65535,0,65535,65535,65535
.long 0,65535,65535,65535,0,65535,65535,65535
.long 0,65535,65535,65535,0,65535,65535,65535
.long 67240706,65535,65535,524306,67502850,65535,65535,524338
.long 83886338,65535,65535,65610,84279554,65535,65535,65658
.long 67895813,131155,786593,262282,67897349,131179,2359457,262288
.long 133379,1573017,65535,65694,328964,2097309,65535,65535
.long 537070855,65535,1048788,65535,0,65535,65535,65535
.long 0,65535,65535,65535,0,65535,65535,65535
.long 0,65535,65535,65535,0,65535,65535,65535
.long 0,65535,65535,65535,0,65535,65535,65535
.long 84017666,65535,65535,524306,84279810,65535,65535,524338
.long 0x6000102,65535,65535,65611,0x6060102,65535,65535,65659
.long 67634693,131170,1835169,262286,67635461,131178,2621601,262289
.long 133635,1573017,65535,65694,537201927,65535,1048788,65535
.long 0,65535,65535,65535,0,65535,65535,65535
.long 0,65535,65535,65535,0,65535,65535,65535
.long 0,65535,65535,65535,0,65535,65535,65535
.long 0,65535,65535,65535,0,65535,65535,65535
.long 84017922,65535,65535,524306,84280066,65535,65535,524338
.long 0x7000102,65535,65535,65611,0x7060102,65535,65535,65659
.long 67896837,131171,1835169,262286,67897605,131179,2621601,262289
.long 133891,1573017,65535,65694,537332999,65535,1048788,65535
.long 0,65535,65535,65535,0,65535,65535,65535
.long 0,65535,65535,65535,0,65535,65535,65535
.long 0,65535,65535,65535,0,65535,65535,65535
.long 0,65535,65535,65535,0,65535,65535,65535
.long 0x6020202,65535,65535,524307,0x6060202,65535,65535,524339
.long 67174658,65535,65535,65618,67567874,65535,65535,65666
.long 67633925,131154,1048737,262283,134147,1573017,65535,65694
.long 1284,2097309,65535,65535,536939527,65535,1048780,65535
.long 0,65535,65535,65535,0,65535,65535,65535
.long 0,65535,65535,65535,0,65535,65535,65535
.long 0,65535,65535,65535,0,65535,65535,65535
.long 0,65535,65535,65535,0,65535,65535,65535
.long 0x6020302,65535,65535,524307,0x6060302,65535,65535,524339
.long 83951874,65535,65535,65618,84345090,65535,65535,65666
.long 67896069,131155,1048737,262283,134403,1573017,65535,65694
.long 66820,2097309,65535,65535,537070599,65535,1048780,65535
.long 0,65535,65535,65535,0,65535,65535,65535
.long 0,65535,65535,65535,0,65535,65535,65535
.long 0,65535,65535,65535,0,65535,65535,65535
.long 0,65535,65535,65535,0,65535,65535,65535
.long 0x7020202,65535,65535,524307,0x7060202,65535,65535,524339
.long 0x6010102,65535,65535,65619,0x6070102,65535,65535,65667
.long 67634949,131170,2097313,262287,134659,1573017,65535,65694
.long 132356,2097309,65535,65535,537201671,65535,1048780,65535
.long 0,65535,65535,65535,0,65535,65535,65535
.long 0,65535,65535,65535,0,65535,65535,65535
.long 0,65535,65535,65535,0,65535,65535,65535
.long 0,65535,65535,65535,0,65535,65535,65535
.long 0x7020302,65535,65535,524307,0x7060302,65535,65535,524339
.long 0x7010102,65535,65535,65619,0x7070102,65535,65535,65667
.long 67897093,131171,2097313,262287,134915,1573017,65535,65694
.long 197892,2097309,65535,65535,537332743,65535,1048780,65535
.long 0,65535,65535,65535,0,65535,65535,65535
.long 0,65535,65535,65535,0,65535,65535,65535
.long 0,65535,65535,65535,0,65535,65535,65535
.long 0,65535,65535,65535,0,65535,65535,65535
.long 268435969,65535,65535,262148,268501505,65535,65535,262212
.long 0x8030202,65535,65535,524316,33554434,65535,65535,65690
.long 0x8070202,65535,65535,524348,4099,1573018,65535,65692
.long 1540,2097309,65535,65535,263684,2097309,65535,65535
.long 2564,2097310,65535,65535,264708,2097310,65535,65535
.long 0,65535,65535,65535,0,65535,65535,65535
.long 0,65535,65535,65535,0,65535,65535,65535
.long 0,65535,65535,65535,0,65535,65535,65535
.long 268436225,65535,65535,262148,268501761,65535,65535,262212
.long 0x8030302,65535,65535,524316,33619970,65535,65535,65690
.long 0x8070302,65535,65535,524348,4355,1573018,65535,65692
.long 67076,2097309,65535,65535,329220,2097309,65535,65535
.long 68100,2097310,65535,65535,330244,2097310,65535,65535
.long 0,65535,65535,65535,0,65535,65535,65535
.long 0,65535,65535,65535,0,65535,65535,65535
.long 0,65535,65535,65535,0,65535,65535,65535
.long 285213185,65535,65535,262148,285278721,65535,65535,262212
.long 0x9030202,65535,65535,524316,33685506,65535,65535,65690
.long 0x9070202,65535,65535,524348,4611,1573018,65535,65692
.long 132612,2097309,65535,65535,394756,2097309,65535,65535
.long 133636,2097310,65535,65535,395780,2097310,65535,65535
.long 0,65535,65535,65535,0,65535,65535,65535
.long 0,65535,65535,65535,0,65535,65535,65535
.long 0,65535,65535,65535,0,65535,65535,65535
.long 285213441,65535,65535,262148,285278977,65535,65535,262212
.long 0x9030302,65535,65535,524316,33751042,65535,65535,65690
.long 0x9070302,65535,65535,524348,4867,1573018,65535,65692
.long 198148,2097309,65535,65535,460292,2097309,65535,65535
.long 199172,2097310,65535,65535,461316,2097310,65535,65535
.long 0,65535,65535,65535,0,65535,65535,65535
.long 0,65535,65535,65535,0,65535,65535,65535
.long 0,65535,65535,65535,0,65535,65535,65535
.long 301990401,65535,65535,262148,302055937,65535,65535,262212
.long 0xa030202,65535,65535,524317,33816578,65535,65535,65690
.long 0xa070202,65535,65535,524349,5123,1573018,65535,65692
.long 68160005,131188,2883746,262290,264712,2097298,65535,65535
.long 396804,2097311,65535,65535,0,65535,65535,65535
.long 0,65535,65535,65535,0,65535,65535,65535
.long 0,65535,65535,65535,0,65535,65535,65535
.long 0,65535,65535,65535,0,65535,65535,65535
.long 301990657,65535,65535,262148,302056193,65535,65535,262212
.long 0xa030302,65535,65535,524317,33882114,65535,65535,65690
.long 0xa070302,65535,65535,524349,5379,1573018,65535,65692
.long 68422149,131189,2883746,262290,330248,2097298,65535,65535
.long 462340,2097311,65535,65535,0,65535,65535,65535
.long 0,65535,65535,65535,0,65535,65535,65535
.long 0,65535,65535,65535,0,65535,65535,65535
.long 0,65535,65535,65535,0,65535,65535,65535
.long 318767617,65535,65535,262148,318833153,65535,65535,262212
.long 0xb030202,65535,65535,524317,33947650,65535,65535,65690
.long 0xb070202,65535,65535,524349,5635,1573018,65535,65692
.long 68160261,131188,3145890,262291,264968,2097299,65535,65535
.long 0,65535,65535,65535,0,65535,65535,65535
.long 0,65535,65535,65535,0,65535,65535,65535
.long 0,65535,65535,65535,0,65535,65535,65535
.long 0,65535,65535,65535,0,65535,65535,65535
.long 318767873,65535,65535,262148,318833409,65535,65535,262212
.long 0xb030302,65535,65535,524317,34013186,65535,65535,65690
.long 0xb070302,65535,65535,524349,5891,1573018,65535,65692
.long 68422405,131189,3145890,262291,330504,2097299,65535,65535
.long 0,65535,65535,65535,0,65535,65535,65535
.long 0,65535,65535,65535,0,65535,65535,65535
.long 0,65535,65535,65535,0,65535,65535,65535
.long 0,65535,65535,65535,0,65535,65535,65535
.long 335544833,65535,65535,262149,335610369,65535,65535,262213
.long 0x8040202,65535,65535,524324,0x6000002,65535,65535,65690
.long 0x8020102,65535,65535,65628,69635,1573018,65535,65693
.long 518,2097290,65535,65535,3076,2097311,65535,65535
.long 0,65535,65535,65535,0,65535,65535,65535
.long 0,65535,65535,65535,0,65535,65535,65535
.long 0,65535,65535,65535,0,65535,65535,65535
.long 0,65535,65535,65535,0,65535,65535,65535
.long 335545089,65535,65535,262149,335610625,65535,65535,262213
.long 0x8040302,65535,65535,524324,0x6010002,65535,65535,65690
.long 0x9020102,65535,65535,65628,69891,1573018,65535,65693
.long 66054,2097290,65535,65535,68612,2097311,65535,65535
.long 0,65535,65535,65535,0,65535,65535,65535
.long 0,65535,65535,65535,0,65535,65535,65535
.long 0,65535,65535,65535,0,65535,65535,65535
.long 0,65535,65535,65535,0,65535,65535,65535
.long 352322049,65535,65535,262149,352387585,65535,65535,262213
.long 0x9040202,65535,65535,524324,0x6020002,65535,65535,65690
.long 0xa020102,65535,65535,65629,70147,1573018,65535,65693
.long 131590,2097290,65535,65535,134148,2097311,65535,65535
.long 0,65535,65535,65535,0,65535,65535,65535
.long 0,65535,65535,65535,0,65535,65535,65535
.long 0,65535,65535,65535,0,65535,65535,65535
.long 0,65535,65535,65535,0,65535,65535,65535
.long 352322305,65535,65535,262149,352387841,65535,65535,262213
.long 0x9040302,65535,65535,524324,0x6030002,65535,65535,65690
.long 0xb020102,65535,65535,65629,70403,1573018,65535,65693
.long 197126,2097290,65535,65535,199684,2097311,65535,65535
.long 0,65535,65535,65535,0,65535,65535,65535
.long 0,65535,65535,65535,0,65535,65535,65535
.long 0,65535,65535,65535,0,65535,65535,65535
.long 0,65535,65535,65535,0,65535,65535,65535
.long 369099265,65535,65535,262149,369164801,65535,65535,262213
.long 0xa040202,65535,65535,524325,0x6040002,65535,65535,65690
.long 0x8030102,65535,65535,65636,70659,1573018,65535,65693
.long 1542,2097294,65535,65535,265220,2097311,65535,65535
.long 0,65535,65535,65535,0,65535,65535,65535
.long 0,65535,65535,65535,0,65535,65535,65535
.long 0,65535,65535,65535,0,65535,65535,65535
.long 0,65535,65535,65535,0,65535,65535,65535
.long 369099521,65535,65535,262149,369165057,65535,65535,262213
.long 0xa040302,65535,65535,524325,0x6050002,65535,65535,65690
.long 0x9030102,65535,65535,65636,70915,1573018,65535,65693
.long 67078,2097294,65535,65535,330756,2097311,65535,65535
.long 0,65535,65535,65535,0,65535,65535,65535
.long 0,65535,65535,65535,0,65535,65535,65535
.long 0,65535,65535,65535,0,65535,65535,65535
.long 0,65535,65535,65535,0,65535,65535,65535
.long 385876481,65535,65535,262149,385942017,65535,65535,262213
.long 0xb040202,65535,65535,524325,0x6060002,65535,65535,65690
.long 0xa030102,65535,65535,65637,71171,1573018,65535,65693
.long 132614,2097294,65535,65535,396292,2097311,65535,65535
.long 0,65535,65535,65535,0,65535,65535,65535
.long 0,65535,65535,65535,0,65535,65535,65535
.long 0,65535,65535,65535,0,65535,65535,65535
.long 0,65535,65535,65535,0,65535,65535,65535
.long 385876737,65535,65535,262149,385942273,65535,65535,262213
.long 0xb040302,65535,65535,524325,0x6070002,65535,65535,65690
.long 0xb030102,65535,65535,65637,71427,1573018,65535,65693
.long 198150,2097294,65535,65535,461828,2097311,65535,65535
.long 0,65535,65535,65535,0,65535,65535,65535
.long 0,65535,65535,65535,0,65535,65535,65535
.long 0,65535,65535,65535,0,65535,65535,65535
.long 0,65535,65535,65535,0,65535,65535,65535
.long 0x8010202,65535,65535,524300,0x8050202,65535,65535,524332
.long 0xa000002,65535,65535,65690,0x8040102,65535,65535,65644
.long 68157445,131148,262306,262280,200707,1573018,65535,65695
.long 516,2097308,65535,65535,17828869,131196,3408034,65741
.long 17829125,131196,3670178,65749,17829381,131204,3932322,65758
.long 17829637,131204,262396,65768,0,65535,65535,65535
.long 0,65535,65535,65535,0,65535,65535,65535
.long 0,65535,65535,65535,0,65535,65535,65535
.long 0x8010302,65535,65535,524300,0x8050302,65535,65535,524332
.long 0xa010002,65535,65535,65690,0x9040102,65535,65535,65644
.long 68419589,131149,262306,262280,200963,1573018,65535,65695
.long 66052,2097308,65535,65535,17894405,131196,3408034,65741
.long 17894661,131196,3670178,65749,17894917,131204,3932322,65758
.long 17895173,131204,262397,65768,0,65535,65535,65535
.long 0,65535,65535,65535,0,65535,65535,65535
.long 0,65535,65535,65535,0,65535,65535,65535
.long 0x9010202,65535,65535,524300,0x9050202,65535,65535,524332
.long 0xa020002,65535,65535,65690,0xa040102,65535,65535,65645
.long 68158469,131164,1310882,262284,201219,1573018,65535,65695
.long 131588,2097308,65535,65535,17959941,131196,3408034,65741
.long 17960197,131196,3670178,65749,17960453,131204,3932322,65758
.long 17960709,131204,262398,65768,0,65535,65535,65535
.long 0,65535,65535,65535,0,65535,65535,65535
.long 0,65535,65535,65535,0,65535,65535,65535
.long 0x9010302,65535,65535,524300,0x9050302,65535,65535,524332
.long 0xa030002,65535,65535,65690,0xb040102,65535,65535,65645
.long 68420613,131165,1310882,262284,201475,1573018,65535,65695
.long 197124,2097308,65535,65535,18025477,131196,3408034,65741
.long 18025733,131196,3670178,65749,18025989,131204,3932322,65758
.long 18026245,131204,262399,65768,0,65535,65535,65535
.long 0,65535,65535,65535,0,65535,65535,65535
.long 0,65535,65535,65535,0,65535,65535,65535
.long 0xa010202,65535,65535,524301,0xa050202,65535,65535,524333
.long 0xa040002,65535,65535,65690,0x8050102,65535,65535,65652
.long 68157701,131148,524450,262281,201731,1573018,65535,65695
.long 262660,2097308,65535,65535,18091013,131197,3408034,65741
.long 18091269,131197,3670178,65749,18091525,131205,3932322,65758
.long 18091781,131205,262400,65769,0,65535,65535,65535
.long 0,65535,65535,65535,0,65535,65535,65535
.long 0,65535,65535,65535,0,65535,65535,65535
.long 0xa010302,65535,65535,524301,0xa050302,65535,65535,524333
.long 0xa050002,65535,65535,65690,0x9050102,65535,65535,65652
.long 68419845,131149,524450,262281,201987,1573018,65535,65695
.long 328196,2097308,65535,65535,18156549,131197,3408034,65741
.long 18156805,131197,3670178,65749,18157061,131205,3932322,65758
.long 18157317,131205,262401,65769,0,65535,65535,65535
.long 0,65535,65535,65535,0,65535,65535,65535
.long 0,65535,65535,65535,0,65535,65535,65535
.long 0xb010202,65535,65535,524301,0xb050202,65535,65535,524333
.long 0xa060002,65535,65535,65690,0xa050102,65535,65535,65653
.long 68158725,131164,1573026,262285,202243,1573018,65535,65695
.long 393732,2097308,65535,65535,18222085,131197,3408034,65741
.long 18222341,131197,3670178,65749,18222597,131205,3932322,65758
.long 18222853,131205,262402,65769,0,65535,65535,65535
.long 0,65535,65535,65535,0,65535,65535,65535
.long 0,65535,65535,65535,0,65535,65535,65535
.long 0xb010302,65535,65535,524301,0xb050302,65535,65535,524333
.long 0xa070002,65535,65535,65690,0xb050102,65535,65535,65653
.long 68420869,131165,1573026,262285,202499,1573018,65535,65695
.long 459268,2097308,65535,65535,18287621,131197,3408034,65741
.long 18287877,131197,3670178,65749,18288133,131205,3932322,65758
.long 18288389,131205,262403,65769,0,65535,65535,65535
.long 0,65535,65535,65535,0,65535,65535,65535
.long 0,65535,65535,65535,0,65535,65535,65535
.long 0x8020202,65535,65535,524308,0x8060202,65535,65535,524340
.long 0x8000102,65535,65535,65612,0x8060102,65535,65535,65660
.long 68157957,131156,786594,262282,68159493,131180,2359458,262288
.long 135171,1573018,65535,65694,265732,2097311,65535,65535
.long 553651463,65535,1048789,65535,0,65535,65535,65535
.long 0,65535,65535,65535,0,65535,65535,65535
.long 0,65535,65535,65535,0,65535,65535,65535
.long 0,65535,65535,65535,0,65535,65535,65535
.long 0x8020302,65535,65535,524308,0x8060302,65535,65535,524340
.long 0x9000102,65535,65535,65612,0x9060102,65535,65535,65660
.long 68420101,131157,786594,262282,68421637,131181,2359458,262288
.long 135427,1573018,65535,65694,331268,2097311,65535,65535
.long 553782535,65535,1048789,65535,0,65535,65535,65535
.long 0,65535,65535,65535,0,65535,65535,65535
.long 0,65535,65535,65535,0,65535,65535,65535
.long 0,65535,65535,65535,0,65535,65535,65535
.long 0x9020202,65535,65535,524308,0x9060202,65535,65535,524340
.long 0xa000102,65535,65535,65613,0xa060102,65535,65535,65661
.long 68158981,131172,1835170,262286,68159749,131180,2621602,262289
.long 135683,1573018,65535,65694,553913607,65535,1048789,65535
.long 0,65535,65535,65535,0,65535,65535,65535
.long 0,65535,65535,65535,0,65535,65535,65535
.long 0,65535,65535,65535,0,65535,65535,65535
.long 0,65535,65535,65535,0,65535,65535,65535
.long 0x9020302,65535,65535,524308,0x9060302,65535,65535,524340
.long 0xb000102,65535,65535,65613,0xb060102,65535,65535,65661
.long 68421125,131173,1835170,262286,68421893,131181,2621602,262289
.long 135939,1573018,65535,65694,554044679,65535,1048789,65535
.long 0,65535,65535,65535,0,65535,65535,65535
.long 0,65535,65535,65535,0,65535,65535,65535
.long 0,65535,65535,65535,0,65535,65535,65535
.long 0,65535,65535,65535,0,65535,65535,65535
.long 0xa020202,65535,65535,524309,0xa060202,65535,65535,524341
.long 0x8010102,65535,65535,65620,0x8070102,65535,65535,65668
.long 68158213,131156,1048738,262283,136195,1573018,65535,65694
.long 3588,2097311,65535,65535,553651207,65535,1048781,65535
.long 0,65535,65535,65535,0,65535,65535,65535
.long 0,65535,65535,65535,0,65535,65535,65535
.long 0,65535,65535,65535,0,65535,65535,65535
.long 0,65535,65535,65535,0,65535,65535,65535
.long 0xa020302,65535,65535,524309,0xa060302,65535,65535,524341
.long 0x9010102,65535,65535,65620,0x9070102,65535,65535,65668
.long 68420357,131157,1048738,262283,136451,1573018,65535,65694
.long 69124,2097311,65535,65535,553782279,65535,1048781,65535
.long 0,65535,65535,65535,0,65535,65535,65535
.long 0,65535,65535,65535,0,65535,65535,65535
.long 0,65535,65535,65535,0,65535,65535,65535
.long 0,65535,65535,65535,0,65535,65535,65535
.long 0xb020202,65535,65535,524309,0xb060202,65535,65535,524341
.long 0xa010102,65535,65535,65621,0xa070102,65535,65535,65669
.long 68159237,131172,2097314,262287,136707,1573018,65535,65694
.long 134660,2097311,65535,65535,553913351,65535,1048781,65535
.long 0,65535,65535,65535,0,65535,65535,65535
.long 0,65535,65535,65535,0,65535,65535,65535
.long 0,65535,65535,65535,0,65535,65535,65535
.long 0,65535,65535,65535,0,65535,65535,65535
.long 0xb020302,65535,65535,524309,0xb060302,65535,65535,524341
.long 0xb010102,65535,65535,65621,0xb070102,65535,65535,65669
.long 68421381,131173,2097314,262287,136963,1573018,65535,65694
.long 200196,2097311,65535,65535,554044423,65535,1048781,65535
.long 0,65535,65535,65535,0,65535,65535,65535
.long 0,65535,65535,65535,0,65535,65535,65535
.long 0,65535,65535,65535,0,65535,65535,65535
.long 0,65535,65535,65535,0,65535,65535,65535
.long 402653697,65535,65535,262150,402719233,65535,65535,262214
.long 0xc030202,65535,65535,524318,50331650,65535,65535,65691
.long 0xc070202,65535,65535,524350,6147,1573019,65535,65692
.long 1796,2097309,65535,65535,263940,2097309,65535,65535
.long 2820,2097310,65535,65535,264964,2097310,65535,65535
.long 0,65535,65535,65535,0,65535,65535,65535
.long 0,65535,65535,65535,0,65535,65535,65535
.long 0,65535,65535,65535,0,65535,65535,65535
.long 402653953,65535,65535,262150,402719489,65535,65535,262214
.long 0xc030302,65535,65535,524318,50397186,65535,65535,65691
.long 0xc070302,65535,65535,524350,6403,1573019,65535,65692
.long 67332,2097309,65535,65535,329476,2097309,65535,65535
.long 68356,2097310,65535,65535,330500,2097310,65535,65535
.long 0,65535,65535,65535,0,65535,65535,65535
.long 0,65535,65535,65535,0,65535,65535,65535
.long 0,65535,65535,65535,0,65535,65535,65535
.long 419430913,65535,65535,262150,419496449,65535,65535,262214
.long 0xd030202,65535,65535,524318,50462722,65535,65535,65691
.long 0xd070202,65535,65535,524350,6659,1573019,65535,65692
.long 132868,2097309,65535,65535,395012,2097309,65535,65535
.long 133892,2097310,65535,65535,396036,2097310,65535,65535
.long 0,65535,65535,65535,0,65535,65535,65535
.long 0,65535,65535,65535,0,65535,65535,65535
.long 0,65535,65535,65535,0,65535,65535,65535
.long 419431169,65535,65535,262150,419496705,65535,65535,262214
.long 0xd030302,65535,65535,524318,50528258,65535,65535,65691
.long 0xd070302,65535,65535,524350,6915,1573019,65535,65692
.long 198404,2097309,65535,65535,460548,2097309,65535,65535
.long 199428,2097310,65535,65535,461572,2097310,65535,65535
.long 0,65535,65535,65535,0,65535,65535,65535
.long 0,65535,65535,65535,0,65535,65535,65535
.long 0,65535,65535,65535,0,65535,65535,65535
.long 436208129,65535,65535,262150,436273665,65535,65535,262214
.long 0xe030202,65535,65535,524319,50593794,65535,65535,65691
.long 0xe070202,65535,65535,524351,7171,1573019,65535,65692
.long 68684293,131190,2883747,262290,395784,2097298,65535,65535
.long 397060,2097311,65535,65535,0,65535,65535,65535
.long 0,65535,65535,65535,0,65535,65535,65535
.long 0,65535,65535,65535,0,65535,65535,65535
.long 0,65535,65535,65535,0,65535,65535,65535
.long 436208385,65535,65535,262150,436273921,65535,65535,262214
.long 0xe030302,65535,65535,524319,50659330,65535,65535,65691
.long 0xe070302,65535,65535,524351,7427,1573019,65535,65692
.long 68946437,131191,2883747,262290,461320,2097298,65535,65535
.long 462596,2097311,65535,65535,0,65535,65535,65535
.long 0,65535,65535,65535,0,65535,65535,65535
.long 0,65535,65535,65535,0,65535,65535,65535
.long 0,65535,65535,65535,0,65535,65535,65535
.long 452985345,65535,65535,262150,453050881,65535,65535,262214
.long 0xf030202,65535,65535,524319,50724866,65535,65535,65691
.long 0xf070202,65535,65535,524351,7683,1573019,65535,65692
.long 68684549,131190,3145891,262291,396040,2097299,65535,65535
.long 0,65535,65535,65535,0,65535,65535,65535
.long 0,65535,65535,65535,0,65535,65535,65535
.long 0,65535,65535,65535,0,65535,65535,65535
.long 0,65535,65535,65535,0,65535,65535,65535
.long 452985601,65535,65535,262150,453051137,65535,65535,262214
.long 0xf030302,65535,65535,524319,50790402,65535,65535,65691
.long 0xf070302,65535,65535,524351,7939,1573019,65535,65692
.long 68946693,131191,3145891,262291,461576,2097299,65535,65535
.long 0,65535,65535,65535,0,65535,65535,65535
.long 0,65535,65535,65535,0,65535,65535,65535
.long 0,65535,65535,65535,0,65535,65535,65535
.long 0,65535,65535,65535,0,65535,65535,65535
.long 469762561,65535,65535,262151,469828097,65535,65535,262215
.long 0xc040202,65535,65535,524326,0x7000002,65535,65535,65691
.long 0xc020102,65535,65535,65630,71683,1573019,65535,65693
.long 774,2097291,65535,65535,3332,2097311,65535,65535
.long 0,65535,65535,65535,0,65535,65535,65535
.long 0,65535,65535,65535,0,65535,65535,65535
.long 0,65535,65535,65535,0,65535,65535,65535
.long 0,65535,65535,65535,0,65535,65535,65535
.long 469762817,65535,65535,262151,469828353,65535,65535,262215
.long 0xc040302,65535,65535,524326,0x7010002,65535,65535,65691
.long 0xd020102,65535,65535,65630,71939,1573019,65535,65693
.long 66310,2097291,65535,65535,68868,2097311,65535,65535
.long 0,65535,65535,65535,0,65535,65535,65535
.long 0,65535,65535,65535,0,65535,65535,65535
.long 0,65535,65535,65535,0,65535,65535,65535
.long 0,65535,65535,65535,0,65535,65535,65535
.long 486539777,65535,65535,262151,486605313,65535,65535,262215
.long 0xd040202,65535,65535,524326,0x7020002,65535,65535,65691
.long 0xe020102,65535,65535,65631,72195,1573019,65535,65693
.long 131846,2097291,65535,65535,134404,2097311,65535,65535
.long 0,65535,65535,65535,0,65535,65535,65535
.long 0,65535,65535,65535,0,65535,65535,65535
.long 0,65535,65535,65535,0,65535,65535,65535
.long 0,65535,65535,65535,0,65535,65535,65535
.long 486540033,65535,65535,262151,486605569,65535,65535,262215
.long 0xd040302,65535,65535,524326,0x7030002,65535,65535,65691
.long 0xf020102,65535,65535,65631,72451,1573019,65535,65693
.long 197382,2097291,65535,65535,199940,2097311,65535,65535
.long 0,65535,65535,65535,0,65535,65535,65535
.long 0,65535,65535,65535,0,65535,65535,65535
.long 0,65535,65535,65535,0,65535,65535,65535
.long 0,65535,65535,65535,0,65535,65535,65535
.long 503316993,65535,65535,262151,503382529,65535,65535,262215
.long 0xe040202,65535,65535,524327,0x7040002,65535,65535,65691
.long 0xc030102,65535,65535,65638,72707,1573019,65535,65693
.long 1798,2097295,65535,65535,265476,2097311,65535,65535
.long 0,65535,65535,65535,0,65535,65535,65535
.long 0,65535,65535,65535,0,65535,65535,65535
.long 0,65535,65535,65535,0,65535,65535,65535
.long 0,65535,65535,65535,0,65535,65535,65535
.long 503317249,65535,65535,262151,503382785,65535,65535,262215
.long 0xe040302,65535,65535,524327,0x7050002,65535,65535,65691
.long 0xd030102,65535,65535,65638,72963,1573019,65535,65693
.long 67334,2097295,65535,65535,331012,2097311,65535,65535
.long 0,65535,65535,65535,0,65535,65535,65535
.long 0,65535,65535,65535,0,65535,65535,65535
.long 0,65535,65535,65535,0,65535,65535,65535
.long 0,65535,65535,65535,0,65535,65535,65535
.long 520094209,65535,65535,262151,520159745,65535,65535,262215
.long 0xf040202,65535,65535,524327,0x7060002,65535,65535,65691
.long 0xe030102,65535,65535,65639,73219,1573019,65535,65693
.long 132870,2097295,65535,65535,396548,2097311,65535,65535
.long 0,65535,65535,65535,0,65535,65535,65535
.long 0,65535,65535,65535,0,65535,65535,65535
.long 0,65535,65535,65535,0,65535,65535,65535
.long 0,65535,65535,65535,0,65535,65535,65535
.long 520094465,65535,65535,262151,520160001,65535,65535,262215
.long 0xf040302,65535,65535,524327,0x7070002,65535,65535,65691
.long 0xf030102,65535,65535,65639,73475,1573019,65535,65693
.long 198406,2097295,65535,65535,462084,2097311,65535,65535
.long 0,65535,65535,65535,0,65535,65535,65535
.long 0,65535,65535,65535,0,65535,65535,65535
.long 0,65535,65535,65535,0,65535,65535,65535
.long 0,65535,65535,65535,0,65535,65535,65535
.long 0xc010202,65535,65535,524302,0xc050202,65535,65535,524334
.long 0xb000002,65535,65535,65691,0xc040102,65535,65535,65646
.long 68681733,131150,262307,262280,202755,1573019,65535,65695
.long 772,2097308,65535,65535,18353157,131198,3408035,65741
.long 18353413,131198,3670179,65749,18353669,131206,3932323,65759
.long 18353925,131206,262404,65770,0,65535,65535,65535
.long 0,65535,65535,65535,0,65535,65535,65535
.long 0,65535,65535,65535,0,65535,65535,65535
.long 0xc010302,65535,65535,524302,0xc050302,65535,65535,524334
.long 0xb010002,65535,65535,65691,0xd040102,65535,65535,65646
.long 68943877,131151,262307,262280,203011,1573019,65535,65695
.long 66308,2097308,65535,65535,18418693,131198,3408035,65741
.long 18418949,131198,3670179,65749,18419205,131206,3932323,65759
.long 18419461,131206,262405,65770,0,65535,65535,65535
.long 0,65535,65535,65535,0,65535,65535,65535
.long 0,65535,65535,65535,0,65535,65535,65535
.long 0xd010202,65535,65535,524302,0xd050202,65535,65535,524334
.long 0xb020002,65535,65535,65691,0xe040102,65535,65535,65647
.long 68682757,131166,1310883,262284,203267,1573019,65535,65695
.long 131844,2097308,65535,65535,18484229,131198,3408035,65741
.long 18484485,131198,3670179,65749,18484741,131206,3932323,65759
.long 18484997,131206,262406,65770,0,65535,65535,65535
.long 0,65535,65535,65535,0,65535,65535,65535
.long 0,65535,65535,65535,0,65535,65535,65535
.long 0xd010302,65535,65535,524302,0xd050302,65535,65535,524334
.long 0xb030002,65535,65535,65691,0xf040102,65535,65535,65647
.long 68944901,131167,1310883,262284,203523,1573019,65535,65695
.long 197380,2097308,65535,65535,18549765,131198,3408035,65741
.long 18550021,131198,3670179,65749,18550277,131206,3932323,65759
.long 18550533,131206,262407,65770,0,65535,65535,65535
.long 0,65535,65535,65535,0,65535,65535,65535
.long 0,65535,65535,65535,0,65535,65535,65535
.long 0xe010202,65535,65535,524303,0xe050202,65535,65535,524335
.long 0xb040002,65535,65535,65691,0xc050102,65535,65535,65654
.long 68681989,131150,524451,262281,203779,1573019,65535,65695
.long 262916,2097308,65535,65535,18615301,131199,3408035,65741
.long 18615557,131199,3670179,65749,18615813,131207,3932323,65759
.long 18616069,131207,262408,65771,0,65535,65535,65535
.long 0,65535,65535,65535,0,65535,65535,65535
.long 0,65535,65535,65535,0,65535,65535,65535
.long 0xe010302,65535,65535,524303,0xe050302,65535,65535,524335
.long 0xb050002,65535,65535,65691,0xd050102,65535,65535,65654
.long 68944133,131151,524451,262281,204035,1573019,65535,65695
.long 328452,2097308,65535,65535,18680837,131199,3408035,65741
.long 18681093,131199,3670179,65749,18681349,131207,3932323,65759
.long 18681605,131207,262409,65771,0,65535,65535,65535
.long 0,65535,65535,65535,0,65535,65535,65535
.long 0,65535,65535,65535,0,65535,65535,65535
.long 0xf010202,65535,65535,524303,0xf050202,65535,65535,524335
.long 0xb060002,65535,65535,65691,0xe050102,65535,65535,65655
.long 68683013,131166,1573027,262285,204291,1573019,65535,65695
.long 393988,2097308,65535,65535,18746373,131199,3408035,65741
.long 18746629,131199,3670179,65749,18746885,131207,3932323,65759
.long 18747141,131207,262410,65771,0,65535,65535,65535
.long 0,65535,65535,65535,0,65535,65535,65535
.long 0,65535,65535,65535,0,65535,65535,65535
.long 0xf010302,65535,65535,524303,0xf050302,65535,65535,524335
.long 0xb070002,65535,65535,65691,0xf050102,65535,65535,65655
.long 68945157,131167,1573027,262285,204547,1573019,65535,65695
.long 459524,2097308,65535,65535,18811909,131199,3408035,65741
.long 18812165,131199,3670179,65749,18812421,131207,3932323,65759
.long 18812677,131207,262411,65771,0,65535,65535,65535
.long 0,65535,65535,65535,0,65535,65535,65535
.long 0,65535,65535,65535,0,65535,65535,65535
.long 0xc020202,65535,65535,524310,0xc060202,65535,65535,524342
.long 0xc000102,65535,65535,65614,0xc060102,65535,65535,65662
.long 68682245,131158,786595,262282,68683781,131182,2359459,262288
.long 137219,1573019,65535,65694,265988,2097311,65535,65535
.long 553716999,65535,1048789,65535,0,65535,65535,65535
.long 0,65535,65535,65535,0,65535,65535,65535
.long 0,65535,65535,65535,0,65535,65535,65535
.long 0,65535,65535,65535,0,65535,65535,65535
.long 0xc020302,65535,65535,524310,0xc060302,65535,65535,524342
.long 0xd000102,65535,65535,65614,0xd060102,65535,65535,65662
.long 68944389,131159,786595,262282,68945925,131183,2359459,262288
.long 137475,1573019,65535,65694,331524,2097311,65535,65535
.long 553848071,65535,1048789,65535,0,65535,65535,65535
.long 0,65535,65535,65535,0,65535,65535,65535
.long 0,65535,65535,65535,0,65535,65535,65535
.long 0,65535,65535,65535,0,65535,65535,65535
.long 0xd020202,65535,65535,524310,0xd060202,65535,65535,524342
.long 0xe000102,65535,65535,65615,0xe060102,65535,65535,65663
.long 68683269,131174,1835171,262286,68684037,131182,2621603,262289
.long 137731,1573019,65535,65694,553979143,65535,1048789,65535
.long 0,65535,65535,65535,0,65535,65535,65535
.long 0,65535,65535,65535,0,65535,65535,65535
.long 0,65535,65535,65535,0,65535,65535,65535
.long 0,65535,65535,65535,0,65535,65535,65535
.long 0xd020302,65535,65535,524310,0xd060302,65535,65535,524342
.long 0xf000102,65535,65535,65615,0xf060102,65535,65535,65663
.long 68945413,131175,1835171,262286,68946181,131183,2621603,262289
.long 137987,1573019,65535,65694,554110215,65535,1048789,65535
.long 0,65535,65535,65535,0,65535,65535,65535
.long 0,65535,65535,65535,0,65535,65535,65535
.long 0,65535,65535,65535,0,65535,65535,65535
.long 0,65535,65535,65535,0,65535,65535,65535
.long 0xe020202,65535,65535,524311,0xe060202,65535,65535,524343
.long 0xc010102,65535,65535,65622,0xc070102,65535,65535,65670
.long 68682501,131158,1048739,262283,138243,1573019,65535,65694
.long 3844,2097311,65535,65535,553716743,65535,1048781,65535
.long 0,65535,65535,65535,0,65535,65535,65535
.long 0,65535,65535,65535,0,65535,65535,65535
.long 0,65535,65535,65535,0,65535,65535,65535
.long 0,65535,65535,65535,0,65535,65535,65535
.long 0xe020302,65535,65535,524311,0xe060302,65535,65535,524343
.long 0xd010102,65535,65535,65622,0xd070102,65535,65535,65670
.long 68944645,131159,1048739,262283,138499,1573019,65535,65694
.long 69380,2097311,65535,65535,553847815,65535,1048781,65535
.long 0,65535,65535,65535,0,65535,65535,65535
.long 0,65535,65535,65535,0,65535,65535,65535
.long 0,65535,65535,65535,0,65535,65535,65535
.long 0,65535,65535,65535,0,65535,65535,65535
.long 0xf020202,65535,65535,524311,0xf060202,65535,65535,524343
.long 0xe010102,65535,65535,65623,0xe070102,65535,65535,65671
.long 68683525,131174,2097315,262287,138755,1573019,65535,65694
.long 134916,2097311,65535,65535,553978887,65535,1048781,65535
.long 0,65535,65535,65535,0,65535,65535,65535
.long 0,65535,65535,65535,0,65535,65535,65535
.long 0,65535,65535,65535,0,65535,65535,65535
.long 0,65535,65535,65535,0,65535,65535,65535
.long 0xf020302,65535,65535,524311,0xf060302,65535,65535,524343
.long 0xf010102,65535,65535,65623,0xf070102,65535,65535,65671
.long 68945669,131175,2097315,262287,139011,1573019,65535,65694
.long 200452,2097311,65535,65535,554109959,65535,1048781,65535
.long 0,65535,65535,65535,0,65535,65535,65535
.long 0,65535,65535,65535,0,65535,65535,65535
.long 0,65535,65535,65535,0,65535,65535,65535
.long 0,65535,65535,65535,0,65535,65535,65535
.long 3847,65535,262372,65535,0,65535,65535,65535
.long 0,65535,65535,65535,0,65535,65535,65535
.long 0,65535,65535,65535,0,65535,65535,65535
.long 0,65535,65535,65535,0,65535,65535,65535
.long 0,65535,65535,65535,0,65535,65535,65535
.long 0,65535,65535,65535,0,65535,65535,65535
.long 0,65535,65535,65535,0,65535,65535,65535
.long 0,65535,65535,65535,0,65535,65535,65535
.long 16781063,65535,262373,65535,0,65535,65535,65535
.long 0,65535,65535,65535,0,65535,65535,65535
.long 0,65535,65535,65535,0,65535,65535,65535
.long 0,65535,65535,65535,0,65535,65535,65535
.long 0,65535,65535,65535,0,65535,65535,65535
.long 0,65535,65535,65535,0,65535,65535,65535
.long 0,65535,65535,65535,0,65535,65535,65535
.long 0,65535,65535,65535,0,65535,65535,65535
.long 69383,65535,262372,65535,0,65535,65535,65535
.long 0,65535,65535,65535,0,65535,65535,65535
.long 0,65535,65535,65535,0,65535,65535,65535
.long 0,65535,65535,65535,0,65535,65535,65535
.long 0,65535,65535,65535,0,65535,65535,65535
.long 0,65535,65535,65535,0,65535,65535,65535
.long 0,65535,65535,65535,0,65535,65535,65535
.long 0,65535,65535,65535,0,65535,65535,65535
.long 16846599,65535,262373,65535,0,65535,65535,65535
.long 0,65535,65535,65535,0,65535,65535,65535
.long 0,65535,65535,65535,0,65535,65535,65535
.long 0,65535,65535,65535,0,65535,65535,65535
.long 0,65535,65535,65535,0,65535,65535,65535
.long 0,65535,65535,65535,0,65535,65535,65535
.long 0,65535,65535,65535,0,65535,65535,65535
.long 0,65535,65535,65535,0,65535,65535,65535
.long 134919,65535,262372,65535,0,65535,65535,65535
.long 0,65535,65535,65535,0,65535,65535,65535
.long 0,65535,65535,65535,0,65535,65535,65535
.long 0,65535,65535,65535,0,65535,65535,65535
.long 0,65535,65535,65535,0,65535,65535,65535
.long 0,65535,65535,65535,0,65535,65535,65535
.long 0,65535,65535,65535,0,65535,65535,65535
.long 0,65535,65535,65535,0,65535,65535,65535
.long 16912135,65535,262373,65535,0,65535,65535,65535
.long 0,65535,65535,65535,0,65535,65535,65535
.long 0,65535,65535,65535,0,65535,65535,65535
.long 0,65535,65535,65535,0,65535,65535,65535
.long 0,65535,65535,65535,0,65535,65535,65535
.long 0,65535,65535,65535,0,65535,65535,65535
.long 0,65535,65535,65535,0,65535,65535,65535
.long 0,65535,65535,65535,0,65535,65535,65535
.long 200455,65535,262372,65535,0,65535,65535,65535
.long 0,65535,65535,65535,0,65535,65535,65535
.long 0,65535,65535,65535,0,65535,65535,65535
.long 0,65535,65535,65535,0,65535,65535,65535
.long 0,65535,65535,65535,0,65535,65535,65535
.long 0,65535,65535,65535,0,65535,65535,65535
.long 0,65535,65535,65535,0,65535,65535,65535
.long 0,65535,65535,65535,0,65535,65535,65535
.long 16977671,65535,262373,65535,0,65535,65535,65535
.long 0,65535,65535,65535,0,65535,65535,65535
.long 0,65535,65535,65535,0,65535,65535,65535
.long 0,65535,65535,65535,0,65535,65535,65535
.long 0,65535,65535,65535,0,65535,65535,65535
.long 0,65535,65535,65535,0,65535,65535,65535
.long 0,65535,65535,65535,0,65535,65535,65535
.long 0,65535,65535,65535,0,65535,65535,65535
.long 265991,65535,262372,65535,0,65535,65535,65535
.long 0,65535,65535,65535,0,65535,65535,65535
.long 0,65535,65535,65535,0,65535,65535,65535
.long 0,65535,65535,65535,0,65535,65535,65535
.long 0,65535,65535,65535,0,65535,65535,65535
.long 0,65535,65535,65535,0,65535,65535,65535
.long 0,65535,65535,65535,0,65535,65535,65535
.long 0,65535,65535,65535,0,65535,65535,65535
.long 17043207,65535,262373,65535,0,65535,65535,65535
.long 0,65535,65535,65535,0,65535,65535,65535
.long 0,65535,65535,65535,0,65535,65535,65535
.long 0,65535,65535,65535,0,65535,65535,65535
.long 0,65535,65535,65535,0,65535,65535,65535
.long 0,65535,65535,65535,0,65535,65535,65535
.long 0,65535,65535,65535,0,65535,65535,65535
.long 0,65535,65535,65535,0,65535,65535,65535
.long 331527,65535,262372,65535,0,65535,65535,65535
.long 0,65535,65535,65535,0,65535,65535,65535
.long 0,65535,65535,65535,0,65535,65535,65535
.long 0,65535,65535,65535,0,65535,65535,65535
.long 0,65535,65535,65535,0,65535,65535,65535
.long 0,65535,65535,65535,0,65535,65535,65535
.long 0,65535,65535,65535,0,65535,65535,65535
.long 0,65535,65535,65535,0,65535,65535,65535
.long 17108743,65535,262373,65535,0,65535,65535,65535
.long 0,65535,65535,65535,0,65535,65535,65535
.long 0,65535,65535,65535,0,65535,65535,65535
.long 0,65535,65535,65535,0,65535,65535,65535
.long 0,65535,65535,65535,0,65535,65535,65535
.long 0,65535,65535,65535,0,65535,65535,65535
.long 0,65535,65535,65535,0,65535,65535,65535
.long 0,65535,65535,65535,0,65535,65535,65535
.long 397063,65535,262372,65535,0,65535,65535,65535
.long 0,65535,65535,65535,0,65535,65535,65535
.long 0,65535,65535,65535,0,65535,65535,65535
.long 0,65535,65535,65535,0,65535,65535,65535
.long 0,65535,65535,65535,0,65535,65535,65535
.long 0,65535,65535,65535,0,65535,65535,65535
.long 0,65535,65535,65535,0,65535,65535,65535
.long 0,65535,65535,65535,0,65535,65535,65535
.long 17174279,65535,262373,65535,0,65535,65535,65535
.long 0,65535,65535,65535,0,65535,65535,65535
.long 0,65535,65535,65535,0,65535,65535,65535
.long 0,65535,65535,65535,0,65535,65535,65535
.long 0,65535,65535,65535,0,65535,65535,65535
.long 0,65535,65535,65535,0,65535,65535,65535
.long 0,65535,65535,65535,0,65535,65535,65535
.long 0,65535,65535,65535,0,65535,65535,65535
.long 462599,65535,262372,65535,0,65535,65535,65535
.long 0,65535,65535,65535,0,65535,65535,65535
.long 0,65535,65535,65535,0,65535,65535,65535
.long 0,65535,65535,65535,0,65535,65535,65535
.long 0,65535,65535,65535,0,65535,65535,65535
.long 0,65535,65535,65535,0,65535,65535,65535
.long 0,65535,65535,65535,0,65535,65535,65535
.long 0,65535,65535,65535,0,65535,65535,65535
.long 17239815,65535,262373,65535,0,65535,65535,65535
.long 0,65535,65535,65535,0,65535,65535,65535
.long 0,65535,65535,65535,0,65535,65535,65535
.long 0,65535,65535,65535,0,65535,65535,65535
.long 0,65535,65535,65535,0,65535,65535,65535
.long 0,65535,65535,65535,0,65535,65535,65535
.long 0,65535,65535,65535,0,65535,65535,65535
.long 0,65535,65535,65535,0,65535,65535,65535
.long 268439047,65535,524508,65535,0,65535,65535,65535
.long 0,65535,65535,65535,0,65535,65535,65535
.long 0,65535,65535,65535,0,65535,65535,65535
.long 0,65535,65535,65535,0,65535,65535,65535
.long 0,65535,65535,65535,0,65535,65535,65535
.long 0,65535,65535,65535,0,65535,65535,65535
.long 0,65535,65535,65535,0,65535,65535,65535
.long 0,65535,65535,65535,0,65535,65535,65535
.long 268504583,65535,524508,65535,0,65535,65535,65535
.long 0,65535,65535,65535,0,65535,65535,65535
.long 0,65535,65535,65535,0,65535,65535,65535
.long 0,65535,65535,65535,0,65535,65535,65535
.long 0,65535,65535,65535,0,65535,65535,65535
.long 0,65535,65535,65535,0,65535,65535,65535
.long 0,65535,65535,65535,0,65535,65535,65535
.long 0,65535,65535,65535,0,65535,65535,65535
.long 268570119,65535,524508,65535,0,65535,65535,65535
.long 0,65535,65535,65535,0,65535,65535,65535
.long 0,65535,65535,65535,0,65535,65535,65535
.long 0,65535,65535,65535,0,65535,65535,65535
.long 0,65535,65535,65535,0,65535,65535,65535
.long 0,65535,65535,65535,0,65535,65535,65535
.long 0,65535,65535,65535,0,65535,65535,65535
.long 0,65535,65535,65535,0,65535,65535,65535
.long 268635655,65535,524508,65535,0,65535,65535,65535
.long 0,65535,65535,65535,0,65535,65535,65535
.long 0,65535,65535,65535,0,65535,65535,65535
.long 0,65535,65535,65535,0,65535,65535,65535
.long 0,65535,65535,65535,0,65535,65535,65535
.long 0,65535,65535,65535,0,65535,65535,65535
.long 0,65535,65535,65535,0,65535,65535,65535
.long 0,65535,65535,65535,0,65535,65535,65535
.long 268701191,65535,524508,65535,0,65535,65535,65535
.long 0,65535,65535,65535,0,65535,65535,65535
.long 0,65535,65535,65535,0,65535,65535,65535
.long 0,65535,65535,65535,0,65535,65535,65535
.long 0,65535,65535,65535,0,65535,65535,65535
.long 0,65535,65535,65535,0,65535,65535,65535
.long 0,65535,65535,65535,0,65535,65535,65535
.long 0,65535,65535,65535,0,65535,65535,65535
.long 268766727,65535,524508,65535,0,65535,65535,65535
.long 0,65535,65535,65535,0,65535,65535,65535
.long 0,65535,65535,65535,0,65535,65535,65535
.long 0,65535,65535,65535,0,65535,65535,65535
.long 0,65535,65535,65535,0,65535,65535,65535
.long 0,65535,65535,65535,0,65535,65535,65535
.long 0,65535,65535,65535,0,65535,65535,65535
.long 0,65535,65535,65535,0,65535,65535,65535
.long 268832263,65535,524508,65535,0,65535,65535,65535
.long 0,65535,65535,65535,0,65535,65535,65535
.long 0,65535,65535,65535,0,65535,65535,65535
.long 0,65535,65535,65535,0,65535,65535,65535
.long 0,65535,65535,65535,0,65535,65535,65535
.long 0,65535,65535,65535,0,65535,65535,65535
.long 0,65535,65535,65535,0,65535,65535,65535
.long 0,65535,65535,65535,0,65535,65535,65535
.long 268897799,65535,524508,65535,0,65535,65535,65535
.long 0,65535,65535,65535,0,65535,65535,65535
.long 0,65535,65535,65535,0,65535,65535,65535
.long 0,65535,65535,65535,0,65535,65535,65535
.long 0,65535,65535,65535,0,65535,65535,65535
.long 0,65535,65535,65535,0,65535,65535,65535
.long 0,65535,65535,65535,0,65535,65535,65535
.long 0,65535,65535,65535,0,65535,65535,65535
.long 0,65535,65535,65535,0,65535,65535,65535
.long 0,65535,65535,65535,0,65535,65535,65535
.long 0,65535,65535,65535,0,65535,65535,65535
.long 0,65535,65535,65535,0,65535,65535,65535
.long 0,65535,65535,65535,0,65535,65535,65535
.long 0,65535,65535,65535,0,65535,65535,65535
.long 0,65535,65535,65535,0,65535,65535,65535
.long 0,65535,65535,65535,0,65535,65535,65535
.long 0,65535,65535,65535,0,65535,65535,65535
.long 0,65535,65535,65535,0,65535,65535,65535
.long 0,65535,65535,65535,0,65535,65535,65535
.long 0,65535,65535,65535,0,65535,65535,65535
.long 0,65535,65535,65535,0,65535,65535,65535
.long 0,65535,65535,65535,0,65535,65535,65535
.long 0,65535,65535,65535,0,65535,65535,65535
.long 0,65535,65535,65535,0,65535,65535,65535
.long 0,65535,65535,65535,0,65535,65535,65535
.long 0,65535,65535,65535,0,65535,65535,65535
.long 0,65535,65535,65535,0,65535,65535,65535
.long 0,65535,65535,65535,0,65535,65535,65535
.long 0,65535,65535,65535,0,65535,65535,65535
.long 0,65535,65535,65535,0,65535,65535,65535
.long 0,65535,65535,65535,0,65535,65535,65535
.long 0,65535,65535,65535,0,65535,65535,65535
.long 0,65535,65535,65535,0,65535,65535,65535
.long 0,65535,65535,65535,0,65535,65535,65535
.long 0,65535,65535,65535,0,65535,65535,65535
.long 0,65535,65535,65535,0,65535,65535,65535
.long 0,65535,65535,65535,0,65535,65535,65535
.long 0,65535,65535,65535,0,65535,65535,65535
.long 0,65535,65535,65535,0,65535,65535,65535
.long 0,65535,65535,65535,0,65535,65535,65535
.long 0,65535,65535,65535,0,65535,65535,65535
.long 0,65535,65535,65535,0,65535,65535,65535
.long 0,65535,65535,65535,0,65535,65535,65535
.long 0,65535,65535,65535,0,65535,65535,65535
.long 0,65535,65535,65535,0,65535,65535,65535
.long 0,65535,65535,65535,0,65535,65535,65535
.long 0,65535,65535,65535,0,65535,65535,65535
.long 0,65535,65535,65535,0,65535,65535,65535
.long 0,65535,65535,65535,0,65535,65535,65535
.long 0,65535,65535,65535,0,65535,65535,65535
.long 0,65535,65535,65535,0,65535,65535,65535
.long 0,65535,65535,65535,0,65535,65535,65535
.long 0,65535,65535,65535,0,65535,65535,65535
.long 0,65535,65535,65535,0,65535,65535,65535
.long 0,65535,65535,65535,0,65535,65535,65535
.long 0,65535,65535,65535,0,65535,65535,65535
.long 0,65535,65535,65535,0,65535,65535,65535
.long 0,65535,65535,65535,0,65535,65535,65535
.long 0,65535,65535,65535,0,65535,65535,65535
.long 0,65535,65535,65535,0,65535,65535,65535
.long 0,65535,65535,65535,0,65535,65535,65535
.long 0,65535,65535,65535,0,65535,65535,65535
.long 0,65535,65535,65535,0,65535,65535,65535
.long 0,65535,65535,65535,0,65535,65535,65535
.long 0,65535,65535,65535,0,65535,65535,65535
.long 0,65535,65535,65535,0,65535,65535,65535
.long 0,65535,65535,65535,0,65535,65535,65535
.long 0,65535,65535,65535,0,65535,65535,65535
.long 0,65535,65535,65535,0,65535,65535,65535
.long 0,65535,65535,65535,0,65535,65535,65535
.long 0,65535,65535,65535,0,65535,65535,65535
.long 0,65535,65535,65535,0,65535,65535,65535
.long 33558279,65535,262374,65535,0,65535,65535,65535
.long 0,65535,65535,65535,0,65535,65535,65535
.long 0,65535,65535,65535,0,65535,65535,65535
.long 0,65535,65535,65535,0,65535,65535,65535
.long 0,65535,65535,65535,0,65535,65535,65535
.long 0,65535,65535,65535,0,65535,65535,65535
.long 0,65535,65535,65535,0,65535,65535,65535
.long 0,65535,65535,65535,0,65535,65535,65535
.long 50335495,65535,262375,65535,0,65535,65535,65535
.long 0,65535,65535,65535,0,65535,65535,65535
.long 0,65535,65535,65535,0,65535,65535,65535
.long 0,65535,65535,65535,0,65535,65535,65535
.long 0,65535,65535,65535,0,65535,65535,65535
.long 0,65535,65535,65535,0,65535,65535,65535
.long 0,65535,65535,65535,0,65535,65535,65535
.long 0,65535,65535,65535,0,65535,65535,65535
.long 33623815,65535,262374,65535,0,65535,65535,65535
.long 0,65535,65535,65535,0,65535,65535,65535
.long 0,65535,65535,65535,0,65535,65535,65535
.long 0,65535,65535,65535,0,65535,65535,65535
.long 0,65535,65535,65535,0,65535,65535,65535
.long 0,65535,65535,65535,0,65535,65535,65535
.long 0,65535,65535,65535,0,65535,65535,65535
.long 0,65535,65535,65535,0,65535,65535,65535
.long 50401031,65535,262375,65535,0,65535,65535,65535
.long 0,65535,65535,65535,0,65535,65535,65535
.long 0,65535,65535,65535,0,65535,65535,65535
.long 0,65535,65535,65535,0,65535,65535,65535
.long 0,65535,65535,65535,0,65535,65535,65535
.long 0,65535,65535,65535,0,65535,65535,65535
.long 0,65535,65535,65535,0,65535,65535,65535
.long 0,65535,65535,65535,0,65535,65535,65535
.long 33689351,65535,262374,65535,0,65535,65535,65535
.long 0,65535,65535,65535,0,65535,65535,65535
.long 0,65535,65535,65535,0,65535,65535,65535
.long 0,65535,65535,65535,0,65535,65535,65535
.long 0,65535,65535,65535,0,65535,65535,65535
.long 0,65535,65535,65535,0,65535,65535,65535
.long 0,65535,65535,65535,0,65535,65535,65535
.long 0,65535,65535,65535,0,65535,65535,65535
.long 50466567,65535,262375,65535,0,65535,65535,65535
.long 0,65535,65535,65535,0,65535,65535,65535
.long 0,65535,65535,65535,0,65535,65535,65535
.long 0,65535,65535,65535,0,65535,65535,65535
.long 0,65535,65535,65535,0,65535,65535,65535
.long 0,65535,65535,65535,0,65535,65535,65535
.long 0,65535,65535,65535,0,65535,65535,65535
.long 0,65535,65535,65535,0,65535,65535,65535
.long 33754887,65535,262374,65535,0,65535,65535,65535
.long 0,65535,65535,65535,0,65535,65535,65535
.long 0,65535,65535,65535,0,65535,65535,65535
.long 0,65535,65535,65535,0,65535,65535,65535
.long 0,65535,65535,65535,0,65535,65535,65535
.long 0,65535,65535,65535,0,65535,65535,65535
.long 0,65535,65535,65535,0,65535,65535,65535
.long 0,65535,65535,65535,0,65535,65535,65535
.long 50532103,65535,262375,65535,0,65535,65535,65535
.long 0,65535,65535,65535,0,65535,65535,65535
.long 0,65535,65535,65535,0,65535,65535,65535
.long 0,65535,65535,65535,0,65535,65535,65535
.long 0,65535,65535,65535,0,65535,65535,65535
.long 0,65535,65535,65535,0,65535,65535,65535
.long 0,65535,65535,65535,0,65535,65535,65535
.long 0,65535,65535,65535,0,65535,65535,65535
.long 33820423,65535,262374,65535,0,65535,65535,65535
.long 0,65535,65535,65535,0,65535,65535,65535
.long 0,65535,65535,65535,0,65535,65535,65535
.long 0,65535,65535,65535,0,65535,65535,65535
.long 0,65535,65535,65535,0,65535,65535,65535
.long 0,65535,65535,65535,0,65535,65535,65535
.long 0,65535,65535,65535,0,65535,65535,65535
.long 0,65535,65535,65535,0,65535,65535,65535
.long 50597639,65535,262375,65535,0,65535,65535,65535
.long 0,65535,65535,65535,0,65535,65535,65535
.long 0,65535,65535,65535,0,65535,65535,65535
.long 0,65535,65535,65535,0,65535,65535,65535
.long 0,65535,65535,65535,0,65535,65535,65535
.long 0,65535,65535,65535,0,65535,65535,65535
.long 0,65535,65535,65535,0,65535,65535,65535
.long 0,65535,65535,65535,0,65535,65535,65535
.long 33885959,65535,262374,65535,0,65535,65535,65535
.long 0,65535,65535,65535,0,65535,65535,65535
.long 0,65535,65535,65535,0,65535,65535,65535
.long 0,65535,65535,65535,0,65535,65535,65535
.long 0,65535,65535,65535,0,65535,65535,65535
.long 0,65535,65535,65535,0,65535,65535,65535
.long 0,65535,65535,65535,0,65535,65535,65535
.long 0,65535,65535,65535,0,65535,65535,65535
.long 50663175,65535,262375,65535,0,65535,65535,65535
.long 0,65535,65535,65535,0,65535,65535,65535
.long 0,65535,65535,65535,0,65535,65535,65535
.long 0,65535,65535,65535,0,65535,65535,65535
.long 0,65535,65535,65535,0,65535,65535,65535
.long 0,65535,65535,65535,0,65535,65535,65535
.long 0,65535,65535,65535,0,65535,65535,65535
.long 0,65535,65535,65535,0,65535,65535,65535
.long 33951495,65535,262374,65535,0,65535,65535,65535
.long 0,65535,65535,65535,0,65535,65535,65535
.long 0,65535,65535,65535,0,65535,65535,65535
.long 0,65535,65535,65535,0,65535,65535,65535
.long 0,65535,65535,65535,0,65535,65535,65535
.long 0,65535,65535,65535,0,65535,65535,65535
.long 0,65535,65535,65535,0,65535,65535,65535
.long 0,65535,65535,65535,0,65535,65535,65535
.long 50728711,65535,262375,65535,0,65535,65535,65535
.long 0,65535,65535,65535,0,65535,65535,65535
.long 0,65535,65535,65535,0,65535,65535,65535
.long 0,65535,65535,65535,0,65535,65535,65535
.long 0,65535,65535,65535,0,65535,65535,65535
.long 0,65535,65535,65535,0,65535,65535,65535
.long 0,65535,65535,65535,0,65535,65535,65535
.long 0,65535,65535,65535,0,65535,65535,65535
.long 34017031,65535,262374,65535,0,65535,65535,65535
.long 0,65535,65535,65535,0,65535,65535,65535
.long 0,65535,65535,65535,0,65535,65535,65535
.long 0,65535,65535,65535,0,65535,65535,65535
.long 0,65535,65535,65535,0,65535,65535,65535
.long 0,65535,65535,65535,0,65535,65535,65535
.long 0,65535,65535,65535,0,65535,65535,65535
.long 0,65535,65535,65535,0,65535,65535,65535
.long 50794247,65535,262375,65535,0,65535,65535,65535
.long 0,65535,65535,65535,0,65535,65535,65535
.long 0,65535,65535,65535,0,65535,65535,65535
.long 0,65535,65535,65535,0,65535,65535,65535
.long 0,65535,65535,65535,0,65535,65535,65535
.long 0,65535,65535,65535,0,65535,65535,65535
.long 0,65535,65535,65535,0,65535,65535,65535
.long 0,65535,65535,65535,0,65535,65535,65535
.long 285216263,65535,524509,65535,0,65535,65535,65535
.long 0,65535,65535,65535,0,65535,65535,65535
.long 0,65535,65535,65535,0,65535,65535,65535
.long 0,65535,65535,65535,0,65535,65535,65535
.long 0,65535,65535,65535,0,65535,65535,65535
.long 0,65535,65535,65535,0,65535,65535,65535
.long 0,65535,65535,65535,0,65535,65535,65535
.long 0,65535,65535,65535,0,65535,65535,65535
.long 285281799,65535,524509,65535,0,65535,65535,65535
.long 0,65535,65535,65535,0,65535,65535,65535
.long 0,65535,65535,65535,0,65535,65535,65535
.long 0,65535,65535,65535,0,65535,65535,65535
.long 0,65535,65535,65535,0,65535,65535,65535
.long 0,65535,65535,65535,0,65535,65535,65535
.long 0,65535,65535,65535,0,65535,65535,65535
.long 0,65535,65535,65535,0,65535,65535,65535
.long 285347335,65535,524509,65535,0,65535,65535,65535
.long 0,65535,65535,65535,0,65535,65535,65535
.long 0,65535,65535,65535,0,65535,65535,65535
.long 0,65535,65535,65535,0,65535,65535,65535
.long 0,65535,65535,65535,0,65535,65535,65535
.long 0,65535,65535,65535,0,65535,65535,65535
.long 0,65535,65535,65535,0,65535,65535,65535
.long 0,65535,65535,65535,0,65535,65535,65535
.long 285412871,65535,524509,65535,0,65535,65535,65535
.long 0,65535,65535,65535,0,65535,65535,65535
.long 0,65535,65535,65535,0,65535,65535,65535
.long 0,65535,65535,65535,0,65535,65535,65535
.long 0,65535,65535,65535,0,65535,65535,65535
.long 0,65535,65535,65535,0,65535,65535,65535
.long 0,65535,65535,65535,0,65535,65535,65535
.long 0,65535,65535,65535,0,65535,65535,65535
.long 285478407,65535,524509,65535,0,65535,65535,65535
.long 0,65535,65535,65535,0,65535,65535,65535
.long 0,65535,65535,65535,0,65535,65535,65535
.long 0,65535,65535,65535,0,65535,65535,65535
.long 0,65535,65535,65535,0,65535,65535,65535
.long 0,65535,65535,65535,0,65535,65535,65535
.long 0,65535,65535,65535,0,65535,65535,65535
.long 0,65535,65535,65535,0,65535,65535,65535
.long 285543943,65535,524509,65535,0,65535,65535,65535
.long 0,65535,65535,65535,0,65535,65535,65535
.long 0,65535,65535,65535,0,65535,65535,65535
.long 0,65535,65535,65535,0,65535,65535,65535
.long 0,65535,65535,65535,0,65535,65535,65535
.long 0,65535,65535,65535,0,65535,65535,65535
.long 0,65535,65535,65535,0,65535,65535,65535
.long 0,65535,65535,65535,0,65535,65535,65535
.long 285609479,65535,524509,65535,0,65535,65535,65535
.long 0,65535,65535,65535,0,65535,65535,65535
.long 0,65535,65535,65535,0,65535,65535,65535
.long 0,65535,65535,65535,0,65535,65535,65535
.long 0,65535,65535,65535,0,65535,65535,65535
.long 0,65535,65535,65535,0,65535,65535,65535
.long 0,65535,65535,65535,0,65535,65535,65535
.long 0,65535,65535,65535,0,65535,65535,65535
.long 285675015,65535,524509,65535,0,65535,65535,65535
.long 0,65535,65535,65535,0,65535,65535,65535
.long 0,65535,65535,65535,0,65535,65535,65535
.long 0,65535,65535,65535,0,65535,65535,65535
.long 0,65535,65535,65535,0,65535,65535,65535
.long 0,65535,65535,65535,0,65535,65535,65535
.long 0,65535,65535,65535,0,65535,65535,65535
.long 0,65535,65535,65535,0,65535,65535,65535
.long 0,65535,65535,65535,0,65535,65535,65535
.long 0,65535,65535,65535,0,65535,65535,65535
.long 0,65535,65535,65535,0,65535,65535,65535
.long 0,65535,65535,65535,0,65535,65535,65535
.long 0,65535,65535,65535,0,65535,65535,65535
.long 0,65535,65535,65535,0,65535,65535,65535
.long 0,65535,65535,65535,0,65535,65535,65535
.long 0,65535,65535,65535,0,65535,65535,65535
.long 0,65535,65535,65535,0,65535,65535,65535
.long 0,65535,65535,65535,0,65535,65535,65535
.long 0,65535,65535,65535,0,65535,65535,65535
.long 0,65535,65535,65535,0,65535,65535,65535
.long 0,65535,65535,65535,0,65535,65535,65535
.long 0,65535,65535,65535,0,65535,65535,65535
.long 0,65535,65535,65535,0,65535,65535,65535
.long 0,65535,65535,65535,0,65535,65535,65535
.long 0,65535,65535,65535,0,65535,65535,65535
.long 0,65535,65535,65535,0,65535,65535,65535
.long 0,65535,65535,65535,0,65535,65535,65535
.long 0,65535,65535,65535,0,65535,65535,65535
.long 0,65535,65535,65535,0,65535,65535,65535
.long 0,65535,65535,65535,0,65535,65535,65535
.long 0,65535,65535,65535,0,65535,65535,65535
.long 0,65535,65535,65535,0,65535,65535,65535
.long 0,65535,65535,65535,0,65535,65535,65535
.long 0,65535,65535,65535,0,65535,65535,65535
.long 0,65535,65535,65535,0,65535,65535,65535
.long 0,65535,65535,65535,0,65535,65535,65535
.long 0,65535,65535,65535,0,65535,65535,65535
.long 0,65535,65535,65535,0,65535,65535,65535
.long 0,65535,65535,65535,0,65535,65535,65535
.long 0,65535,65535,65535,0,65535,65535,65535
.long 0,65535,65535,65535,0,65535,65535,65535
.long 0,65535,65535,65535,0,65535,65535,65535
.long 0,65535,65535,65535,0,65535,65535,65535
.long 0,65535,65535,65535,0,65535,65535,65535
.long 0,65535,65535,65535,0,65535,65535,65535
.long 0,65535,65535,65535,0,65535,65535,65535
.long 0,65535,65535,65535,0,65535,65535,65535
.long 0,65535,65535,65535,0,65535,65535,65535
.long 0,65535,65535,65535,0,65535,65535,65535
.long 0,65535,65535,65535,0,65535,65535,65535
.long 0,65535,65535,65535,0,65535,65535,65535
.long 0,65535,65535,65535,0,65535,65535,65535
.long 0,65535,65535,65535,0,65535,65535,65535
.long 0,65535,65535,65535,0,65535,65535,65535
.long 0,65535,65535,65535,0,65535,65535,65535
.long 0,65535,65535,65535,0,65535,65535,65535
.long 0,65535,65535,65535,0,65535,65535,65535
.long 0,65535,65535,65535,0,65535,65535,65535
.long 0,65535,65535,65535,0,65535,65535,65535
.long 0,65535,65535,65535,0,65535,65535,65535
.long 0,65535,65535,65535,0,65535,65535,65535
.long 0,65535,65535,65535,0,65535,65535,65535
.long 0,65535,65535,65535,0,65535,65535,65535
.long 0,65535,65535,65535,0,65535,65535,65535
.long 0,65535,65535,65535,0,65535,65535,65535
.long 0,65535,65535,65535,0,65535,65535,65535
.long 0,65535,65535,65535,0,65535,65535,65535
.long 0,65535,65535,65535,0,65535,65535,65535
.long 0,65535,65535,65535,0,65535,65535,65535
.long 0,65535,65535,65535,0,65535,65535,65535
.long 0,65535,65535,65535,0,65535,65535,65535
.long 0,65535,65535,65535,0,65535,65535,65535
.long 67112711,65535,262376,65535,0,65535,65535,65535
.long 0,65535,65535,65535,0,65535,65535,65535
.long 0,65535,65535,65535,0,65535,65535,65535
.long 0,65535,65535,65535,0,65535,65535,65535
.long 0,65535,65535,65535,0,65535,65535,65535
.long 0,65535,65535,65535,0,65535,65535,65535
.long 0,65535,65535,65535,0,65535,65535,65535
.long 0,65535,65535,65535,0,65535,65535,65535
.long 83889927,65535,262377,65535,0,65535,65535,65535
.long 0,65535,65535,65535,0,65535,65535,65535
.long 0,65535,65535,65535,0,65535,65535,65535
.long 0,65535,65535,65535,0,65535,65535,65535
.long 0,65535,65535,65535,0,65535,65535,65535
.long 0,65535,65535,65535,0,65535,65535,65535
.long 0,65535,65535,65535,0,65535,65535,65535
.long 0,65535,65535,65535,0,65535,65535,65535
.long 67178247,65535,262376,65535,0,65535,65535,65535
.long 0,65535,65535,65535,0,65535,65535,65535
.long 0,65535,65535,65535,0,65535,65535,65535
.long 0,65535,65535,65535,0,65535,65535,65535
.long 0,65535,65535,65535,0,65535,65535,65535
.long 0,65535,65535,65535,0,65535,65535,65535
.long 0,65535,65535,65535,0,65535,65535,65535
.long 0,65535,65535,65535,0,65535,65535,65535
.long 83955463,65535,262377,65535,0,65535,65535,65535
.long 0,65535,65535,65535,0,65535,65535,65535
.long 0,65535,65535,65535,0,65535,65535,65535
.long 0,65535,65535,65535,0,65535,65535,65535
.long 0,65535,65535,65535,0,65535,65535,65535
.long 0,65535,65535,65535,0,65535,65535,65535
.long 0,65535,65535,65535,0,65535,65535,65535
.long 0,65535,65535,65535,0,65535,65535,65535
.long 67243783,65535,262376,65535,0,65535,65535,65535
.long 0,65535,65535,65535,0,65535,65535,65535
.long 0,65535,65535,65535,0,65535,65535,65535
.long 0,65535,65535,65535,0,65535,65535,65535
.long 0,65535,65535,65535,0,65535,65535,65535
.long 0,65535,65535,65535,0,65535,65535,65535
.long 0,65535,65535,65535,0,65535,65535,65535
.long 0,65535,65535,65535,0,65535,65535,65535
.long 84020999,65535,262377,65535,0,65535,65535,65535
.long 0,65535,65535,65535,0,65535,65535,65535
.long 0,65535,65535,65535,0,65535,65535,65535
.long 0,65535,65535,65535,0,65535,65535,65535
.long 0,65535,65535,65535,0,65535,65535,65535
.long 0,65535,65535,65535,0,65535,65535,65535
.long 0,65535,65535,65535,0,65535,65535,65535
.long 0,65535,65535,65535,0,65535,65535,65535
.long 67309319,65535,262376,65535,0,65535,65535,65535
.long 0,65535,65535,65535,0,65535,65535,65535
.long 0,65535,65535,65535,0,65535,65535,65535
.long 0,65535,65535,65535,0,65535,65535,65535
.long 0,65535,65535,65535,0,65535,65535,65535
.long 0,65535,65535,65535,0,65535,65535,65535
.long 0,65535,65535,65535,0,65535,65535,65535
.long 0,65535,65535,65535,0,65535,65535,65535
.long 84086535,65535,262377,65535,0,65535,65535,65535
.long 0,65535,65535,65535,0,65535,65535,65535
.long 0,65535,65535,65535,0,65535,65535,65535
.long 0,65535,65535,65535,0,65535,65535,65535
.long 0,65535,65535,65535,0,65535,65535,65535
.long 0,65535,65535,65535,0,65535,65535,65535
.long 0,65535,65535,65535,0,65535,65535,65535
.long 0,65535,65535,65535,0,65535,65535,65535
.long 67374855,65535,262376,65535,0,65535,65535,65535
.long 0,65535,65535,65535,0,65535,65535,65535
.long 0,65535,65535,65535,0,65535,65535,65535
.long 0,65535,65535,65535,0,65535,65535,65535
.long 0,65535,65535,65535,0,65535,65535,65535
.long 0,65535,65535,65535,0,65535,65535,65535
.long 0,65535,65535,65535,0,65535,65535,65535
.long 0,65535,65535,65535,0,65535,65535,65535
.long 84152071,65535,262377,65535,0,65535,65535,65535
.long 0,65535,65535,65535,0,65535,65535,65535
.long 0,65535,65535,65535,0,65535,65535,65535
.long 0,65535,65535,65535,0,65535,65535,65535
.long 0,65535,65535,65535,0,65535,65535,65535
.long 0,65535,65535,65535,0,65535,65535,65535
.long 0,65535,65535,65535,0,65535,65535,65535
.long 0,65535,65535,65535,0,65535,65535,65535
.long 67440391,65535,262376,65535,0,65535,65535,65535
.long 0,65535,65535,65535,0,65535,65535,65535
.long 0,65535,65535,65535,0,65535,65535,65535
.long 0,65535,65535,65535,0,65535,65535,65535
.long 0,65535,65535,65535,0,65535,65535,65535
.long 0,65535,65535,65535,0,65535,65535,65535
.long 0,65535,65535,65535,0,65535,65535,65535
.long 0,65535,65535,65535,0,65535,65535,65535
.long 84217607,65535,262377,65535,0,65535,65535,65535
.long 0,65535,65535,65535,0,65535,65535,65535
.long 0,65535,65535,65535,0,65535,65535,65535
.long 0,65535,65535,65535,0,65535,65535,65535
.long 0,65535,65535,65535,0,65535,65535,65535
.long 0,65535,65535,65535,0,65535,65535,65535
.long 0,65535,65535,65535,0,65535,65535,65535
.long 0,65535,65535,65535,0,65535,65535,65535
.long 67505927,65535,262376,65535,0,65535,65535,65535
.long 0,65535,65535,65535,0,65535,65535,65535
.long 0,65535,65535,65535,0,65535,65535,65535
.long 0,65535,65535,65535,0,65535,65535,65535
.long 0,65535,65535,65535,0,65535,65535,65535
.long 0,65535,65535,65535,0,65535,65535,65535
.long 0,65535,65535,65535,0,65535,65535,65535
.long 0,65535,65535,65535,0,65535,65535,65535
.long 84283143,65535,262377,65535,0,65535,65535,65535
.long 0,65535,65535,65535,0,65535,65535,65535
.long 0,65535,65535,65535,0,65535,65535,65535
.long 0,65535,65535,65535,0,65535,65535,65535
.long 0,65535,65535,65535,0,65535,65535,65535
.long 0,65535,65535,65535,0,65535,65535,65535
.long 0,65535,65535,65535,0,65535,65535,65535
.long 0,65535,65535,65535,0,65535,65535,65535
.long 67571463,65535,262376,65535,0,65535,65535,65535
.long 0,65535,65535,65535,0,65535,65535,65535
.long 0,65535,65535,65535,0,65535,65535,65535
.long 0,65535,65535,65535,0,65535,65535,65535
.long 0,65535,65535,65535,0,65535,65535,65535
.long 0,65535,65535,65535,0,65535,65535,65535
.long 0,65535,65535,65535,0,65535,65535,65535
.long 0,65535,65535,65535,0,65535,65535,65535
.long 84348679,65535,262377,65535,0,65535,65535,65535
.long 0,65535,65535,65535,0,65535,65535,65535
.long 0,65535,65535,65535,0,65535,65535,65535
.long 0,65535,65535,65535,0,65535,65535,65535
.long 0,65535,65535,65535,0,65535,65535,65535
.long 0,65535,65535,65535,0,65535,65535,65535
.long 0,65535,65535,65535,0,65535,65535,65535
.long 0,65535,65535,65535,0,65535,65535,65535
.long 301993479,65535,524510,65535,0,65535,65535,65535
.long 0,65535,65535,65535,0,65535,65535,65535
.long 0,65535,65535,65535,0,65535,65535,65535
.long 0,65535,65535,65535,0,65535,65535,65535
.long 0,65535,65535,65535,0,65535,65535,65535
.long 0,65535,65535,65535,0,65535,65535,65535
.long 0,65535,65535,65535,0,65535,65535,65535
.long 0,65535,65535,65535,0,65535,65535,65535
.long 302059015,65535,524510,65535,0,65535,65535,65535
.long 0,65535,65535,65535,0,65535,65535,65535
.long 0,65535,65535,65535,0,65535,65535,65535
.long 0,65535,65535,65535,0,65535,65535,65535
.long 0,65535,65535,65535,0,65535,65535,65535
.long 0,65535,65535,65535,0,65535,65535,65535
.long 0,65535,65535,65535,0,65535,65535,65535
.long 0,65535,65535,65535,0,65535,65535,65535
.long 302124551,65535,524510,65535,0,65535,65535,65535
.long 0,65535,65535,65535,0,65535,65535,65535
.long 0,65535,65535,65535,0,65535,65535,65535
.long 0,65535,65535,65535,0,65535,65535,65535
.long 0,65535,65535,65535,0,65535,65535,65535
.long 0,65535,65535,65535,0,65535,65535,65535
.long 0,65535,65535,65535,0,65535,65535,65535
.long 0,65535,65535,65535,0,65535,65535,65535
.long 302190087,65535,524510,65535,0,65535,65535,65535
.long 0,65535,65535,65535,0,65535,65535,65535
.long 0,65535,65535,65535,0,65535,65535,65535
.long 0,65535,65535,65535,0,65535,65535,65535
.long 0,65535,65535,65535,0,65535,65535,65535
.long 0,65535,65535,65535,0,65535,65535,65535
.long 0,65535,65535,65535,0,65535,65535,65535
.long 0,65535,65535,65535,0,65535,65535,65535
.long 302255623,65535,524510,65535,0,65535,65535,65535
.long 0,65535,65535,65535,0,65535,65535,65535
.long 0,65535,65535,65535,0,65535,65535,65535
.long 0,65535,65535,65535,0,65535,65535,65535
.long 0,65535,65535,65535,0,65535,65535,65535
.long 0,65535,65535,65535,0,65535,65535,65535
.long 0,65535,65535,65535,0,65535,65535,65535
.long 0,65535,65535,65535,0,65535,65535,65535
.long 302321159,65535,524510,65535,0,65535,65535,65535
.long 0,65535,65535,65535,0,65535,65535,65535
.long 0,65535,65535,65535,0,65535,65535,65535
.long 0,65535,65535,65535,0,65535,65535,65535
.long 0,65535,65535,65535,0,65535,65535,65535
.long 0,65535,65535,65535,0,65535,65535,65535
.long 0,65535,65535,65535,0,65535,65535,65535
.long 0,65535,65535,65535,0,65535,65535,65535
.long 302386695,65535,524510,65535,0,65535,65535,65535
.long 0,65535,65535,65535,0,65535,65535,65535
.long 0,65535,65535,65535,0,65535,65535,65535
.long 0,65535,65535,65535,0,65535,65535,65535
.long 0,65535,65535,65535,0,65535,65535,65535
.long 0,65535,65535,65535,0,65535,65535,65535
.long 0,65535,65535,65535,0,65535,65535,65535
.long 0,65535,65535,65535,0,65535,65535,65535
.long 302452231,65535,524510,65535,0,65535,65535,65535
.long 0,65535,65535,65535,0,65535,65535,65535
.long 0,65535,65535,65535,0,65535,65535,65535
.long 0,65535,65535,65535,0,65535,65535,65535
.long 0,65535,65535,65535,0,65535,65535,65535
.long 0,65535,65535,65535,0,65535,65535,65535
.long 0,65535,65535,65535,0,65535,65535,65535
.long 0,65535,65535,65535,0,65535,65535,65535
.long 0,65535,65535,65535,0,65535,65535,65535
.long 0,65535,65535,65535,0,65535,65535,65535
.long 0,65535,65535,65535,0,65535,65535,65535
.long 0,65535,65535,65535,0,65535,65535,65535
.long 0,65535,65535,65535,0,65535,65535,65535
.long 0,65535,65535,65535,0,65535,65535,65535
.long 0,65535,65535,65535,0,65535,65535,65535
.long 0,65535,65535,65535,0,65535,65535,65535
.long 0,65535,65535,65535,0,65535,65535,65535
.long 0,65535,65535,65535,0,65535,65535,65535
.long 0,65535,65535,65535,0,65535,65535,65535
.long 0,65535,65535,65535,0,65535,65535,65535
.long 0,65535,65535,65535,0,65535,65535,65535
.long 0,65535,65535,65535,0,65535,65535,65535
.long 0,65535,65535,65535,0,65535,65535,65535
.long 0,65535,65535,65535,0,65535,65535,65535
.long 0,65535,65535,65535,0,65535,65535,65535
.long 0,65535,65535,65535,0,65535,65535,65535
.long 0,65535,65535,65535,0,65535,65535,65535
.long 0,65535,65535,65535,0,65535,65535,65535
.long 0,65535,65535,65535,0,65535,65535,65535
.long 0,65535,65535,65535,0,65535,65535,65535
.long 0,65535,65535,65535,0,65535,65535,65535
.long 0,65535,65535,65535,0,65535,65535,65535
.long 0,65535,65535,65535,0,65535,65535,65535
.long 0,65535,65535,65535,0,65535,65535,65535
.long 0,65535,65535,65535,0,65535,65535,65535
.long 0,65535,65535,65535,0,65535,65535,65535
.long 0,65535,65535,65535,0,65535,65535,65535
.long 0,65535,65535,65535,0,65535,65535,65535
.long 0,65535,65535,65535,0,65535,65535,65535
.long 0,65535,65535,65535,0,65535,65535,65535
.long 0,65535,65535,65535,0,65535,65535,65535
.long 0,65535,65535,65535,0,65535,65535,65535
.long 0,65535,65535,65535,0,65535,65535,65535
.long 0,65535,65535,65535,0,65535,65535,65535
.long 0,65535,65535,65535,0,65535,65535,65535
.long 0,65535,65535,65535,0,65535,65535,65535
.long 0,65535,65535,65535,0,65535,65535,65535
.long 0,65535,65535,65535,0,65535,65535,65535
.long 0,65535,65535,65535,0,65535,65535,65535
.long 0,65535,65535,65535,0,65535,65535,65535
.long 0,65535,65535,65535,0,65535,65535,65535
.long 0,65535,65535,65535,0,65535,65535,65535
.long 0,65535,65535,65535,0,65535,65535,65535
.long 0,65535,65535,65535,0,65535,65535,65535
.long 0,65535,65535,65535,0,65535,65535,65535
.long 0,65535,65535,65535,0,65535,65535,65535
.long 0,65535,65535,65535,0,65535,65535,65535
.long 0,65535,65535,65535,0,65535,65535,65535
.long 0,65535,65535,65535,0,65535,65535,65535
.long 0,65535,65535,65535,0,65535,65535,65535
.long 0,65535,65535,65535,0,65535,65535,65535
.long 0,65535,65535,65535,0,65535,65535,65535
.long 0,65535,65535,65535,0,65535,65535,65535
.long 0,65535,65535,65535,0,65535,65535,65535
.long 0,65535,65535,65535,0,65535,65535,65535
.long 0,65535,65535,65535,0,65535,65535,65535
.long 0,65535,65535,65535,0,65535,65535,65535
.long 0,65535,65535,65535,0,65535,65535,65535
.long 0,65535,65535,65535,0,65535,65535,65535
.long 0,65535,65535,65535,0,65535,65535,65535
.long 0,65535,65535,65535,0,65535,65535,65535
.long 0,65535,65535,65535,0,65535,65535,65535
.long 0x6000f07,65535,262378,65535,0,65535,65535,65535
.long 0,65535,65535,65535,0,65535,65535,65535
.long 0,65535,65535,65535,0,65535,65535,65535
.long 0,65535,65535,65535,0,65535,65535,65535
.long 0,65535,65535,65535,0,65535,65535,65535
.long 0,65535,65535,65535,0,65535,65535,65535
.long 0,65535,65535,65535,0,65535,65535,65535
.long 0,65535,65535,65535,0,65535,65535,65535
.long 0x7000f07,65535,262379,65535,0,65535,65535,65535
.long 0,65535,65535,65535,0,65535,65535,65535
.long 0,65535,65535,65535,0,65535,65535,65535
.long 0,65535,65535,65535,0,65535,65535,65535
.long 0,65535,65535,65535,0,65535,65535,65535
.long 0,65535,65535,65535,0,65535,65535,65535
.long 0,65535,65535,65535,0,65535,65535,65535
.long 0,65535,65535,65535,0,65535,65535,65535
.long 0x6010f07,65535,262378,65535,0,65535,65535,65535
.long 0,65535,65535,65535,0,65535,65535,65535
.long 0,65535,65535,65535,0,65535,65535,65535
.long 0,65535,65535,65535,0,65535,65535,65535
.long 0,65535,65535,65535,0,65535,65535,65535
.long 0,65535,65535,65535,0,65535,65535,65535
.long 0,65535,65535,65535,0,65535,65535,65535
.long 0,65535,65535,65535,0,65535,65535,65535
.long 0x7010f07,65535,262379,65535,0,65535,65535,65535
.long 0,65535,65535,65535,0,65535,65535,65535
.long 0,65535,65535,65535,0,65535,65535,65535
.long 0,65535,65535,65535,0,65535,65535,65535
.long 0,65535,65535,65535,0,65535,65535,65535
.long 0,65535,65535,65535,0,65535,65535,65535
.long 0,65535,65535,65535,0,65535,65535,65535
.long 0,65535,65535,65535,0,65535,65535,65535
.long 0x6020f07,65535,262378,65535,0,65535,65535,65535
.long 0,65535,65535,65535,0,65535,65535,65535
.long 0,65535,65535,65535,0,65535,65535,65535
.long 0,65535,65535,65535,0,65535,65535,65535
.long 0,65535,65535,65535,0,65535,65535,65535
.long 0,65535,65535,65535,0,65535,65535,65535
.long 0,65535,65535,65535,0,65535,65535,65535
.long 0,65535,65535,65535,0,65535,65535,65535
.long 0x7020f07,65535,262379,65535,0,65535,65535,65535
.long 0,65535,65535,65535,0,65535,65535,65535
.long 0,65535,65535,65535,0,65535,65535,65535
.long 0,65535,65535,65535,0,65535,65535,65535
.long 0,65535,65535,65535,0,65535,65535,65535
.long 0,65535,65535,65535,0,65535,65535,65535
.long 0,65535,65535,65535,0,65535,65535,65535
.long 0,65535,65535,65535,0,65535,65535,65535
.long 0x6030f07,65535,262378,65535,0,65535,65535,65535
.long 0,65535,65535,65535,0,65535,65535,65535
.long 0,65535,65535,65535,0,65535,65535,65535
.long 0,65535,65535,65535,0,65535,65535,65535
.long 0,65535,65535,65535,0,65535,65535,65535
.long 0,65535,65535,65535,0,65535,65535,65535
.long 0,65535,65535,65535,0,65535,65535,65535
.long 0,65535,65535,65535,0,65535,65535,65535
.long 0x7030f07,65535,262379,65535,0,65535,65535,65535
.long 0,65535,65535,65535,0,65535,65535,65535
.long 0,65535,65535,65535,0,65535,65535,65535
.long 0,65535,65535,65535,0,65535,65535,65535
.long 0,65535,65535,65535,0,65535,65535,65535
.long 0,65535,65535,65535,0,65535,65535,65535
.long 0,65535,65535,65535,0,65535,65535,65535
.long 0,65535,65535,65535,0,65535,65535,65535
.long 0x6040f07,65535,262378,65535,0,65535,65535,65535
.long 0,65535,65535,65535,0,65535,65535,65535
.long 0,65535,65535,65535,0,65535,65535,65535
.long 0,65535,65535,65535,0,65535,65535,65535
.long 0,65535,65535,65535,0,65535,65535,65535
.long 0,65535,65535,65535,0,65535,65535,65535
.long 0,65535,65535,65535,0,65535,65535,65535
.long 0,65535,65535,65535,0,65535,65535,65535
.long 0x7040f07,65535,262379,65535,0,65535,65535,65535
.long 0,65535,65535,65535,0,65535,65535,65535
.long 0,65535,65535,65535,0,65535,65535,65535
.long 0,65535,65535,65535,0,65535,65535,65535
.long 0,65535,65535,65535,0,65535,65535,65535
.long 0,65535,65535,65535,0,65535,65535,65535
.long 0,65535,65535,65535,0,65535,65535,65535
.long 0,65535,65535,65535,0,65535,65535,65535
.long 0x6050f07,65535,262378,65535,0,65535,65535,65535
.long 0,65535,65535,65535,0,65535,65535,65535
.long 0,65535,65535,65535,0,65535,65535,65535
.long 0,65535,65535,65535,0,65535,65535,65535
.long 0,65535,65535,65535,0,65535,65535,65535
.long 0,65535,65535,65535,0,65535,65535,65535
.long 0,65535,65535,65535,0,65535,65535,65535
.long 0,65535,65535,65535,0,65535,65535,65535
.long 0x7050f07,65535,262379,65535,0,65535,65535,65535
.long 0,65535,65535,65535,0,65535,65535,65535
.long 0,65535,65535,65535,0,65535,65535,65535
.long 0,65535,65535,65535,0,65535,65535,65535
.long 0,65535,65535,65535,0,65535,65535,65535
.long 0,65535,65535,65535,0,65535,65535,65535
.long 0,65535,65535,65535,0,65535,65535,65535
.long 0,65535,65535,65535,0,65535,65535,65535
.long 0x6060f07,65535,262378,65535,0,65535,65535,65535
.long 0,65535,65535,65535,0,65535,65535,65535
.long 0,65535,65535,65535,0,65535,65535,65535
.long 0,65535,65535,65535,0,65535,65535,65535
.long 0,65535,65535,65535,0,65535,65535,65535
.long 0,65535,65535,65535,0,65535,65535,65535
.long 0,65535,65535,65535,0,65535,65535,65535
.long 0,65535,65535,65535,0,65535,65535,65535
.long 0x7060f07,65535,262379,65535,0,65535,65535,65535
.long 0,65535,65535,65535,0,65535,65535,65535
.long 0,65535,65535,65535,0,65535,65535,65535
.long 0,65535,65535,65535,0,65535,65535,65535
.long 0,65535,65535,65535,0,65535,65535,65535
.long 0,65535,65535,65535,0,65535,65535,65535
.long 0,65535,65535,65535,0,65535,65535,65535
.long 0,65535,65535,65535,0,65535,65535,65535
.long 0x6070f07,65535,262378,65535,0,65535,65535,65535
.long 0,65535,65535,65535,0,65535,65535,65535
.long 0,65535,65535,65535,0,65535,65535,65535
.long 0,65535,65535,65535,0,65535,65535,65535
.long 0,65535,65535,65535,0,65535,65535,65535
.long 0,65535,65535,65535,0,65535,65535,65535
.long 0,65535,65535,65535,0,65535,65535,65535
.long 0,65535,65535,65535,0,65535,65535,65535
.long 0x7070f07,65535,262379,65535,0,65535,65535,65535
.long 0,65535,65535,65535,0,65535,65535,65535
.long 0,65535,65535,65535,0,65535,65535,65535
.long 0,65535,65535,65535,0,65535,65535,65535
.long 0,65535,65535,65535,0,65535,65535,65535
.long 0,65535,65535,65535,0,65535,65535,65535
.long 0,65535,65535,65535,0,65535,65535,65535
.long 0,65535,65535,65535,0,65535,65535,65535
.long 318770695,65535,524511,65535,0,65535,65535,65535
.long 0,65535,65535,65535,0,65535,65535,65535
.long 0,65535,65535,65535,0,65535,65535,65535
.long 0,65535,65535,65535,0,65535,65535,65535
.long 0,65535,65535,65535,0,65535,65535,65535
.long 0,65535,65535,65535,0,65535,65535,65535
.long 0,65535,65535,65535,0,65535,65535,65535
.long 0,65535,65535,65535,0,65535,65535,65535
.long 318836231,65535,524511,65535,0,65535,65535,65535
.long 0,65535,65535,65535,0,65535,65535,65535
.long 0,65535,65535,65535,0,65535,65535,65535
.long 0,65535,65535,65535,0,65535,65535,65535
.long 0,65535,65535,65535,0,65535,65535,65535
.long 0,65535,65535,65535,0,65535,65535,65535
.long 0,65535,65535,65535,0,65535,65535,65535
.long 0,65535,65535,65535,0,65535,65535,65535
.long 318901767,65535,524511,65535,0,65535,65535,65535
.long 0,65535,65535,65535,0,65535,65535,65535
.long 0,65535,65535,65535,0,65535,65535,65535
.long 0,65535,65535,65535,0,65535,65535,65535
.long 0,65535,65535,65535,0,65535,65535,65535
.long 0,65535,65535,65535,0,65535,65535,65535
.long 0,65535,65535,65535,0,65535,65535,65535
.long 0,65535,65535,65535,0,65535,65535,65535
.long 318967303,65535,524511,65535,0,65535,65535,65535
.long 0,65535,65535,65535,0,65535,65535,65535
.long 0,65535,65535,65535,0,65535,65535,65535
.long 0,65535,65535,65535,0,65535,65535,65535
.long 0,65535,65535,65535,0,65535,65535,65535
.long 0,65535,65535,65535,0,65535,65535,65535
.long 0,65535,65535,65535,0,65535,65535,65535
.long 0,65535,65535,65535,0,65535,65535,65535
.long 319032839,65535,524511,65535,0,65535,65535,65535
.long 0,65535,65535,65535,0,65535,65535,65535
.long 0,65535,65535,65535,0,65535,65535,65535
.long 0,65535,65535,65535,0,65535,65535,65535
.long 0,65535,65535,65535,0,65535,65535,65535
.long 0,65535,65535,65535,0,65535,65535,65535
.long 0,65535,65535,65535,0,65535,65535,65535
.long 0,65535,65535,65535,0,65535,65535,65535
.long 319098375,65535,524511,65535,0,65535,65535,65535
.long 0,65535,65535,65535,0,65535,65535,65535
.long 0,65535,65535,65535,0,65535,65535,65535
.long 0,65535,65535,65535,0,65535,65535,65535
.long 0,65535,65535,65535,0,65535,65535,65535
.long 0,65535,65535,65535,0,65535,65535,65535
.long 0,65535,65535,65535,0,65535,65535,65535
.long 0,65535,65535,65535,0,65535,65535,65535
.long 319163911,65535,524511,65535,0,65535,65535,65535
.long 0,65535,65535,65535,0,65535,65535,65535
.long 0,65535,65535,65535,0,65535,65535,65535
.long 0,65535,65535,65535,0,65535,65535,65535
.long 0,65535,65535,65535,0,65535,65535,65535
.long 0,65535,65535,65535,0,65535,65535,65535
.long 0,65535,65535,65535,0,65535,65535,65535
.long 0,65535,65535,65535,0,65535,65535,65535
.long 319229447,65535,524511,65535,0,65535,65535,65535
.long 0,65535,65535,65535,0,65535,65535,65535
.long 0,65535,65535,65535,0,65535,65535,65535
.long 0,65535,65535,65535,0,65535,65535,65535
.long 0,65535,65535,65535,0,65535,65535,65535
.long 0,65535,65535,65535,0,65535,65535,65535
.long 0,65535,65535,65535,0,65535,65535,65535
.long 0,65535,65535,65535,0,65535,65535,65535
.long 0,65535,65535,65535,0,65535,65535,65535
.long 0,65535,65535,65535,0,65535,65535,65535
.long 0,65535,65535,65535,0,65535,65535,65535
.long 0,65535,65535,65535,0,65535,65535,65535
.long 0,65535,65535,65535,0,65535,65535,65535
.long 0,65535,65535,65535,0,65535,65535,65535
.long 0,65535,65535,65535,0,65535,65535,65535
.long 0,65535,65535,65535,0,65535,65535,65535
.long 0,65535,65535,65535,0,65535,65535,65535
.long 0,65535,65535,65535,0,65535,65535,65535
.long 0,65535,65535,65535,0,65535,65535,65535
.long 0,65535,65535,65535,0,65535,65535,65535
.long 0,65535,65535,65535,0,65535,65535,65535
.long 0,65535,65535,65535,0,65535,65535,65535
.long 0,65535,65535,65535,0,65535,65535,65535
.long 0,65535,65535,65535,0,65535,65535,65535
.long 0,65535,65535,65535,0,65535,65535,65535
.long 0,65535,65535,65535,0,65535,65535,65535
.long 0,65535,65535,65535,0,65535,65535,65535
.long 0,65535,65535,65535,0,65535,65535,65535
.long 0,65535,65535,65535,0,65535,65535,65535
.long 0,65535,65535,65535,0,65535,65535,65535
.long 0,65535,65535,65535,0,65535,65535,65535
.long 0,65535,65535,65535,0,65535,65535,65535
.long 0,65535,65535,65535,0,65535,65535,65535
.long 0,65535,65535,65535,0,65535,65535,65535
.long 0,65535,65535,65535,0,65535,65535,65535
.long 0,65535,65535,65535,0,65535,65535,65535
.long 0,65535,65535,65535,0,65535,65535,65535
.long 0,65535,65535,65535,0,65535,65535,65535
.long 0,65535,65535,65535,0,65535,65535,65535
.long 0,65535,65535,65535,0,65535,65535,65535
.long 0,65535,65535,65535,0,65535,65535,65535
.long 0,65535,65535,65535,0,65535,65535,65535
.long 0,65535,65535,65535,0,65535,65535,65535
.long 0,65535,65535,65535,0,65535,65535,65535
.long 0,65535,65535,65535,0,65535,65535,65535
.long 0,65535,65535,65535,0,65535,65535,65535
.long 0,65535,65535,65535,0,65535,65535,65535
.long 0,65535,65535,65535,0,65535,65535,65535
.long 0,65535,65535,65535,0,65535,65535,65535
.long 0,65535,65535,65535,0,65535,65535,65535
.long 0,65535,65535,65535,0,65535,65535,65535
.long 0,65535,65535,65535,0,65535,65535,65535
.long 0,65535,65535,65535,0,65535,65535,65535
.long 0,65535,65535,65535,0,65535,65535,65535
.long 0,65535,65535,65535,0,65535,65535,65535
.long 0,65535,65535,65535,0,65535,65535,65535
.long 0,65535,65535,65535,0,65535,65535,65535
.long 0,65535,65535,65535,0,65535,65535,65535
.long 0,65535,65535,65535,0,65535,65535,65535
.long 0,65535,65535,65535,0,65535,65535,65535
.long 0,65535,65535,65535,0,65535,65535,65535
.long 0,65535,65535,65535,0,65535,65535,65535
.long 0,65535,65535,65535,0,65535,65535,65535
.long 0,65535,65535,65535,0,65535,65535,65535
.long 0,65535,65535,65535,0,65535,65535,65535
.long 0,65535,65535,65535,0,65535,65535,65535
.long 0,65535,65535,65535,0,65535,65535,65535
.long 0,65535,65535,65535,0,65535,65535,65535
.long 0,65535,65535,65535,0,65535,65535,65535
.long 0,65535,65535,65535,0,65535,65535,65535
.long 0,65535,65535,65535,0,65535,65535,65535
.long 0,65535,65535,65535,0,65535,65535,65535
.size task_table, 65536
.section .rodata,"a"
.p2align 6
.amdhsa_kernel concat_heads__softmax_full_mha__memory_aug_recurrent_mem_tr__prompt_kernel
.amdhsa_next_free_vgpr 512
.amdhsa_next_free_sgpr 102
.amdhsa_accum_offset 256
.amdhsa_group_segment_fixed_size 0
.amdhsa_kernarg_size 104
.amdhsa_user_sgpr_count 2
.amdhsa_user_sgpr_kernarg_segment_ptr 1
.amdhsa_system_sgpr_workgroup_id_x 1
.amdhsa_float_denorm_mode_32 3
.end_amdhsa_kernel
```
